```python
import torch

def _softmax(x, axis=-1):
    return torch.softmax(x, dim=axis)

def _gelu(x):
    return torch.nn.functional.gelu(x, approximate='tanh')

def _silu(x):
    return torch.nn.functional.silu(x)

def _sigmoid(x):
    return torch.sigmoid(x)

def _layernorm(x, axis=-1, eps=1e-05):
    m = x.mean(dim=axis, keepdim=True)
    v = x.var(dim=axis, keepdim=True, unbiased=False)
    return (x - m) / torch.sqrt(v + eps)

def _scatter_add(tgt, idx, src, axis=0):
    return tgt.clone().index_add_(axis, idx, src)

def _segment_sum(src, seg, n):
    out = torch.zeros((n,) + src.shape[1:], dtype=src.dtype)
    return out.index_add_(0, seg, src)

def _pad(x, pw):
    flat = tuple((v for pair in reversed(pw) for v in pair))
    return torch.nn.functional.pad(x, flat)
kernel_name = 'adaLN_cond__sliding_block_cached__geglu_ffn__prompt'

def setup_inputs():

    _w = lambda a: (lambda t: t.to(torch.bfloat16) if t.is_floating_point() else t)(torch.as_tensor(a))

    def _A_setup():
        B, Sq, D = (1, 2048, 640)
        Hq, Hkv, Sk, Dh = (32, 32, 2048, 192)
        assert Hq % Hkv == 0, (Hq, Hkv)
        return {'x': _w((lambda *s: torch.randn(*s, dtype=torch.bfloat16) * 0.05)(B, Sq, D)), 'k_cache': _w((lambda *s: torch.randn(*s, dtype=torch.bfloat16) * 3.2)(B, Hkv, Sk, Dh)), 'v_cache': _w((lambda *s: torch.randn(*s, dtype=torch.bfloat16) * 0.4)(B, Hkv, Sk, Dh)), 'wq': _w((lambda *s: torch.randn(*s, dtype=torch.bfloat16) * 3.2)(D, Hq * Dh) * D ** (-0.5)), 'wo': _w((lambda *s: torch.randn(*s, dtype=torch.bfloat16) * 0.4)(Hq * Dh, D) * (Hq * Dh) ** (-0.5))}
    _A_in = _A_setup()

    def _B_setup():
        B, S, D, F = (1, 2048, 640, 1536)
        return {'x': _w((lambda *s: torch.randn(*s, dtype=torch.bfloat16) * 0.05)(B, S, D)), 'w_gate': _w((lambda *s: torch.randn(*s, dtype=torch.bfloat16) * 0.05)(D, F)), 'w_up': _w((lambda *s: torch.randn(*s, dtype=torch.bfloat16) * 0.05)(D, F)), 'w_down': _w((lambda *s: torch.randn(*s, dtype=torch.bfloat16) * 0.05)(F, D))}
    _B_in = _B_setup()
    return {'A_x': _A_in['x'], 'A_k_cache': _A_in['k_cache'], 'A_v_cache': _A_in['v_cache'], 'A_wq': _A_in['wq'], 'A_wo': _A_in['wo'], 'B_x': _B_in['x'], 'B_w_gate': _B_in['w_gate'], 'B_w_up': _B_in['w_up'], 'B_w_down': _B_in['w_down'], 'c': _w((lambda *s: torch.randn(*s, dtype=torch.bfloat16) * 0.1)(1, 640) * 8.0), 'w_mod': _w((lambda *s: torch.randn(*s, dtype=torch.bfloat16) * 0.1)(640, 6 * 640) * 640 ** (-0.5) * 8.0)}

def reference(A_x, A_k_cache, A_v_cache, A_wq, A_wo, B_x, B_w_gate, B_w_up, B_w_down, c, w_mod):

    def _A_ref(x, k_cache, v_cache, wq, wo):
        B, Sq, D = x.shape
        Hq, Dh = (32, 192)
        Hkv, Sk = (k_cache.shape[1], k_cache.shape[2])
        W = min(4096, max(256, Sk // 4))
        rep = Hq // Hkv
        q = (lambda x, *d: x.permute(*d))((x @ wq).reshape(B, Sq, Hq, Dh), 0, 2, 1, 3)
        k = (lambda x, n, axis: torch.repeat_interleave(x, n, dim=axis))(k_cache[:, :, Sk - W:, :], rep, axis=1)
        v = (lambda x, n, axis: torch.repeat_interleave(x, n, dim=axis))(v_cache[:, :, Sk - W:, :], rep, axis=1)
        scores = torch.einsum('bhqd,bhkd->bhqk', q, k) * Dh ** (-0.5)
        p = _softmax(scores, axis=-1)
        o = torch.einsum('bhqk,bhkd->bhqd', p, v)
        return (lambda x, *d: x.permute(*d))(o, 0, 2, 1, 3).reshape(B, Sq, Hq * Dh) @ wo

    def _B_ref(x, w_gate, w_up, w_down):
        return _gelu(x @ w_gate) * (x @ w_up) @ w_down
    x = A_x
    mod = (_silu(c) @ w_mod).reshape(c.shape[0], 6, 1, -1)
    sa, ca, ga, sb, cb, gb = (mod[:, 0].clone(), mod[:, 1].clone(), mod[:, 2].clone(), mod[:, 3].clone(), mod[:, 4].clone(), mod[:, 5].clone())
    h = _layernorm(x, axis=-1) * (1 + ca) + sa
    x = x + ga * _A_ref(h, A_k_cache, A_v_cache, A_wq, A_wo)
    h = _layernorm(x, axis=-1) * (1 + cb) + sb
    x = x + gb * _B_ref(h, B_w_gate, B_w_up, B_w_down)
    return x
```

```asm
; @launch kernel=main_kernel grid=(256,1,1) block=(256,1,1) lds=163840
.amdgcn_target "amdgcn-amd-amdhsa--gfx950"
.text
.globl main_kernel
.p2align 12
.p2align 8
.type main_kernel,@function
main_kernel:
s_cmp_ge_u32 s2, 256
s_cbranch_scc1 L_main_end
s_load_dwordx4 s[48:51], s[0:1], 72
s_load_dwordx2 s[56:57], s[0:1], 0
s_load_dwordx2 s[46:47], s[0:1], 104
s_load_dwordx4 s[40:43], s[0:1], 8
s_load_dwordx2 s[44:45], s[0:1], 24
s_load_dwordx2 s[76:77], s[0:1], 32
s_load_dwordx4 s[84:87], s[0:1], 48
s_load_dwordx2 s[88:89], s[0:1], 64
s_load_dwordx2 s[58:59], s[0:1], 88
s_lshr_b32 s6, s2, 3
s_mul_i32 s6, s6, 3328
s_getpc_b64 s[80:81]
L_code_0:
s_add_u32 s80, s80, s6
s_addc_u32 s81, s81, 0
s_sub_i32 s82, L_code_end-L_code_0, s6
s_max_i32 s82, s82, 0
s_min_i32 s82, s82, 3328
s_mov_b32 s83, 0x20000
v_lshlrev_b32 v107, 7, v0
buffer_load_dword v15, v107, s[80:83], 0 offen
v_lshrrev_b32 v1, 6, v0
v_and_b32 v2, 63, v0
v_readfirstlane_b32 s36, v1
s_and_b32 s3, s2, 7
s_lshl_b32 s3, s3, 2
s_lshr_b32 s4, s2, 3
s_and_b32 s4, s4, 3
s_add_u32 s3, s3, s4
s_lshr_b32 s4, s2, 5
v_lshlrev_b32 v238, 4, v2
s_mul_i32 s28, s36, 3072
s_lshl_b32 s29, s36, 10
s_lshl_b32 s5, s4, 3
s_lshl_b32 s6, s36, 1
s_add_u32 s5, s5, s6
s_mov_b32 s35, 0
s_and_b32 s6, s2, 7
s_lshr_b32 s7, s2, 5
s_lshl_b32 s7, s7, 3
s_add_u32 s7, s7, s6
s_lshr_b32 s6, s2, 3
s_and_b32 s6, s6, 3
s_lshl_b32 s7, s7, 2
s_add_u32 s39, s7, s6
s_and_b32 s37, s39, 1
s_mul_i32 s37, s37, 320
v_lshrrev_b32 v3, 2, v0
v_and_b32 v11, 3, v0
v_add_u32 v3, s37, v3
v_mul_u32_u24 v12, 7680, v3
v_lshl_add_u32 v12, v11, 4, v12
v_lshlrev_b32 v13, 1, v3
s_andn2_b32 s37, s39, 1
s_lshl_b32 s37, s37, 5
v_and_b32 v3, 7, v2
v_lshrrev_b32 v4, 3, v2
v_mul_u32_u24 v5, 20, v1
v_add_u32 v6, v5, v4
v_mul_u32_u24 v91, 1280, v3
v_lshl_add_u32 v90, v6, 4, v91
v_and_b32 v6, 3, v4
v_add3_u32 v6, v5, v6, 16
v_lshrrev_b32 v7, 2, v4
v_lshl_add_u32 v6, v6, 1, v7
v_lshl_add_u32 v91, v6, 3, v91
s_waitcnt lgkmcnt(0)
s_mov_b32 s16, s48
s_mov_b32 s17, s49
s_mov_b32 s18, 1280
s_mov_b32 s19, 0x20000
buffer_load_ushort v36, v13, s[16:19], 0 offen offset:0
buffer_load_ushort v37, v13, s[16:19], 0 offen offset:128
buffer_load_ushort v38, v13, s[16:19], 0 offen offset:256
buffer_load_ushort v39, v13, s[16:19], 0 offen offset:384
buffer_load_ushort v40, v13, s[16:19], 0 offen offset:512
s_mov_b32 s12, s50
s_mov_b32 s13, s51
s_mov_b32 s14, 4915200
s_mov_b32 s15, 0x20000
s_cmp_ge_u32 s39, 240
s_cselect_b32 s14, 0, s14
buffer_load_dwordx4 v[16:19], v12, s[12:15], s37 offen nt
s_add_u32 s37, s37, 491520
buffer_load_dwordx4 v[20:23], v12, s[12:15], s37 offen nt
s_add_u32 s37, s37, 491520
buffer_load_dwordx4 v[24:27], v12, s[12:15], s37 offen nt
s_add_u32 s37, s37, 491520
buffer_load_dwordx4 v[28:31], v12, s[12:15], s37 offen nt
s_add_u32 s37, s37, 491520
buffer_load_dwordx4 v[32:35], v12, s[12:15], s37 offen nt
s_mov_b32 s24, s46
s_mov_b32 s25, s47
s_mov_b32 s26, 69206016
s_mov_b32 s27, 0x20000
s_mov_b32 s7, 3862528
buffer_load_dword v14, off, s[24:27], s7 sc1
s_mov_b32 s52, s56
s_mov_b32 s53, s57
s_mov_b32 s54, 2621440
s_mov_b32 s55, 0x20000
s_mul_i32 s6, s2, 10240
buffer_load_dwordx4 v[60:63], v90, s[52:55], s6 offen nt
buffer_load_dwordx4 v[64:67], v90, s[52:55], s6 offen offset:128 nt
buffer_load_dwordx2 v[68:69], v91, s[52:55], s6 offen nt
s_mov_b32 s48, s39
s_mul_i32 s6, s3, 384
s_sub_u32 s7, 7864320, s6
s_add_u32 s8, s44, s6
s_addc_u32 s9, s45, 0
s_mov_b32 s10, s7
s_mov_b32 s11, 0x20000
v_mul_u32_u24 v3, 43, v2
v_lshrrev_b32 v3, 7, v3
v_mul_u32_u24 v4, 11904, v3
v_lshl_add_u32 v4, v2, 7, v4
v_lshrrev_b32 v3, 4, v3
v_lshl_add_u32 v4, v3, 30, v4
s_sub_u32 s6, 3, s36
s_cmp_lt_u32 s6, 2
s_cselect_b32 s6, s6, 5
s_lshl_b32 s6, s6, 3
s_add_u32 s6, s6, s4
s_mul_i32 s6, s6, 196608
buffer_load_dword v111, v4, s[8:11], s6 offen nt
v_mul_u32_u24 v3, 192, v1
v_add_u32 v3, v3, v2
v_add_u32 v4, 0, v3
v_mul_u32_u24 v5, 2731, v4
v_lshrrev_b32 v5, 16, v5
v_mul_u32_u24 v6, 24, v5
v_sub_u32 v6, v4, v6
v_lshrrev_b32 v7, 1, v5
v_and_b32 v7, 4, v7
v_and_or_b32 v7, v5, 2, v7
v_xor_b32 v8, v7, v6
v_mul_u32_u24 v9, 12288, v5
v_lshl_add_u32 v9, v8, 4, v9
v_subrev_u32 v231, 0, v9
v_bfe_u32 v7, v5, 2, 1
v_xor_b32 v8, v8, v7
v_mul_u32_u24 v9, 384, v5
v_lshl_add_u32 v9, v8, 4, v9
v_subrev_u32 v234, 0, v9
v_add_u32 v4, 64, v3
v_mul_u32_u24 v5, 2731, v4
v_lshrrev_b32 v5, 16, v5
v_mul_u32_u24 v6, 24, v5
v_sub_u32 v6, v4, v6
v_lshrrev_b32 v7, 1, v5
v_and_b32 v7, 4, v7
v_and_or_b32 v7, v5, 2, v7
v_xor_b32 v8, v7, v6
v_mul_u32_u24 v9, 12288, v5
v_lshl_add_u32 v9, v8, 4, v9
v_subrev_u32 v232, 1024, v9
v_bfe_u32 v7, v5, 2, 1
v_xor_b32 v8, v8, v7
v_mul_u32_u24 v9, 384, v5
v_lshl_add_u32 v9, v8, 4, v9
v_subrev_u32 v235, 1024, v9
v_add_u32 v4, 128, v3
v_mul_u32_u24 v5, 2731, v4
v_lshrrev_b32 v5, 16, v5
v_mul_u32_u24 v6, 24, v5
v_sub_u32 v6, v4, v6
v_lshrrev_b32 v7, 1, v5
v_and_b32 v7, 4, v7
v_and_or_b32 v7, v5, 2, v7
v_xor_b32 v8, v7, v6
v_mul_u32_u24 v9, 12288, v5
v_lshl_add_u32 v9, v8, 4, v9
v_subrev_u32 v233, 2048, v9
v_bfe_u32 v7, v5, 2, 1
v_xor_b32 v8, v8, v7
v_mul_u32_u24 v9, 384, v5
v_lshl_add_u32 v9, v8, 4, v9
v_subrev_u32 v236, 2048, v9
s_mul_i32 s6, s5, 40960
s_add_u32 s6, s6, 65536
s_add_u32 s20, s46, s6
s_addc_u32 s21, s47, 0
s_mov_b32 s22, 81920
s_mov_b32 s23, 0x20000
v_and_b32 v6, 15, v2
v_lshrrev_b32 v4, 4, v2
v_mul_u32_u24 v5, 5120, v4
v_lshl_add_u32 v96, v6, 4, v5
v_lshrrev_b32 v3, 5, v2
v_mul_u32_u24 v5, 20480, v3
v_add_u32 v96, v96, v5
v_add_u32 v108, 30720, v238
v_and_b32 v3, 7, v2
s_mul_i32 s37, s36, 1280
s_add_u32 s6, s37, 103424
s_add_u32 s37, s37, 3801088
s_add_u32 s39, s37, 5120
s_lshr_b32 s7, s2, 5
s_lshl_b32 s7, s7, 2
s_add_u32 s7, s7, s36
s_lshl_b32 s7, s7, 12
s_add_u32 s7, s7, 3670016
v_lshl_add_u32 v101, v3, 9, s7
v_lshl_add_u32 v97, v2, 3, s6
v_and_b32 v4, 1, v4
v_mul_u32_u24 v5, 640, v4
v_lshl_add_u32 v5, v6, 3, v5
v_lshrrev_b32 v4, 5, v2
v_lshl_add_u32 v5, v4, 2, v5
v_add_u32 v98, s6, v5
v_and_b32 v3, 7, v2
v_lshrrev_b32 v4, 3, v2
v_lshl_add_u32 v99, v4, 5, s6
v_and_b32 v5, 3, v4
v_lshrrev_b32 v6, 2, v4
v_lshl_add_u32 v7, v5, 1, v6
v_lshl_add_u32 v100, v7, 4, s6
v_mul_u32_u24 v7, 20, v1
v_add_u32 v4, v7, v4
v_lshlrev_b32 v92, 9, v4
v_lshl_add_u32 v92, v3, 4, v92
v_add3_u32 v5, v7, v5, 16
v_lshlrev_b32 v5, 9, v5
v_lshl_add_u32 v5, v3, 4, v5
v_lshl_add_u32 v93, v6, 30, v5
v_lshlrev_b32 v95, 5, v3
v_add_u32 v95, 102912, v95
v_lshl_add_u32 v94, v1, 3, v95
v_min_u32 v3, 1, v2
v_lshlrev_b32 v103, 30, v3
v_lshrrev_b32 v4, 5, v2
v_bfe_u32 v5, v2, 4, 1
v_lshlrev_b32 v6, 5, v11
v_lshl_add_u32 v6, v4, 4, v6
v_lshl_add_u32 v6, v5, 3, v6
v_lshl_add_u32 v6, v1, 7, v6
v_add_u32 v105, 102400, v6
v_and_b32 v3, 31, v2
v_lshlrev_b32 v106, 2, v3
v_add_u32 v106, 102400, v106
s_mul_i32 s6, s48, 205
s_lshr_b32 s6, s6, 13
s_cmp_eq_u32 s6, 0
s_cselect_b32 s49, 0x3dd53b95, 1.0
s_bitcmp1_b32 18, s6
s_cselect_b32 s50, 1.0, 0
s_and_b32 s6, s48, 1
s_cselect_b32 s50, 0, s50
s_mul_i32 s6, s6, 30720
s_lshr_b32 s7, s48, 1
s_lshl_b32 s7, s7, 8
s_add_u32 s7, s7, 3801088
s_add_u32 s6, s6, s7
s_cmp_lt_u32 s48, 240
s_cselect_b32 s6, s6, 0x40000000
s_cselect_b32 s7, s7, 3801088
v_lshl_add_u32 v109, v2, 3, s6
v_lshl_add_u32 v109, v4, 30, v109
v_mul_u32_u24 v5, 30464, v4
v_lshl_add_u32 v5, v2, 3, v5
v_add_u32 v112, s7, v5
s_cselect_b32 s6, 0, 1
s_or_b32 s6, s6, s48
s_and_b32 s6, s6, 1
s_or_b32 s6, s6, s36
s_lshl_b32 s6, s6, 28
s_lshl_b32 s7, s48, 6
s_add_u32 s7, s7, s6
v_lshl_add_u32 v110, v2, 2, s7
v_lshl_add_u32 v110, v4, 30, v110
s_cmp_lg_u32 s36, 0
s_cselect_b32 s6, 0x40000000, 0
v_or_b32 v103, s6, v103
s_waitcnt vmcnt(14)
v_lshlrev_b32 v36, 16, v36
v_mul_f32 v41, 0xbfb8aa3b, v36
s_waitcnt vmcnt(13)
v_lshlrev_b32 v37, 16, v37
v_mul_f32 v42, 0xbfb8aa3b, v37
s_waitcnt vmcnt(12)
v_lshlrev_b32 v38, 16, v38
v_mul_f32 v43, 0xbfb8aa3b, v38
s_waitcnt vmcnt(11)
v_lshlrev_b32 v39, 16, v39
v_mul_f32 v44, 0xbfb8aa3b, v39
s_waitcnt vmcnt(10)
v_lshlrev_b32 v40, 16, v40
v_mul_f32 v45, 0xbfb8aa3b, v40
v_exp_f32 v41, v41
v_exp_f32 v42, v42
v_exp_f32 v43, v43
v_exp_f32 v44, v44
v_exp_f32 v45, v45
v_add_f32 v41, 1.0, v41
v_add_f32 v42, 1.0, v42
v_add_f32 v43, 1.0, v43
v_add_f32 v44, 1.0, v44
v_add_f32 v45, 1.0, v45
v_rcp_f32 v41, v41
v_rcp_f32 v42, v42
v_rcp_f32 v43, v43
v_rcp_f32 v44, v44
v_rcp_f32 v45, v45
v_mul_f32 v36, v36, v41
v_mul_f32 v37, v37, v42
v_mul_f32 v38, v38, v43
v_mul_f32 v39, v39, v44
v_mul_f32 v40, v40, v45
s_waitcnt vmcnt(9)
v_lshlrev_b32 v56, 16, v16
v_and_b32 v57, 0xffff0000, v16
v_mul_f32 v48, v56, v36
v_mul_f32 v49, v57, v36
v_lshlrev_b32 v58, 16, v17
v_and_b32 v59, 0xffff0000, v17
v_mul_f32 v50, v58, v36
v_mul_f32 v51, v59, v36
v_lshlrev_b32 v56, 16, v18
v_and_b32 v57, 0xffff0000, v18
v_mul_f32 v52, v56, v36
v_mul_f32 v53, v57, v36
v_lshlrev_b32 v58, 16, v19
v_and_b32 v59, 0xffff0000, v19
v_mul_f32 v54, v58, v36
v_mul_f32 v55, v59, v36
s_waitcnt vmcnt(8)
v_lshlrev_b32 v56, 16, v20
v_and_b32 v57, 0xffff0000, v20
v_fmac_f32 v48, v56, v37
v_fmac_f32 v49, v57, v37
v_lshlrev_b32 v58, 16, v21
v_and_b32 v59, 0xffff0000, v21
v_fmac_f32 v50, v58, v37
v_fmac_f32 v51, v59, v37
v_lshlrev_b32 v56, 16, v22
v_and_b32 v57, 0xffff0000, v22
v_fmac_f32 v52, v56, v37
v_fmac_f32 v53, v57, v37
v_lshlrev_b32 v58, 16, v23
v_and_b32 v59, 0xffff0000, v23
v_fmac_f32 v54, v58, v37
v_fmac_f32 v55, v59, v37
s_waitcnt vmcnt(7)
v_lshlrev_b32 v56, 16, v24
v_and_b32 v57, 0xffff0000, v24
v_fmac_f32 v48, v56, v38
v_fmac_f32 v49, v57, v38
v_lshlrev_b32 v58, 16, v25
v_and_b32 v59, 0xffff0000, v25
v_fmac_f32 v50, v58, v38
v_fmac_f32 v51, v59, v38
v_lshlrev_b32 v56, 16, v26
v_and_b32 v57, 0xffff0000, v26
v_fmac_f32 v52, v56, v38
v_fmac_f32 v53, v57, v38
v_lshlrev_b32 v58, 16, v27
v_and_b32 v59, 0xffff0000, v27
v_fmac_f32 v54, v58, v38
v_fmac_f32 v55, v59, v38
s_waitcnt vmcnt(6)
v_lshlrev_b32 v56, 16, v28
v_and_b32 v57, 0xffff0000, v28
v_fmac_f32 v48, v56, v39
v_fmac_f32 v49, v57, v39
v_lshlrev_b32 v58, 16, v29
v_and_b32 v59, 0xffff0000, v29
v_fmac_f32 v50, v58, v39
v_fmac_f32 v51, v59, v39
v_lshlrev_b32 v56, 16, v30
v_and_b32 v57, 0xffff0000, v30
v_fmac_f32 v52, v56, v39
v_fmac_f32 v53, v57, v39
v_lshlrev_b32 v58, 16, v31
v_and_b32 v59, 0xffff0000, v31
v_fmac_f32 v54, v58, v39
v_fmac_f32 v55, v59, v39
s_waitcnt vmcnt(5)
v_lshlrev_b32 v56, 16, v32
v_and_b32 v57, 0xffff0000, v32
v_fmac_f32 v48, v56, v40
v_fmac_f32 v49, v57, v40
v_lshlrev_b32 v58, 16, v33
v_and_b32 v59, 0xffff0000, v33
v_fmac_f32 v50, v58, v40
v_fmac_f32 v51, v59, v40
v_lshlrev_b32 v56, 16, v34
v_and_b32 v57, 0xffff0000, v34
v_fmac_f32 v52, v56, v40
v_fmac_f32 v53, v57, v40
v_lshlrev_b32 v58, 16, v35
v_and_b32 v59, 0xffff0000, v35
v_fmac_f32 v54, v58, v40
v_fmac_f32 v55, v59, v40
v_permlane32_swap_b32 v48, v52
v_permlane32_swap_b32 v49, v53
v_permlane32_swap_b32 v50, v54
v_permlane32_swap_b32 v51, v55
v_add_f32 v48, v48, v52
v_add_f32 v49, v49, v53
v_add_f32 v50, v50, v54
v_add_f32 v51, v51, v55
s_nop 0
v_permlane16_swap_b32 v48, v50
v_permlane16_swap_b32 v49, v51
v_add_f32 v48, v48, v50
v_add_f32 v49, v49, v51
s_nop 0
v_add_f32_dpp v48, v48, v48 row_ror:4 row_mask:0xf bank_mask:0xf
v_add_f32_dpp v49, v49, v49 row_ror:4 row_mask:0xf bank_mask:0xf
s_nop 0
v_add_f32_dpp v48, v48, v48 row_ror:8 row_mask:0xf bank_mask:0xf
v_add_f32_dpp v49, v49, v49 row_ror:8 row_mask:0xf bank_mask:0xf
ds_write_b64 v105, v[48:49]
s_waitcnt vmcnt(4)
v_readfirstlane_b32 s51, v14
s_nop 3
s_add_u32 s51, s51, 0x9e3779b8
s_waitcnt lgkmcnt(0)
s_barrier
s_cmp_lg_u32 s36, 0
s_cbranch_scc1 L_nopub
ds_read_b32 v48, v106 offset:0
ds_read_b32 v49, v106 offset:128
ds_read_b32 v50, v106 offset:256
ds_read_b32 v51, v106 offset:384
v_mov_b32 v52, s50
v_mov_b32 v53, s51
s_waitcnt lgkmcnt(0)
v_add_f32 v48, v48, v49
v_add_f32 v50, v50, v51
v_add_f32 v48, v48, v50
v_fmac_f32 v52, s49, v48
buffer_store_dwordx2 v[52:53], v109, s[24:27], 0 offen sc1
L_nopub:
s_waitcnt vmcnt(3)
v_mov_b32 v192, v60
v_mov_b32 v193, v61
v_mov_b32 v194, v62
v_mov_b32 v195, v63
s_waitcnt vmcnt(2)
v_mov_b32 v196, v64
v_mov_b32 v197, v65
v_mov_b32 v198, v66
v_mov_b32 v199, v67
s_waitcnt vmcnt(1)
v_mov_b32 v200, v68
v_mov_b32 v201, v69
v_lshlrev_b32 v202, 3, v2
v_lshlrev_b32 v70, 16, v60
v_and_b32 v71, 0xffff0000, v60
v_lshlrev_b32 v72, 16, v61
v_and_b32 v73, 0xffff0000, v61
v_lshlrev_b32 v74, 16, v62
v_and_b32 v75, 0xffff0000, v62
v_lshlrev_b32 v76, 16, v63
v_and_b32 v77, 0xffff0000, v63
v_lshlrev_b32 v78, 16, v64
v_and_b32 v79, 0xffff0000, v64
v_lshlrev_b32 v80, 16, v65
v_and_b32 v81, 0xffff0000, v65
v_lshlrev_b32 v82, 16, v66
v_and_b32 v83, 0xffff0000, v66
v_lshlrev_b32 v84, 16, v67
v_and_b32 v85, 0xffff0000, v67
v_lshlrev_b32 v86, 16, v68
v_and_b32 v87, 0xffff0000, v68
v_lshlrev_b32 v88, 16, v69
v_and_b32 v89, 0xffff0000, v69
v_pk_add_f32 v[120:121], v[70:71], v[72:73]
v_pk_add_f32 v[122:123], v[74:75], v[76:77]
v_pk_add_f32 v[120:121], v[120:121], v[78:79]
v_pk_add_f32 v[122:123], v[122:123], v[80:81]
v_pk_add_f32 v[120:121], v[120:121], v[82:83]
v_pk_add_f32 v[122:123], v[122:123], v[84:85]
v_pk_add_f32 v[120:121], v[120:121], v[86:87]
v_pk_add_f32 v[122:123], v[122:123], v[88:89]
v_pk_add_f32 v[120:121], v[120:121], v[122:123]
v_add_f32 v120, v120, v121
s_nop 1
v_add_f32_dpp v120, v120, v120 row_ror:8 row_mask:0xf bank_mask:0xf
v_mov_b32 v121, v120
s_nop 1
v_permlane16_swap_b32 v120, v121
v_add_f32 v120, v120, v121
v_mov_b32 v121, v120
s_nop 1
v_permlane32_swap_b32 v120, v121
v_add_f32 v120, v120, v121
v_mul_f32 v130, 0x3bcccccd, v120
v_mul_f32 v124, 0xbbcccccd, v120
v_mov_b32 v125, v124
v_pk_add_f32 v[70:71], v[70:71], v[124:125]
v_pk_add_f32 v[72:73], v[72:73], v[124:125]
v_pk_add_f32 v[74:75], v[74:75], v[124:125]
v_pk_add_f32 v[76:77], v[76:77], v[124:125]
v_pk_add_f32 v[78:79], v[78:79], v[124:125]
v_pk_add_f32 v[80:81], v[80:81], v[124:125]
v_pk_add_f32 v[82:83], v[82:83], v[124:125]
v_pk_add_f32 v[84:85], v[84:85], v[124:125]
v_pk_add_f32 v[86:87], v[86:87], v[124:125]
v_pk_add_f32 v[88:89], v[88:89], v[124:125]
v_pk_mul_f32 v[120:121], v[70:71], v[70:71]
v_pk_mul_f32 v[122:123], v[72:73], v[72:73]
v_pk_fma_f32 v[120:121], v[74:75], v[74:75], v[120:121]
v_pk_fma_f32 v[122:123], v[76:77], v[76:77], v[122:123]
v_pk_fma_f32 v[120:121], v[78:79], v[78:79], v[120:121]
v_pk_fma_f32 v[122:123], v[80:81], v[80:81], v[122:123]
v_pk_fma_f32 v[120:121], v[82:83], v[82:83], v[120:121]
v_pk_fma_f32 v[122:123], v[84:85], v[84:85], v[122:123]
v_pk_fma_f32 v[120:121], v[86:87], v[86:87], v[120:121]
v_pk_fma_f32 v[122:123], v[88:89], v[88:89], v[122:123]
v_pk_add_f32 v[120:121], v[120:121], v[122:123]
v_add_f32 v131, v120, v121
s_nop 1
v_add_f32_dpp v131, v131, v131 row_ror:8 row_mask:0xf bank_mask:0xf
v_mov_b32 v121, v131
s_nop 1
v_permlane16_swap_b32 v131, v121
v_add_f32 v131, v131, v121
v_mov_b32 v121, v131
s_nop 1
v_permlane32_swap_b32 v131, v121
v_add_f32 v131, v131, v121
ds_write_b64 v94, v[130:131] offset:0
s_waitcnt lgkmcnt(0)
s_barrier
ds_read_b128 v[132:135], v95 offset:0
ds_read_b128 v[136:139], v95 offset:16
s_waitcnt lgkmcnt(1)
v_add_f32 v120, v132, v134
s_waitcnt lgkmcnt(0)
v_add_f32 v121, v136, v138
v_add_f32 v120, v120, v121
v_mul_f32 v120, 0x3e800000, v120
v_sub_f32 v132, v132, v120
v_sub_f32 v134, v134, v120
v_sub_f32 v136, v136, v120
v_sub_f32 v138, v138, v120
v_mul_f32 v122, v132, v132
v_fmac_f32 v122, v134, v134
v_fmac_f32 v122, v136, v136
v_fmac_f32 v122, v138, v138
v_add_f32 v133, v133, v135
v_add_f32 v137, v137, v139
v_add_f32 v133, v133, v137
v_mov_b32 v126, 0x3a71d1e6
v_fmac_f32 v126, 0x3e13985d, v133
v_fmac_f32 v126, 0x41b87e74, v122
v_rsq_f32 v126, v126
v_sub_f32 v124, v130, v120
v_mul_f32 v124, v124, v126
v_mov_b32 v127, v126
v_mov_b32 v125, v124
v_pk_fma_f32 v[70:71], v[70:71], v[126:127], v[124:125]
v_pk_fma_f32 v[72:73], v[72:73], v[126:127], v[124:125]
v_pk_fma_f32 v[74:75], v[74:75], v[126:127], v[124:125]
v_pk_fma_f32 v[76:77], v[76:77], v[126:127], v[124:125]
v_pk_fma_f32 v[78:79], v[78:79], v[126:127], v[124:125]
v_pk_fma_f32 v[80:81], v[80:81], v[126:127], v[124:125]
v_pk_fma_f32 v[82:83], v[82:83], v[126:127], v[124:125]
v_pk_fma_f32 v[84:85], v[84:85], v[126:127], v[124:125]
v_pk_fma_f32 v[86:87], v[86:87], v[126:127], v[124:125]
v_pk_fma_f32 v[88:89], v[88:89], v[126:127], v[124:125]
s_lshr_b32 s6, s2, 2
s_mul_i32 s6, s6, 40960
s_and_b32 s7, s2, 3
s_lshl_b32 s7, s7, 7
s_add_u32 s6, s6, s7
s_add_u32 s48, s6, 65536
s_add_u32 s49, s48, 4096
s_lshl_b32 s6, s2, 2
s_add_u32 s6, s6, s36
s_lshl_b32 s6, s6, 7
s_add_u32 s50, s6, 3670016
v_mov_b32 v104, s51
s_mov_b32 s38, 0x40000
L_fpoll:
buffer_load_dwordx4 v[160:163], v238, s[24:27], s37 offen sc1
buffer_load_dwordx4 v[164:167], v238, s[24:27], s39 offen sc1
buffer_load_dwordx4 v[168:171], v108, s[24:27], s37 offen sc1
buffer_load_dwordx4 v[172:175], v108, s[24:27], s39 offen sc1
buffer_load_dwordx4 v[176:179], v96, s[24:27], s37 offen offset:1024 sc1
s_waitcnt vmcnt(0)
v_bitop3_b32 v161, v161, v163, s51 bitop3:0x7e
v_bitop3_b32 v165, v165, v167, s51 bitop3:0x7e
v_bitop3_b32 v169, v169, v171, s51 bitop3:0x7e
v_bitop3_b32 v173, v173, v175, s51 bitop3:0x7e
v_bitop3_b32 v177, v177, v179, s51 bitop3:0x7e
v_or3_b32 v161, v161, v165, v169
v_or3_b32 v161, v161, v173, v177
v_cmp_ne_u32 vcc, 0, v161
v_add_f32 v160, v160, v168
v_add_f32 v162, v162, v170
v_permlane32_swap_b32 v176, v178
v_add_f32 v164, v164, v172
v_add_f32 v166, v166, v174
v_add_f32 v176, v176, v178
s_cbranch_vccz L_fgot
s_sleep 2
s_sub_u32 s38, s38, 1
s_cbranch_scc0 L_fpoll
L_fgot:
ds_write2_b32 v97, v160, v162 offset0:0 offset1:1
ds_write2_b32 v97, v164, v166 offset0:160 offset1:161
ds_write_b32 v98, v176 offset:512
ds_read_b128 v[120:123], v99 offset:640
ds_read_b128 v[140:143], v99 offset:0
ds_read_b128 v[124:127], v99 offset:656
ds_read_b128 v[144:147], v99 offset:16
ds_read_b128 v[128:131], v99 offset:896
ds_read_b128 v[148:151], v99 offset:256
ds_read_b128 v[132:135], v99 offset:912
ds_read_b128 v[152:155], v99 offset:272
ds_read_b128 v[136:139], v100 offset:1152
ds_read_b128 v[156:159], v100 offset:512
s_waitcnt lgkmcnt(8)
v_pk_fma_f32 v[70:71], v[70:71], v[120:121], v[140:141]
v_pk_fma_f32 v[72:73], v[72:73], v[122:123], v[142:143]
s_waitcnt lgkmcnt(6)
v_pk_fma_f32 v[74:75], v[74:75], v[124:125], v[144:145]
v_pk_fma_f32 v[76:77], v[76:77], v[126:127], v[146:147]
v_cvt_pk_bf16_f32 v60, v70, v71
v_cvt_pk_bf16_f32 v61, v72, v73
v_cvt_pk_bf16_f32 v62, v74, v75
v_cvt_pk_bf16_f32 v63, v76, v77
buffer_store_dwordx4 v[60:63], v92, s[24:27], s48 offen sc1
s_waitcnt lgkmcnt(4)
v_pk_fma_f32 v[78:79], v[78:79], v[128:129], v[148:149]
v_pk_fma_f32 v[80:81], v[80:81], v[130:131], v[150:151]
s_waitcnt lgkmcnt(2)
v_pk_fma_f32 v[82:83], v[82:83], v[132:133], v[152:153]
v_pk_fma_f32 v[84:85], v[84:85], v[134:135], v[154:155]
v_cvt_pk_bf16_f32 v64, v78, v79
v_cvt_pk_bf16_f32 v65, v80, v81
v_cvt_pk_bf16_f32 v66, v82, v83
v_cvt_pk_bf16_f32 v67, v84, v85
buffer_store_dwordx4 v[64:67], v92, s[24:27], s49 offen sc1
s_waitcnt lgkmcnt(0)
v_pk_fma_f32 v[86:87], v[86:87], v[136:137], v[156:157]
v_pk_fma_f32 v[88:89], v[88:89], v[138:139], v[158:159]
v_cvt_pk_bf16_f32 v68, v86, v87
v_cvt_pk_bf16_f32 v69, v88, v89
s_nop 0
v_permlane32_swap_b32 v68, v70
v_permlane32_swap_b32 v69, v71
buffer_store_dwordx4 v[68:71], v93, s[24:27], s48 offen sc1
s_mul_i32 s6, s3, 786432
s_add_u32 s6, s6, 589824
s_add_u32 s12, s40, s6
s_addc_u32 s13, s41, 0
s_mov_b32 s14, 196608
s_mov_b32 s15, 0x20000
s_add_u32 s16, s42, s6
s_addc_u32 s17, s43, 0
s_mov_b32 s18, 196608
s_mov_b32 s19, 0x20000
v_lshlrev_b32 v254, 7, v2
v_mul_u32_u24 v255, 384, v2
v_cmp_lt_u32 vcc, 15, v2
v_mov_b32 v3, 0x40000000
s_nop 0
v_cndmask_b32 v254, v254, v3, vcc
v_cndmask_b32 v255, v255, v3, vcc
s_lshl_b32 s90, s2, 2
s_add_u32 s90, s90, s36
s_mul_i32 s90, s90, 1920
s_lshl_b32 s91, s4, 2
s_add_u32 s91, s91, s36
s_mul_i32 s91, s91, 6144
s_mov_b32 s78, 7864320
s_mov_b32 s79, 0x20000
s_mov_b32 s82, 1966080
s_mov_b32 s83, 0x20000
s_lshr_b32 s92, s2, 3
s_lshl_b32 s92, s92, 2
s_add_u32 s92, s92, s36
s_mul_i32 s92, s92, 7680
s_and_b32 s6, s2, 7
s_mul_i32 s6, s6, 983040
s_add_u32 s92, s92, s6
v_lshrrev_b32 v3, 1, v2
v_lshl_add_u32 v255, v3, 7, v254
v_lshrrev_b32 v3, 4, v2
v_and_b32 v4, 1, v3
v_bfe_u32 v5, v2, 2, 2
v_and_b32 v6, 3, v2
v_lshrrev_b32 v7, 1, v5
v_lshl_add_u32 v8, v3, 3, v5
v_mul_u32_u24 v8, 384, v8
v_lshl_add_u32 v8, v6, 3, v8
v_add_u32 v8, 102400, v8
v_lshl_add_u32 v9, v4, 1, v7
v_xor_b32 v10, 0, v9
v_lshl_add_u32 v224, v10, 5, v8
v_xor_b32 v10, 1, v9
v_lshl_add_u32 v225, v10, 5, v8
v_xor_b32 v10, 2, v9
v_lshl_add_u32 v226, v10, 5, v8
v_xor_b32 v10, 3, v9
v_lshl_add_u32 v227, v10, 5, v8
v_lshl_add_u32 v8, v3, 2, v5
v_lshlrev_b32 v8, 7, v8
v_lshrrev_b32 v9, 1, v6
v_lshl_add_u32 v8, v9, 3, v8
v_lshl_add_u32 v9, v4, 2, v7
v_and_b32 v10, 1, v6
v_lshl_add_u32 v9, v10, 1, v9
v_lshl_add_u32 v230, v9, 4, v8
v_xor_b32 v223, 16, v230
v_and_b32 v8, 15, v2
v_lshlrev_b32 v9, 4, v8
v_lshl_add_u32 v243, v3, 9, v9
v_lshrrev_b32 v9, 1, v8
v_and_b32 v9, 4, v9
v_and_or_b32 v9, v8, 2, v9
v_and_b32 v10, 1, v5
v_or_b32 v9, v9, v10
v_lshrrev_b32 v10, 1, v3
v_lshl_add_u32 v10, v4, 1, v10
v_xor_b32 v9, v9, v10
v_mul_u32_u24 v8, 384, v8
v_add_u32 v8, 65536, v8
v_lshl_add_u32 v228, v9, 4, v8
v_xor_b32 v9, 4, v9
v_lshl_add_u32 v229, v9, 4, v8
v_lshrrev_b32 v8, 3, v2
v_mul_u32_u24 v8, 384, v8
v_and_b32 v9, 7, v2
v_and_b32 v10, 2, v3
v_lshl_add_u32 v10, v10, 1, v4
v_xor_b32 v9, v9, v10
v_lshl_add_u32 v8, v9, 4, v8
v_add_u32 v237, s28, v8
s_lshl_b32 s4, s4, 2
s_add_u32 s4, s4, s36
s_lshl_b32 s37, s4, 5
s_add_u32 s37, s37, s3
s_mul_i32 s33, s37, 24576
s_add_u32 s33, s33, 4194304
s_lshl_b32 s34, s37, 7
s_add_u32 s34, s34, 3538944
s_and_b32 s37, s37, -4
s_lshr_b32 s38, s3, 2
s_and_b32 s3, s3, 3
s_add_u32 s39, s3, 0
s_and_b32 s39, s39, 3
s_mul_i32 s40, s39, 245760
s_add_u32 s39, s3, 1
s_and_b32 s39, s39, 3
s_mul_i32 s41, s39, 245760
s_add_u32 s39, s39, s37
s_mul_i32 s44, s39, 24576
s_add_u32 s44, s44, 4194304
s_add_u32 s39, s3, 2
s_and_b32 s39, s39, 3
s_mul_i32 s42, s39, 245760
s_add_u32 s39, s39, s37
s_mul_i32 s45, s39, 24576
s_add_u32 s45, s45, 4194304
s_add_u32 s39, s3, 3
s_and_b32 s39, s39, 3
s_mul_i32 s43, s39, 245760
s_add_u32 s39, s39, s37
s_mul_i32 s46, s39, 24576
s_add_u32 s46, s46, 4194304
s_mul_i32 s47, s36, 5120
s_mul_i32 s5, s3, 320
s_lshl_b32 s6, s47, 2
s_add_u32 s5, s5, s6
s_sub_u32 s6, 983040, s5
s_mul_i32 s7, s38, 983040
s_add_u32 s5, s5, s7
s_add_u32 s52, s76, s5
s_addc_u32 s53, s77, 0
s_mov_b32 s54, s6
s_mov_b32 s55, 0x20000
s_mul_i32 s5, s4, 327680
s_mul_i32 s7, s3, 10240
s_add_u32 s5, s5, s7
s_mul_i32 s7, s38, 1280
s_add_u32 s5, s5, s7
s_add_u32 s5, s5, 33554432
s_lshl_b32 s6, s4, 2
s_add_u32 s6, s6, s3
s_lshl_b32 s6, s6, 3
s_add_u32 s6, s6, s38
s_lshl_b32 s6, s6, 7
s_add_u32 s6, s6, 3145728
s_lshr_b32 s7, s2, 3
s_lshl_b32 s7, s7, 2
s_bfe_u32 s4, s2, 0x10002
s_add_u32 s7, s7, s4
s_mul_i32 s7, s7, 20480
s_and_b32 s4, s2, 3
s_lshl_b32 s4, s4, 8
s_add_u32 s7, s7, s4
s_lshl_b32 s4, s37, 7
s_add_u32 s4, s4, 3538944
s_add_u32 s3, s3, 1
s_waitcnt vmcnt(0)
s_barrier
buffer_store_dword v104, v103, s[24:27], s50 offen sc1
s_add_u32 m0, s28, 114688
s_mov_b32 s30, 0
buffer_load_dwordx4 v231, s[8:11], s30 offen offset:0 nt lds
buffer_load_dwordx4 v232, s[8:11], s30 offen offset:1024 nt lds
buffer_load_dwordx4 v233, s[8:11], s30 offen offset:2048 nt lds
s_add_u32 m0, s28, 126976
s_mov_b32 s30, 393216
buffer_load_dwordx4 v231, s[8:11], s30 offen offset:0 nt lds
buffer_load_dwordx4 v232, s[8:11], s30 offen offset:1024 nt lds
buffer_load_dwordx4 v233, s[8:11], s30 offen offset:2048 nt lds
s_add_u32 m0, s28, 139264
s_mov_b32 s30, 786432
buffer_load_dwordx4 v231, s[8:11], s30 offen offset:0 nt lds
buffer_load_dwordx4 v232, s[8:11], s30 offen offset:1024 nt lds
buffer_load_dwordx4 v233, s[8:11], s30 offen offset:2048 nt lds
s_mov_b64 exec, 0
s_cmp_eq_u32 s36, 0
s_cbranch_scc1 L_pg0
s_cmp_eq_u32 s36, 1
s_cbranch_scc1 L_pg1
s_cmp_eq_u32 s36, 2
s_cbranch_scc1 L_pg2
s_cmp_eq_u32 s36, 3
s_cbranch_scc1 L_pg3
L_ret_A:
s_mov_b64 exec, -1
s_mov_b32 s38, 0x40000
L_lpoll:
buffer_load_dwordx2 v[114:115], v112, s[24:27], 0 offen sc1
buffer_load_dword v102, v101, s[24:27], 0 offen sc1
s_waitcnt vmcnt(0)
v_bitop3_b32 v102, v102, v115, s51 bitop3:0x7e
v_cmp_ne_u32 vcc, 0, v102
s_nop 4
s_cbranch_vccz L_lgot
s_sleep 2
s_sub_u32 s38, s38, 1
s_cbranch_scc0 L_lpoll
L_lgot:
s_mov_b32 s31, 0
s_mov_b32 s32, 40960
buffer_load_dwordx4 a[0:3], v243, s[20:23], s31 offen offset:0 sc1
buffer_load_dwordx4 a[4:7], v243, s[20:23], s31 offen offset:256 sc1
buffer_load_dwordx4 a[8:11], v243, s[20:23], s32 offen offset:0 sc1
buffer_load_dwordx4 a[12:15], v243, s[20:23], s32 offen offset:256 sc1
buffer_load_dwordx4 a[16:19], v243, s[20:23], s31 offen offset:2048 sc1
buffer_load_dwordx4 a[20:23], v243, s[20:23], s31 offen offset:2304 sc1
buffer_load_dwordx4 a[24:27], v243, s[20:23], s32 offen offset:2048 sc1
buffer_load_dwordx4 a[28:31], v243, s[20:23], s32 offen offset:2304 sc1
s_mov_b32 s31, 4096
s_mov_b32 s32, 45056
buffer_load_dwordx4 a[32:35], v243, s[20:23], s31 offen offset:0 sc1
buffer_load_dwordx4 a[36:39], v243, s[20:23], s31 offen offset:256 sc1
buffer_load_dwordx4 a[40:43], v243, s[20:23], s32 offen offset:0 sc1
buffer_load_dwordx4 a[44:47], v243, s[20:23], s32 offen offset:256 sc1
v_mov_b32 v115, v114
s_nop 1
v_permlane32_swap_b32 v114, v115
v_add_f32 v114, v114, v115
buffer_store_dword v114, v110, s[24:27], 0 offen sc1
v_min_u32 v3, 4, v2
v_lshlrev_b32 v3, 17, v3
s_sub_u32 s50, s50, 524288
buffer_load_dword v244, v3, s[24:27], s50 offen sc1
s_xor_b32 s48, s2, 1
s_lshl_b32 s48, s48, 2
s_add_u32 s48, s48, s36
s_mul_i32 s48, s48, 2560
s_branch L_body
.p2align 12
L_body:
L_pg0:
s_cbranch_execz L_pg4
s_barrier
ds_read_b64_tr_b16 a[224:225], v224 offset:12288
ds_read_b64_tr_b16 a[226:227], v224 offset:13824
ds_read_b64_tr_b16 a[228:229], v225 offset:12288
ds_read_b64_tr_b16 a[230:231], v225 offset:13824
ds_read_b64_tr_b16 a[232:233], v226 offset:12288
ds_read_b64_tr_b16 a[234:235], v226 offset:13824
ds_read_b64_tr_b16 a[236:237], v227 offset:12288
ds_read_b64_tr_b16 a[238:239], v227 offset:13824
s_waitcnt vmcnt(10) lgkmcnt(6)
v_mfma_f32_16x16x32_bf16 v[128:131], a[224:227], a[0:3], 0
ds_read_b64_tr_b16 a[240:241], v224 offset:12416
v_mfma_f32_16x16x32_bf16 v[136:139], a[224:227], a[4:7], 0
v_mfma_f32_16x16x32_bf16 v[144:147], a[224:227], a[8:11], 0
s_waitcnt lgkmcnt(5)
ds_read_b64_tr_b16 a[242:243], v224 offset:13952
v_mfma_f32_16x16x32_bf16 v[152:155], a[224:227], a[12:15], 0
buffer_load_dwordx4 a[48:51], v243, s[20:23], s31 offen offset:2048 sc1
v_mfma_f32_16x16x32_bf16 v[132:135], a[228:231], a[0:3], 0
s_add_u32 m0, s28, 151552
ds_read_b64_tr_b16 a[244:245], v225 offset:12416
v_mfma_f32_16x16x32_bf16 v[140:143], a[228:231], a[4:7], 0
buffer_load_dwordx4 a[52:55], v243, s[20:23], s31 offen offset:2304 sc1
v_mfma_f32_16x16x32_bf16 v[148:151], a[228:231], a[8:11], 0
s_waitcnt lgkmcnt(5)
ds_read_b64_tr_b16 a[246:247], v225 offset:13952
v_mfma_f32_16x16x32_bf16 v[156:159], a[228:231], a[12:15], 0
buffer_load_dwordx4 a[56:59], v243, s[20:23], s32 offen offset:2048 sc1
v_mfma_f32_16x16x32_bf16 v[160:163], a[232:235], a[0:3], 0
s_mov_b32 s30, 1179648
ds_read_b64_tr_b16 a[248:249], v226 offset:12416
v_mfma_f32_16x16x32_bf16 v[168:171], a[232:235], a[4:7], 0
buffer_load_dwordx4 a[60:63], v243, s[20:23], s32 offen offset:2304 sc1
v_mfma_f32_16x16x32_bf16 v[176:179], a[232:235], a[8:11], 0
s_waitcnt lgkmcnt(5)
ds_read_b64_tr_b16 a[250:251], v226 offset:13952
v_mfma_f32_16x16x32_bf16 v[184:187], a[232:235], a[12:15], 0
buffer_load_dwordx4 v231, s[8:11], s30 offen offset:0 nt lds
v_mfma_f32_16x16x32_bf16 v[164:167], a[236:239], a[0:3], 0
s_mov_b32 s31, 8192
ds_read_b64_tr_b16 a[252:253], v227 offset:12416
v_mfma_f32_16x16x32_bf16 v[172:175], a[236:239], a[4:7], 0
buffer_load_dwordx4 v232, s[8:11], s30 offen offset:1024 nt lds
v_mfma_f32_16x16x32_bf16 v[180:183], a[236:239], a[8:11], 0
s_waitcnt lgkmcnt(5)
ds_read_b64_tr_b16 a[254:255], v227 offset:13952
v_mfma_f32_16x16x32_bf16 v[188:191], a[236:239], a[12:15], 0
buffer_load_dwordx4 v233, s[8:11], s30 offen offset:2048 nt lds
v_mfma_f32_16x16x32_bf16 v[0:3], a[240:243], a[0:3], 0
s_add_u32 m0, s28, 65536
v_mfma_f32_16x16x32_bf16 v[8:11], a[240:243], a[4:7], 0
ds_read_b64_tr_b16 a[224:225], v224 offset:12544
v_mfma_f32_16x16x32_bf16 v[16:19], a[240:243], a[8:11], 0
s_waitcnt lgkmcnt(5)
v_mfma_f32_16x16x32_bf16 v[24:27], a[240:243], a[12:15], 0
ds_read_b64_tr_b16 a[226:227], v224 offset:14080
v_mfma_f32_16x16x32_bf16 v[4:7], a[244:247], a[0:3], 0
s_mov_b32 s30, 1572864
v_mfma_f32_16x16x32_bf16 v[12:15], a[244:247], a[4:7], 0
ds_read_b64_tr_b16 a[228:229], v225 offset:12544
v_mfma_f32_16x16x32_bf16 v[20:23], a[244:247], a[8:11], 0
s_waitcnt lgkmcnt(5)
ds_read_b64_tr_b16 a[230:231], v225 offset:14080
v_mfma_f32_16x16x32_bf16 v[28:31], a[244:247], a[12:15], 0
buffer_load_dwordx4 v231, s[8:11], s30 offen offset:0 nt lds
v_mfma_f32_16x16x32_bf16 v[32:35], a[248:251], a[0:3], 0
s_mov_b32 s32, 49152
ds_read_b64_tr_b16 a[232:233], v226 offset:12544
v_mfma_f32_16x16x32_bf16 v[40:43], a[248:251], a[4:7], 0
buffer_load_dwordx4 v232, s[8:11], s30 offen offset:1024 nt lds
v_mfma_f32_16x16x32_bf16 v[48:51], a[248:251], a[8:11], 0
s_waitcnt lgkmcnt(5)
ds_read_b64_tr_b16 a[234:235], v226 offset:14080
v_mfma_f32_16x16x32_bf16 v[56:59], a[248:251], a[12:15], 0
buffer_load_dwordx4 v233, s[8:11], s30 offen offset:2048 nt lds
v_mfma_f32_16x16x32_bf16 v[36:39], a[252:255], a[0:3], 0
s_add_u32 m0, s28, 77824
ds_read_b64_tr_b16 a[236:237], v227 offset:12544
v_mfma_f32_16x16x32_bf16 v[44:47], a[252:255], a[4:7], 0
buffer_load_dwordx4 a[64:67], v243, s[20:23], s31 offen offset:0 sc1
v_mfma_f32_16x16x32_bf16 v[52:55], a[252:255], a[8:11], 0
s_waitcnt lgkmcnt(5)
ds_read_b64_tr_b16 a[238:239], v227 offset:14080
v_mfma_f32_16x16x32_bf16 v[60:63], a[252:255], a[12:15], 0
buffer_load_dwordx4 a[68:71], v243, s[20:23], s31 offen offset:256 sc1
v_mfma_f32_16x16x32_bf16 v[64:67], a[224:227], a[0:3], 0
s_barrier
v_mfma_f32_16x16x32_bf16 v[72:75], a[224:227], a[4:7], 0
ds_read_b64_tr_b16 a[240:241], v224 offset:24576
v_mfma_f32_16x16x32_bf16 v[80:83], a[224:227], a[8:11], 0
s_waitcnt lgkmcnt(5)
v_mfma_f32_16x16x32_bf16 v[88:91], a[224:227], a[12:15], 0
ds_read_b64_tr_b16 a[242:243], v224 offset:26112
v_mfma_f32_16x16x32_bf16 v[68:71], a[228:231], a[0:3], 0
s_mov_b32 s30, 1966080
v_mfma_f32_16x16x32_bf16 v[76:79], a[228:231], a[4:7], 0
ds_read_b64_tr_b16 a[244:245], v225 offset:24576
v_mfma_f32_16x16x32_bf16 v[84:87], a[228:231], a[8:11], 0
s_waitcnt lgkmcnt(5)
ds_read_b64_tr_b16 a[246:247], v225 offset:26112
v_mfma_f32_16x16x32_bf16 v[92:95], a[228:231], a[12:15], 0
buffer_load_dwordx4 v231, s[8:11], s30 offen offset:0 nt lds
v_mfma_f32_16x16x32_bf16 v[96:99], a[232:235], a[0:3], 0
ds_read_b64_tr_b16 a[248:249], v226 offset:24576
v_mfma_f32_16x16x32_bf16 v[104:107], a[232:235], a[4:7], 0
v_mfma_f32_16x16x32_bf16 v[112:115], a[232:235], a[8:11], 0
s_waitcnt lgkmcnt(5)
v_mfma_f32_16x16x32_bf16 v[120:123], a[232:235], a[12:15], 0
ds_read_b64_tr_b16 a[250:251], v226 offset:26112
v_mfma_f32_16x16x32_bf16 v[100:103], a[236:239], a[0:3], 0
ds_read_b64_tr_b16 a[252:253], v227 offset:24576
v_mfma_f32_16x16x32_bf16 v[108:111], a[236:239], a[4:7], 0
buffer_load_dwordx4 v232, s[8:11], s30 offen offset:1024 nt lds
v_mfma_f32_16x16x32_bf16 v[116:119], a[236:239], a[8:11], 0
s_waitcnt vmcnt(20) lgkmcnt(5)
v_mfma_f32_16x16x32_bf16 v[124:127], a[236:239], a[12:15], 0
ds_read_b64_tr_b16 a[254:255], v227 offset:26112
v_mfma_f32_16x16x32_bf16 v[128:131], a[240:243], a[16:19], v[128:131]
ds_read_b64_tr_b16 a[224:225], v224 offset:24704
v_mfma_f32_16x16x32_bf16 v[136:139], a[240:243], a[20:23], v[136:139]
v_mfma_f32_16x16x32_bf16 v[144:147], a[240:243], a[24:27], v[144:147]
s_waitcnt lgkmcnt(5)
ds_read_b64_tr_b16 a[226:227], v224 offset:26240
v_mfma_f32_16x16x32_bf16 v[152:155], a[240:243], a[28:31], v[152:155]
buffer_load_dwordx4 v233, s[8:11], s30 offen offset:2048 nt lds
v_mfma_f32_16x16x32_bf16 v[132:135], a[244:247], a[16:19], v[132:135]
s_add_u32 m0, s28, 90112
v_mfma_f32_16x16x32_bf16 v[140:143], a[244:247], a[20:23], v[140:143]
ds_read_b64_tr_b16 a[228:229], v225 offset:24704
v_mfma_f32_16x16x32_bf16 v[148:151], a[244:247], a[24:27], v[148:151]
s_waitcnt lgkmcnt(5)
v_mfma_f32_16x16x32_bf16 v[156:159], a[244:247], a[28:31], v[156:159]
ds_read_b64_tr_b16 a[230:231], v225 offset:26240
v_mfma_f32_16x16x32_bf16 v[160:163], a[248:251], a[16:19], v[160:163]
s_mov_b32 s30, 2359296
ds_read_b64_tr_b16 a[232:233], v226 offset:24704
v_mfma_f32_16x16x32_bf16 v[168:171], a[248:251], a[20:23], v[168:171]
buffer_load_dwordx4 a[72:75], v243, s[20:23], s32 offen offset:0 sc1
v_mfma_f32_16x16x32_bf16 v[176:179], a[248:251], a[24:27], v[176:179]
s_waitcnt lgkmcnt(5)
v_mfma_f32_16x16x32_bf16 v[184:187], a[248:251], a[28:31], v[184:187]
ds_read_b64_tr_b16 a[234:235], v226 offset:26240
v_mfma_f32_16x16x32_bf16 v[164:167], a[252:255], a[16:19], v[164:167]
ds_read_b64_tr_b16 a[236:237], v227 offset:24704
v_mfma_f32_16x16x32_bf16 v[172:175], a[252:255], a[20:23], v[172:175]
v_mfma_f32_16x16x32_bf16 v[180:183], a[252:255], a[24:27], v[180:183]
s_waitcnt lgkmcnt(5)
ds_read_b64_tr_b16 a[238:239], v227 offset:26240
v_mfma_f32_16x16x32_bf16 v[188:191], a[252:255], a[28:31], v[188:191]
buffer_load_dwordx4 a[76:79], v243, s[20:23], s32 offen offset:256 sc1
v_mfma_f32_16x16x32_bf16 v[0:3], a[224:227], a[16:19], v[0:3]
ds_read_b64_tr_b16 a[240:241], v224 offset:24832
v_mfma_f32_16x16x32_bf16 v[8:11], a[224:227], a[20:23], v[8:11]
v_mfma_f32_16x16x32_bf16 v[16:19], a[224:227], a[24:27], v[16:19]
s_waitcnt lgkmcnt(5)
v_mfma_f32_16x16x32_bf16 v[24:27], a[224:227], a[28:31], v[24:27]
ds_read_b64_tr_b16 a[242:243], v224 offset:26368
v_mfma_f32_16x16x32_bf16 v[4:7], a[228:231], a[16:19], v[4:7]
ds_read_b64_tr_b16 a[244:245], v225 offset:24832
v_mfma_f32_16x16x32_bf16 v[12:15], a[228:231], a[20:23], v[12:15]
buffer_load_dwordx4 a[80:83], v243, s[20:23], s31 offen offset:2048 sc1
v_mfma_f32_16x16x32_bf16 v[20:23], a[228:231], a[24:27], v[20:23]
s_waitcnt lgkmcnt(5)
v_mfma_f32_16x16x32_bf16 v[28:31], a[228:231], a[28:31], v[28:31]
ds_read_b64_tr_b16 a[246:247], v225 offset:26368
v_mfma_f32_16x16x32_bf16 v[32:35], a[232:235], a[16:19], v[32:35]
ds_read_b64_tr_b16 a[248:249], v226 offset:24832
v_mfma_f32_16x16x32_bf16 v[40:43], a[232:235], a[20:23], v[40:43]
v_mfma_f32_16x16x32_bf16 v[48:51], a[232:235], a[24:27], v[48:51]
s_waitcnt lgkmcnt(5)
ds_read_b64_tr_b16 a[250:251], v226 offset:26368
v_mfma_f32_16x16x32_bf16 v[56:59], a[232:235], a[28:31], v[56:59]
buffer_load_dwordx4 a[84:87], v243, s[20:23], s31 offen offset:2304 sc1
v_mfma_f32_16x16x32_bf16 v[36:39], a[236:239], a[16:19], v[36:39]
ds_read_b64_tr_b16 a[252:253], v227 offset:24832
v_mfma_f32_16x16x32_bf16 v[44:47], a[236:239], a[20:23], v[44:47]
v_mfma_f32_16x16x32_bf16 v[52:55], a[236:239], a[24:27], v[52:55]
s_waitcnt vmcnt(12) lgkmcnt(5)
v_mfma_f32_16x16x32_bf16 v[60:63], a[236:239], a[28:31], v[60:63]
ds_read_b64_tr_b16 a[254:255], v227 offset:26368
v_mfma_f32_16x16x32_bf16 v[64:67], a[240:243], a[16:19], v[64:67]
s_barrier
ds_read_b64_tr_b16 a[224:225], v224 offset:36864
v_mfma_f32_16x16x32_bf16 v[72:75], a[240:243], a[20:23], v[72:75]
buffer_load_dwordx4 a[88:91], v243, s[20:23], s32 offen offset:2048 sc1
v_mfma_f32_16x16x32_bf16 v[80:83], a[240:243], a[24:27], v[80:83]
s_waitcnt lgkmcnt(5)
v_mfma_f32_16x16x32_bf16 v[88:91], a[240:243], a[28:31], v[88:91]
ds_read_b64_tr_b16 a[226:227], v224 offset:38400
v_mfma_f32_16x16x32_bf16 v[68:71], a[244:247], a[16:19], v[68:71]
ds_read_b64_tr_b16 a[228:229], v224 offset:49152
v_mfma_f32_16x16x32_bf16 v[76:79], a[244:247], a[20:23], v[76:79]
v_mfma_f32_16x16x32_bf16 v[84:87], a[244:247], a[24:27], v[84:87]
s_waitcnt lgkmcnt(5)
ds_read_b64_tr_b16 a[230:231], v224 offset:50688
v_mfma_f32_16x16x32_bf16 v[92:95], a[244:247], a[28:31], v[92:95]
buffer_load_dwordx4 a[92:95], v243, s[20:23], s32 offen offset:2304 sc1
v_mfma_f32_16x16x32_bf16 v[96:99], a[248:251], a[16:19], v[96:99]
s_mov_b32 s31, 12288
v_mfma_f32_16x16x32_bf16 v[104:107], a[248:251], a[20:23], v[104:107]
ds_read_b64_tr_b16 a[232:233], v225 offset:36864
v_mfma_f32_16x16x32_bf16 v[112:115], a[248:251], a[24:27], v[112:115]
s_waitcnt lgkmcnt(5)
v_mfma_f32_16x16x32_bf16 v[120:123], a[248:251], a[28:31], v[120:123]
ds_read_b64_tr_b16 a[234:235], v225 offset:38400
v_mfma_f32_16x16x32_bf16 v[100:103], a[252:255], a[16:19], v[100:103]
s_mov_b32 s32, 53248
ds_read_b64_tr_b16 a[236:237], v225 offset:49152
v_mfma_f32_16x16x32_bf16 v[108:111], a[252:255], a[20:23], v[108:111]
buffer_load_dwordx4 v231, s[8:11], s30 offen offset:0 nt lds
v_mfma_f32_16x16x32_bf16 v[116:119], a[252:255], a[24:27], v[116:119]
s_waitcnt lgkmcnt(3)
v_mfma_f32_16x16x32_bf16 v[124:127], a[252:255], a[28:31], v[124:127]
ds_read_b64_tr_b16 a[238:239], v225 offset:50688
v_mfma_f32_16x16x32_bf16 v[128:131], a[224:227], a[32:35], v[128:131]
s_barrier
v_mfma_f32_16x16x32_bf16 v[128:131], a[228:231], a[48:51], v[128:131]
ds_read_b64_tr_b16 a[240:241], v226 offset:36864
v_mfma_f32_16x16x32_bf16 v[136:139], a[224:227], a[36:39], v[136:139]
ds_read_b64_tr_b16 a[242:243], v226 offset:38400
v_mfma_f32_16x16x32_bf16 v[136:139], a[228:231], a[52:55], v[136:139]
buffer_load_dwordx4 v232, s[8:11], s30 offen offset:1024 nt lds
v_mfma_f32_16x16x32_bf16 v[144:147], a[224:227], a[40:43], v[144:147]
ds_read_b64_tr_b16 a[244:245], v226 offset:49152
v_mfma_f32_16x16x32_bf16 v[144:147], a[228:231], a[56:59], v[144:147]
v_mfma_f32_16x16x32_bf16 v[152:155], a[224:227], a[44:47], v[152:155]
s_waitcnt lgkmcnt(3)
v_mfma_f32_16x16x32_bf16 v[152:155], a[228:231], a[60:63], v[152:155]
ds_read_b64_tr_b16 a[246:247], v226 offset:50688
v_mfma_f32_16x16x32_bf16 v[132:135], a[232:235], a[32:35], v[132:135]
ds_read_b64_tr_b16 a[248:249], v227 offset:36864
v_mfma_f32_16x16x32_bf16 v[132:135], a[236:239], a[48:51], v[132:135]
buffer_load_dwordx4 v233, s[8:11], s30 offen offset:2048 nt lds
v_mfma_f32_16x16x32_bf16 v[140:143], a[232:235], a[36:39], v[140:143]
s_add_u32 m0, s28, 102400
v_mfma_f32_16x16x32_bf16 v[140:143], a[236:239], a[52:55], v[140:143]
ds_read_b64_tr_b16 a[250:251], v227 offset:38400
v_mfma_f32_16x16x32_bf16 v[148:151], a[232:235], a[40:43], v[148:151]
s_mov_b32 s30, 2752512
v_mfma_f32_16x16x32_bf16 v[148:151], a[236:239], a[56:59], v[148:151]
ds_read_b64_tr_b16 a[252:253], v227 offset:49152
v_mfma_f32_16x16x32_bf16 v[156:159], a[232:235], a[44:47], v[156:159]
s_waitcnt lgkmcnt(3)
ds_read_b64_tr_b16 a[254:255], v227 offset:50688
v_mfma_f32_16x16x32_bf16 v[156:159], a[236:239], a[60:63], v[156:159]
buffer_load_dwordx4 v231, s[8:11], s30 offen offset:0 nt lds
v_mfma_f32_16x16x32_bf16 v[160:163], a[240:243], a[32:35], v[160:163]
ds_read_b64_tr_b16 a[224:225], v224 offset:36992
v_mfma_f32_16x16x32_bf16 v[160:163], a[244:247], a[48:51], v[160:163]
v_mfma_f32_16x16x32_bf16 v[168:171], a[240:243], a[36:39], v[168:171]
ds_read_b64_tr_b16 a[226:227], v224 offset:38528
v_mfma_f32_16x16x32_bf16 v[168:171], a[244:247], a[52:55], v[168:171]
v_mfma_f32_16x16x32_bf16 v[176:179], a[240:243], a[40:43], v[176:179]
ds_read_b64_tr_b16 a[228:229], v224 offset:49280
v_mfma_f32_16x16x32_bf16 v[176:179], a[244:247], a[56:59], v[176:179]
buffer_load_dwordx4 v232, s[8:11], s30 offen offset:1024 nt lds
v_mfma_f32_16x16x32_bf16 v[184:187], a[240:243], a[44:47], v[184:187]
s_waitcnt lgkmcnt(3)
v_mfma_f32_16x16x32_bf16 v[184:187], a[244:247], a[60:63], v[184:187]
ds_read_b64_tr_b16 a[230:231], v224 offset:50816
v_mfma_f32_16x16x32_bf16 v[164:167], a[248:251], a[32:35], v[164:167]
ds_read_b64_tr_b16 a[232:233], v225 offset:36992
v_mfma_f32_16x16x32_bf16 v[164:167], a[252:255], a[48:51], v[164:167]
v_mfma_f32_16x16x32_bf16 v[172:175], a[248:251], a[36:39], v[172:175]
ds_read_b64_tr_b16 a[234:235], v225 offset:38528
v_mfma_f32_16x16x32_bf16 v[172:175], a[252:255], a[52:55], v[172:175]
buffer_load_dwordx4 v233, s[8:11], s30 offen offset:2048 nt lds
v_mfma_f32_16x16x32_bf16 v[180:183], a[248:251], a[40:43], v[180:183]
s_add_u32 m0, s28, 114688
v_mfma_f32_16x16x32_bf16 v[180:183], a[252:255], a[56:59], v[180:183]
ds_read_b64_tr_b16 a[236:237], v225 offset:49280
v_mfma_f32_16x16x32_bf16 v[188:191], a[248:251], a[44:47], v[188:191]
s_waitcnt lgkmcnt(3)
v_mfma_f32_16x16x32_bf16 v[188:191], a[252:255], a[60:63], v[188:191]
ds_read_b64_tr_b16 a[238:239], v225 offset:50816
v_mfma_f32_16x16x32_bf16 v[0:3], a[224:227], a[32:35], v[0:3]
s_mov_b32 s30, 3145728
ds_read_b64_tr_b16 a[240:241], v226 offset:36992
v_mfma_f32_16x16x32_bf16 v[0:3], a[228:231], a[48:51], v[0:3]
buffer_load_dwordx4 a[96:99], v243, s[20:23], s31 offen offset:0 sc1
v_mfma_f32_16x16x32_bf16 v[8:11], a[224:227], a[36:39], v[8:11]
ds_read_b64_tr_b16 a[242:243], v226 offset:38528
v_mfma_f32_16x16x32_bf16 v[8:11], a[228:231], a[52:55], v[8:11]
v_mfma_f32_16x16x32_bf16 v[16:19], a[224:227], a[40:43], v[16:19]
ds_read_b64_tr_b16 a[244:245], v226 offset:49280
v_mfma_f32_16x16x32_bf16 v[16:19], a[228:231], a[56:59], v[16:19]
v_mfma_f32_16x16x32_bf16 v[24:27], a[224:227], a[44:47], v[24:27]
s_waitcnt lgkmcnt(3)
ds_read_b64_tr_b16 a[246:247], v226 offset:50816
v_mfma_f32_16x16x32_bf16 v[24:27], a[228:231], a[60:63], v[24:27]
buffer_load_dwordx4 a[100:103], v243, s[20:23], s31 offen offset:256 sc1
v_mfma_f32_16x16x32_bf16 v[4:7], a[232:235], a[32:35], v[4:7]
ds_read_b64_tr_b16 a[248:249], v227 offset:36992
v_mfma_f32_16x16x32_bf16 v[4:7], a[236:239], a[48:51], v[4:7]
v_mfma_f32_16x16x32_bf16 v[12:15], a[232:235], a[36:39], v[12:15]
ds_read_b64_tr_b16 a[250:251], v227 offset:38528
v_mfma_f32_16x16x32_bf16 v[12:15], a[236:239], a[52:55], v[12:15]
v_mfma_f32_16x16x32_bf16 v[20:23], a[232:235], a[40:43], v[20:23]
ds_read_b64_tr_b16 a[252:253], v227 offset:49280
v_mfma_f32_16x16x32_bf16 v[20:23], a[236:239], a[56:59], v[20:23]
buffer_load_dwordx4 v231, s[8:11], s30 offen offset:0 nt lds
v_mfma_f32_16x16x32_bf16 v[28:31], a[232:235], a[44:47], v[28:31]
s_waitcnt lgkmcnt(3)
v_mfma_f32_16x16x32_bf16 v[28:31], a[236:239], a[60:63], v[28:31]
ds_read_b64_tr_b16 a[254:255], v227 offset:50816
v_mfma_f32_16x16x32_bf16 v[32:35], a[240:243], a[32:35], v[32:35]
ds_read_b64_tr_b16 a[224:225], v224 offset:37120
v_mfma_f32_16x16x32_bf16 v[32:35], a[244:247], a[48:51], v[32:35]
v_mfma_f32_16x16x32_bf16 v[40:43], a[240:243], a[36:39], v[40:43]
ds_read_b64_tr_b16 a[226:227], v224 offset:38656
v_mfma_f32_16x16x32_bf16 v[40:43], a[244:247], a[52:55], v[40:43]
buffer_load_dwordx4 v232, s[8:11], s30 offen offset:1024 nt lds
v_mfma_f32_16x16x32_bf16 v[48:51], a[240:243], a[40:43], v[48:51]
ds_read_b64_tr_b16 a[228:229], v224 offset:49408
v_mfma_f32_16x16x32_bf16 v[48:51], a[244:247], a[56:59], v[48:51]
v_mfma_f32_16x16x32_bf16 v[56:59], a[240:243], a[44:47], v[56:59]
s_waitcnt lgkmcnt(3)
v_mfma_f32_16x16x32_bf16 v[56:59], a[244:247], a[60:63], v[56:59]
ds_read_b64_tr_b16 a[230:231], v224 offset:50944
v_mfma_f32_16x16x32_bf16 v[36:39], a[248:251], a[32:35], v[36:39]
ds_read_b64_tr_b16 a[232:233], v225 offset:37120
v_mfma_f32_16x16x32_bf16 v[36:39], a[252:255], a[48:51], v[36:39]
buffer_load_dwordx4 v233, s[8:11], s30 offen offset:2048 nt lds
v_mfma_f32_16x16x32_bf16 v[44:47], a[248:251], a[36:39], v[44:47]
s_add_u32 m0, s28, 126976
v_mfma_f32_16x16x32_bf16 v[44:47], a[252:255], a[52:55], v[44:47]
ds_read_b64_tr_b16 a[234:235], v225 offset:38656
v_mfma_f32_16x16x32_bf16 v[52:55], a[248:251], a[40:43], v[52:55]
s_mov_b32 s30, 3538944
v_mfma_f32_16x16x32_bf16 v[52:55], a[252:255], a[56:59], v[52:55]
ds_read_b64_tr_b16 a[236:237], v225 offset:49408
v_mfma_f32_16x16x32_bf16 v[60:63], a[248:251], a[44:47], v[60:63]
s_waitcnt lgkmcnt(3)
ds_read_b64_tr_b16 a[238:239], v225 offset:50944
v_mfma_f32_16x16x32_bf16 v[60:63], a[252:255], a[60:63], v[60:63]
buffer_load_dwordx4 a[104:107], v243, s[20:23], s32 offen offset:0 sc1
v_mfma_f32_16x16x32_bf16 v[64:67], a[224:227], a[32:35], v[64:67]
ds_read_b64_tr_b16 a[240:241], v226 offset:37120
v_mfma_f32_16x16x32_bf16 v[64:67], a[228:231], a[48:51], v[64:67]
v_mfma_f32_16x16x32_bf16 v[72:75], a[224:227], a[36:39], v[72:75]
ds_read_b64_tr_b16 a[242:243], v226 offset:38656
v_mfma_f32_16x16x32_bf16 v[72:75], a[228:231], a[52:55], v[72:75]
v_mfma_f32_16x16x32_bf16 v[80:83], a[224:227], a[40:43], v[80:83]
ds_read_b64_tr_b16 a[244:245], v226 offset:49408
v_mfma_f32_16x16x32_bf16 v[80:83], a[228:231], a[56:59], v[80:83]
buffer_load_dwordx4 a[108:111], v243, s[20:23], s32 offen offset:256 sc1
v_mfma_f32_16x16x32_bf16 v[88:91], a[224:227], a[44:47], v[88:91]
s_waitcnt lgkmcnt(3)
v_mfma_f32_16x16x32_bf16 v[88:91], a[228:231], a[60:63], v[88:91]
ds_read_b64_tr_b16 a[246:247], v226 offset:50944
v_mfma_f32_16x16x32_bf16 v[68:71], a[232:235], a[32:35], v[68:71]
ds_read_b64_tr_b16 a[248:249], v227 offset:37120
v_mfma_f32_16x16x32_bf16 v[68:71], a[236:239], a[48:51], v[68:71]
v_mfma_f32_16x16x32_bf16 v[76:79], a[232:235], a[36:39], v[76:79]
ds_read_b64_tr_b16 a[250:251], v227 offset:38656
v_mfma_f32_16x16x32_bf16 v[76:79], a[236:239], a[52:55], v[76:79]
buffer_load_dwordx4 a[112:115], v243, s[20:23], s31 offen offset:2048 sc1
v_mfma_f32_16x16x32_bf16 v[84:87], a[232:235], a[40:43], v[84:87]
ds_read_b64_tr_b16 a[252:253], v227 offset:49408
v_mfma_f32_16x16x32_bf16 v[84:87], a[236:239], a[56:59], v[84:87]
v_mfma_f32_16x16x32_bf16 v[92:95], a[232:235], a[44:47], v[92:95]
s_waitcnt vmcnt(20) lgkmcnt(3)
ds_read_b64_tr_b16 a[254:255], v227 offset:50944
v_add_u32 v224, 4294930432, v224
v_mfma_f32_16x16x32_bf16 v[92:95], a[236:239], a[60:63], v[92:95]
v_add_u32 v225, 4294930432, v225
v_add_u32 v226, 4294930432, v226
v_add_u32 v227, 4294930432, v227
v_mfma_f32_16x16x32_bf16 v[96:99], a[240:243], a[32:35], v[96:99]
s_barrier
ds_read_b64_tr_b16 a[224:225], v224 offset:0
v_mfma_f32_16x16x32_bf16 v[96:99], a[244:247], a[48:51], v[96:99]
buffer_load_dwordx4 a[116:119], v243, s[20:23], s31 offen offset:2304 sc1
v_mfma_f32_16x16x32_bf16 v[104:107], a[240:243], a[36:39], v[104:107]
ds_read_b64_tr_b16 a[226:227], v224 offset:1536
v_mfma_f32_16x16x32_bf16 v[104:107], a[244:247], a[52:55], v[104:107]
v_mfma_f32_16x16x32_bf16 v[112:115], a[240:243], a[40:43], v[112:115]
ds_read_b64_tr_b16 a[228:229], v224 offset:12288
v_mfma_f32_16x16x32_bf16 v[112:115], a[244:247], a[56:59], v[112:115]
v_mfma_f32_16x16x32_bf16 v[120:123], a[240:243], a[44:47], v[120:123]
s_waitcnt lgkmcnt(3)
ds_read_b64_tr_b16 a[230:231], v224 offset:13824
v_mfma_f32_16x16x32_bf16 v[120:123], a[244:247], a[60:63], v[120:123]
buffer_load_dwordx4 a[120:123], v243, s[20:23], s32 offen offset:2048 sc1
v_mfma_f32_16x16x32_bf16 v[100:103], a[248:251], a[32:35], v[100:103]
ds_read_b64_tr_b16 a[232:233], v225 offset:0
v_mfma_f32_16x16x32_bf16 v[100:103], a[252:255], a[48:51], v[100:103]
v_mfma_f32_16x16x32_bf16 v[108:111], a[248:251], a[36:39], v[108:111]
ds_read_b64_tr_b16 a[234:235], v225 offset:1536
v_mfma_f32_16x16x32_bf16 v[108:111], a[252:255], a[52:55], v[108:111]
v_mfma_f32_16x16x32_bf16 v[116:119], a[248:251], a[40:43], v[116:119]
ds_read_b64_tr_b16 a[236:237], v225 offset:12288
v_mfma_f32_16x16x32_bf16 v[116:119], a[252:255], a[56:59], v[116:119]
buffer_load_dwordx4 a[124:127], v243, s[20:23], s32 offen offset:2304 sc1
v_mfma_f32_16x16x32_bf16 v[124:127], a[248:251], a[44:47], v[124:127]
s_waitcnt vmcnt(17) lgkmcnt(3)
v_mfma_f32_16x16x32_bf16 v[124:127], a[252:255], a[60:63], v[124:127]
ds_read_b64_tr_b16 a[238:239], v225 offset:13824
v_mfma_f32_16x16x32_bf16 v[128:131], a[224:227], a[64:67], v[128:131]
s_barrier
v_mfma_f32_16x16x32_bf16 v[128:131], a[228:231], a[80:83], v[128:131]
ds_read_b64_tr_b16 a[240:241], v226 offset:0
v_mfma_f32_16x16x32_bf16 v[136:139], a[224:227], a[68:71], v[136:139]
s_mov_b32 s31, 16384
v_mfma_f32_16x16x32_bf16 v[136:139], a[228:231], a[84:87], v[136:139]
ds_read_b64_tr_b16 a[242:243], v226 offset:1536
v_mfma_f32_16x16x32_bf16 v[144:147], a[224:227], a[72:75], v[144:147]
s_mov_b32 s32, 57344
v_mfma_f32_16x16x32_bf16 v[144:147], a[228:231], a[88:91], v[144:147]
ds_read_b64_tr_b16 a[244:245], v226 offset:12288
v_mfma_f32_16x16x32_bf16 v[152:155], a[224:227], a[76:79], v[152:155]
s_waitcnt lgkmcnt(3)
ds_read_b64_tr_b16 a[246:247], v226 offset:13824
v_mfma_f32_16x16x32_bf16 v[152:155], a[228:231], a[92:95], v[152:155]
buffer_load_dwordx4 a[0:3], v243, s[20:23], s31 offen offset:0 sc1
v_mfma_f32_16x16x32_bf16 v[132:135], a[232:235], a[64:67], v[132:135]
ds_read_b64_tr_b16 a[248:249], v227 offset:0
v_mfma_f32_16x16x32_bf16 v[132:135], a[236:239], a[80:83], v[132:135]
v_mfma_f32_16x16x32_bf16 v[140:143], a[232:235], a[68:71], v[140:143]
ds_read_b64_tr_b16 a[250:251], v227 offset:1536
v_mfma_f32_16x16x32_bf16 v[140:143], a[236:239], a[84:87], v[140:143]
v_mfma_f32_16x16x32_bf16 v[148:151], a[232:235], a[72:75], v[148:151]
ds_read_b64_tr_b16 a[252:253], v227 offset:12288
v_mfma_f32_16x16x32_bf16 v[148:151], a[236:239], a[88:91], v[148:151]
buffer_load_dwordx4 a[4:7], v243, s[20:23], s31 offen offset:256 sc1
v_mfma_f32_16x16x32_bf16 v[156:159], a[232:235], a[76:79], v[156:159]
s_waitcnt lgkmcnt(3)
v_mfma_f32_16x16x32_bf16 v[156:159], a[236:239], a[92:95], v[156:159]
ds_read_b64_tr_b16 a[254:255], v227 offset:13824
v_mfma_f32_16x16x32_bf16 v[160:163], a[240:243], a[64:67], v[160:163]
ds_read_b64_tr_b16 a[224:225], v224 offset:128
v_mfma_f32_16x16x32_bf16 v[160:163], a[244:247], a[80:83], v[160:163]
v_mfma_f32_16x16x32_bf16 v[168:171], a[240:243], a[68:71], v[168:171]
ds_read_b64_tr_b16 a[226:227], v224 offset:1664
v_mfma_f32_16x16x32_bf16 v[168:171], a[244:247], a[84:87], v[168:171]
buffer_load_dwordx4 a[8:11], v243, s[20:23], s32 offen offset:0 sc1
v_mfma_f32_16x16x32_bf16 v[176:179], a[240:243], a[72:75], v[176:179]
ds_read_b64_tr_b16 a[228:229], v224 offset:12416
v_mfma_f32_16x16x32_bf16 v[176:179], a[244:247], a[88:91], v[176:179]
v_mfma_f32_16x16x32_bf16 v[184:187], a[240:243], a[76:79], v[184:187]
s_waitcnt lgkmcnt(3)
v_mfma_f32_16x16x32_bf16 v[184:187], a[244:247], a[92:95], v[184:187]
ds_read_b64_tr_b16 a[230:231], v224 offset:13952
v_mfma_f32_16x16x32_bf16 v[164:167], a[248:251], a[64:67], v[164:167]
ds_read_b64_tr_b16 a[232:233], v225 offset:128
v_mfma_f32_16x16x32_bf16 v[164:167], a[252:255], a[80:83], v[164:167]
buffer_load_dwordx4 a[12:15], v243, s[20:23], s32 offen offset:256 sc1
v_mfma_f32_16x16x32_bf16 v[172:175], a[248:251], a[68:71], v[172:175]
ds_read_b64_tr_b16 a[234:235], v225 offset:1664
v_mfma_f32_16x16x32_bf16 v[172:175], a[252:255], a[84:87], v[172:175]
v_mfma_f32_16x16x32_bf16 v[180:183], a[248:251], a[72:75], v[180:183]
ds_read_b64_tr_b16 a[236:237], v225 offset:12416
v_mfma_f32_16x16x32_bf16 v[180:183], a[252:255], a[88:91], v[180:183]
v_mfma_f32_16x16x32_bf16 v[188:191], a[248:251], a[76:79], v[188:191]
s_waitcnt lgkmcnt(3)
ds_read_b64_tr_b16 a[238:239], v225 offset:13952
v_mfma_f32_16x16x32_bf16 v[188:191], a[252:255], a[92:95], v[188:191]
buffer_load_dwordx4 v231, s[8:11], s30 offen offset:0 nt lds
v_mfma_f32_16x16x32_bf16 v[0:3], a[224:227], a[64:67], v[0:3]
ds_read_b64_tr_b16 a[240:241], v226 offset:128
v_mfma_f32_16x16x32_bf16 v[0:3], a[228:231], a[80:83], v[0:3]
v_mfma_f32_16x16x32_bf16 v[8:11], a[224:227], a[68:71], v[8:11]
ds_read_b64_tr_b16 a[242:243], v226 offset:1664
v_mfma_f32_16x16x32_bf16 v[8:11], a[228:231], a[84:87], v[8:11]
v_mfma_f32_16x16x32_bf16 v[16:19], a[224:227], a[72:75], v[16:19]
ds_read_b64_tr_b16 a[244:245], v226 offset:12416
v_mfma_f32_16x16x32_bf16 v[16:19], a[228:231], a[88:91], v[16:19]
buffer_load_dwordx4 v232, s[8:11], s30 offen offset:1024 nt lds
v_mfma_f32_16x16x32_bf16 v[24:27], a[224:227], a[76:79], v[24:27]
s_waitcnt lgkmcnt(3)
v_mfma_f32_16x16x32_bf16 v[24:27], a[228:231], a[92:95], v[24:27]
ds_read_b64_tr_b16 a[246:247], v226 offset:13952
v_mfma_f32_16x16x32_bf16 v[4:7], a[232:235], a[64:67], v[4:7]
ds_read_b64_tr_b16 a[248:249], v227 offset:128
v_mfma_f32_16x16x32_bf16 v[4:7], a[236:239], a[80:83], v[4:7]
v_mfma_f32_16x16x32_bf16 v[12:15], a[232:235], a[68:71], v[12:15]
ds_read_b64_tr_b16 a[250:251], v227 offset:1664
v_mfma_f32_16x16x32_bf16 v[12:15], a[236:239], a[84:87], v[12:15]
buffer_load_dwordx4 v233, s[8:11], s30 offen offset:2048 nt lds
v_mfma_f32_16x16x32_bf16 v[20:23], a[232:235], a[72:75], v[20:23]
s_add_u32 m0, s28, 139264
v_mfma_f32_16x16x32_bf16 v[20:23], a[236:239], a[88:91], v[20:23]
ds_read_b64_tr_b16 a[252:253], v227 offset:12416
v_mfma_f32_16x16x32_bf16 v[28:31], a[232:235], a[76:79], v[28:31]
s_waitcnt lgkmcnt(3)
v_mfma_f32_16x16x32_bf16 v[28:31], a[236:239], a[92:95], v[28:31]
ds_read_b64_tr_b16 a[254:255], v227 offset:13952
v_mfma_f32_16x16x32_bf16 v[32:35], a[240:243], a[64:67], v[32:35]
s_mov_b32 s30, 3932160
ds_read_b64_tr_b16 a[224:225], v224 offset:256
v_mfma_f32_16x16x32_bf16 v[32:35], a[244:247], a[80:83], v[32:35]
buffer_load_dwordx4 a[16:19], v243, s[20:23], s31 offen offset:2048 sc1
v_mfma_f32_16x16x32_bf16 v[40:43], a[240:243], a[68:71], v[40:43]
ds_read_b64_tr_b16 a[226:227], v224 offset:1792
v_mfma_f32_16x16x32_bf16 v[40:43], a[244:247], a[84:87], v[40:43]
v_mfma_f32_16x16x32_bf16 v[48:51], a[240:243], a[72:75], v[48:51]
ds_read_b64_tr_b16 a[228:229], v224 offset:12544
v_mfma_f32_16x16x32_bf16 v[48:51], a[244:247], a[88:91], v[48:51]
v_mfma_f32_16x16x32_bf16 v[56:59], a[240:243], a[76:79], v[56:59]
s_waitcnt lgkmcnt(3)
ds_read_b64_tr_b16 a[230:231], v224 offset:14080
v_mfma_f32_16x16x32_bf16 v[56:59], a[244:247], a[92:95], v[56:59]
buffer_load_dwordx4 a[20:23], v243, s[20:23], s31 offen offset:2304 sc1
v_mfma_f32_16x16x32_bf16 v[36:39], a[248:251], a[64:67], v[36:39]
ds_read_b64_tr_b16 a[232:233], v225 offset:256
v_mfma_f32_16x16x32_bf16 v[36:39], a[252:255], a[80:83], v[36:39]
v_mfma_f32_16x16x32_bf16 v[44:47], a[248:251], a[68:71], v[44:47]
ds_read_b64_tr_b16 a[234:235], v225 offset:1792
v_mfma_f32_16x16x32_bf16 v[44:47], a[252:255], a[84:87], v[44:47]
v_mfma_f32_16x16x32_bf16 v[52:55], a[248:251], a[72:75], v[52:55]
ds_read_b64_tr_b16 a[236:237], v225 offset:12544
v_mfma_f32_16x16x32_bf16 v[52:55], a[252:255], a[88:91], v[52:55]
buffer_load_dwordx4 a[24:27], v243, s[20:23], s32 offen offset:2048 sc1
v_mfma_f32_16x16x32_bf16 v[60:63], a[248:251], a[76:79], v[60:63]
s_waitcnt lgkmcnt(3)
v_mfma_f32_16x16x32_bf16 v[60:63], a[252:255], a[92:95], v[60:63]
ds_read_b64_tr_b16 a[238:239], v225 offset:14080
v_mfma_f32_16x16x32_bf16 v[64:67], a[224:227], a[64:67], v[64:67]
ds_read_b64_tr_b16 a[240:241], v226 offset:256
v_mfma_f32_16x16x32_bf16 v[64:67], a[228:231], a[80:83], v[64:67]
v_mfma_f32_16x16x32_bf16 v[72:75], a[224:227], a[68:71], v[72:75]
ds_read_b64_tr_b16 a[242:243], v226 offset:1792
v_mfma_f32_16x16x32_bf16 v[72:75], a[228:231], a[84:87], v[72:75]
buffer_load_dwordx4 a[28:31], v243, s[20:23], s32 offen offset:2304 sc1
v_mfma_f32_16x16x32_bf16 v[80:83], a[224:227], a[72:75], v[80:83]
s_mov_b32 s31, 20480
v_mfma_f32_16x16x32_bf16 v[80:83], a[228:231], a[88:91], v[80:83]
ds_read_b64_tr_b16 a[244:245], v226 offset:12544
v_mfma_f32_16x16x32_bf16 v[88:91], a[224:227], a[76:79], v[88:91]
s_waitcnt lgkmcnt(3)
v_mfma_f32_16x16x32_bf16 v[88:91], a[228:231], a[92:95], v[88:91]
ds_read_b64_tr_b16 a[246:247], v226 offset:14080
v_mfma_f32_16x16x32_bf16 v[68:71], a[232:235], a[64:67], v[68:71]
s_mov_b32 s32, 61440
ds_read_b64_tr_b16 a[248:249], v227 offset:256
v_mfma_f32_16x16x32_bf16 v[68:71], a[236:239], a[80:83], v[68:71]
buffer_load_dwordx4 v231, s[8:11], s30 offen offset:0 nt lds
v_mfma_f32_16x16x32_bf16 v[76:79], a[232:235], a[68:71], v[76:79]
L_pg1:
s_cbranch_execz L_pg5
ds_read_b64_tr_b16 a[250:251], v227 offset:1792
v_mfma_f32_16x16x32_bf16 v[76:79], a[236:239], a[84:87], v[76:79]
v_mfma_f32_16x16x32_bf16 v[84:87], a[232:235], a[72:75], v[84:87]
ds_read_b64_tr_b16 a[252:253], v227 offset:12544
v_mfma_f32_16x16x32_bf16 v[84:87], a[236:239], a[88:91], v[84:87]
v_mfma_f32_16x16x32_bf16 v[92:95], a[232:235], a[76:79], v[92:95]
s_waitcnt vmcnt(23) lgkmcnt(3)
ds_read_b64_tr_b16 a[254:255], v227 offset:14080
v_mfma_f32_16x16x32_bf16 v[92:95], a[236:239], a[92:95], v[92:95]
buffer_load_dwordx4 v232, s[8:11], s30 offen offset:1024 nt lds
v_mfma_f32_16x16x32_bf16 v[96:99], a[240:243], a[64:67], v[96:99]
s_barrier
v_mfma_f32_16x16x32_bf16 v[96:99], a[244:247], a[80:83], v[96:99]
ds_read_b64_tr_b16 a[224:225], v224 offset:24576
v_mfma_f32_16x16x32_bf16 v[104:107], a[240:243], a[68:71], v[104:107]
ds_read_b64_tr_b16 a[226:227], v224 offset:26112
v_mfma_f32_16x16x32_bf16 v[104:107], a[244:247], a[84:87], v[104:107]
v_mfma_f32_16x16x32_bf16 v[112:115], a[240:243], a[72:75], v[112:115]
ds_read_b64_tr_b16 a[228:229], v224 offset:36864
v_mfma_f32_16x16x32_bf16 v[112:115], a[244:247], a[88:91], v[112:115]
buffer_load_dwordx4 v233, s[8:11], s30 offen offset:2048 nt lds
v_mfma_f32_16x16x32_bf16 v[120:123], a[240:243], a[76:79], v[120:123]
s_waitcnt lgkmcnt(3)
v_mfma_f32_16x16x32_bf16 v[120:123], a[244:247], a[92:95], v[120:123]
ds_read_b64_tr_b16 a[230:231], v224 offset:38400
v_mfma_f32_16x16x32_bf16 v[100:103], a[248:251], a[64:67], v[100:103]
s_add_u32 m0, s28, 151552
v_mfma_f32_16x16x32_bf16 v[100:103], a[252:255], a[80:83], v[100:103]
ds_read_b64_tr_b16 a[232:233], v225 offset:24576
v_mfma_f32_16x16x32_bf16 v[108:111], a[248:251], a[68:71], v[108:111]
s_mov_b32 s30, 4325376
v_mfma_f32_16x16x32_bf16 v[108:111], a[252:255], a[84:87], v[108:111]
ds_read_b64_tr_b16 a[234:235], v225 offset:26112
v_mfma_f32_16x16x32_bf16 v[116:119], a[248:251], a[72:75], v[116:119]
ds_read_b64_tr_b16 a[236:237], v225 offset:36864
v_mfma_f32_16x16x32_bf16 v[116:119], a[252:255], a[88:91], v[116:119]
buffer_load_dwordx4 v231, s[8:11], s30 offen offset:0 nt lds
v_mfma_f32_16x16x32_bf16 v[124:127], a[248:251], a[76:79], v[124:127]
s_waitcnt vmcnt(15) lgkmcnt(3)
v_mfma_f32_16x16x32_bf16 v[124:127], a[252:255], a[92:95], v[124:127]
ds_read_b64_tr_b16 a[238:239], v225 offset:38400
v_mfma_f32_16x16x32_bf16 v[128:131], a[224:227], a[96:99], v[128:131]
s_barrier
v_mfma_f32_16x16x32_bf16 v[128:131], a[228:231], a[112:115], v[128:131]
ds_read_b64_tr_b16 a[240:241], v226 offset:24576
v_mfma_f32_16x16x32_bf16 v[136:139], a[224:227], a[100:103], v[136:139]
ds_read_b64_tr_b16 a[242:243], v226 offset:26112
v_mfma_f32_16x16x32_bf16 v[136:139], a[228:231], a[116:119], v[136:139]
buffer_load_dwordx4 v232, s[8:11], s30 offen offset:1024 nt lds
v_mfma_f32_16x16x32_bf16 v[144:147], a[224:227], a[104:107], v[144:147]
ds_read_b64_tr_b16 a[244:245], v226 offset:36864
v_mfma_f32_16x16x32_bf16 v[144:147], a[228:231], a[120:123], v[144:147]
v_mfma_f32_16x16x32_bf16 v[152:155], a[224:227], a[108:111], v[152:155]
s_waitcnt lgkmcnt(3)
v_mfma_f32_16x16x32_bf16 v[152:155], a[228:231], a[124:127], v[152:155]
ds_read_b64_tr_b16 a[246:247], v226 offset:38400
v_mfma_f32_16x16x32_bf16 v[132:135], a[232:235], a[96:99], v[132:135]
ds_read_b64_tr_b16 a[248:249], v227 offset:24576
v_mfma_f32_16x16x32_bf16 v[132:135], a[236:239], a[112:115], v[132:135]
buffer_load_dwordx4 v233, s[8:11], s30 offen offset:2048 nt lds
v_mfma_f32_16x16x32_bf16 v[140:143], a[232:235], a[100:103], v[140:143]
s_add_u32 m0, s28, 65536
v_mfma_f32_16x16x32_bf16 v[140:143], a[236:239], a[116:119], v[140:143]
ds_read_b64_tr_b16 a[250:251], v227 offset:26112
v_mfma_f32_16x16x32_bf16 v[148:151], a[232:235], a[104:107], v[148:151]
s_mov_b32 s30, 4718592
v_mfma_f32_16x16x32_bf16 v[148:151], a[236:239], a[120:123], v[148:151]
ds_read_b64_tr_b16 a[252:253], v227 offset:36864
v_mfma_f32_16x16x32_bf16 v[156:159], a[232:235], a[108:111], v[156:159]
s_waitcnt lgkmcnt(3)
ds_read_b64_tr_b16 a[254:255], v227 offset:38400
v_mfma_f32_16x16x32_bf16 v[156:159], a[236:239], a[124:127], v[156:159]
buffer_load_dwordx4 a[32:35], v243, s[20:23], s31 offen offset:0 sc1
v_mfma_f32_16x16x32_bf16 v[160:163], a[240:243], a[96:99], v[160:163]
ds_read_b64_tr_b16 a[224:225], v224 offset:24704
v_mfma_f32_16x16x32_bf16 v[160:163], a[244:247], a[112:115], v[160:163]
v_mfma_f32_16x16x32_bf16 v[168:171], a[240:243], a[100:103], v[168:171]
ds_read_b64_tr_b16 a[226:227], v224 offset:26240
v_mfma_f32_16x16x32_bf16 v[168:171], a[244:247], a[116:119], v[168:171]
v_mfma_f32_16x16x32_bf16 v[176:179], a[240:243], a[104:107], v[176:179]
ds_read_b64_tr_b16 a[228:229], v224 offset:36992
v_mfma_f32_16x16x32_bf16 v[176:179], a[244:247], a[120:123], v[176:179]
buffer_load_dwordx4 a[36:39], v243, s[20:23], s31 offen offset:256 sc1
v_mfma_f32_16x16x32_bf16 v[184:187], a[240:243], a[108:111], v[184:187]
s_waitcnt lgkmcnt(3)
v_mfma_f32_16x16x32_bf16 v[184:187], a[244:247], a[124:127], v[184:187]
ds_read_b64_tr_b16 a[230:231], v224 offset:38528
v_mfma_f32_16x16x32_bf16 v[164:167], a[248:251], a[96:99], v[164:167]
ds_read_b64_tr_b16 a[232:233], v225 offset:24704
v_mfma_f32_16x16x32_bf16 v[164:167], a[252:255], a[112:115], v[164:167]
v_mfma_f32_16x16x32_bf16 v[172:175], a[248:251], a[100:103], v[172:175]
ds_read_b64_tr_b16 a[234:235], v225 offset:26240
v_mfma_f32_16x16x32_bf16 v[172:175], a[252:255], a[116:119], v[172:175]
buffer_load_dwordx4 a[40:43], v243, s[20:23], s32 offen offset:0 sc1
v_mfma_f32_16x16x32_bf16 v[180:183], a[248:251], a[104:107], v[180:183]
ds_read_b64_tr_b16 a[236:237], v225 offset:36992
v_mfma_f32_16x16x32_bf16 v[180:183], a[252:255], a[120:123], v[180:183]
v_mfma_f32_16x16x32_bf16 v[188:191], a[248:251], a[108:111], v[188:191]
s_waitcnt lgkmcnt(3)
v_mfma_f32_16x16x32_bf16 v[188:191], a[252:255], a[124:127], v[188:191]
ds_read_b64_tr_b16 a[238:239], v225 offset:38528
v_mfma_f32_16x16x32_bf16 v[0:3], a[224:227], a[96:99], v[0:3]
ds_read_b64_tr_b16 a[240:241], v226 offset:24704
v_mfma_f32_16x16x32_bf16 v[0:3], a[228:231], a[112:115], v[0:3]
buffer_load_dwordx4 a[44:47], v243, s[20:23], s32 offen offset:256 sc1
v_mfma_f32_16x16x32_bf16 v[8:11], a[224:227], a[100:103], v[8:11]
ds_read_b64_tr_b16 a[242:243], v226 offset:26240
v_mfma_f32_16x16x32_bf16 v[8:11], a[228:231], a[116:119], v[8:11]
v_mfma_f32_16x16x32_bf16 v[16:19], a[224:227], a[104:107], v[16:19]
ds_read_b64_tr_b16 a[244:245], v226 offset:36992
v_mfma_f32_16x16x32_bf16 v[16:19], a[228:231], a[120:123], v[16:19]
v_mfma_f32_16x16x32_bf16 v[24:27], a[224:227], a[108:111], v[24:27]
s_waitcnt lgkmcnt(3)
ds_read_b64_tr_b16 a[246:247], v226 offset:38528
v_mfma_f32_16x16x32_bf16 v[24:27], a[228:231], a[124:127], v[24:27]
buffer_load_dwordx4 a[48:51], v243, s[20:23], s31 offen offset:2048 sc1
v_mfma_f32_16x16x32_bf16 v[4:7], a[232:235], a[96:99], v[4:7]
ds_read_b64_tr_b16 a[248:249], v227 offset:24704
v_mfma_f32_16x16x32_bf16 v[4:7], a[236:239], a[112:115], v[4:7]
v_mfma_f32_16x16x32_bf16 v[12:15], a[232:235], a[100:103], v[12:15]
ds_read_b64_tr_b16 a[250:251], v227 offset:26240
v_mfma_f32_16x16x32_bf16 v[12:15], a[236:239], a[116:119], v[12:15]
v_mfma_f32_16x16x32_bf16 v[20:23], a[232:235], a[104:107], v[20:23]
ds_read_b64_tr_b16 a[252:253], v227 offset:36992
v_mfma_f32_16x16x32_bf16 v[20:23], a[236:239], a[120:123], v[20:23]
buffer_load_dwordx4 a[52:55], v243, s[20:23], s31 offen offset:2304 sc1
v_mfma_f32_16x16x32_bf16 v[28:31], a[232:235], a[108:111], v[28:31]
s_waitcnt lgkmcnt(3)
v_mfma_f32_16x16x32_bf16 v[28:31], a[236:239], a[124:127], v[28:31]
ds_read_b64_tr_b16 a[254:255], v227 offset:38528
v_mfma_f32_16x16x32_bf16 v[32:35], a[240:243], a[96:99], v[32:35]
ds_read_b64_tr_b16 a[224:225], v224 offset:24832
v_mfma_f32_16x16x32_bf16 v[32:35], a[244:247], a[112:115], v[32:35]
v_mfma_f32_16x16x32_bf16 v[40:43], a[240:243], a[100:103], v[40:43]
ds_read_b64_tr_b16 a[226:227], v224 offset:26368
v_mfma_f32_16x16x32_bf16 v[40:43], a[244:247], a[116:119], v[40:43]
buffer_load_dwordx4 a[56:59], v243, s[20:23], s32 offen offset:2048 sc1
v_mfma_f32_16x16x32_bf16 v[48:51], a[240:243], a[104:107], v[48:51]
ds_read_b64_tr_b16 a[228:229], v224 offset:37120
v_mfma_f32_16x16x32_bf16 v[48:51], a[244:247], a[120:123], v[48:51]
v_mfma_f32_16x16x32_bf16 v[56:59], a[240:243], a[108:111], v[56:59]
s_waitcnt lgkmcnt(3)
v_mfma_f32_16x16x32_bf16 v[56:59], a[244:247], a[124:127], v[56:59]
ds_read_b64_tr_b16 a[230:231], v224 offset:38656
v_mfma_f32_16x16x32_bf16 v[36:39], a[248:251], a[96:99], v[36:39]
ds_read_b64_tr_b16 a[232:233], v225 offset:24832
v_mfma_f32_16x16x32_bf16 v[36:39], a[252:255], a[112:115], v[36:39]
buffer_load_dwordx4 a[60:63], v243, s[20:23], s32 offen offset:2304 sc1
v_mfma_f32_16x16x32_bf16 v[44:47], a[248:251], a[100:103], v[44:47]
s_mov_b32 s31, 24576
v_mfma_f32_16x16x32_bf16 v[44:47], a[252:255], a[116:119], v[44:47]
ds_read_b64_tr_b16 a[234:235], v225 offset:26368
v_mfma_f32_16x16x32_bf16 v[52:55], a[248:251], a[104:107], v[52:55]
s_mov_b32 s32, 65536
v_mfma_f32_16x16x32_bf16 v[52:55], a[252:255], a[120:123], v[52:55]
ds_read_b64_tr_b16 a[236:237], v225 offset:37120
v_mfma_f32_16x16x32_bf16 v[60:63], a[248:251], a[108:111], v[60:63]
s_waitcnt lgkmcnt(3)
ds_read_b64_tr_b16 a[238:239], v225 offset:38656
v_mfma_f32_16x16x32_bf16 v[60:63], a[252:255], a[124:127], v[60:63]
buffer_load_dwordx4 v231, s[8:11], s30 offen offset:0 nt lds
v_mfma_f32_16x16x32_bf16 v[64:67], a[224:227], a[96:99], v[64:67]
ds_read_b64_tr_b16 a[240:241], v226 offset:24832
v_mfma_f32_16x16x32_bf16 v[64:67], a[228:231], a[112:115], v[64:67]
v_mfma_f32_16x16x32_bf16 v[72:75], a[224:227], a[100:103], v[72:75]
ds_read_b64_tr_b16 a[242:243], v226 offset:26368
v_mfma_f32_16x16x32_bf16 v[72:75], a[228:231], a[116:119], v[72:75]
v_mfma_f32_16x16x32_bf16 v[80:83], a[224:227], a[104:107], v[80:83]
ds_read_b64_tr_b16 a[244:245], v226 offset:37120
v_mfma_f32_16x16x32_bf16 v[80:83], a[228:231], a[120:123], v[80:83]
buffer_load_dwordx4 v232, s[8:11], s30 offen offset:1024 nt lds
v_mfma_f32_16x16x32_bf16 v[88:91], a[224:227], a[108:111], v[88:91]
s_waitcnt lgkmcnt(3)
v_mfma_f32_16x16x32_bf16 v[88:91], a[228:231], a[124:127], v[88:91]
ds_read_b64_tr_b16 a[246:247], v226 offset:38656
v_mfma_f32_16x16x32_bf16 v[68:71], a[232:235], a[96:99], v[68:71]
ds_read_b64_tr_b16 a[248:249], v227 offset:24832
v_mfma_f32_16x16x32_bf16 v[68:71], a[236:239], a[112:115], v[68:71]
v_mfma_f32_16x16x32_bf16 v[76:79], a[232:235], a[100:103], v[76:79]
ds_read_b64_tr_b16 a[250:251], v227 offset:26368
v_mfma_f32_16x16x32_bf16 v[76:79], a[236:239], a[116:119], v[76:79]
buffer_load_dwordx4 v233, s[8:11], s30 offen offset:2048 nt lds
v_mfma_f32_16x16x32_bf16 v[84:87], a[232:235], a[104:107], v[84:87]
s_add_u32 m0, s28, 77824
v_mfma_f32_16x16x32_bf16 v[84:87], a[236:239], a[120:123], v[84:87]
ds_read_b64_tr_b16 a[252:253], v227 offset:37120
v_mfma_f32_16x16x32_bf16 v[92:95], a[232:235], a[108:111], v[92:95]
s_waitcnt vmcnt(21) lgkmcnt(3)
ds_read_b64_tr_b16 a[254:255], v227 offset:38656
v_add_u32 v224, 36864, v224
v_mfma_f32_16x16x32_bf16 v[92:95], a[236:239], a[124:127], v[92:95]
v_add_u32 v225, 36864, v225
v_add_u32 v226, 36864, v226
v_add_u32 v227, 36864, v227
v_mfma_f32_16x16x32_bf16 v[96:99], a[240:243], a[96:99], v[96:99]
s_barrier
v_mfma_f32_16x16x32_bf16 v[96:99], a[244:247], a[112:115], v[96:99]
ds_read_b64_tr_b16 a[224:225], v224 offset:12288
v_mfma_f32_16x16x32_bf16 v[104:107], a[240:243], a[100:103], v[104:107]
s_mov_b32 s30, 5111808
v_mfma_f32_16x16x32_bf16 v[104:107], a[244:247], a[116:119], v[104:107]
ds_read_b64_tr_b16 a[226:227], v224 offset:13824
v_mfma_f32_16x16x32_bf16 v[112:115], a[240:243], a[104:107], v[112:115]
ds_read_b64_tr_b16 a[228:229], v224 offset:24576
v_mfma_f32_16x16x32_bf16 v[112:115], a[244:247], a[120:123], v[112:115]
buffer_load_dwordx4 v231, s[8:11], s30 offen offset:0 nt lds
v_mfma_f32_16x16x32_bf16 v[120:123], a[240:243], a[108:111], v[120:123]
s_waitcnt lgkmcnt(3)
v_mfma_f32_16x16x32_bf16 v[120:123], a[244:247], a[124:127], v[120:123]
ds_read_b64_tr_b16 a[230:231], v224 offset:26112
v_mfma_f32_16x16x32_bf16 v[100:103], a[248:251], a[96:99], v[100:103]
ds_read_b64_tr_b16 a[232:233], v225 offset:12288
v_mfma_f32_16x16x32_bf16 v[100:103], a[252:255], a[112:115], v[100:103]
v_mfma_f32_16x16x32_bf16 v[108:111], a[248:251], a[100:103], v[108:111]
ds_read_b64_tr_b16 a[234:235], v225 offset:13824
v_mfma_f32_16x16x32_bf16 v[108:111], a[252:255], a[116:119], v[108:111]
buffer_load_dwordx4 v232, s[8:11], s30 offen offset:1024 nt lds
v_mfma_f32_16x16x32_bf16 v[116:119], a[248:251], a[104:107], v[116:119]
ds_read_b64_tr_b16 a[236:237], v225 offset:24576
v_mfma_f32_16x16x32_bf16 v[116:119], a[252:255], a[120:123], v[116:119]
v_mfma_f32_16x16x32_bf16 v[124:127], a[248:251], a[108:111], v[124:127]
s_waitcnt vmcnt(19) lgkmcnt(3)
v_mfma_f32_16x16x32_bf16 v[124:127], a[252:255], a[124:127], v[124:127]
ds_read_b64_tr_b16 a[238:239], v225 offset:26112
v_mfma_f32_16x16x32_bf16 v[128:131], a[224:227], a[0:3], v[128:131]
s_barrier
ds_read_b64_tr_b16 a[240:241], v226 offset:12288
v_mfma_f32_16x16x32_bf16 v[128:131], a[228:231], a[16:19], v[128:131]
buffer_load_dwordx4 v233, s[8:11], s30 offen offset:2048 nt lds
v_mfma_f32_16x16x32_bf16 v[136:139], a[224:227], a[4:7], v[136:139]
s_add_u32 m0, s28, 90112
v_mfma_f32_16x16x32_bf16 v[136:139], a[228:231], a[20:23], v[136:139]
ds_read_b64_tr_b16 a[242:243], v226 offset:13824
v_mfma_f32_16x16x32_bf16 v[144:147], a[224:227], a[8:11], v[144:147]
s_mov_b32 s30, 5505024
v_mfma_f32_16x16x32_bf16 v[144:147], a[228:231], a[24:27], v[144:147]
ds_read_b64_tr_b16 a[244:245], v226 offset:24576
v_mfma_f32_16x16x32_bf16 v[152:155], a[224:227], a[12:15], v[152:155]
s_waitcnt lgkmcnt(3)
ds_read_b64_tr_b16 a[246:247], v226 offset:26112
v_mfma_f32_16x16x32_bf16 v[152:155], a[228:231], a[28:31], v[152:155]
buffer_load_dwordx4 a[64:67], v243, s[20:23], s31 offen offset:0 sc1
v_mfma_f32_16x16x32_bf16 v[132:135], a[232:235], a[0:3], v[132:135]
ds_read_b64_tr_b16 a[248:249], v227 offset:12288
v_mfma_f32_16x16x32_bf16 v[132:135], a[236:239], a[16:19], v[132:135]
v_mfma_f32_16x16x32_bf16 v[140:143], a[232:235], a[4:7], v[140:143]
ds_read_b64_tr_b16 a[250:251], v227 offset:13824
v_mfma_f32_16x16x32_bf16 v[140:143], a[236:239], a[20:23], v[140:143]
v_mfma_f32_16x16x32_bf16 v[148:151], a[232:235], a[8:11], v[148:151]
ds_read_b64_tr_b16 a[252:253], v227 offset:24576
v_mfma_f32_16x16x32_bf16 v[148:151], a[236:239], a[24:27], v[148:151]
buffer_load_dwordx4 a[68:71], v243, s[20:23], s31 offen offset:256 sc1
v_mfma_f32_16x16x32_bf16 v[156:159], a[232:235], a[12:15], v[156:159]
s_waitcnt lgkmcnt(3)
v_mfma_f32_16x16x32_bf16 v[156:159], a[236:239], a[28:31], v[156:159]
ds_read_b64_tr_b16 a[254:255], v227 offset:26112
v_mfma_f32_16x16x32_bf16 v[160:163], a[240:243], a[0:3], v[160:163]
ds_read_b64_tr_b16 a[224:225], v224 offset:12416
v_mfma_f32_16x16x32_bf16 v[160:163], a[244:247], a[16:19], v[160:163]
v_mfma_f32_16x16x32_bf16 v[168:171], a[240:243], a[4:7], v[168:171]
ds_read_b64_tr_b16 a[226:227], v224 offset:13952
v_mfma_f32_16x16x32_bf16 v[168:171], a[244:247], a[20:23], v[168:171]
buffer_load_dwordx4 a[72:75], v243, s[20:23], s32 offen offset:0 sc1
v_mfma_f32_16x16x32_bf16 v[176:179], a[240:243], a[8:11], v[176:179]
ds_read_b64_tr_b16 a[228:229], v224 offset:24704
v_mfma_f32_16x16x32_bf16 v[176:179], a[244:247], a[24:27], v[176:179]
v_mfma_f32_16x16x32_bf16 v[184:187], a[240:243], a[12:15], v[184:187]
s_waitcnt lgkmcnt(3)
v_mfma_f32_16x16x32_bf16 v[184:187], a[244:247], a[28:31], v[184:187]
ds_read_b64_tr_b16 a[230:231], v224 offset:26240
v_mfma_f32_16x16x32_bf16 v[164:167], a[248:251], a[0:3], v[164:167]
ds_read_b64_tr_b16 a[232:233], v225 offset:12416
v_mfma_f32_16x16x32_bf16 v[164:167], a[252:255], a[16:19], v[164:167]
buffer_load_dwordx4 a[76:79], v243, s[20:23], s32 offen offset:256 sc1
v_mfma_f32_16x16x32_bf16 v[172:175], a[248:251], a[4:7], v[172:175]
ds_read_b64_tr_b16 a[234:235], v225 offset:13952
v_mfma_f32_16x16x32_bf16 v[172:175], a[252:255], a[20:23], v[172:175]
v_mfma_f32_16x16x32_bf16 v[180:183], a[248:251], a[8:11], v[180:183]
ds_read_b64_tr_b16 a[236:237], v225 offset:24704
v_mfma_f32_16x16x32_bf16 v[180:183], a[252:255], a[24:27], v[180:183]
v_mfma_f32_16x16x32_bf16 v[188:191], a[248:251], a[12:15], v[188:191]
s_waitcnt lgkmcnt(3)
ds_read_b64_tr_b16 a[238:239], v225 offset:26240
v_mfma_f32_16x16x32_bf16 v[188:191], a[252:255], a[28:31], v[188:191]
buffer_load_dwordx4 a[80:83], v243, s[20:23], s31 offen offset:2048 sc1
v_mfma_f32_16x16x32_bf16 v[0:3], a[224:227], a[0:3], v[0:3]
ds_read_b64_tr_b16 a[240:241], v226 offset:12416
v_mfma_f32_16x16x32_bf16 v[0:3], a[228:231], a[16:19], v[0:3]
v_mfma_f32_16x16x32_bf16 v[8:11], a[224:227], a[4:7], v[8:11]
ds_read_b64_tr_b16 a[242:243], v226 offset:13952
v_mfma_f32_16x16x32_bf16 v[8:11], a[228:231], a[20:23], v[8:11]
v_mfma_f32_16x16x32_bf16 v[16:19], a[224:227], a[8:11], v[16:19]
ds_read_b64_tr_b16 a[244:245], v226 offset:24704
v_mfma_f32_16x16x32_bf16 v[16:19], a[228:231], a[24:27], v[16:19]
buffer_load_dwordx4 a[84:87], v243, s[20:23], s31 offen offset:2304 sc1
v_mfma_f32_16x16x32_bf16 v[24:27], a[224:227], a[12:15], v[24:27]
s_waitcnt lgkmcnt(3)
v_mfma_f32_16x16x32_bf16 v[24:27], a[228:231], a[28:31], v[24:27]
ds_read_b64_tr_b16 a[246:247], v226 offset:26240
v_mfma_f32_16x16x32_bf16 v[4:7], a[232:235], a[0:3], v[4:7]
ds_read_b64_tr_b16 a[248:249], v227 offset:12416
v_mfma_f32_16x16x32_bf16 v[4:7], a[236:239], a[16:19], v[4:7]
v_mfma_f32_16x16x32_bf16 v[12:15], a[232:235], a[4:7], v[12:15]
ds_read_b64_tr_b16 a[250:251], v227 offset:13952
v_mfma_f32_16x16x32_bf16 v[12:15], a[236:239], a[20:23], v[12:15]
buffer_load_dwordx4 a[88:91], v243, s[20:23], s32 offen offset:2048 sc1
v_mfma_f32_16x16x32_bf16 v[20:23], a[232:235], a[8:11], v[20:23]
ds_read_b64_tr_b16 a[252:253], v227 offset:24704
v_mfma_f32_16x16x32_bf16 v[20:23], a[236:239], a[24:27], v[20:23]
v_mfma_f32_16x16x32_bf16 v[28:31], a[232:235], a[12:15], v[28:31]
s_waitcnt lgkmcnt(3)
v_mfma_f32_16x16x32_bf16 v[28:31], a[236:239], a[28:31], v[28:31]
ds_read_b64_tr_b16 a[254:255], v227 offset:26240
v_mfma_f32_16x16x32_bf16 v[32:35], a[240:243], a[0:3], v[32:35]
ds_read_b64_tr_b16 a[224:225], v224 offset:12544
v_mfma_f32_16x16x32_bf16 v[32:35], a[244:247], a[16:19], v[32:35]
buffer_load_dwordx4 a[92:95], v243, s[20:23], s32 offen offset:2304 sc1
v_mfma_f32_16x16x32_bf16 v[40:43], a[240:243], a[4:7], v[40:43]
s_mov_b32 s31, 28672
v_mfma_f32_16x16x32_bf16 v[40:43], a[244:247], a[20:23], v[40:43]
ds_read_b64_tr_b16 a[226:227], v224 offset:14080
v_mfma_f32_16x16x32_bf16 v[48:51], a[240:243], a[8:11], v[48:51]
s_mov_b32 s32, 69632
v_mfma_f32_16x16x32_bf16 v[48:51], a[244:247], a[24:27], v[48:51]
ds_read_b64_tr_b16 a[228:229], v224 offset:24832
v_mfma_f32_16x16x32_bf16 v[56:59], a[240:243], a[12:15], v[56:59]
s_waitcnt lgkmcnt(3)
ds_read_b64_tr_b16 a[230:231], v224 offset:26368
v_mfma_f32_16x16x32_bf16 v[56:59], a[244:247], a[28:31], v[56:59]
buffer_load_dwordx4 v231, s[8:11], s30 offen offset:0 nt lds
v_mfma_f32_16x16x32_bf16 v[36:39], a[248:251], a[0:3], v[36:39]
ds_read_b64_tr_b16 a[232:233], v225 offset:12544
v_mfma_f32_16x16x32_bf16 v[36:39], a[252:255], a[16:19], v[36:39]
v_mfma_f32_16x16x32_bf16 v[44:47], a[248:251], a[4:7], v[44:47]
ds_read_b64_tr_b16 a[234:235], v225 offset:14080
v_mfma_f32_16x16x32_bf16 v[44:47], a[252:255], a[20:23], v[44:47]
v_mfma_f32_16x16x32_bf16 v[52:55], a[248:251], a[8:11], v[52:55]
ds_read_b64_tr_b16 a[236:237], v225 offset:24832
v_mfma_f32_16x16x32_bf16 v[52:55], a[252:255], a[24:27], v[52:55]
buffer_load_dwordx4 v232, s[8:11], s30 offen offset:1024 nt lds
v_mfma_f32_16x16x32_bf16 v[60:63], a[248:251], a[12:15], v[60:63]
s_waitcnt lgkmcnt(3)
v_mfma_f32_16x16x32_bf16 v[60:63], a[252:255], a[28:31], v[60:63]
ds_read_b64_tr_b16 a[238:239], v225 offset:26368
v_mfma_f32_16x16x32_bf16 v[64:67], a[224:227], a[0:3], v[64:67]
ds_read_b64_tr_b16 a[240:241], v226 offset:12544
v_mfma_f32_16x16x32_bf16 v[64:67], a[228:231], a[16:19], v[64:67]
v_mfma_f32_16x16x32_bf16 v[72:75], a[224:227], a[4:7], v[72:75]
ds_read_b64_tr_b16 a[242:243], v226 offset:14080
v_mfma_f32_16x16x32_bf16 v[72:75], a[228:231], a[20:23], v[72:75]
buffer_load_dwordx4 v233, s[8:11], s30 offen offset:2048 nt lds
v_mfma_f32_16x16x32_bf16 v[80:83], a[224:227], a[8:11], v[80:83]
s_add_u32 m0, s28, 102400
v_mfma_f32_16x16x32_bf16 v[80:83], a[228:231], a[24:27], v[80:83]
ds_read_b64_tr_b16 a[244:245], v226 offset:24832
v_mfma_f32_16x16x32_bf16 v[88:91], a[224:227], a[12:15], v[88:91]
s_waitcnt lgkmcnt(3)
v_mfma_f32_16x16x32_bf16 v[88:91], a[228:231], a[28:31], v[88:91]
ds_read_b64_tr_b16 a[246:247], v226 offset:26368
v_mfma_f32_16x16x32_bf16 v[68:71], a[232:235], a[0:3], v[68:71]
s_mov_b32 s30, 5898240
v_mfma_f32_16x16x32_bf16 v[68:71], a[236:239], a[16:19], v[68:71]
ds_read_b64_tr_b16 a[248:249], v227 offset:12544
v_mfma_f32_16x16x32_bf16 v[76:79], a[232:235], a[4:7], v[76:79]
ds_read_b64_tr_b16 a[250:251], v227 offset:14080
v_mfma_f32_16x16x32_bf16 v[76:79], a[236:239], a[20:23], v[76:79]
buffer_load_dwordx4 v231, s[8:11], s30 offen offset:0 nt lds
v_mfma_f32_16x16x32_bf16 v[84:87], a[232:235], a[8:11], v[84:87]
ds_read_b64_tr_b16 a[252:253], v227 offset:24832
v_mfma_f32_16x16x32_bf16 v[84:87], a[236:239], a[24:27], v[84:87]
v_mfma_f32_16x16x32_bf16 v[92:95], a[232:235], a[12:15], v[92:95]
s_waitcnt vmcnt(26) lgkmcnt(3)
v_mfma_f32_16x16x32_bf16 v[92:95], a[236:239], a[28:31], v[92:95]
ds_read_b64_tr_b16 a[254:255], v227 offset:26368
v_mfma_f32_16x16x32_bf16 v[96:99], a[240:243], a[0:3], v[96:99]
s_barrier
ds_read_b64_tr_b16 a[224:225], v224 offset:36864
v_mfma_f32_16x16x32_bf16 v[96:99], a[244:247], a[16:19], v[96:99]
buffer_load_dwordx4 v232, s[8:11], s30 offen offset:1024 nt lds
v_mfma_f32_16x16x32_bf16 v[104:107], a[240:243], a[4:7], v[104:107]
ds_read_b64_tr_b16 a[226:227], v224 offset:38400
v_mfma_f32_16x16x32_bf16 v[104:107], a[244:247], a[20:23], v[104:107]
v_mfma_f32_16x16x32_bf16 v[112:115], a[240:243], a[8:11], v[112:115]
ds_read_b64_tr_b16 a[228:229], v224 offset:49152
v_mfma_f32_16x16x32_bf16 v[112:115], a[244:247], a[24:27], v[112:115]
v_mfma_f32_16x16x32_bf16 v[120:123], a[240:243], a[12:15], v[120:123]
s_waitcnt lgkmcnt(3)
ds_read_b64_tr_b16 a[230:231], v224 offset:50688
v_mfma_f32_16x16x32_bf16 v[120:123], a[244:247], a[28:31], v[120:123]
buffer_load_dwordx4 v233, s[8:11], s30 offen offset:2048 nt lds
v_mfma_f32_16x16x32_bf16 v[100:103], a[248:251], a[0:3], v[100:103]
ds_read_b64_tr_b16 a[232:233], v225 offset:36864
v_mfma_f32_16x16x32_bf16 v[100:103], a[252:255], a[16:19], v[100:103]
v_mfma_f32_16x16x32_bf16 v[108:111], a[248:251], a[4:7], v[108:111]
ds_read_b64_tr_b16 a[234:235], v225 offset:38400
v_mfma_f32_16x16x32_bf16 v[108:111], a[252:255], a[20:23], v[108:111]
v_mfma_f32_16x16x32_bf16 v[116:119], a[248:251], a[8:11], v[116:119]
ds_read_b64_tr_b16 a[236:237], v225 offset:49152
v_mfma_f32_16x16x32_bf16 v[116:119], a[252:255], a[24:27], v[116:119]
buffer_load_dwordx4 a[96:99], v243, s[20:23], s31 offen offset:0 sc1
v_mfma_f32_16x16x32_bf16 v[124:127], a[248:251], a[12:15], v[124:127]
s_waitcnt vmcnt(21) lgkmcnt(3)
v_mfma_f32_16x16x32_bf16 v[124:127], a[252:255], a[28:31], v[124:127]
ds_read_b64_tr_b16 a[238:239], v225 offset:50688
v_mfma_f32_16x16x32_bf16 v[128:131], a[224:227], a[32:35], v[128:131]
s_barrier
v_mfma_f32_16x16x32_bf16 v[128:131], a[228:231], a[48:51], v[128:131]
ds_read_b64_tr_b16 a[240:241], v226 offset:36864
v_mfma_f32_16x16x32_bf16 v[136:139], a[224:227], a[36:39], v[136:139]
s_add_u32 m0, s28, 114688
ds_read_b64_tr_b16 a[242:243], v226 offset:38400
v_mfma_f32_16x16x32_bf16 v[136:139], a[228:231], a[52:55], v[136:139]
buffer_load_dwordx4 a[100:103], v243, s[20:23], s31 offen offset:256 sc1
v_mfma_f32_16x16x32_bf16 v[144:147], a[224:227], a[40:43], v[144:147]
s_mov_b32 s30, 6291456
v_mfma_f32_16x16x32_bf16 v[144:147], a[228:231], a[56:59], v[144:147]
ds_read_b64_tr_b16 a[244:245], v226 offset:49152
v_mfma_f32_16x16x32_bf16 v[152:155], a[224:227], a[44:47], v[152:155]
s_waitcnt lgkmcnt(3)
v_mfma_f32_16x16x32_bf16 v[152:155], a[228:231], a[60:63], v[152:155]
ds_read_b64_tr_b16 a[246:247], v226 offset:50688
v_mfma_f32_16x16x32_bf16 v[132:135], a[232:235], a[32:35], v[132:135]
ds_read_b64_tr_b16 a[248:249], v227 offset:36864
v_mfma_f32_16x16x32_bf16 v[132:135], a[236:239], a[48:51], v[132:135]
buffer_load_dwordx4 a[104:107], v243, s[20:23], s32 offen offset:0 sc1
v_mfma_f32_16x16x32_bf16 v[140:143], a[232:235], a[36:39], v[140:143]
ds_read_b64_tr_b16 a[250:251], v227 offset:38400
v_mfma_f32_16x16x32_bf16 v[140:143], a[236:239], a[52:55], v[140:143]
v_mfma_f32_16x16x32_bf16 v[148:151], a[232:235], a[40:43], v[148:151]
ds_read_b64_tr_b16 a[252:253], v227 offset:49152
v_mfma_f32_16x16x32_bf16 v[148:151], a[236:239], a[56:59], v[148:151]
v_mfma_f32_16x16x32_bf16 v[156:159], a[232:235], a[44:47], v[156:159]
s_waitcnt lgkmcnt(3)
ds_read_b64_tr_b16 a[254:255], v227 offset:50688
v_mfma_f32_16x16x32_bf16 v[156:159], a[236:239], a[60:63], v[156:159]
buffer_load_dwordx4 a[108:111], v243, s[20:23], s32 offen offset:256 sc1
v_mfma_f32_16x16x32_bf16 v[160:163], a[240:243], a[32:35], v[160:163]
ds_read_b64_tr_b16 a[224:225], v224 offset:36992
v_mfma_f32_16x16x32_bf16 v[160:163], a[244:247], a[48:51], v[160:163]
v_mfma_f32_16x16x32_bf16 v[168:171], a[240:243], a[36:39], v[168:171]
ds_read_b64_tr_b16 a[226:227], v224 offset:38528
v_mfma_f32_16x16x32_bf16 v[168:171], a[244:247], a[52:55], v[168:171]
v_mfma_f32_16x16x32_bf16 v[176:179], a[240:243], a[40:43], v[176:179]
ds_read_b64_tr_b16 a[228:229], v224 offset:49280
v_mfma_f32_16x16x32_bf16 v[176:179], a[244:247], a[56:59], v[176:179]
buffer_load_dwordx4 a[112:115], v243, s[20:23], s31 offen offset:2048 sc1
v_mfma_f32_16x16x32_bf16 v[184:187], a[240:243], a[44:47], v[184:187]
s_waitcnt lgkmcnt(3)
v_mfma_f32_16x16x32_bf16 v[184:187], a[244:247], a[60:63], v[184:187]
ds_read_b64_tr_b16 a[230:231], v224 offset:50816
v_mfma_f32_16x16x32_bf16 v[164:167], a[248:251], a[32:35], v[164:167]
ds_read_b64_tr_b16 a[232:233], v225 offset:36992
v_mfma_f32_16x16x32_bf16 v[164:167], a[252:255], a[48:51], v[164:167]
v_mfma_f32_16x16x32_bf16 v[172:175], a[248:251], a[36:39], v[172:175]
ds_read_b64_tr_b16 a[234:235], v225 offset:38528
v_mfma_f32_16x16x32_bf16 v[172:175], a[252:255], a[52:55], v[172:175]
buffer_load_dwordx4 a[116:119], v243, s[20:23], s31 offen offset:2304 sc1
v_mfma_f32_16x16x32_bf16 v[180:183], a[248:251], a[40:43], v[180:183]
ds_read_b64_tr_b16 a[236:237], v225 offset:49280
v_mfma_f32_16x16x32_bf16 v[180:183], a[252:255], a[56:59], v[180:183]
v_mfma_f32_16x16x32_bf16 v[188:191], a[248:251], a[44:47], v[188:191]
s_waitcnt lgkmcnt(3)
v_mfma_f32_16x16x32_bf16 v[188:191], a[252:255], a[60:63], v[188:191]
ds_read_b64_tr_b16 a[238:239], v225 offset:50816
v_mfma_f32_16x16x32_bf16 v[0:3], a[224:227], a[32:35], v[0:3]
ds_read_b64_tr_b16 a[240:241], v226 offset:36992
v_mfma_f32_16x16x32_bf16 v[0:3], a[228:231], a[48:51], v[0:3]
buffer_load_dwordx4 a[120:123], v243, s[20:23], s32 offen offset:2048 sc1
v_mfma_f32_16x16x32_bf16 v[8:11], a[224:227], a[36:39], v[8:11]
ds_read_b64_tr_b16 a[242:243], v226 offset:38528
v_mfma_f32_16x16x32_bf16 v[8:11], a[228:231], a[52:55], v[8:11]
v_mfma_f32_16x16x32_bf16 v[16:19], a[224:227], a[40:43], v[16:19]
ds_read_b64_tr_b16 a[244:245], v226 offset:49280
v_mfma_f32_16x16x32_bf16 v[16:19], a[228:231], a[56:59], v[16:19]
v_mfma_f32_16x16x32_bf16 v[24:27], a[224:227], a[44:47], v[24:27]
s_waitcnt lgkmcnt(3)
ds_read_b64_tr_b16 a[246:247], v226 offset:50816
v_mfma_f32_16x16x32_bf16 v[24:27], a[228:231], a[60:63], v[24:27]
buffer_load_dwordx4 a[124:127], v243, s[20:23], s32 offen offset:2304 sc1
v_mfma_f32_16x16x32_bf16 v[4:7], a[232:235], a[32:35], v[4:7]
s_mov_b32 s31, 32768
v_mfma_f32_16x16x32_bf16 v[4:7], a[236:239], a[48:51], v[4:7]
ds_read_b64_tr_b16 a[248:249], v227 offset:36992
v_mfma_f32_16x16x32_bf16 v[12:15], a[232:235], a[36:39], v[12:15]
s_mov_b32 s32, 73728
v_mfma_f32_16x16x32_bf16 v[12:15], a[236:239], a[52:55], v[12:15]
ds_read_b64_tr_b16 a[250:251], v227 offset:38528
v_mfma_f32_16x16x32_bf16 v[20:23], a[232:235], a[40:43], v[20:23]
ds_read_b64_tr_b16 a[252:253], v227 offset:49280
v_mfma_f32_16x16x32_bf16 v[20:23], a[236:239], a[56:59], v[20:23]
buffer_load_dwordx4 v231, s[8:11], s30 offen offset:0 nt lds
v_mfma_f32_16x16x32_bf16 v[28:31], a[232:235], a[44:47], v[28:31]
s_waitcnt lgkmcnt(3)
v_mfma_f32_16x16x32_bf16 v[28:31], a[236:239], a[60:63], v[28:31]
ds_read_b64_tr_b16 a[254:255], v227 offset:50816
v_mfma_f32_16x16x32_bf16 v[32:35], a[240:243], a[32:35], v[32:35]
ds_read_b64_tr_b16 a[224:225], v224 offset:37120
v_mfma_f32_16x16x32_bf16 v[32:35], a[244:247], a[48:51], v[32:35]
v_mfma_f32_16x16x32_bf16 v[40:43], a[240:243], a[36:39], v[40:43]
ds_read_b64_tr_b16 a[226:227], v224 offset:38656
v_mfma_f32_16x16x32_bf16 v[40:43], a[244:247], a[52:55], v[40:43]
buffer_load_dwordx4 v232, s[8:11], s30 offen offset:1024 nt lds
v_mfma_f32_16x16x32_bf16 v[48:51], a[240:243], a[40:43], v[48:51]
ds_read_b64_tr_b16 a[228:229], v224 offset:49408
v_mfma_f32_16x16x32_bf16 v[48:51], a[244:247], a[56:59], v[48:51]
v_mfma_f32_16x16x32_bf16 v[56:59], a[240:243], a[44:47], v[56:59]
s_waitcnt lgkmcnt(3)
v_mfma_f32_16x16x32_bf16 v[56:59], a[244:247], a[60:63], v[56:59]
ds_read_b64_tr_b16 a[230:231], v224 offset:50944
v_mfma_f32_16x16x32_bf16 v[36:39], a[248:251], a[32:35], v[36:39]
ds_read_b64_tr_b16 a[232:233], v225 offset:37120
v_mfma_f32_16x16x32_bf16 v[36:39], a[252:255], a[48:51], v[36:39]
buffer_load_dwordx4 v233, s[8:11], s30 offen offset:2048 nt lds
v_mfma_f32_16x16x32_bf16 v[44:47], a[248:251], a[36:39], v[44:47]
s_add_u32 m0, s28, 126976
v_mfma_f32_16x16x32_bf16 v[44:47], a[252:255], a[52:55], v[44:47]
ds_read_b64_tr_b16 a[234:235], v225 offset:38656
v_mfma_f32_16x16x32_bf16 v[52:55], a[248:251], a[40:43], v[52:55]
s_mov_b32 s30, 6684672
v_mfma_f32_16x16x32_bf16 v[52:55], a[252:255], a[56:59], v[52:55]
ds_read_b64_tr_b16 a[236:237], v225 offset:49408
v_mfma_f32_16x16x32_bf16 v[60:63], a[248:251], a[44:47], v[60:63]
s_waitcnt lgkmcnt(3)
ds_read_b64_tr_b16 a[238:239], v225 offset:50944
v_mfma_f32_16x16x32_bf16 v[60:63], a[252:255], a[60:63], v[60:63]
buffer_load_dwordx4 v231, s[8:11], s30 offen offset:0 nt lds
v_mfma_f32_16x16x32_bf16 v[64:67], a[224:227], a[32:35], v[64:67]
ds_read_b64_tr_b16 a[240:241], v226 offset:37120
v_mfma_f32_16x16x32_bf16 v[64:67], a[228:231], a[48:51], v[64:67]
v_mfma_f32_16x16x32_bf16 v[72:75], a[224:227], a[36:39], v[72:75]
ds_read_b64_tr_b16 a[242:243], v226 offset:38656
v_mfma_f32_16x16x32_bf16 v[72:75], a[228:231], a[52:55], v[72:75]
L_pg2:
s_cbranch_execz L_pg6
v_mfma_f32_16x16x32_bf16 v[80:83], a[224:227], a[40:43], v[80:83]
ds_read_b64_tr_b16 a[244:245], v226 offset:49408
v_mfma_f32_16x16x32_bf16 v[80:83], a[228:231], a[56:59], v[80:83]
buffer_load_dwordx4 v232, s[8:11], s30 offen offset:1024 nt lds
v_mfma_f32_16x16x32_bf16 v[88:91], a[224:227], a[44:47], v[88:91]
s_waitcnt lgkmcnt(3)
v_mfma_f32_16x16x32_bf16 v[88:91], a[228:231], a[60:63], v[88:91]
ds_read_b64_tr_b16 a[246:247], v226 offset:50944
v_mfma_f32_16x16x32_bf16 v[68:71], a[232:235], a[32:35], v[68:71]
ds_read_b64_tr_b16 a[248:249], v227 offset:37120
v_mfma_f32_16x16x32_bf16 v[68:71], a[236:239], a[48:51], v[68:71]
v_mfma_f32_16x16x32_bf16 v[76:79], a[232:235], a[36:39], v[76:79]
ds_read_b64_tr_b16 a[250:251], v227 offset:38656
v_mfma_f32_16x16x32_bf16 v[76:79], a[236:239], a[52:55], v[76:79]
buffer_load_dwordx4 v233, s[8:11], s30 offen offset:2048 nt lds
v_mfma_f32_16x16x32_bf16 v[84:87], a[232:235], a[40:43], v[84:87]
ds_read_b64_tr_b16 a[252:253], v227 offset:49408
v_mfma_f32_16x16x32_bf16 v[84:87], a[236:239], a[56:59], v[84:87]
v_mfma_f32_16x16x32_bf16 v[92:95], a[232:235], a[44:47], v[92:95]
s_waitcnt vmcnt(28) lgkmcnt(3)
ds_read_b64_tr_b16 a[254:255], v227 offset:50944
v_add_u32 v224, 4294930432, v224
v_mfma_f32_16x16x32_bf16 v[92:95], a[236:239], a[60:63], v[92:95]
v_add_u32 v225, 4294930432, v225
v_add_u32 v226, 4294930432, v226
v_add_u32 v227, 4294930432, v227
v_mfma_f32_16x16x32_bf16 v[96:99], a[240:243], a[32:35], v[96:99]
s_barrier
ds_read_b64_tr_b16 a[224:225], v224 offset:0
v_mfma_f32_16x16x32_bf16 v[96:99], a[244:247], a[48:51], v[96:99]
buffer_load_dwordx4 a[0:3], v243, s[20:23], s31 offen offset:0 sc1
v_mfma_f32_16x16x32_bf16 v[104:107], a[240:243], a[36:39], v[104:107]
ds_read_b64_tr_b16 a[226:227], v224 offset:1536
v_mfma_f32_16x16x32_bf16 v[104:107], a[244:247], a[52:55], v[104:107]
v_mfma_f32_16x16x32_bf16 v[112:115], a[240:243], a[40:43], v[112:115]
ds_read_b64_tr_b16 a[228:229], v224 offset:12288
v_mfma_f32_16x16x32_bf16 v[112:115], a[244:247], a[56:59], v[112:115]
v_mfma_f32_16x16x32_bf16 v[120:123], a[240:243], a[44:47], v[120:123]
s_waitcnt lgkmcnt(3)
ds_read_b64_tr_b16 a[230:231], v224 offset:13824
v_mfma_f32_16x16x32_bf16 v[120:123], a[244:247], a[60:63], v[120:123]
buffer_load_dwordx4 a[4:7], v243, s[20:23], s31 offen offset:256 sc1
v_mfma_f32_16x16x32_bf16 v[100:103], a[248:251], a[32:35], v[100:103]
ds_read_b64_tr_b16 a[232:233], v225 offset:0
v_mfma_f32_16x16x32_bf16 v[100:103], a[252:255], a[48:51], v[100:103]
v_mfma_f32_16x16x32_bf16 v[108:111], a[248:251], a[36:39], v[108:111]
ds_read_b64_tr_b16 a[234:235], v225 offset:1536
v_mfma_f32_16x16x32_bf16 v[108:111], a[252:255], a[52:55], v[108:111]
v_mfma_f32_16x16x32_bf16 v[116:119], a[248:251], a[40:43], v[116:119]
ds_read_b64_tr_b16 a[236:237], v225 offset:12288
v_mfma_f32_16x16x32_bf16 v[116:119], a[252:255], a[56:59], v[116:119]
buffer_load_dwordx4 a[8:11], v243, s[20:23], s32 offen offset:0 sc1
v_mfma_f32_16x16x32_bf16 v[124:127], a[248:251], a[44:47], v[124:127]
s_waitcnt vmcnt(23) lgkmcnt(3)
v_mfma_f32_16x16x32_bf16 v[124:127], a[252:255], a[60:63], v[124:127]
ds_read_b64_tr_b16 a[238:239], v225 offset:13824
v_mfma_f32_16x16x32_bf16 v[128:131], a[224:227], a[64:67], v[128:131]
s_barrier
v_mfma_f32_16x16x32_bf16 v[128:131], a[228:231], a[80:83], v[128:131]
ds_read_b64_tr_b16 a[240:241], v226 offset:0
v_mfma_f32_16x16x32_bf16 v[136:139], a[224:227], a[68:71], v[136:139]
s_add_u32 m0, s28, 139264
ds_read_b64_tr_b16 a[242:243], v226 offset:1536
v_mfma_f32_16x16x32_bf16 v[136:139], a[228:231], a[84:87], v[136:139]
buffer_load_dwordx4 a[12:15], v243, s[20:23], s32 offen offset:256 sc1
v_mfma_f32_16x16x32_bf16 v[144:147], a[224:227], a[72:75], v[144:147]
s_mov_b32 s30, 7077888
v_mfma_f32_16x16x32_bf16 v[144:147], a[228:231], a[88:91], v[144:147]
ds_read_b64_tr_b16 a[244:245], v226 offset:12288
v_mfma_f32_16x16x32_bf16 v[152:155], a[224:227], a[76:79], v[152:155]
s_waitcnt lgkmcnt(3)
v_mfma_f32_16x16x32_bf16 v[152:155], a[228:231], a[92:95], v[152:155]
ds_read_b64_tr_b16 a[246:247], v226 offset:13824
v_mfma_f32_16x16x32_bf16 v[132:135], a[232:235], a[64:67], v[132:135]
ds_read_b64_tr_b16 a[248:249], v227 offset:0
v_mfma_f32_16x16x32_bf16 v[132:135], a[236:239], a[80:83], v[132:135]
buffer_load_dwordx4 a[16:19], v243, s[20:23], s31 offen offset:2048 sc1
v_mfma_f32_16x16x32_bf16 v[140:143], a[232:235], a[68:71], v[140:143]
ds_read_b64_tr_b16 a[250:251], v227 offset:1536
v_mfma_f32_16x16x32_bf16 v[140:143], a[236:239], a[84:87], v[140:143]
v_mfma_f32_16x16x32_bf16 v[148:151], a[232:235], a[72:75], v[148:151]
ds_read_b64_tr_b16 a[252:253], v227 offset:12288
v_mfma_f32_16x16x32_bf16 v[148:151], a[236:239], a[88:91], v[148:151]
v_mfma_f32_16x16x32_bf16 v[156:159], a[232:235], a[76:79], v[156:159]
s_waitcnt lgkmcnt(3)
ds_read_b64_tr_b16 a[254:255], v227 offset:13824
v_mfma_f32_16x16x32_bf16 v[156:159], a[236:239], a[92:95], v[156:159]
buffer_load_dwordx4 a[20:23], v243, s[20:23], s31 offen offset:2304 sc1
v_mfma_f32_16x16x32_bf16 v[160:163], a[240:243], a[64:67], v[160:163]
ds_read_b64_tr_b16 a[224:225], v224 offset:128
v_mfma_f32_16x16x32_bf16 v[160:163], a[244:247], a[80:83], v[160:163]
v_mfma_f32_16x16x32_bf16 v[168:171], a[240:243], a[68:71], v[168:171]
ds_read_b64_tr_b16 a[226:227], v224 offset:1664
v_mfma_f32_16x16x32_bf16 v[168:171], a[244:247], a[84:87], v[168:171]
v_mfma_f32_16x16x32_bf16 v[176:179], a[240:243], a[72:75], v[176:179]
ds_read_b64_tr_b16 a[228:229], v224 offset:12416
v_mfma_f32_16x16x32_bf16 v[176:179], a[244:247], a[88:91], v[176:179]
buffer_load_dwordx4 a[24:27], v243, s[20:23], s32 offen offset:2048 sc1
v_mfma_f32_16x16x32_bf16 v[184:187], a[240:243], a[76:79], v[184:187]
s_waitcnt lgkmcnt(3)
v_mfma_f32_16x16x32_bf16 v[184:187], a[244:247], a[92:95], v[184:187]
ds_read_b64_tr_b16 a[230:231], v224 offset:13952
v_mfma_f32_16x16x32_bf16 v[164:167], a[248:251], a[64:67], v[164:167]
ds_read_b64_tr_b16 a[232:233], v225 offset:128
v_mfma_f32_16x16x32_bf16 v[164:167], a[252:255], a[80:83], v[164:167]
v_mfma_f32_16x16x32_bf16 v[172:175], a[248:251], a[68:71], v[172:175]
ds_read_b64_tr_b16 a[234:235], v225 offset:1664
v_mfma_f32_16x16x32_bf16 v[172:175], a[252:255], a[84:87], v[172:175]
buffer_load_dwordx4 a[28:31], v243, s[20:23], s32 offen offset:2304 sc1
v_mfma_f32_16x16x32_bf16 v[180:183], a[248:251], a[72:75], v[180:183]
s_mov_b32 s31, 36864
v_mfma_f32_16x16x32_bf16 v[180:183], a[252:255], a[88:91], v[180:183]
ds_read_b64_tr_b16 a[236:237], v225 offset:12416
v_mfma_f32_16x16x32_bf16 v[188:191], a[248:251], a[76:79], v[188:191]
s_waitcnt lgkmcnt(3)
v_mfma_f32_16x16x32_bf16 v[188:191], a[252:255], a[92:95], v[188:191]
ds_read_b64_tr_b16 a[238:239], v225 offset:13952
v_mfma_f32_16x16x32_bf16 v[0:3], a[224:227], a[64:67], v[0:3]
s_mov_b32 s32, 77824
ds_read_b64_tr_b16 a[240:241], v226 offset:128
v_mfma_f32_16x16x32_bf16 v[0:3], a[228:231], a[80:83], v[0:3]
buffer_load_dwordx4 v231, s[8:11], s30 offen offset:0 nt lds
v_mfma_f32_16x16x32_bf16 v[8:11], a[224:227], a[68:71], v[8:11]
ds_read_b64_tr_b16 a[242:243], v226 offset:1664
v_mfma_f32_16x16x32_bf16 v[8:11], a[228:231], a[84:87], v[8:11]
v_mfma_f32_16x16x32_bf16 v[16:19], a[224:227], a[72:75], v[16:19]
ds_read_b64_tr_b16 a[244:245], v226 offset:12416
v_mfma_f32_16x16x32_bf16 v[16:19], a[228:231], a[88:91], v[16:19]
v_mfma_f32_16x16x32_bf16 v[24:27], a[224:227], a[76:79], v[24:27]
s_waitcnt lgkmcnt(3)
ds_read_b64_tr_b16 a[246:247], v226 offset:13952
v_mfma_f32_16x16x32_bf16 v[24:27], a[228:231], a[92:95], v[24:27]
buffer_load_dwordx4 v232, s[8:11], s30 offen offset:1024 nt lds
v_mfma_f32_16x16x32_bf16 v[4:7], a[232:235], a[64:67], v[4:7]
ds_read_b64_tr_b16 a[248:249], v227 offset:128
v_mfma_f32_16x16x32_bf16 v[4:7], a[236:239], a[80:83], v[4:7]
v_mfma_f32_16x16x32_bf16 v[12:15], a[232:235], a[68:71], v[12:15]
ds_read_b64_tr_b16 a[250:251], v227 offset:1664
v_mfma_f32_16x16x32_bf16 v[12:15], a[236:239], a[84:87], v[12:15]
v_mfma_f32_16x16x32_bf16 v[20:23], a[232:235], a[72:75], v[20:23]
ds_read_b64_tr_b16 a[252:253], v227 offset:12416
v_mfma_f32_16x16x32_bf16 v[20:23], a[236:239], a[88:91], v[20:23]
buffer_load_dwordx4 v233, s[8:11], s30 offen offset:2048 nt lds
v_mfma_f32_16x16x32_bf16 v[28:31], a[232:235], a[76:79], v[28:31]
s_waitcnt lgkmcnt(3)
v_mfma_f32_16x16x32_bf16 v[28:31], a[236:239], a[92:95], v[28:31]
ds_read_b64_tr_b16 a[254:255], v227 offset:13952
v_mfma_f32_16x16x32_bf16 v[32:35], a[240:243], a[64:67], v[32:35]
s_add_u32 m0, s28, 151552
v_mfma_f32_16x16x32_bf16 v[32:35], a[244:247], a[80:83], v[32:35]
ds_read_b64_tr_b16 a[224:225], v224 offset:256
v_mfma_f32_16x16x32_bf16 v[40:43], a[240:243], a[68:71], v[40:43]
s_mov_b32 s30, 7471104
v_mfma_f32_16x16x32_bf16 v[40:43], a[244:247], a[84:87], v[40:43]
ds_read_b64_tr_b16 a[226:227], v224 offset:1792
v_mfma_f32_16x16x32_bf16 v[48:51], a[240:243], a[72:75], v[48:51]
ds_read_b64_tr_b16 a[228:229], v224 offset:12544
v_mfma_f32_16x16x32_bf16 v[48:51], a[244:247], a[88:91], v[48:51]
buffer_load_dwordx4 v231, s[8:11], s30 offen offset:0 nt lds
v_mfma_f32_16x16x32_bf16 v[56:59], a[240:243], a[76:79], v[56:59]
s_waitcnt lgkmcnt(3)
v_mfma_f32_16x16x32_bf16 v[56:59], a[244:247], a[92:95], v[56:59]
ds_read_b64_tr_b16 a[230:231], v224 offset:14080
v_mfma_f32_16x16x32_bf16 v[36:39], a[248:251], a[64:67], v[36:39]
ds_read_b64_tr_b16 a[232:233], v225 offset:256
v_mfma_f32_16x16x32_bf16 v[36:39], a[252:255], a[80:83], v[36:39]
v_mfma_f32_16x16x32_bf16 v[44:47], a[248:251], a[68:71], v[44:47]
ds_read_b64_tr_b16 a[234:235], v225 offset:1792
v_mfma_f32_16x16x32_bf16 v[44:47], a[252:255], a[84:87], v[44:47]
buffer_load_dwordx4 v232, s[8:11], s30 offen offset:1024 nt lds
v_mfma_f32_16x16x32_bf16 v[52:55], a[248:251], a[72:75], v[52:55]
ds_read_b64_tr_b16 a[236:237], v225 offset:12544
v_mfma_f32_16x16x32_bf16 v[52:55], a[252:255], a[88:91], v[52:55]
v_mfma_f32_16x16x32_bf16 v[60:63], a[248:251], a[76:79], v[60:63]
s_waitcnt lgkmcnt(3)
v_mfma_f32_16x16x32_bf16 v[60:63], a[252:255], a[92:95], v[60:63]
ds_read_b64_tr_b16 a[238:239], v225 offset:14080
v_mfma_f32_16x16x32_bf16 v[64:67], a[224:227], a[64:67], v[64:67]
ds_read_b64_tr_b16 a[240:241], v226 offset:256
v_mfma_f32_16x16x32_bf16 v[64:67], a[228:231], a[80:83], v[64:67]
buffer_load_dwordx4 v233, s[8:11], s30 offen offset:2048 nt lds
v_mfma_f32_16x16x32_bf16 v[72:75], a[224:227], a[68:71], v[72:75]
ds_read_b64_tr_b16 a[242:243], v226 offset:1792
v_mfma_f32_16x16x32_bf16 v[72:75], a[228:231], a[84:87], v[72:75]
v_mfma_f32_16x16x32_bf16 v[80:83], a[224:227], a[72:75], v[80:83]
ds_read_b64_tr_b16 a[244:245], v226 offset:12544
v_mfma_f32_16x16x32_bf16 v[80:83], a[228:231], a[88:91], v[80:83]
v_mfma_f32_16x16x32_bf16 v[88:91], a[224:227], a[76:79], v[88:91]
s_waitcnt lgkmcnt(3)
ds_read_b64_tr_b16 a[246:247], v226 offset:14080
v_mfma_f32_16x16x32_bf16 v[88:91], a[228:231], a[92:95], v[88:91]
buffer_load_dwordx4 a[32:35], v243, s[20:23], s31 offen offset:0 sc1
v_mfma_f32_16x16x32_bf16 v[68:71], a[232:235], a[64:67], v[68:71]
ds_read_b64_tr_b16 a[248:249], v227 offset:256
v_mfma_f32_16x16x32_bf16 v[68:71], a[236:239], a[80:83], v[68:71]
v_mfma_f32_16x16x32_bf16 v[76:79], a[232:235], a[68:71], v[76:79]
ds_read_b64_tr_b16 a[250:251], v227 offset:1792
v_mfma_f32_16x16x32_bf16 v[76:79], a[236:239], a[84:87], v[76:79]
v_mfma_f32_16x16x32_bf16 v[84:87], a[232:235], a[72:75], v[84:87]
ds_read_b64_tr_b16 a[252:253], v227 offset:12544
v_mfma_f32_16x16x32_bf16 v[84:87], a[236:239], a[88:91], v[84:87]
buffer_load_dwordx4 a[36:39], v243, s[20:23], s31 offen offset:256 sc1
v_mfma_f32_16x16x32_bf16 v[92:95], a[232:235], a[76:79], v[92:95]
s_waitcnt vmcnt(30) lgkmcnt(3)
v_mfma_f32_16x16x32_bf16 v[92:95], a[236:239], a[92:95], v[92:95]
ds_read_b64_tr_b16 a[254:255], v227 offset:14080
v_mfma_f32_16x16x32_bf16 v[96:99], a[240:243], a[64:67], v[96:99]
s_barrier
v_mfma_f32_16x16x32_bf16 v[96:99], a[244:247], a[80:83], v[96:99]
ds_read_b64_tr_b16 a[224:225], v224 offset:24576
v_mfma_f32_16x16x32_bf16 v[104:107], a[240:243], a[68:71], v[104:107]
s_add_u32 m0, s29, 0
ds_read_b64_tr_b16 a[226:227], v224 offset:26112
v_mfma_f32_16x16x32_bf16 v[104:107], a[244:247], a[84:87], v[104:107]
buffer_load_dwordx4 a[40:43], v243, s[20:23], s32 offen offset:0 sc1
v_mfma_f32_16x16x32_bf16 v[112:115], a[240:243], a[72:75], v[112:115]
s_mov_b32 s30, 0
v_mfma_f32_16x16x32_bf16 v[112:115], a[244:247], a[88:91], v[112:115]
ds_read_b64_tr_b16 a[228:229], v224 offset:36864
v_mfma_f32_16x16x32_bf16 v[120:123], a[240:243], a[76:79], v[120:123]
s_waitcnt lgkmcnt(3)
v_mfma_f32_16x16x32_bf16 v[120:123], a[244:247], a[92:95], v[120:123]
ds_read_b64_tr_b16 a[230:231], v224 offset:38400
v_mfma_f32_16x16x32_bf16 v[100:103], a[248:251], a[64:67], v[100:103]
ds_read_b64_tr_b16 a[232:233], v225 offset:24576
v_mfma_f32_16x16x32_bf16 v[100:103], a[252:255], a[80:83], v[100:103]
buffer_load_dwordx4 a[44:47], v243, s[20:23], s32 offen offset:256 sc1
v_mfma_f32_16x16x32_bf16 v[108:111], a[248:251], a[68:71], v[108:111]
ds_read_b64_tr_b16 a[234:235], v225 offset:26112
v_mfma_f32_16x16x32_bf16 v[108:111], a[252:255], a[84:87], v[108:111]
v_mfma_f32_16x16x32_bf16 v[116:119], a[248:251], a[72:75], v[116:119]
ds_read_b64_tr_b16 a[236:237], v225 offset:36864
v_mfma_f32_16x16x32_bf16 v[116:119], a[252:255], a[88:91], v[116:119]
v_mfma_f32_16x16x32_bf16 v[124:127], a[248:251], a[76:79], v[124:127]
s_waitcnt vmcnt(24) lgkmcnt(3)
ds_read_b64_tr_b16 a[238:239], v225 offset:38400
v_mfma_f32_16x16x32_bf16 v[124:127], a[252:255], a[92:95], v[124:127]
buffer_load_dwordx4 a[48:51], v243, s[20:23], s31 offen offset:2048 sc1
v_mfma_f32_16x16x32_bf16 v[128:131], a[224:227], a[96:99], v[128:131]
s_barrier
v_mfma_f32_16x16x32_bf16 v[128:131], a[228:231], a[112:115], v[128:131]
ds_read_b64_tr_b16 a[240:241], v226 offset:24576
v_mfma_f32_16x16x32_bf16 v[136:139], a[224:227], a[100:103], v[136:139]
ds_read_b64_tr_b16 a[242:243], v226 offset:26112
v_mfma_f32_16x16x32_bf16 v[136:139], a[228:231], a[116:119], v[136:139]
v_mfma_f32_16x16x32_bf16 v[144:147], a[224:227], a[104:107], v[144:147]
ds_read_b64_tr_b16 a[244:245], v226 offset:36864
v_mfma_f32_16x16x32_bf16 v[144:147], a[228:231], a[120:123], v[144:147]
buffer_load_dwordx4 a[52:55], v243, s[20:23], s31 offen offset:2304 sc1
v_mfma_f32_16x16x32_bf16 v[152:155], a[224:227], a[108:111], v[152:155]
s_waitcnt lgkmcnt(3)
v_mfma_f32_16x16x32_bf16 v[152:155], a[228:231], a[124:127], v[152:155]
ds_read_b64_tr_b16 a[246:247], v226 offset:38400
v_mfma_f32_16x16x32_bf16 v[132:135], a[232:235], a[96:99], v[132:135]
ds_read_b64_tr_b16 a[248:249], v227 offset:24576
v_mfma_f32_16x16x32_bf16 v[132:135], a[236:239], a[112:115], v[132:135]
v_mfma_f32_16x16x32_bf16 v[140:143], a[232:235], a[100:103], v[140:143]
ds_read_b64_tr_b16 a[250:251], v227 offset:26112
v_mfma_f32_16x16x32_bf16 v[140:143], a[236:239], a[116:119], v[140:143]
buffer_load_dwordx4 a[56:59], v243, s[20:23], s32 offen offset:2048 sc1
v_mfma_f32_16x16x32_bf16 v[148:151], a[232:235], a[104:107], v[148:151]
ds_read_b64_tr_b16 a[252:253], v227 offset:36864
v_mfma_f32_16x16x32_bf16 v[148:151], a[236:239], a[120:123], v[148:151]
v_mfma_f32_16x16x32_bf16 v[156:159], a[232:235], a[108:111], v[156:159]
s_waitcnt lgkmcnt(3)
v_mfma_f32_16x16x32_bf16 v[156:159], a[236:239], a[124:127], v[156:159]
ds_read_b64_tr_b16 a[254:255], v227 offset:38400
v_mfma_f32_16x16x32_bf16 v[160:163], a[240:243], a[96:99], v[160:163]
ds_read_b64_tr_b16 a[224:225], v224 offset:24704
v_mfma_f32_16x16x32_bf16 v[160:163], a[244:247], a[112:115], v[160:163]
buffer_load_dwordx4 a[60:63], v243, s[20:23], s32 offen offset:2304 sc1
v_mfma_f32_16x16x32_bf16 v[168:171], a[240:243], a[100:103], v[168:171]
ds_read_b64_tr_b16 a[226:227], v224 offset:26240
v_mfma_f32_16x16x32_bf16 v[168:171], a[244:247], a[116:119], v[168:171]
v_mfma_f32_16x16x32_bf16 v[176:179], a[240:243], a[104:107], v[176:179]
ds_read_b64_tr_b16 a[228:229], v224 offset:36992
v_mfma_f32_16x16x32_bf16 v[176:179], a[244:247], a[120:123], v[176:179]
v_mfma_f32_16x16x32_bf16 v[184:187], a[240:243], a[108:111], v[184:187]
s_waitcnt lgkmcnt(3)
ds_read_b64_tr_b16 a[230:231], v224 offset:38528
v_mfma_f32_16x16x32_bf16 v[184:187], a[244:247], a[124:127], v[184:187]
buffer_load_dwordx4 v237, s[16:19], s30 offen nt lds
v_mfma_f32_16x16x32_bf16 v[164:167], a[248:251], a[96:99], v[164:167]
s_add_u32 m0, s29, 4096
v_mfma_f32_16x16x32_bf16 v[164:167], a[252:255], a[112:115], v[164:167]
ds_read_b64_tr_b16 a[232:233], v225 offset:24704
v_mfma_f32_16x16x32_bf16 v[172:175], a[248:251], a[100:103], v[172:175]
s_mov_b32 s30, 12288
v_mfma_f32_16x16x32_bf16 v[172:175], a[252:255], a[116:119], v[172:175]
ds_read_b64_tr_b16 a[234:235], v225 offset:26240
v_mfma_f32_16x16x32_bf16 v[180:183], a[248:251], a[104:107], v[180:183]
ds_read_b64_tr_b16 a[236:237], v225 offset:36992
v_mfma_f32_16x16x32_bf16 v[180:183], a[252:255], a[120:123], v[180:183]
buffer_load_dwordx4 v237, s[16:19], s30 offen nt lds
v_mfma_f32_16x16x32_bf16 v[188:191], a[248:251], a[108:111], v[188:191]
s_waitcnt lgkmcnt(3)
v_mfma_f32_16x16x32_bf16 v[188:191], a[252:255], a[124:127], v[188:191]
ds_read_b64_tr_b16 a[238:239], v225 offset:38528
v_mfma_f32_16x16x32_bf16 v[0:3], a[224:227], a[96:99], v[0:3]
s_add_u32 m0, s29, 8192
v_mfma_f32_16x16x32_bf16 v[0:3], a[228:231], a[112:115], v[0:3]
ds_read_b64_tr_b16 a[240:241], v226 offset:24704
v_mfma_f32_16x16x32_bf16 v[8:11], a[224:227], a[100:103], v[8:11]
s_mov_b32 s30, 24576
v_mfma_f32_16x16x32_bf16 v[8:11], a[228:231], a[116:119], v[8:11]
ds_read_b64_tr_b16 a[242:243], v226 offset:26240
v_mfma_f32_16x16x32_bf16 v[16:19], a[224:227], a[104:107], v[16:19]
ds_read_b64_tr_b16 a[244:245], v226 offset:36992
v_mfma_f32_16x16x32_bf16 v[16:19], a[228:231], a[120:123], v[16:19]
buffer_load_dwordx4 v237, s[16:19], s30 offen nt lds
v_mfma_f32_16x16x32_bf16 v[24:27], a[224:227], a[108:111], v[24:27]
s_waitcnt lgkmcnt(3)
v_mfma_f32_16x16x32_bf16 v[24:27], a[228:231], a[124:127], v[24:27]
ds_read_b64_tr_b16 a[246:247], v226 offset:38528
v_mfma_f32_16x16x32_bf16 v[4:7], a[232:235], a[96:99], v[4:7]
s_add_u32 m0, s28, 65536
v_mfma_f32_16x16x32_bf16 v[4:7], a[236:239], a[112:115], v[4:7]
ds_read_b64_tr_b16 a[248:249], v227 offset:24704
v_mfma_f32_16x16x32_bf16 v[12:15], a[232:235], a[100:103], v[12:15]
s_mov_b32 s30, 0
v_mfma_f32_16x16x32_bf16 v[12:15], a[236:239], a[116:119], v[12:15]
ds_read_b64_tr_b16 a[250:251], v227 offset:26240
v_mfma_f32_16x16x32_bf16 v[20:23], a[232:235], a[104:107], v[20:23]
ds_read_b64_tr_b16 a[252:253], v227 offset:36992
v_mfma_f32_16x16x32_bf16 v[20:23], a[236:239], a[120:123], v[20:23]
buffer_load_dwordx4 v234, s[12:15], s30 offen offset:0 nt lds
v_mfma_f32_16x16x32_bf16 v[28:31], a[232:235], a[108:111], v[28:31]
s_waitcnt lgkmcnt(3)
v_mfma_f32_16x16x32_bf16 v[28:31], a[236:239], a[124:127], v[28:31]
ds_read_b64_tr_b16 a[254:255], v227 offset:38528
v_mfma_f32_16x16x32_bf16 v[32:35], a[240:243], a[96:99], v[32:35]
ds_read_b64_tr_b16 a[224:225], v224 offset:24832
v_mfma_f32_16x16x32_bf16 v[32:35], a[244:247], a[112:115], v[32:35]
v_mfma_f32_16x16x32_bf16 v[40:43], a[240:243], a[100:103], v[40:43]
ds_read_b64_tr_b16 a[226:227], v224 offset:26368
v_mfma_f32_16x16x32_bf16 v[40:43], a[244:247], a[116:119], v[40:43]
buffer_load_dwordx4 v235, s[12:15], s30 offen offset:1024 nt lds
v_mfma_f32_16x16x32_bf16 v[48:51], a[240:243], a[104:107], v[48:51]
ds_read_b64_tr_b16 a[228:229], v224 offset:37120
v_mfma_f32_16x16x32_bf16 v[48:51], a[244:247], a[120:123], v[48:51]
v_mfma_f32_16x16x32_bf16 v[56:59], a[240:243], a[108:111], v[56:59]
s_waitcnt lgkmcnt(3)
v_mfma_f32_16x16x32_bf16 v[56:59], a[244:247], a[124:127], v[56:59]
ds_read_b64_tr_b16 a[230:231], v224 offset:38656
v_mfma_f32_16x16x32_bf16 v[36:39], a[248:251], a[96:99], v[36:39]
ds_read_b64_tr_b16 a[232:233], v225 offset:24832
v_mfma_f32_16x16x32_bf16 v[36:39], a[252:255], a[112:115], v[36:39]
buffer_load_dwordx4 v236, s[12:15], s30 offen offset:2048 nt lds
v_mfma_f32_16x16x32_bf16 v[44:47], a[248:251], a[100:103], v[44:47]
s_lshl2_add_u32 s49, s2, s36
v_mfma_f32_16x16x32_bf16 v[44:47], a[252:255], a[116:119], v[44:47]
ds_read_b64_tr_b16 a[234:235], v225 offset:26368
v_mfma_f32_16x16x32_bf16 v[52:55], a[248:251], a[104:107], v[52:55]
s_mul_i32 s49, s49, 2560
v_mfma_f32_16x16x32_bf16 v[52:55], a[252:255], a[120:123], v[52:55]
ds_read_b64_tr_b16 a[236:237], v225 offset:37120
v_mfma_f32_16x16x32_bf16 v[60:63], a[248:251], a[108:111], v[60:63]
s_waitcnt lgkmcnt(3)
v_mfma_f32_16x16x32_bf16 v[60:63], a[252:255], a[124:127], v[60:63]
ds_read_b64_tr_b16 a[238:239], v225 offset:38656
v_mfma_f32_16x16x32_bf16 v[64:67], a[224:227], a[96:99], v[64:67]
s_add_u32 s49, s49, 29360128
v_mfma_f32_16x16x32_bf16 v[64:67], a[228:231], a[112:115], v[64:67]
ds_read_b64_tr_b16 a[240:241], v226 offset:24832
v_mfma_f32_16x16x32_bf16 v[72:75], a[224:227], a[100:103], v[72:75]
ds_read_b64_tr_b16 a[242:243], v226 offset:26368
v_mfma_f32_16x16x32_bf16 v[72:75], a[228:231], a[116:119], v[72:75]
buffer_store_dwordx4 v[192:195], v238, s[24:27], s49 offen offset:0 sc1
v_mfma_f32_16x16x32_bf16 v[80:83], a[224:227], a[104:107], v[80:83]
ds_read_b64_tr_b16 a[244:245], v226 offset:37120
v_mfma_f32_16x16x32_bf16 v[80:83], a[228:231], a[120:123], v[80:83]
v_mfma_f32_16x16x32_bf16 v[88:91], a[224:227], a[108:111], v[88:91]
s_waitcnt lgkmcnt(3)
v_mfma_f32_16x16x32_bf16 v[88:91], a[228:231], a[124:127], v[88:91]
ds_read_b64_tr_b16 a[246:247], v226 offset:38656
v_mfma_f32_16x16x32_bf16 v[68:71], a[232:235], a[96:99], v[68:71]
ds_read_b64_tr_b16 a[248:249], v227 offset:24832
v_mfma_f32_16x16x32_bf16 v[68:71], a[236:239], a[112:115], v[68:71]
buffer_store_dwordx4 v[196:199], v238, s[24:27], s49 offen offset:1024 sc1
v_mfma_f32_16x16x32_bf16 v[76:79], a[232:235], a[100:103], v[76:79]
ds_read_b64_tr_b16 a[250:251], v227 offset:26368
v_mfma_f32_16x16x32_bf16 v[76:79], a[236:239], a[116:119], v[76:79]
v_mfma_f32_16x16x32_bf16 v[84:87], a[232:235], a[104:107], v[84:87]
ds_read_b64_tr_b16 a[252:253], v227 offset:37120
v_mfma_f32_16x16x32_bf16 v[84:87], a[236:239], a[120:123], v[84:87]
v_mfma_f32_16x16x32_bf16 v[92:95], a[232:235], a[108:111], v[92:95]
s_waitcnt vmcnt(16) lgkmcnt(3)
ds_read_b64_tr_b16 a[254:255], v227 offset:38656
buffer_store_dwordx2 v[200:201], v202, s[24:27], s49 offen offset:2048 sc1
v_add_u32 v224, 36864, v224
v_mfma_f32_16x16x32_bf16 v[92:95], a[236:239], a[124:127], v[92:95]
v_add_u32 v225, 36864, v225
v_add_u32 v226, 36864, v226
v_add_u32 v227, 36864, v227
v_mfma_f32_16x16x32_bf16 v[96:99], a[240:243], a[96:99], v[96:99]
s_barrier
v_mfma_f32_16x16x32_bf16 v[96:99], a[244:247], a[112:115], v[96:99]
ds_read_b64_tr_b16 a[224:225], v224 offset:12288
v_mfma_f32_16x16x32_bf16 v[104:107], a[240:243], a[100:103], v[104:107]
s_add_u32 m0, s29, 12288
v_mfma_f32_16x16x32_bf16 v[104:107], a[244:247], a[116:119], v[104:107]
ds_read_b64_tr_b16 a[226:227], v224 offset:13824
v_mfma_f32_16x16x32_bf16 v[112:115], a[240:243], a[104:107], v[112:115]
s_mov_b32 s30, 36864
v_mfma_f32_16x16x32_bf16 v[112:115], a[244:247], a[120:123], v[112:115]
ds_read_b64_tr_b16 a[228:229], v224 offset:24576
v_mfma_f32_16x16x32_bf16 v[120:123], a[240:243], a[108:111], v[120:123]
s_waitcnt lgkmcnt(3)
ds_read_b64_tr_b16 a[230:231], v224 offset:26112
v_mfma_f32_16x16x32_bf16 v[120:123], a[244:247], a[124:127], v[120:123]
buffer_load_dwordx4 v237, s[16:19], s30 offen nt lds
v_mfma_f32_16x16x32_bf16 v[100:103], a[248:251], a[96:99], v[100:103]
s_add_u32 m0, s29, 16384
v_mfma_f32_16x16x32_bf16 v[100:103], a[252:255], a[112:115], v[100:103]
ds_read_b64_tr_b16 a[232:233], v224 offset:36864
v_mfma_f32_16x16x32_bf16 v[108:111], a[248:251], a[100:103], v[108:111]
s_mov_b32 s30, 49152
v_mfma_f32_16x16x32_bf16 v[108:111], a[252:255], a[116:119], v[108:111]
ds_read_b64_tr_b16 a[234:235], v224 offset:38400
v_mfma_f32_16x16x32_bf16 v[116:119], a[248:251], a[104:107], v[116:119]
ds_read_b64_tr_b16 a[236:237], v224 offset:49152
v_mfma_f32_16x16x32_bf16 v[116:119], a[252:255], a[120:123], v[116:119]
buffer_load_dwordx4 v237, s[16:19], s30 offen nt lds
v_mfma_f32_16x16x32_bf16 v[124:127], a[248:251], a[108:111], v[124:127]
s_waitcnt lgkmcnt(3)
v_mfma_f32_16x16x32_bf16 v[124:127], a[252:255], a[124:127], v[124:127]
ds_read_b64_tr_b16 a[238:239], v224 offset:50688
v_mfma_f32_16x16x32_bf16 v[128:131], a[224:227], a[0:3], v[128:131]
s_barrier
v_mfma_f32_16x16x32_bf16 v[128:131], a[228:231], a[16:19], v[128:131]
ds_read_b64_tr_b16 a[240:241], v225 offset:12288
v_mfma_f32_16x16x32_bf16 v[136:139], a[224:227], a[4:7], v[136:139]
s_add_u32 m0, s29, 20480
v_mfma_f32_16x16x32_bf16 v[136:139], a[228:231], a[20:23], v[136:139]
ds_read_b64_tr_b16 a[242:243], v225 offset:13824
v_mfma_f32_16x16x32_bf16 v[144:147], a[224:227], a[8:11], v[144:147]
s_mov_b32 s30, 61440
v_mfma_f32_16x16x32_bf16 v[144:147], a[228:231], a[24:27], v[144:147]
ds_read_b64_tr_b16 a[244:245], v225 offset:24576
v_mfma_f32_16x16x32_bf16 v[152:155], a[224:227], a[12:15], v[152:155]
s_waitcnt vmcnt(11) lgkmcnt(3)
ds_read_b64_tr_b16 a[246:247], v225 offset:26112
v_mfma_f32_16x16x32_bf16 v[152:155], a[228:231], a[28:31], v[152:155]
buffer_load_dwordx4 v237, s[16:19], s30 offen nt lds
v_mfma_f32_16x16x32_bf16 v[128:131], a[232:235], a[32:35], v[128:131]
s_add_u32 m0, s28, 77824
v_mfma_f32_16x16x32_bf16 v[128:131], a[236:239], a[48:51], v[128:131]
ds_read_b64_tr_b16 a[248:249], v225 offset:36864
v_mfma_f32_16x16x32_bf16 v[136:139], a[232:235], a[36:39], v[136:139]
s_mov_b32 s30, 12288
v_mfma_f32_16x16x32_bf16 v[136:139], a[236:239], a[52:55], v[136:139]
ds_read_b64_tr_b16 a[250:251], v225 offset:38400
v_mfma_f32_16x16x32_bf16 v[144:147], a[232:235], a[40:43], v[144:147]
ds_read_b64_tr_b16 a[252:253], v225 offset:49152
v_mfma_f32_16x16x32_bf16 v[144:147], a[236:239], a[56:59], v[144:147]
buffer_load_dwordx4 v234, s[12:15], s30 offen offset:0 nt lds
v_mfma_f32_16x16x32_bf16 v[152:155], a[232:235], a[44:47], v[152:155]
s_waitcnt lgkmcnt(3)
v_mfma_f32_16x16x32_bf16 v[152:155], a[236:239], a[60:63], v[152:155]
ds_read_b64_tr_b16 a[254:255], v225 offset:50688
v_mfma_f32_16x16x32_bf16 v[132:135], a[240:243], a[0:3], v[132:135]
ds_read_b64_tr_b16 a[224:225], v226 offset:12288
v_mfma_f32_16x16x32_bf16 v[132:135], a[244:247], a[16:19], v[132:135]
v_mfma_f32_16x16x32_bf16 v[140:143], a[240:243], a[4:7], v[140:143]
ds_read_b64_tr_b16 a[226:227], v226 offset:13824
v_mfma_f32_16x16x32_bf16 v[140:143], a[244:247], a[20:23], v[140:143]
buffer_load_dwordx4 v235, s[12:15], s30 offen offset:1024 nt lds
v_mfma_f32_16x16x32_bf16 v[148:151], a[240:243], a[8:11], v[148:151]
ds_read_b64_tr_b16 a[228:229], v226 offset:24576
v_mfma_f32_16x16x32_bf16 v[148:151], a[244:247], a[24:27], v[148:151]
v_mfma_f32_16x16x32_bf16 v[156:159], a[240:243], a[12:15], v[156:159]
s_waitcnt lgkmcnt(3)
v_mfma_f32_16x16x32_bf16 v[156:159], a[244:247], a[28:31], v[156:159]
ds_read_b64_tr_b16 a[230:231], v226 offset:26112
v_mfma_f32_16x16x32_bf16 v[132:135], a[248:251], a[32:35], v[132:135]
ds_read_b64_tr_b16 a[232:233], v226 offset:36864
v_mfma_f32_16x16x32_bf16 v[132:135], a[252:255], a[48:51], v[132:135]
buffer_load_dwordx4 v236, s[12:15], s30 offen offset:2048 nt lds
v_mfma_f32_16x16x32_bf16 v[140:143], a[248:251], a[36:39], v[140:143]
s_add_u32 m0, s29, 24576
v_mfma_f32_16x16x32_bf16 v[140:143], a[252:255], a[52:55], v[140:143]
ds_read_b64_tr_b16 a[234:235], v226 offset:38400
v_mfma_f32_16x16x32_bf16 v[148:151], a[248:251], a[40:43], v[148:151]
s_mov_b32 s30, 73728
v_mfma_f32_16x16x32_bf16 v[148:151], a[252:255], a[56:59], v[148:151]
ds_read_b64_tr_b16 a[236:237], v226 offset:49152
v_mfma_f32_16x16x32_bf16 v[156:159], a[248:251], a[44:47], v[156:159]
s_waitcnt lgkmcnt(3)
ds_read_b64_tr_b16 a[238:239], v226 offset:50688
v_mfma_f32_16x16x32_bf16 v[156:159], a[252:255], a[60:63], v[156:159]
buffer_load_dwordx4 v237, s[16:19], s30 offen nt lds
v_mfma_f32_16x16x32_bf16 v[160:163], a[224:227], a[0:3], v[160:163]
s_add_u32 m0, s29, 28672
ds_read_b64_tr_b16 a[240:241], v227 offset:12288
v_mfma_f32_16x16x32_bf16 v[160:163], a[228:231], a[16:19], v[160:163]
v_mov_b32 v192, 0xff800000
v_mov_b32 v196, 0xff800000
v_mfma_f32_16x16x32_bf16 v[168:171], a[224:227], a[4:7], v[168:171]
s_mov_b32 s30, 86016
ds_read_b64_tr_b16 a[242:243], v227 offset:13824
v_mov_b32 v200, 0xff800000
v_mfma_f32_16x16x32_bf16 v[168:171], a[228:231], a[20:23], v[168:171]
v_mov_b32 v204, 0xff800000
v_cvt_pk_bf16_f32 v128, v128, v129
v_mfma_f32_16x16x32_bf16 v[176:179], a[224:227], a[8:11], v[176:179]
ds_read_b64_tr_b16 a[244:245], v227 offset:24576
buffer_load_dwordx4 v237, s[16:19], s30 offen nt lds
v_mfma_f32_16x16x32_bf16 v[176:179], a[228:231], a[24:27], v[176:179]
v_cvt_pk_bf16_f32 v129, v130, v131
v_cvt_pk_bf16_f32 v130, v132, v133
v_mfma_f32_16x16x32_bf16 v[184:187], a[224:227], a[12:15], v[184:187]
s_waitcnt lgkmcnt(3)
ds_read_b64_tr_b16 a[246:247], v227 offset:26112
v_cvt_pk_bf16_f32 v131, v134, v135
v_mfma_f32_16x16x32_bf16 v[184:187], a[228:231], a[28:31], v[184:187]
v_cvt_pk_bf16_f32 v136, v136, v137
v_cvt_pk_bf16_f32 v137, v138, v139
v_mfma_f32_16x16x32_bf16 v[160:163], a[232:235], a[32:35], v[160:163]
s_add_u32 m0, s29, 32768
ds_read_b64_tr_b16 a[248:249], v227 offset:36864
v_mfma_f32_16x16x32_bf16 v[160:163], a[236:239], a[48:51], v[160:163]
v_cvt_pk_bf16_f32 v138, v140, v141
v_cvt_pk_bf16_f32 v139, v142, v143
v_mfma_f32_16x16x32_bf16 v[168:171], a[232:235], a[36:39], v[168:171]
s_mov_b32 s30, 98304
ds_read_b64_tr_b16 a[250:251], v227 offset:38400
v_mfma_f32_16x16x32_bf16 v[168:171], a[236:239], a[52:55], v[168:171]
v_permlane16_swap_b32 v128, v130
v_mfma_f32_16x16x32_bf16 v[176:179], a[232:235], a[40:43], v[176:179]
ds_read_b64_tr_b16 a[252:253], v227 offset:49152
buffer_load_dwordx4 v237, s[16:19], s30 offen nt lds
v_mfma_f32_16x16x32_bf16 v[176:179], a[236:239], a[56:59], v[176:179]
v_permlane16_swap_b32 v129, v131
v_mfma_f32_16x16x32_bf16 v[184:187], a[232:235], a[44:47], v[184:187]
L_pg3:
s_cbranch_execz L_pg7
s_waitcnt lgkmcnt(3)
ds_read_b64_tr_b16 a[254:255], v227 offset:50688
v_mfma_f32_16x16x32_bf16 v[184:187], a[236:239], a[60:63], v[184:187]
v_permlane16_swap_b32 v136, v138
v_mfma_f32_16x16x32_bf16 v[164:167], a[240:243], a[0:3], v[164:167]
s_add_u32 m0, s29, 36864
ds_read_b64_tr_b16 a[224:225], v224 offset:12416
v_mfma_f32_16x16x32_bf16 v[164:167], a[244:247], a[16:19], v[164:167]
v_permlane16_swap_b32 v137, v139
v_accvgpr_write_b32 a128, v128
v_mfma_f32_16x16x32_bf16 v[172:175], a[240:243], a[4:7], v[172:175]
s_mov_b32 s30, 110592
ds_read_b64_tr_b16 a[226:227], v224 offset:13952
v_accvgpr_write_b32 a129, v129
v_mfma_f32_16x16x32_bf16 v[172:175], a[244:247], a[20:23], v[172:175]
v_accvgpr_write_b32 a130, v130
v_accvgpr_write_b32 a131, v131
v_mfma_f32_16x16x32_bf16 v[180:183], a[240:243], a[8:11], v[180:183]
ds_read_b64_tr_b16 a[228:229], v224 offset:24704
buffer_load_dwordx4 v237, s[16:19], s30 offen nt lds
v_mfma_f32_16x16x32_bf16 v[180:183], a[244:247], a[24:27], v[180:183]
v_accvgpr_write_b32 a132, v136
v_accvgpr_write_b32 a133, v137
v_mfma_f32_16x16x32_bf16 v[188:191], a[240:243], a[12:15], v[188:191]
s_waitcnt lgkmcnt(3)
ds_read_b64_tr_b16 a[230:231], v224 offset:26240
v_accvgpr_write_b32 a134, v138
v_mfma_f32_16x16x32_bf16 v[188:191], a[244:247], a[28:31], v[188:191]
v_accvgpr_write_b32 a135, v139
v_cvt_pk_bf16_f32 v144, v144, v145
v_mfma_f32_16x16x32_bf16 v[164:167], a[248:251], a[32:35], v[164:167]
s_add_u32 m0, s29, 40960
ds_read_b64_tr_b16 a[232:233], v224 offset:36992
v_cvt_pk_bf16_f32 v145, v146, v147
v_mfma_f32_16x16x32_bf16 v[164:167], a[252:255], a[48:51], v[164:167]
v_cvt_pk_bf16_f32 v146, v148, v149
v_cvt_pk_bf16_f32 v147, v150, v151
v_mfma_f32_16x16x32_bf16 v[172:175], a[248:251], a[36:39], v[172:175]
s_mov_b32 s30, 122880
ds_read_b64_tr_b16 a[234:235], v224 offset:38528
v_cvt_pk_bf16_f32 v152, v152, v153
v_mfma_f32_16x16x32_bf16 v[172:175], a[252:255], a[52:55], v[172:175]
v_cvt_pk_bf16_f32 v153, v154, v155
v_cvt_pk_bf16_f32 v154, v156, v157
v_mfma_f32_16x16x32_bf16 v[180:183], a[248:251], a[40:43], v[180:183]
ds_read_b64_tr_b16 a[236:237], v224 offset:49280
buffer_load_dwordx4 v237, s[16:19], s30 offen nt lds
v_mfma_f32_16x16x32_bf16 v[180:183], a[252:255], a[56:59], v[180:183]
v_cvt_pk_bf16_f32 v155, v158, v159
v_mfma_f32_16x16x32_bf16 v[188:191], a[248:251], a[44:47], v[188:191]
s_waitcnt lgkmcnt(3)
ds_read_b64_tr_b16 a[238:239], v224 offset:50816
v_mfma_f32_16x16x32_bf16 v[188:191], a[252:255], a[60:63], v[188:191]
v_permlane16_swap_b32 v144, v146
v_mfma_f32_16x16x32_bf16 v[0:3], a[224:227], a[0:3], v[0:3]
s_add_u32 m0, s29, 45056
ds_read_b64_tr_b16 a[240:241], v225 offset:12416
v_mfma_f32_16x16x32_bf16 v[0:3], a[228:231], a[16:19], v[0:3]
v_permlane16_swap_b32 v145, v147
v_mfma_f32_16x16x32_bf16 v[8:11], a[224:227], a[4:7], v[8:11]
s_mov_b32 s30, 135168
ds_read_b64_tr_b16 a[242:243], v225 offset:13952
v_mfma_f32_16x16x32_bf16 v[8:11], a[228:231], a[20:23], v[8:11]
v_permlane16_swap_b32 v152, v154
v_mfma_f32_16x16x32_bf16 v[16:19], a[224:227], a[8:11], v[16:19]
ds_read_b64_tr_b16 a[244:245], v225 offset:24704
buffer_load_dwordx4 v237, s[16:19], s30 offen nt lds
v_mfma_f32_16x16x32_bf16 v[16:19], a[228:231], a[24:27], v[16:19]
v_permlane16_swap_b32 v153, v155
v_mfma_f32_16x16x32_bf16 v[24:27], a[224:227], a[12:15], v[24:27]
s_waitcnt lgkmcnt(3)
ds_read_b64_tr_b16 a[246:247], v225 offset:26240
v_accvgpr_write_b32 a136, v144
v_mfma_f32_16x16x32_bf16 v[24:27], a[228:231], a[28:31], v[24:27]
v_accvgpr_write_b32 a137, v145
v_accvgpr_write_b32 a138, v146
v_mfma_f32_16x16x32_bf16 v[0:3], a[232:235], a[32:35], v[0:3]
s_add_u32 m0, s29, 49152
ds_read_b64_tr_b16 a[248:249], v225 offset:36992
v_accvgpr_write_b32 a139, v147
v_mfma_f32_16x16x32_bf16 v[0:3], a[236:239], a[48:51], v[0:3]
v_accvgpr_write_b32 a140, v152
v_accvgpr_write_b32 a141, v153
v_mfma_f32_16x16x32_bf16 v[8:11], a[232:235], a[36:39], v[8:11]
s_mov_b32 s30, 147456
ds_read_b64_tr_b16 a[250:251], v225 offset:38528
v_accvgpr_write_b32 a142, v154
v_mfma_f32_16x16x32_bf16 v[8:11], a[236:239], a[52:55], v[8:11]
v_accvgpr_write_b32 a143, v155
v_cvt_pk_bf16_f32 v160, v160, v161
v_mfma_f32_16x16x32_bf16 v[16:19], a[232:235], a[40:43], v[16:19]
ds_read_b64_tr_b16 a[252:253], v225 offset:49280
buffer_load_dwordx4 v237, s[16:19], s30 offen nt lds
v_mfma_f32_16x16x32_bf16 v[16:19], a[236:239], a[56:59], v[16:19]
v_cvt_pk_bf16_f32 v161, v162, v163
v_cvt_pk_bf16_f32 v162, v164, v165
v_mfma_f32_16x16x32_bf16 v[24:27], a[232:235], a[44:47], v[24:27]
s_waitcnt lgkmcnt(3)
ds_read_b64_tr_b16 a[254:255], v225 offset:50816
v_cvt_pk_bf16_f32 v163, v166, v167
v_mfma_f32_16x16x32_bf16 v[24:27], a[236:239], a[60:63], v[24:27]
v_cvt_pk_bf16_f32 v168, v168, v169
v_cvt_pk_bf16_f32 v169, v170, v171
v_mfma_f32_16x16x32_bf16 v[4:7], a[240:243], a[0:3], v[4:7]
s_add_u32 m0, s29, 53248
ds_read_b64_tr_b16 a[224:225], v226 offset:12416
v_mfma_f32_16x16x32_bf16 v[4:7], a[244:247], a[16:19], v[4:7]
v_cvt_pk_bf16_f32 v170, v172, v173
v_cvt_pk_bf16_f32 v171, v174, v175
v_mfma_f32_16x16x32_bf16 v[12:15], a[240:243], a[4:7], v[12:15]
s_mov_b32 s30, 159744
ds_read_b64_tr_b16 a[226:227], v226 offset:13952
v_mfma_f32_16x16x32_bf16 v[12:15], a[244:247], a[20:23], v[12:15]
v_permlane16_swap_b32 v160, v162
v_mfma_f32_16x16x32_bf16 v[20:23], a[240:243], a[8:11], v[20:23]
ds_read_b64_tr_b16 a[228:229], v226 offset:24704
buffer_load_dwordx4 v237, s[16:19], s30 offen nt lds
v_mfma_f32_16x16x32_bf16 v[20:23], a[244:247], a[24:27], v[20:23]
v_permlane16_swap_b32 v161, v163
v_mfma_f32_16x16x32_bf16 v[28:31], a[240:243], a[12:15], v[28:31]
s_waitcnt lgkmcnt(3)
ds_read_b64_tr_b16 a[230:231], v226 offset:26240
v_mfma_f32_16x16x32_bf16 v[28:31], a[244:247], a[28:31], v[28:31]
v_permlane16_swap_b32 v168, v170
v_mfma_f32_16x16x32_bf16 v[4:7], a[248:251], a[32:35], v[4:7]
s_add_u32 m0, s29, 57344
ds_read_b64_tr_b16 a[232:233], v226 offset:36992
v_mfma_f32_16x16x32_bf16 v[4:7], a[252:255], a[48:51], v[4:7]
v_permlane16_swap_b32 v169, v171
v_accvgpr_write_b32 a144, v160
v_mfma_f32_16x16x32_bf16 v[12:15], a[248:251], a[36:39], v[12:15]
s_mov_b32 s30, 172032
ds_read_b64_tr_b16 a[234:235], v226 offset:38528
v_accvgpr_write_b32 a145, v161
v_mfma_f32_16x16x32_bf16 v[12:15], a[252:255], a[52:55], v[12:15]
v_accvgpr_write_b32 a146, v162
v_accvgpr_write_b32 a147, v163
v_mfma_f32_16x16x32_bf16 v[20:23], a[248:251], a[40:43], v[20:23]
ds_read_b64_tr_b16 a[236:237], v226 offset:49280
buffer_load_dwordx4 v237, s[16:19], s30 offen nt lds
v_mfma_f32_16x16x32_bf16 v[20:23], a[252:255], a[56:59], v[20:23]
v_accvgpr_write_b32 a148, v168
v_accvgpr_write_b32 a149, v169
v_mfma_f32_16x16x32_bf16 v[28:31], a[248:251], a[44:47], v[28:31]
s_waitcnt lgkmcnt(3)
ds_read_b64_tr_b16 a[238:239], v226 offset:50816
v_accvgpr_write_b32 a150, v170
v_mfma_f32_16x16x32_bf16 v[28:31], a[252:255], a[60:63], v[28:31]
v_accvgpr_write_b32 a151, v171
v_cvt_pk_bf16_f32 v176, v176, v177
v_mfma_f32_16x16x32_bf16 v[32:35], a[224:227], a[0:3], v[32:35]
s_add_u32 m0, s29, 61440
ds_read_b64_tr_b16 a[240:241], v227 offset:12416
v_cvt_pk_bf16_f32 v177, v178, v179
v_mfma_f32_16x16x32_bf16 v[32:35], a[228:231], a[16:19], v[32:35]
v_cvt_pk_bf16_f32 v178, v180, v181
v_cvt_pk_bf16_f32 v179, v182, v183
v_mfma_f32_16x16x32_bf16 v[40:43], a[224:227], a[4:7], v[40:43]
s_mov_b32 s30, 184320
ds_read_b64_tr_b16 a[242:243], v227 offset:13952
v_cvt_pk_bf16_f32 v184, v184, v185
v_mfma_f32_16x16x32_bf16 v[40:43], a[228:231], a[20:23], v[40:43]
v_cvt_pk_bf16_f32 v185, v186, v187
v_cvt_pk_bf16_f32 v186, v188, v189
v_mfma_f32_16x16x32_bf16 v[48:51], a[224:227], a[8:11], v[48:51]
ds_read_b64_tr_b16 a[244:245], v227 offset:24704
buffer_load_dwordx4 v237, s[16:19], s30 offen nt lds
v_mfma_f32_16x16x32_bf16 v[48:51], a[228:231], a[24:27], v[48:51]
v_cvt_pk_bf16_f32 v187, v190, v191
v_mfma_f32_16x16x32_bf16 v[56:59], a[224:227], a[12:15], v[56:59]
s_waitcnt lgkmcnt(3)
ds_read_b64_tr_b16 a[246:247], v227 offset:26240
v_mfma_f32_16x16x32_bf16 v[56:59], a[228:231], a[28:31], v[56:59]
v_permlane16_swap_b32 v176, v178
v_mfma_f32_16x16x32_bf16 v[32:35], a[232:235], a[32:35], v[32:35]
s_add_u32 m0, s28, 90112
ds_read_b64_tr_b16 a[248:249], v227 offset:36992
v_mfma_f32_16x16x32_bf16 v[32:35], a[236:239], a[48:51], v[32:35]
v_permlane16_swap_b32 v177, v179
v_mfma_f32_16x16x32_bf16 v[40:43], a[232:235], a[36:39], v[40:43]
s_mov_b32 s30, 24576
ds_read_b64_tr_b16 a[250:251], v227 offset:38528
v_mfma_f32_16x16x32_bf16 v[40:43], a[236:239], a[52:55], v[40:43]
v_permlane16_swap_b32 v184, v186
v_mfma_f32_16x16x32_bf16 v[48:51], a[232:235], a[40:43], v[48:51]
ds_read_b64_tr_b16 a[252:253], v227 offset:49280
buffer_load_dwordx4 v234, s[12:15], s30 offen offset:0 nt lds
v_mfma_f32_16x16x32_bf16 v[48:51], a[236:239], a[56:59], v[48:51]
v_permlane16_swap_b32 v185, v187
v_mfma_f32_16x16x32_bf16 v[56:59], a[232:235], a[44:47], v[56:59]
s_waitcnt lgkmcnt(3)
ds_read_b64_tr_b16 a[254:255], v227 offset:50816
v_accvgpr_write_b32 a152, v176
v_mfma_f32_16x16x32_bf16 v[56:59], a[236:239], a[60:63], v[56:59]
v_accvgpr_write_b32 a153, v177
v_accvgpr_write_b32 a154, v178
v_mfma_f32_16x16x32_bf16 v[36:39], a[240:243], a[0:3], v[36:39]
ds_read_b64_tr_b16 a[224:225], v224 offset:12544
v_accvgpr_write_b32 a155, v179
v_mfma_f32_16x16x32_bf16 v[36:39], a[244:247], a[16:19], v[36:39]
v_accvgpr_write_b32 a156, v184
v_accvgpr_write_b32 a157, v185
v_mfma_f32_16x16x32_bf16 v[44:47], a[240:243], a[4:7], v[44:47]
ds_read_b64_tr_b16 a[226:227], v224 offset:14080
buffer_load_dwordx4 v235, s[12:15], s30 offen offset:1024 nt lds
v_mfma_f32_16x16x32_bf16 v[44:47], a[244:247], a[20:23], v[44:47]
v_accvgpr_write_b32 a158, v186
v_accvgpr_write_b32 a159, v187
v_mfma_f32_16x16x32_bf16 v[52:55], a[240:243], a[8:11], v[52:55]
ds_read_b64_tr_b16 a[228:229], v224 offset:24832
v_cvt_pk_bf16_f32 v0, v0, v1
v_mfma_f32_16x16x32_bf16 v[52:55], a[244:247], a[24:27], v[52:55]
v_cvt_pk_bf16_f32 v1, v2, v3
v_cvt_pk_bf16_f32 v2, v4, v5
v_mfma_f32_16x16x32_bf16 v[60:63], a[240:243], a[12:15], v[60:63]
s_waitcnt lgkmcnt(3)
ds_read_b64_tr_b16 a[230:231], v224 offset:26368
v_cvt_pk_bf16_f32 v3, v6, v7
v_mfma_f32_16x16x32_bf16 v[60:63], a[244:247], a[28:31], v[60:63]
v_cvt_pk_bf16_f32 v8, v8, v9
v_cvt_pk_bf16_f32 v9, v10, v11
v_mfma_f32_16x16x32_bf16 v[36:39], a[248:251], a[32:35], v[36:39]
ds_read_b64_tr_b16 a[232:233], v224 offset:37120
buffer_load_dwordx4 v236, s[12:15], s30 offen offset:2048 nt lds
v_mfma_f32_16x16x32_bf16 v[36:39], a[252:255], a[48:51], v[36:39]
v_cvt_pk_bf16_f32 v10, v12, v13
v_cvt_pk_bf16_f32 v11, v14, v15
v_mfma_f32_16x16x32_bf16 v[44:47], a[248:251], a[36:39], v[44:47]
ds_read_b64_tr_b16 a[234:235], v224 offset:38656
v_mfma_f32_16x16x32_bf16 v[44:47], a[252:255], a[52:55], v[44:47]
v_permlane16_swap_b32 v0, v2
v_mfma_f32_16x16x32_bf16 v[52:55], a[248:251], a[40:43], v[52:55]
ds_read_b64_tr_b16 a[236:237], v224 offset:49408
v_mfma_f32_16x16x32_bf16 v[52:55], a[252:255], a[56:59], v[52:55]
v_permlane16_swap_b32 v1, v3
v_mfma_f32_16x16x32_bf16 v[60:63], a[248:251], a[44:47], v[60:63]
s_waitcnt lgkmcnt(3)
ds_read_b64_tr_b16 a[238:239], v224 offset:50944
v_mfma_f32_16x16x32_bf16 v[60:63], a[252:255], a[60:63], v[60:63]
v_permlane16_swap_b32 v8, v10
v_mfma_f32_16x16x32_bf16 v[64:67], a[224:227], a[0:3], v[64:67]
ds_read_b64_tr_b16 a[240:241], v225 offset:12544
v_permlane16_swap_b32 v9, v11
v_mfma_f32_16x16x32_bf16 v[64:67], a[228:231], a[16:19], v[64:67]
v_accvgpr_write_b32 a160, v0
v_mfma_f32_16x16x32_bf16 v[72:75], a[224:227], a[4:7], v[72:75]
ds_read_b64_tr_b16 a[242:243], v225 offset:14080
v_accvgpr_write_b32 a161, v1
v_mfma_f32_16x16x32_bf16 v[72:75], a[228:231], a[20:23], v[72:75]
v_accvgpr_write_b32 a162, v2
v_accvgpr_write_b32 a163, v3
v_mfma_f32_16x16x32_bf16 v[80:83], a[224:227], a[8:11], v[80:83]
ds_read_b64_tr_b16 a[244:245], v225 offset:24832
v_accvgpr_write_b32 a164, v8
v_mfma_f32_16x16x32_bf16 v[80:83], a[228:231], a[24:27], v[80:83]
v_accvgpr_write_b32 a165, v9
v_accvgpr_write_b32 a166, v10
v_mfma_f32_16x16x32_bf16 v[88:91], a[224:227], a[12:15], v[88:91]
s_waitcnt lgkmcnt(3)
ds_read_b64_tr_b16 a[246:247], v225 offset:26368
v_accvgpr_write_b32 a167, v11
v_mfma_f32_16x16x32_bf16 v[88:91], a[228:231], a[28:31], v[88:91]
v_cvt_pk_bf16_f32 v16, v16, v17
v_cvt_pk_bf16_f32 v17, v18, v19
v_mfma_f32_16x16x32_bf16 v[64:67], a[232:235], a[32:35], v[64:67]
ds_read_b64_tr_b16 a[248:249], v225 offset:37120
v_cvt_pk_bf16_f32 v18, v20, v21
v_mfma_f32_16x16x32_bf16 v[64:67], a[236:239], a[48:51], v[64:67]
v_cvt_pk_bf16_f32 v19, v22, v23
v_cvt_pk_bf16_f32 v24, v24, v25
v_mfma_f32_16x16x32_bf16 v[72:75], a[232:235], a[36:39], v[72:75]
ds_read_b64_tr_b16 a[250:251], v225 offset:38656
v_cvt_pk_bf16_f32 v25, v26, v27
v_mfma_f32_16x16x32_bf16 v[72:75], a[236:239], a[52:55], v[72:75]
v_cvt_pk_bf16_f32 v26, v28, v29
v_cvt_pk_bf16_f32 v27, v30, v31
v_mfma_f32_16x16x32_bf16 v[80:83], a[232:235], a[40:43], v[80:83]
ds_read_b64_tr_b16 a[252:253], v225 offset:49408
v_mfma_f32_16x16x32_bf16 v[80:83], a[236:239], a[56:59], v[80:83]
v_permlane16_swap_b32 v16, v18
v_mfma_f32_16x16x32_bf16 v[88:91], a[232:235], a[44:47], v[88:91]
s_waitcnt lgkmcnt(3)
ds_read_b64_tr_b16 a[254:255], v225 offset:50944
v_mfma_f32_16x16x32_bf16 v[88:91], a[236:239], a[60:63], v[88:91]
v_permlane16_swap_b32 v17, v19
v_mfma_f32_16x16x32_bf16 v[68:71], a[240:243], a[0:3], v[68:71]
ds_read_b64_tr_b16 a[224:225], v226 offset:12544
v_mfma_f32_16x16x32_bf16 v[68:71], a[244:247], a[16:19], v[68:71]
v_permlane16_swap_b32 v24, v26
v_mfma_f32_16x16x32_bf16 v[76:79], a[240:243], a[4:7], v[76:79]
ds_read_b64_tr_b16 a[226:227], v226 offset:14080
v_permlane16_swap_b32 v25, v27
v_mfma_f32_16x16x32_bf16 v[76:79], a[244:247], a[20:23], v[76:79]
v_accvgpr_write_b32 a168, v16
v_mfma_f32_16x16x32_bf16 v[84:87], a[240:243], a[8:11], v[84:87]
ds_read_b64_tr_b16 a[228:229], v226 offset:24832
v_accvgpr_write_b32 a169, v17
v_mfma_f32_16x16x32_bf16 v[84:87], a[244:247], a[24:27], v[84:87]
v_accvgpr_write_b32 a170, v18
v_accvgpr_write_b32 a171, v19
v_mfma_f32_16x16x32_bf16 v[92:95], a[240:243], a[12:15], v[92:95]
s_waitcnt lgkmcnt(3)
ds_read_b64_tr_b16 a[230:231], v226 offset:26368
v_accvgpr_write_b32 a172, v24
v_mfma_f32_16x16x32_bf16 v[92:95], a[244:247], a[28:31], v[92:95]
v_accvgpr_write_b32 a173, v25
v_accvgpr_write_b32 a174, v26
v_mfma_f32_16x16x32_bf16 v[68:71], a[248:251], a[32:35], v[68:71]
ds_read_b64_tr_b16 a[232:233], v226 offset:37120
v_accvgpr_write_b32 a175, v27
v_mfma_f32_16x16x32_bf16 v[68:71], a[252:255], a[48:51], v[68:71]
v_cvt_pk_bf16_f32 v32, v32, v33
v_cvt_pk_bf16_f32 v33, v34, v35
v_mfma_f32_16x16x32_bf16 v[76:79], a[248:251], a[36:39], v[76:79]
ds_read_b64_tr_b16 a[234:235], v226 offset:38656
v_cvt_pk_bf16_f32 v34, v36, v37
v_mfma_f32_16x16x32_bf16 v[76:79], a[252:255], a[52:55], v[76:79]
v_cvt_pk_bf16_f32 v35, v38, v39
v_cvt_pk_bf16_f32 v40, v40, v41
v_mfma_f32_16x16x32_bf16 v[84:87], a[248:251], a[40:43], v[84:87]
ds_read_b64_tr_b16 a[236:237], v226 offset:49408
v_cvt_pk_bf16_f32 v41, v42, v43
v_mfma_f32_16x16x32_bf16 v[84:87], a[252:255], a[56:59], v[84:87]
v_cvt_pk_bf16_f32 v42, v44, v45
v_cvt_pk_bf16_f32 v43, v46, v47
v_mfma_f32_16x16x32_bf16 v[92:95], a[248:251], a[44:47], v[92:95]
s_waitcnt lgkmcnt(3)
ds_read_b64_tr_b16 a[238:239], v226 offset:50944
v_mfma_f32_16x16x32_bf16 v[92:95], a[252:255], a[60:63], v[92:95]
v_permlane16_swap_b32 v32, v34
v_mfma_f32_16x16x32_bf16 v[96:99], a[224:227], a[0:3], v[96:99]
ds_read_b64_tr_b16 a[240:241], v227 offset:12544
v_mfma_f32_16x16x32_bf16 v[96:99], a[228:231], a[16:19], v[96:99]
v_permlane16_swap_b32 v33, v35
v_mfma_f32_16x16x32_bf16 v[104:107], a[224:227], a[4:7], v[104:107]
ds_read_b64_tr_b16 a[242:243], v227 offset:14080
v_mfma_f32_16x16x32_bf16 v[104:107], a[228:231], a[20:23], v[104:107]
v_permlane16_swap_b32 v40, v42
v_mfma_f32_16x16x32_bf16 v[112:115], a[224:227], a[8:11], v[112:115]
ds_read_b64_tr_b16 a[244:245], v227 offset:24832
v_permlane16_swap_b32 v41, v43
v_mfma_f32_16x16x32_bf16 v[112:115], a[228:231], a[24:27], v[112:115]
v_accvgpr_write_b32 a176, v32
v_mfma_f32_16x16x32_bf16 v[120:123], a[224:227], a[12:15], v[120:123]
s_waitcnt lgkmcnt(3)
ds_read_b64_tr_b16 a[246:247], v227 offset:26368
v_accvgpr_write_b32 a177, v33
v_mfma_f32_16x16x32_bf16 v[120:123], a[228:231], a[28:31], v[120:123]
v_accvgpr_write_b32 a178, v34
v_accvgpr_write_b32 a179, v35
v_mfma_f32_16x16x32_bf16 v[96:99], a[232:235], a[32:35], v[96:99]
ds_read_b64_tr_b16 a[248:249], v227 offset:37120
v_accvgpr_write_b32 a180, v40
v_mfma_f32_16x16x32_bf16 v[96:99], a[236:239], a[48:51], v[96:99]
v_accvgpr_write_b32 a181, v41
v_accvgpr_write_b32 a182, v42
v_mfma_f32_16x16x32_bf16 v[104:107], a[232:235], a[36:39], v[104:107]
ds_read_b64_tr_b16 a[250:251], v227 offset:38656
v_accvgpr_write_b32 a183, v43
v_mfma_f32_16x16x32_bf16 v[104:107], a[236:239], a[52:55], v[104:107]
v_cvt_pk_bf16_f32 v48, v48, v49
v_cvt_pk_bf16_f32 v49, v50, v51
v_mfma_f32_16x16x32_bf16 v[112:115], a[232:235], a[40:43], v[112:115]
ds_read_b64_tr_b16 a[252:253], v227 offset:49408
v_cvt_pk_bf16_f32 v50, v52, v53
v_mfma_f32_16x16x32_bf16 v[112:115], a[236:239], a[56:59], v[112:115]
v_cvt_pk_bf16_f32 v51, v54, v55
v_cvt_pk_bf16_f32 v56, v56, v57
v_mfma_f32_16x16x32_bf16 v[120:123], a[232:235], a[44:47], v[120:123]
s_waitcnt vmcnt(22) lgkmcnt(3)
ds_read_b64_tr_b16 a[254:255], v227 offset:50944
v_cvt_pk_bf16_f32 v57, v58, v59
v_mfma_f32_16x16x32_bf16 v[120:123], a[236:239], a[60:63], v[120:123]
v_cvt_pk_bf16_f32 v58, v60, v61
v_cvt_pk_bf16_f32 v59, v62, v63
v_mfma_f32_16x16x32_bf16 v[100:103], a[240:243], a[0:3], v[100:103]
s_barrier
ds_read_b128 a[224:227], v228 offset:0
v_mfma_f32_16x16x32_bf16 v[100:103], a[244:247], a[16:19], v[100:103]
v_permlane16_swap_b32 v48, v50
v_mfma_f32_16x16x32_bf16 v[108:111], a[240:243], a[4:7], v[108:111]
s_add_u32 m0, s28, 102400
v_permlane16_swap_b32 v49, v51
v_mfma_f32_16x16x32_bf16 v[108:111], a[244:247], a[20:23], v[108:111]
v_permlane16_swap_b32 v56, v58
v_mfma_f32_16x16x32_bf16 v[116:119], a[240:243], a[8:11], v[116:119]
s_mov_b32 s30, 36864
ds_read_b128 a[228:231], v228 offset:6144
v_mfma_f32_16x16x32_bf16 v[116:119], a[244:247], a[24:27], v[116:119]
v_permlane16_swap_b32 v57, v59
v_accvgpr_write_b32 a184, v48
v_mfma_f32_16x16x32_bf16 v[124:127], a[240:243], a[12:15], v[124:127]
s_waitcnt lgkmcnt(2)
buffer_load_dwordx4 v234, s[12:15], s30 offen offset:0 nt lds
v_accvgpr_write_b32 a185, v49
v_mfma_f32_16x16x32_bf16 v[124:127], a[244:247], a[28:31], v[124:127]
v_accvgpr_write_b32 a186, v50
v_accvgpr_write_b32 a187, v51
v_mfma_f32_16x16x32_bf16 v[100:103], a[248:251], a[32:35], v[100:103]
ds_read_b128 a[232:235], v229 offset:0
buffer_load_dwordx4 v235, s[12:15], s30 offen offset:1024 nt lds
v_mfma_f32_16x16x32_bf16 v[100:103], a[252:255], a[48:51], v[100:103]
v_accvgpr_write_b32 a188, v56
v_accvgpr_write_b32 a189, v57
v_mfma_f32_16x16x32_bf16 v[108:111], a[248:251], a[36:39], v[108:111]
buffer_load_dwordx4 v236, s[12:15], s30 offen offset:2048 nt lds
v_accvgpr_write_b32 a190, v58
v_mfma_f32_16x16x32_bf16 v[108:111], a[252:255], a[52:55], v[108:111]
v_accvgpr_write_b32 a191, v59
v_cvt_pk_bf16_f32 v64, v64, v65
v_mfma_f32_16x16x32_bf16 v[116:119], a[248:251], a[40:43], v[116:119]
s_add_u32 m0, s28, 114688
ds_read_b128 a[236:239], v229 offset:6144
v_cvt_pk_bf16_f32 v65, v66, v67
v_mfma_f32_16x16x32_bf16 v[116:119], a[252:255], a[56:59], v[116:119]
v_cvt_pk_bf16_f32 v66, v68, v69
v_cvt_pk_bf16_f32 v67, v70, v71
v_mfma_f32_16x16x32_bf16 v[124:127], a[248:251], a[44:47], v[124:127]
s_waitcnt lgkmcnt(3)
v_cvt_pk_bf16_f32 v72, v72, v73
v_cvt_pk_bf16_f32 v73, v74, v75
v_mfma_f32_16x16x32_bf16 v[124:127], a[252:255], a[60:63], v[124:127]
v_cvt_pk_bf16_f32 v74, v76, v77
v_cvt_pk_bf16_f32 v75, v78, v79
v_mfma_f32_16x16x32_bf16 v[128:131], a[224:227], a[128:131], 0
s_barrier
ds_read_b128 a[240:243], v228 offset:128
v_mfma_f32_16x16x32_bf16 v[136:139], a[224:227], a[132:135], 0
v_permlane16_swap_b32 v64, v66
v_mfma_f32_16x16x32_bf16 v[144:147], a[224:227], a[136:139], 0
s_waitcnt lgkmcnt(3)
v_permlane16_swap_b32 v65, v67
v_mfma_f32_16x16x32_bf16 v[152:155], a[224:227], a[140:143], 0
v_permlane16_swap_b32 v72, v74
v_mfma_f32_16x16x32_bf16 v[132:135], a[228:231], a[128:131], 0
s_mov_b32 s30, 49152
ds_read_b128 a[244:247], v228 offset:6272
v_mfma_f32_16x16x32_bf16 v[140:143], a[228:231], a[132:135], 0
v_permlane16_swap_b32 v73, v75
v_accvgpr_write_b32 a192, v64
v_mfma_f32_16x16x32_bf16 v[148:151], a[228:231], a[136:139], 0
s_waitcnt lgkmcnt(3)
buffer_load_dwordx4 v234, s[12:15], s30 offen offset:0 nt lds
v_accvgpr_write_b32 a193, v65
v_mfma_f32_16x16x32_bf16 v[156:159], a[228:231], a[140:143], 0
v_accvgpr_write_b32 a194, v66
v_accvgpr_write_b32 a195, v67
v_mfma_f32_16x16x32_bf16 v[128:131], a[232:235], a[144:147], v[128:131]
ds_read_b128 a[248:251], v229 offset:128
v_accvgpr_write_b32 a196, v72
v_mfma_f32_16x16x32_bf16 v[136:139], a[232:235], a[148:151], v[136:139]
v_accvgpr_write_b32 a197, v73
v_accvgpr_write_b32 a198, v74
v_mfma_f32_16x16x32_bf16 v[144:147], a[232:235], a[152:155], v[144:147]
s_waitcnt lgkmcnt(3)
buffer_load_dwordx4 v235, s[12:15], s30 offen offset:1024 nt lds
v_accvgpr_write_b32 a199, v75
v_mfma_f32_16x16x32_bf16 v[152:155], a[232:235], a[156:159], v[152:155]
v_cvt_pk_bf16_f32 v80, v80, v81
v_cvt_pk_bf16_f32 v81, v82, v83
v_mfma_f32_16x16x32_bf16 v[132:135], a[236:239], a[144:147], v[132:135]
ds_read_b128 a[252:255], v229 offset:6272
v_cvt_pk_bf16_f32 v82, v84, v85
v_mfma_f32_16x16x32_bf16 v[140:143], a[236:239], a[148:151], v[140:143]
v_cvt_pk_bf16_f32 v83, v86, v87
v_cvt_pk_bf16_f32 v88, v88, v89
v_mfma_f32_16x16x32_bf16 v[148:151], a[236:239], a[152:155], v[148:151]
s_waitcnt lgkmcnt(3)
buffer_load_dwordx4 v236, s[12:15], s30 offen offset:2048 nt lds
v_cvt_pk_bf16_f32 v89, v90, v91
v_mfma_f32_16x16x32_bf16 v[156:159], a[236:239], a[156:159], v[156:159]
v_cvt_pk_bf16_f32 v90, v92, v93
v_cvt_pk_bf16_f32 v91, v94, v95
v_mfma_f32_16x16x32_bf16 v[128:131], a[240:243], a[160:163], v[128:131]
s_add_u32 m0, s28, 126976
ds_read_b128 a[224:227], v228 offset:256
v_mfma_f32_16x16x32_bf16 v[136:139], a[240:243], a[164:167], v[136:139]
v_permlane16_swap_b32 v80, v82
v_mfma_f32_16x16x32_bf16 v[144:147], a[240:243], a[168:171], v[144:147]
s_waitcnt lgkmcnt(3)
v_permlane16_swap_b32 v81, v83
v_mfma_f32_16x16x32_bf16 v[152:155], a[240:243], a[172:175], v[152:155]
v_permlane16_swap_b32 v88, v90
v_mfma_f32_16x16x32_bf16 v[132:135], a[244:247], a[160:163], v[132:135]
s_mov_b32 s30, 61440
ds_read_b128 a[228:231], v228 offset:6400
v_mfma_f32_16x16x32_bf16 v[140:143], a[244:247], a[164:167], v[140:143]
v_permlane16_swap_b32 v89, v91
v_accvgpr_write_b32 a200, v80
v_mfma_f32_16x16x32_bf16 v[148:151], a[244:247], a[168:171], v[148:151]
s_waitcnt lgkmcnt(3)
buffer_load_dwordx4 v234, s[12:15], s30 offen offset:0 nt lds
v_accvgpr_write_b32 a201, v81
v_mfma_f32_16x16x32_bf16 v[156:159], a[244:247], a[172:175], v[156:159]
v_accvgpr_write_b32 a202, v82
v_accvgpr_write_b32 a203, v83
v_mfma_f32_16x16x32_bf16 v[128:131], a[248:251], a[176:179], v[128:131]
ds_read_b128 a[232:235], v229 offset:256
v_accvgpr_write_b32 a204, v88
v_mfma_f32_16x16x32_bf16 v[136:139], a[248:251], a[180:183], v[136:139]
v_accvgpr_write_b32 a205, v89
v_accvgpr_write_b32 a206, v90
v_mfma_f32_16x16x32_bf16 v[144:147], a[248:251], a[184:187], v[144:147]
s_waitcnt lgkmcnt(3)
buffer_load_dwordx4 v235, s[12:15], s30 offen offset:1024 nt lds
v_accvgpr_write_b32 a207, v91
v_mfma_f32_16x16x32_bf16 v[152:155], a[248:251], a[188:191], v[152:155]
v_cvt_pk_bf16_f32 v96, v96, v97
v_cvt_pk_bf16_f32 v97, v98, v99
v_mfma_f32_16x16x32_bf16 v[132:135], a[252:255], a[176:179], v[132:135]
ds_read_b128 a[236:239], v229 offset:6400
v_cvt_pk_bf16_f32 v98, v100, v101
v_mfma_f32_16x16x32_bf16 v[140:143], a[252:255], a[180:183], v[140:143]
v_cvt_pk_bf16_f32 v99, v102, v103
v_cvt_pk_bf16_f32 v104, v104, v105
v_mfma_f32_16x16x32_bf16 v[148:151], a[252:255], a[184:187], v[148:151]
s_waitcnt vmcnt(21) lgkmcnt(3)
buffer_load_dwordx4 v236, s[12:15], s30 offen offset:2048 nt lds
v_cvt_pk_bf16_f32 v105, v106, v107
v_mfma_f32_16x16x32_bf16 v[156:159], a[252:255], a[188:191], v[156:159]
v_cvt_pk_bf16_f32 v106, v108, v109
v_cvt_pk_bf16_f32 v107, v110, v111
v_mfma_f32_16x16x32_bf16 v[128:131], a[224:227], a[192:195], v[128:131]
s_barrier
ds_read_b128 a[240:243], v228 offset:12288
v_mfma_f32_16x16x32_bf16 v[136:139], a[224:227], a[196:199], v[136:139]
v_permlane16_swap_b32 v96, v98
v_mfma_f32_16x16x32_bf16 v[144:147], a[224:227], a[200:203], v[144:147]
s_waitcnt lgkmcnt(3)
v_permlane16_swap_b32 v97, v99
v_mfma_f32_16x16x32_bf16 v[152:155], a[224:227], a[204:207], v[152:155]
v_permlane16_swap_b32 v104, v106
v_mfma_f32_16x16x32_bf16 v[132:135], a[228:231], a[192:195], v[132:135]
s_add_u32 m0, s28, 139264
ds_read_b128 a[244:247], v229 offset:12288
v_permlane16_swap_b32 v105, v107
v_accvgpr_write_b32 a208, v96
v_accvgpr_write_b32 a209, v97
v_accvgpr_write_b32 a210, v98
v_accvgpr_write_b32 a211, v99
v_accvgpr_write_b32 a212, v104
v_accvgpr_write_b32 a213, v105
v_accvgpr_write_b32 a214, v106
v_accvgpr_write_b32 a215, v107
v_cvt_pk_bf16_f32 v112, v112, v113
v_cvt_pk_bf16_f32 v113, v114, v115
v_cvt_pk_bf16_f32 v114, v116, v117
v_cvt_pk_bf16_f32 v115, v118, v119
v_cvt_pk_bf16_f32 v120, v120, v121
v_cvt_pk_bf16_f32 v121, v122, v123
v_mfma_f32_16x16x32_bf16 v[140:143], a[228:231], a[196:199], v[140:143]
L_pg4:
s_cbranch_execz L_pg8
v_cvt_pk_bf16_f32 v122, v124, v125
v_cvt_pk_bf16_f32 v123, v126, v127
v_permlane16_swap_b32 v112, v114
v_permlane16_swap_b32 v113, v115
v_permlane16_swap_b32 v120, v122
v_permlane16_swap_b32 v121, v123
v_accvgpr_write_b32 a216, v112
v_accvgpr_write_b32 a217, v113
v_accvgpr_write_b32 a218, v114
v_accvgpr_write_b32 a219, v115
v_accvgpr_write_b32 a220, v120
v_accvgpr_write_b32 a221, v121
v_accvgpr_write_b32 a222, v122
v_accvgpr_write_b32 a223, v123
v_mfma_f32_16x16x32_bf16 v[148:151], a[228:231], a[200:203], v[148:151]
s_waitcnt lgkmcnt(3)
v_and_b32 v224, 48, v238
v_cmp_eq_u32 vcc, 0, v224
v_mfma_f32_16x16x32_bf16 v[156:159], a[228:231], a[204:207], v[156:159]
v_mov_b32 v224, 0x3f803f80
v_cndmask_b32 v224, 0, v224, vcc
v_mfma_f32_16x16x32_bf16 v[128:131], a[232:235], a[208:211], v[128:131]
s_mov_b32 s30, 73728
ds_read_b128 a[248:251], v228 offset:18432
v_mov_b32 v225, v224
v_mfma_f32_16x16x32_bf16 v[136:139], a[232:235], a[212:215], v[136:139]
v_mov_b32 v226, v224
v_mov_b32 v227, v224
v_mfma_f32_16x16x32_bf16 v[144:147], a[232:235], a[216:219], v[144:147]
s_waitcnt lgkmcnt(3)
v_mfma_f32_16x16x32_bf16 v[152:155], a[232:235], a[220:223], v[152:155]
buffer_load_dwordx4 v234, s[12:15], s30 offen offset:0 nt lds
v_mfma_f32_16x16x32_bf16 v[132:135], a[236:239], a[208:211], v[132:135]
ds_read_b128 a[252:255], v229 offset:18432
v_mfma_f32_16x16x32_bf16 v[140:143], a[236:239], a[212:215], v[140:143]
v_mfma_f32_16x16x32_bf16 v[148:151], a[236:239], a[216:219], v[148:151]
s_waitcnt lgkmcnt(2)
v_mfma_f32_16x16x32_bf16 v[156:159], a[236:239], a[220:223], v[156:159]
buffer_load_dwordx4 v235, s[12:15], s30 offen offset:1024 nt lds
L_att_t1:
v_mfma_f32_16x16x32_bf16 v[160:163], a[240:243], a[128:131], 0
ds_read_b128 a[224:227], v228 offset:12416
v_mfma_f32_16x16x32_bf16 v[160:163], a[244:247], a[144:147], v[160:163]
v_mfma_f32_16x16x32_bf16 v[168:171], a[240:243], a[132:135], 0
buffer_load_dwordx4 v236, s[12:15], s30 offen offset:2048 nt lds
v_max3_f32 v192, v192, v128, v129
v_max3_f32 v196, v196, v136, v137
v_max3_f32 v200, v200, v144, v145
v_mfma_f32_16x16x32_bf16 v[168:171], a[244:247], a[148:151], v[168:171]
v_max3_f32 v204, v204, v152, v153
v_max3_f32 v192, v192, v130, v131
v_max3_f32 v196, v196, v138, v139
v_max3_f32 v200, v200, v146, v147
v_mfma_f32_16x16x32_bf16 v[176:179], a[240:243], a[136:139], 0
s_add_u32 m0, s28, 151552
ds_read_b128 a[228:231], v229 offset:12416
v_max3_f32 v204, v204, v154, v155
v_max3_f32 v192, v192, v132, v133
v_max3_f32 v196, v196, v140, v141
v_mfma_f32_16x16x32_bf16 v[176:179], a[244:247], a[152:155], v[176:179]
v_max3_f32 v200, v200, v148, v149
v_max3_f32 v204, v204, v156, v157
v_max3_f32 v192, v192, v134, v135
v_max3_f32 v196, v196, v142, v143
v_mfma_f32_16x16x32_bf16 v[184:187], a[240:243], a[140:143], 0
s_waitcnt lgkmcnt(2)
v_max3_f32 v200, v200, v150, v151
v_max3_f32 v204, v204, v158, v159
s_nop 0
v_permlane32_swap_b32 v192, v200
v_mfma_f32_16x16x32_bf16 v[184:187], a[244:247], a[156:159], v[184:187]
v_permlane32_swap_b32 v196, v204
v_max_f32 v192, v192, v200
v_max_f32 v196, v196, v204
v_mfma_f32_16x16x32_bf16 v[164:167], a[248:251], a[128:131], 0
s_mov_b32 s30, 86016
ds_read_b128 a[232:235], v228 offset:18560
s_nop 1
v_permlane16_swap_b32 v192, v196
v_mfma_f32_16x16x32_bf16 v[164:167], a[252:255], a[144:147], v[164:167]
v_max_f32 v192, v192, v196
v_sub_f32 v192, 0xc2200000, v192
v_mov_b32 v196, v192
s_nop 1
v_mfma_f32_16x16x32_bf16 v[172:175], a[248:251], a[132:135], 0
buffer_load_dwordx4 v234, s[12:15], s30 offen offset:0 nt lds
v_permlane16_swap_b32 v192, v196
v_mov_b32 v200, v192
v_mfma_f32_16x16x32_bf16 v[172:175], a[252:255], a[148:151], v[172:175]
v_mov_b32 v204, v196
s_nop 0
v_permlane32_swap_b32 v192, v200
v_mfma_f32_16x16x32_bf16 v[180:183], a[248:251], a[136:139], 0
ds_read_b128 a[236:239], v229 offset:18560
v_mfma_f32_16x16x32_bf16 v[180:183], a[252:255], a[152:155], v[180:183]
v_permlane32_swap_b32 v196, v204
v_mfma_f32_16x16x32_bf16 v[188:191], a[248:251], a[140:143], 0
s_waitcnt lgkmcnt(2)
v_mov_b32 v193, v192
v_mov_b32 v194, v192
v_mov_b32 v195, v192
v_mov_b32 v197, v196
v_mfma_f32_16x16x32_bf16 v[188:191], a[252:255], a[156:159], v[188:191]
buffer_load_dwordx4 v235, s[12:15], s30 offen offset:1024 nt lds
v_mov_b32 v198, v196
v_mov_b32 v199, v196
v_mov_b32 v201, v200
v_mfma_f32_16x16x32_bf16 v[160:163], a[224:227], a[160:163], v[160:163]
ds_read_b128 a[240:243], v228 offset:12544
v_mov_b32 v202, v200
v_mov_b32 v203, v200
v_mov_b32 v205, v204
v_mfma_f32_16x16x32_bf16 v[160:163], a[228:231], a[176:179], v[160:163]
v_add_f32 v128, v192, v128
v_exp_f32 v128, v128
v_mov_b32 v206, v204
v_mfma_f32_16x16x32_bf16 v[168:171], a[224:227], a[164:167], v[168:171]
buffer_load_dwordx4 v236, s[12:15], s30 offen offset:2048 nt lds
v_add_f32 v129, v192, v129
v_exp_f32 v129, v129
v_mfma_f32_16x16x32_bf16 v[168:171], a[228:231], a[180:183], v[168:171]
v_add_f32 v130, v192, v130
v_exp_f32 v130, v130
v_mov_b32 v207, v204
v_mfma_f32_16x16x32_bf16 v[176:179], a[224:227], a[168:171], v[176:179]
ds_read_b128 a[244:247], v229 offset:12544
v_add_f32 v131, v192, v131
v_exp_f32 v131, v131
v_mfma_f32_16x16x32_bf16 v[176:179], a[228:231], a[184:187], v[176:179]
v_add_f32 v132, v192, v132
v_exp_f32 v132, v132
v_cvt_pk_bf16_f32 v0, v128, v129
v_mfma_f32_16x16x32_bf16 v[184:187], a[224:227], a[172:175], v[184:187]
s_waitcnt lgkmcnt(2)
v_add_f32 v133, v192, v133
v_exp_f32 v133, v133
v_cvt_pk_bf16_f32 v1, v130, v131
v_mfma_f32_16x16x32_bf16 v[184:187], a[228:231], a[188:191], v[184:187]
v_add_f32 v134, v192, v134
v_exp_f32 v134, v134
v_cvt_pk_bf16_f32 v2, v132, v133
v_mfma_f32_16x16x32_bf16 v[164:167], a[232:235], a[160:163], v[164:167]
ds_read_b128 a[248:251], v228 offset:18688
v_add_f32 v135, v192, v135
v_exp_f32 v135, v135
v_mfma_f32_16x16x32_bf16 v[164:167], a[236:239], a[176:179], v[164:167]
v_add_f32 v136, v196, v136
v_exp_f32 v136, v136
v_cvt_pk_bf16_f32 v3, v134, v135
v_mfma_f32_16x16x32_bf16 v[172:175], a[232:235], a[164:167], v[172:175]
v_add_f32 v137, v196, v137
v_exp_f32 v137, v137
v_mfma_f32_16x16x32_bf16 v[172:175], a[236:239], a[180:183], v[172:175]
v_add_f32 v138, v196, v138
v_exp_f32 v138, v138
v_cvt_pk_bf16_f32 v4, v136, v137
v_mfma_f32_16x16x32_bf16 v[180:183], a[232:235], a[168:171], v[180:183]
ds_read_b128 a[252:255], v229 offset:18688
v_add_f32 v139, v196, v139
v_exp_f32 v139, v139
v_mfma_f32_16x16x32_bf16 v[180:183], a[236:239], a[184:187], v[180:183]
v_add_f32 v140, v196, v140
v_exp_f32 v140, v140
v_cvt_pk_bf16_f32 v5, v138, v139
v_mfma_f32_16x16x32_bf16 v[188:191], a[232:235], a[172:175], v[188:191]
s_waitcnt vmcnt(15) lgkmcnt(2)
v_add_f32 v141, v196, v141
v_exp_f32 v141, v141
v_mfma_f32_16x16x32_bf16 v[188:191], a[236:239], a[188:191], v[188:191]
v_add_f32 v142, v196, v142
v_exp_f32 v142, v142
v_cvt_pk_bf16_f32 v6, v140, v141
v_mfma_f32_16x16x32_bf16 v[160:163], a[240:243], a[192:195], v[160:163]
s_barrier
v_add_f32 v143, v196, v143
v_exp_f32 v143, v143
v_mfma_f32_16x16x32_bf16 v[160:163], a[244:247], a[208:211], v[160:163]
ds_read_b128 a[224:227], v228 offset:24576
v_add_f32 v144, v200, v144
v_exp_f32 v144, v144
v_mfma_f32_16x16x32_bf16 v[168:171], a[240:243], a[196:199], v[168:171]
s_add_u32 m0, s28, 65536
v_add_f32 v145, v200, v145
v_exp_f32 v145, v145
v_cvt_pk_bf16_f32 v7, v142, v143
v_mfma_f32_16x16x32_bf16 v[168:171], a[244:247], a[212:215], v[168:171]
v_add_f32 v146, v200, v146
v_exp_f32 v146, v146
v_cvt_pk_bf16_f32 v144, v144, v145
v_mfma_f32_16x16x32_bf16 v[176:179], a[240:243], a[200:203], v[176:179]
s_mov_b32 s30, 98304
v_add_f32 v147, v200, v147
v_exp_f32 v147, v147
v_accvgpr_write_b32 a0, v144
v_mfma_f32_16x16x32_bf16 v[176:179], a[244:247], a[216:219], v[176:179]
ds_read_b128 a[228:231], v229 offset:24576
v_add_f32 v148, v200, v148
v_exp_f32 v148, v148
v_mfma_f32_16x16x32_bf16 v[184:187], a[240:243], a[204:207], v[184:187]
s_waitcnt lgkmcnt(2)
v_add_f32 v149, v200, v149
v_exp_f32 v149, v149
v_cvt_pk_bf16_f32 v145, v146, v147
v_mfma_f32_16x16x32_bf16 v[184:187], a[244:247], a[220:223], v[184:187]
buffer_load_dwordx4 v234, s[12:15], s30 offen offset:0 nt lds
v_add_f32 v150, v200, v150
v_exp_f32 v150, v150
v_mfma_f32_16x16x32_bf16 v[164:167], a[248:251], a[192:195], v[164:167]
ds_read_b128 a[232:235], v228 offset:30720
v_add_f32 v151, v200, v151
v_exp_f32 v151, v151
v_mfma_f32_16x16x32_bf16 v[164:167], a[252:255], a[208:211], v[164:167]
v_accvgpr_write_b32 a1, v145
v_add_f32 v152, v204, v152
v_exp_f32 v152, v152
v_mfma_f32_16x16x32_bf16 v[172:175], a[248:251], a[196:199], v[172:175]
buffer_load_dwordx4 v235, s[12:15], s30 offen offset:1024 nt lds
v_add_f32 v153, v204, v153
v_exp_f32 v153, v153
v_mfma_f32_16x16x32_bf16 v[172:175], a[252:255], a[212:215], v[172:175]
v_cvt_pk_bf16_f32 v146, v148, v149
v_accvgpr_write_b32 a2, v146
v_cvt_pk_bf16_f32 v147, v150, v151
v_accvgpr_write_b32 a3, v147
v_mfma_f32_16x16x32_bf16 v[180:183], a[248:251], a[200:203], v[180:183]
ds_read_b128 a[236:239], v229 offset:30720
v_add_f32 v154, v204, v154
v_exp_f32 v154, v154
v_mfma_f32_16x16x32_bf16 v[180:183], a[252:255], a[216:219], v[180:183]
v_add_f32 v155, v204, v155
v_exp_f32 v155, v155
v_cvt_pk_bf16_f32 v152, v152, v153
v_mfma_f32_16x16x32_bf16 v[188:191], a[248:251], a[204:207], v[188:191]
s_waitcnt lgkmcnt(2)
v_add_f32 v156, v204, v156
v_exp_f32 v156, v156
v_accvgpr_write_b32 a4, v152
v_mfma_f32_16x16x32_bf16 v[188:191], a[252:255], a[220:223], v[188:191]
buffer_load_dwordx4 v236, s[12:15], s30 offen offset:2048 nt lds
v_add_f32 v157, v204, v157
v_exp_f32 v157, v157
v_cvt_pk_bf16_f32 v153, v154, v155
v_accvgpr_write_b32 a5, v153
v_cvt_pk_bf16_f32 v154, v156, v157
v_accvgpr_write_b32 a6, v154
v_add_f32 v158, v204, v158
v_exp_f32 v158, v158
v_add_f32 v159, v204, v159
v_exp_f32 v159, v159
s_nop 0
v_cvt_pk_bf16_f32 v155, v158, v159
v_accvgpr_write_b32 a7, v155
v_mfma_f32_16x16x32_bf16 v[128:131], a[224:227], a[128:131], v[192:195]
buffer_load_dword v244, v255, s[16:19], s91 offen offset:128
v_mfma_f32_16x16x32_bf16 v[128:131], a[228:231], a[144:147], v[128:131]
v_add_f32 v160, v192, v160
v_exp_f32 v160, v160
v_mfma_f32_16x16x32_bf16 v[136:139], a[224:227], a[132:135], v[196:199]
v_add_f32 v161, v192, v161
v_exp_f32 v161, v161
v_mfma_f32_16x16x32_bf16 v[136:139], a[228:231], a[148:151], v[136:139]
v_add_f32 v162, v192, v162
v_exp_f32 v162, v162
v_mfma_f32_16x16x32_bf16 v[144:147], a[224:227], a[136:139], v[200:203]
ds_read_b128 a[244:247], v228 offset:24704
v_cvt_pk_bf16_f32 v8, v160, v161
v_mfma_f32_16x16x32_bf16 v[144:147], a[228:231], a[152:155], v[144:147]
v_add_f32 v163, v192, v163
v_exp_f32 v163, v163
v_mfma_f32_16x16x32_bf16 v[152:155], a[224:227], a[140:143], v[204:207]
s_waitcnt lgkmcnt(1)
v_add_f32 v164, v192, v164
v_exp_f32 v164, v164
v_mfma_f32_16x16x32_bf16 v[152:155], a[228:231], a[156:159], v[152:155]
v_add_f32 v165, v192, v165
v_exp_f32 v165, v165
v_mfma_f32_16x16x32_bf16 v[132:135], a[232:235], a[128:131], v[192:195]
ds_read_b128 a[248:251], v229 offset:24704
v_cvt_pk_bf16_f32 v9, v162, v163
v_cvt_pk_bf16_f32 v10, v164, v165
v_mfma_f32_16x16x32_bf16 v[132:135], a[236:239], a[144:147], v[132:135]
v_add_f32 v166, v192, v166
v_exp_f32 v166, v166
v_mfma_f32_16x16x32_bf16 v[140:143], a[232:235], a[132:135], v[196:199]
v_add_f32 v167, v192, v167
v_exp_f32 v167, v167
v_mfma_f32_16x16x32_bf16 v[140:143], a[236:239], a[148:151], v[140:143]
v_add_f32 v168, v196, v168
v_exp_f32 v168, v168
v_mfma_f32_16x16x32_bf16 v[148:151], a[232:235], a[136:139], v[200:203]
ds_read_b128 a[252:255], v228 offset:30848
v_cvt_pk_bf16_f32 v11, v166, v167
v_mfma_f32_16x16x32_bf16 v[148:151], a[236:239], a[152:155], v[148:151]
v_add_f32 v169, v196, v169
v_exp_f32 v169, v169
v_mfma_f32_16x16x32_bf16 v[156:159], a[232:235], a[140:143], v[204:207]
v_add_f32 v170, v196, v170
v_exp_f32 v170, v170
v_mfma_f32_16x16x32_bf16 v[156:159], a[236:239], a[156:159], v[156:159]
v_add_f32 v171, v196, v171
v_exp_f32 v171, v171
v_mfma_f32_16x16x32_bf16 v[208:211], v[224:227], v[0:3], 0
ds_read_b128 a[224:227], v229 offset:30848
v_cvt_pk_bf16_f32 v12, v168, v169
v_cvt_pk_bf16_f32 v13, v170, v171
v_mfma_f32_16x16x32_bf16 v[212:215], v[224:227], v[4:7], 0
v_add_f32 v172, v196, v172
v_exp_f32 v172, v172
v_mfma_f32_16x16x32_bf16 v[216:219], v[224:227], a[0:3], 0
s_waitcnt lgkmcnt(2)
v_add_f32 v173, v196, v173
v_exp_f32 v173, v173
v_mfma_f32_16x16x32_bf16 v[240:243], v[224:227], a[4:7], 0
v_add_f32 v174, v196, v174
v_exp_f32 v174, v174
v_mfma_f32_16x16x32_bf16 v[128:131], a[244:247], a[160:163], v[128:131]
ds_read_b128 a[228:231], v228 offset:24832
v_cvt_pk_bf16_f32 v14, v172, v173
v_mfma_f32_16x16x32_bf16 v[128:131], a[248:251], a[176:179], v[128:131]
v_add_f32 v175, v196, v175
v_exp_f32 v175, v175
v_mfma_f32_16x16x32_bf16 v[136:139], a[244:247], a[164:167], v[136:139]
v_add_f32 v176, v200, v176
v_exp_f32 v176, v176
v_mfma_f32_16x16x32_bf16 v[136:139], a[248:251], a[180:183], v[136:139]
v_add_f32 v177, v200, v177
v_exp_f32 v177, v177
v_mfma_f32_16x16x32_bf16 v[144:147], a[244:247], a[168:171], v[144:147]
ds_read_b128 a[232:235], v229 offset:24832
v_cvt_pk_bf16_f32 v15, v174, v175
v_cvt_pk_bf16_f32 v176, v176, v177
v_mfma_f32_16x16x32_bf16 v[144:147], a[248:251], a[184:187], v[144:147]
v_add_f32 v178, v200, v178
v_exp_f32 v178, v178
v_mfma_f32_16x16x32_bf16 v[152:155], a[244:247], a[172:175], v[152:155]
s_waitcnt lgkmcnt(2)
v_add_f32 v179, v200, v179
v_exp_f32 v179, v179
v_mfma_f32_16x16x32_bf16 v[152:155], a[248:251], a[188:191], v[152:155]
v_add_f32 v180, v200, v180
v_exp_f32 v180, v180
v_mfma_f32_16x16x32_bf16 v[132:135], a[252:255], a[160:163], v[132:135]
ds_read_b128 a[236:239], v228 offset:30976
v_accvgpr_write_b32 a8, v176
v_cvt_pk_bf16_f32 v177, v178, v179
v_mfma_f32_16x16x32_bf16 v[132:135], a[224:227], a[176:179], v[132:135]
v_add_f32 v181, v200, v181
v_exp_f32 v181, v181
v_mfma_f32_16x16x32_bf16 v[140:143], a[252:255], a[164:167], v[140:143]
v_add_f32 v182, v200, v182
v_exp_f32 v182, v182
v_mfma_f32_16x16x32_bf16 v[140:143], a[224:227], a[180:183], v[140:143]
v_add_f32 v183, v200, v183
v_exp_f32 v183, v183
v_mfma_f32_16x16x32_bf16 v[148:151], a[252:255], a[168:171], v[148:151]
ds_read_b128 a[240:243], v229 offset:30976
v_accvgpr_write_b32 a9, v177
v_cvt_pk_bf16_f32 v178, v180, v181
v_mfma_f32_16x16x32_bf16 v[148:151], a[224:227], a[184:187], v[148:151]
v_add_f32 v184, v204, v184
v_exp_f32 v184, v184
v_mfma_f32_16x16x32_bf16 v[156:159], a[252:255], a[172:175], v[156:159]
s_waitcnt vmcnt(16) lgkmcnt(2)
v_add_f32 v185, v204, v185
v_exp_f32 v185, v185
v_mfma_f32_16x16x32_bf16 v[156:159], a[224:227], a[188:191], v[156:159]
v_accvgpr_write_b32 a10, v178
v_cvt_pk_bf16_f32 v179, v182, v183
v_accvgpr_write_b32 a11, v179
v_mfma_f32_16x16x32_bf16 v[128:131], a[228:231], a[192:195], v[128:131]
s_barrier
v_add_f32 v186, v204, v186
v_exp_f32 v186, v186
v_mfma_f32_16x16x32_bf16 v[128:131], a[232:235], a[208:211], v[128:131]
ds_read_b128 a[244:247], v228 offset:36864
v_cvt_pk_bf16_f32 v184, v184, v185
v_accvgpr_write_b32 a12, v184
v_mfma_f32_16x16x32_bf16 v[136:139], a[228:231], a[196:199], v[136:139]
s_add_u32 m0, s28, 77824
v_add_f32 v187, v204, v187
v_exp_f32 v187, v187
v_mfma_f32_16x16x32_bf16 v[136:139], a[232:235], a[212:215], v[136:139]
v_add_f32 v188, v204, v188
v_exp_f32 v188, v188
v_mfma_f32_16x16x32_bf16 v[144:147], a[228:231], a[200:203], v[144:147]
s_mov_b32 s30, 110592
v_add_f32 v189, v204, v189
v_exp_f32 v189, v189
v_mfma_f32_16x16x32_bf16 v[144:147], a[232:235], a[216:219], v[144:147]
ds_read_b128 a[248:251], v229 offset:36864
v_cvt_pk_bf16_f32 v185, v186, v187
v_accvgpr_write_b32 a13, v185
v_mfma_f32_16x16x32_bf16 v[152:155], a[228:231], a[204:207], v[152:155]
s_waitcnt lgkmcnt(2)
v_add_f32 v190, v204, v190
v_exp_f32 v190, v190
v_mfma_f32_16x16x32_bf16 v[152:155], a[232:235], a[220:223], v[152:155]
buffer_load_dwordx4 v234, s[12:15], s30 offen offset:0 nt lds
v_cvt_pk_bf16_f32 v186, v188, v189
v_accvgpr_write_b32 a14, v186
v_mfma_f32_16x16x32_bf16 v[132:135], a[236:239], a[192:195], v[132:135]
ds_read_b128 a[252:255], v228 offset:43008
v_mfma_f32_16x16x32_bf16 v[132:135], a[240:243], a[208:211], v[132:135]
v_add_f32 v191, v204, v191
v_exp_f32 v191, v191
v_mfma_f32_16x16x32_bf16 v[140:143], a[236:239], a[196:199], v[140:143]
buffer_load_dwordx4 v235, s[12:15], s30 offen offset:1024 nt lds
v_cvt_pk_bf16_f32 v187, v190, v191
v_accvgpr_write_b32 a15, v187
v_mfma_f32_16x16x32_bf16 v[140:143], a[240:243], a[212:215], v[140:143]
v_mfma_f32_16x16x32_bf16 v[148:151], a[236:239], a[200:203], v[148:151]
ds_read_b128 a[224:227], v229 offset:43008
v_mfma_f32_16x16x32_bf16 v[148:151], a[240:243], a[216:219], v[148:151]
v_mfma_f32_16x16x32_bf16 v[156:159], a[236:239], a[204:207], v[156:159]
s_waitcnt lgkmcnt(2)
v_mfma_f32_16x16x32_bf16 v[156:159], a[240:243], a[220:223], v[156:159]
buffer_load_dwordx4 v236, s[12:15], s30 offen offset:2048 nt lds
v_mfma_f32_16x16x32_bf16 v[160:163], a[244:247], a[128:131], v[192:195]
v_exp_f32 v128, v128
v_mfma_f32_16x16x32_bf16 v[160:163], a[248:251], a[144:147], v[160:163]
v_exp_f32 v129, v129
v_mfma_f32_16x16x32_bf16 v[168:171], a[244:247], a[132:135], v[196:199]
v_exp_f32 v130, v130
v_mfma_f32_16x16x32_bf16 v[168:171], a[248:251], a[148:151], v[168:171]
v_exp_f32 v131, v131
v_mfma_f32_16x16x32_bf16 v[176:179], a[244:247], a[136:139], v[200:203]
ds_read_b128 a[232:235], v228 offset:36992
v_cvt_pk_bf16_f32 v16, v128, v129
v_mfma_f32_16x16x32_bf16 v[176:179], a[248:251], a[152:155], v[176:179]
v_exp_f32 v132, v132
v_mfma_f32_16x16x32_bf16 v[184:187], a[244:247], a[140:143], v[204:207]
s_waitcnt lgkmcnt(1)
v_exp_f32 v133, v133
v_mfma_f32_16x16x32_bf16 v[184:187], a[248:251], a[156:159], v[184:187]
v_exp_f32 v134, v134
v_mfma_f32_16x16x32_bf16 v[164:167], a[252:255], a[128:131], v[192:195]
ds_read_b128 a[236:239], v229 offset:36992
v_cvt_pk_bf16_f32 v17, v130, v131
v_mfma_f32_16x16x32_bf16 v[164:167], a[224:227], a[144:147], v[164:167]
v_exp_f32 v135, v135
v_mfma_f32_16x16x32_bf16 v[172:175], a[252:255], a[132:135], v[196:199]
v_exp_f32 v136, v136
v_mfma_f32_16x16x32_bf16 v[172:175], a[224:227], a[148:151], v[172:175]
v_exp_f32 v137, v137
v_mfma_f32_16x16x32_bf16 v[180:183], a[252:255], a[136:139], v[200:203]
ds_read_b128 a[240:243], v228 offset:43136
v_cvt_pk_bf16_f32 v18, v132, v133
v_mfma_f32_16x16x32_bf16 v[180:183], a[224:227], a[152:155], v[180:183]
v_exp_f32 v138, v138
v_mfma_f32_16x16x32_bf16 v[188:191], a[252:255], a[140:143], v[204:207]
v_exp_f32 v139, v139
v_mfma_f32_16x16x32_bf16 v[188:191], a[224:227], a[156:159], v[188:191]
v_exp_f32 v140, v140
v_mfma_f32_16x16x32_bf16 v[208:211], v[224:227], v[8:11], v[208:211]
ds_read_b128 a[244:247], v229 offset:43136
v_cvt_pk_bf16_f32 v19, v134, v135
v_mfma_f32_16x16x32_bf16 v[212:215], v[224:227], v[12:15], v[212:215]
v_exp_f32 v141, v141
v_mfma_f32_16x16x32_bf16 v[216:219], v[224:227], a[8:11], v[216:219]
s_waitcnt lgkmcnt(2)
v_exp_f32 v142, v142
v_mfma_f32_16x16x32_bf16 v[240:243], v[224:227], a[12:15], v[240:243]
v_exp_f32 v143, v143
v_mfma_f32_16x16x32_bf16 v[160:163], a[232:235], a[160:163], v[160:163]
ds_read_b128 a[248:251], v228 offset:37120
v_cvt_pk_bf16_f32 v20, v136, v137
v_mfma_f32_16x16x32_bf16 v[160:163], a[236:239], a[176:179], v[160:163]
v_exp_f32 v144, v144
v_mfma_f32_16x16x32_bf16 v[168:171], a[232:235], a[164:167], v[168:171]
v_exp_f32 v145, v145
v_mfma_f32_16x16x32_bf16 v[168:171], a[236:239], a[180:183], v[168:171]
v_cvt_pk_bf16_f32 v21, v138, v139
v_cvt_pk_bf16_f32 v22, v140, v141
v_mfma_f32_16x16x32_bf16 v[176:179], a[232:235], a[168:171], v[176:179]
ds_read_b128 a[252:255], v229 offset:37120
v_cvt_pk_bf16_f32 v23, v142, v143
v_mfma_f32_16x16x32_bf16 v[176:179], a[236:239], a[184:187], v[176:179]
v_exp_f32 v146, v146
v_mfma_f32_16x16x32_bf16 v[184:187], a[232:235], a[172:175], v[184:187]
s_waitcnt lgkmcnt(2)
v_exp_f32 v147, v147
v_mfma_f32_16x16x32_bf16 v[184:187], a[236:239], a[188:191], v[184:187]
v_exp_f32 v148, v148
v_mfma_f32_16x16x32_bf16 v[164:167], a[240:243], a[160:163], v[164:167]
ds_read_b128 a[224:227], v228 offset:43264
v_cvt_pk_bf16_f32 v144, v144, v145
v_mfma_f32_16x16x32_bf16 v[164:167], a[244:247], a[176:179], v[164:167]
v_exp_f32 v149, v149
v_mfma_f32_16x16x32_bf16 v[172:175], a[240:243], a[164:167], v[172:175]
v_accvgpr_write_b32 a16, v144
v_cvt_pk_bf16_f32 v145, v146, v147
v_mfma_f32_16x16x32_bf16 v[172:175], a[244:247], a[180:183], v[172:175]
v_exp_f32 v150, v150
v_mfma_f32_16x16x32_bf16 v[180:183], a[240:243], a[168:171], v[180:183]
ds_read_b128 a[228:231], v229 offset:43264
v_accvgpr_write_b32 a17, v145
v_mfma_f32_16x16x32_bf16 v[180:183], a[244:247], a[184:187], v[180:183]
v_exp_f32 v151, v151
v_mfma_f32_16x16x32_bf16 v[188:191], a[240:243], a[172:175], v[188:191]
s_waitcnt vmcnt(16) lgkmcnt(2)
v_exp_f32 v152, v152
v_mfma_f32_16x16x32_bf16 v[188:191], a[244:247], a[188:191], v[188:191]
v_add_u32 v228, 36864, v228
v_add_u32 v229, 36864, v229
v_mfma_f32_16x16x32_bf16 v[160:163], a[248:251], a[192:195], v[160:163]
s_barrier
v_exp_f32 v153, v153
v_mfma_f32_16x16x32_bf16 v[160:163], a[252:255], a[208:211], v[160:163]
ds_read_b128 a[232:235], v228 offset:12288
v_cvt_pk_bf16_f32 v146, v148, v149
v_mfma_f32_16x16x32_bf16 v[168:171], a[248:251], a[196:199], v[168:171]
s_add_u32 m0, s28, 90112
v_accvgpr_write_b32 a18, v146
v_cvt_pk_bf16_f32 v147, v150, v151
v_mfma_f32_16x16x32_bf16 v[168:171], a[252:255], a[212:215], v[168:171]
v_exp_f32 v154, v154
v_mfma_f32_16x16x32_bf16 v[176:179], a[248:251], a[200:203], v[176:179]
s_mov_b32 s30, 122880
v_exp_f32 v155, v155
v_mfma_f32_16x16x32_bf16 v[176:179], a[252:255], a[216:219], v[176:179]
ds_read_b128 a[236:239], v229 offset:12288
v_accvgpr_write_b32 a19, v147
v_mfma_f32_16x16x32_bf16 v[184:187], a[248:251], a[204:207], v[184:187]
s_waitcnt lgkmcnt(2)
v_exp_f32 v156, v156
v_mfma_f32_16x16x32_bf16 v[184:187], a[252:255], a[220:223], v[184:187]
buffer_load_dwordx4 v234, s[12:15], s30 offen offset:0 nt lds
v_cvt_pk_bf16_f32 v152, v152, v153
v_mfma_f32_16x16x32_bf16 v[164:167], a[224:227], a[192:195], v[164:167]
ds_read_b128 a[240:243], v228 offset:18432
v_accvgpr_write_b32 a20, v152
v_mfma_f32_16x16x32_bf16 v[164:167], a[228:231], a[208:211], v[164:167]
v_exp_f32 v157, v157
v_mfma_f32_16x16x32_bf16 v[172:175], a[224:227], a[196:199], v[172:175]
buffer_load_dwordx4 v235, s[12:15], s30 offen offset:1024 nt lds
v_cvt_pk_bf16_f32 v153, v154, v155
v_mfma_f32_16x16x32_bf16 v[172:175], a[228:231], a[212:215], v[172:175]
v_exp_f32 v158, v158
v_mfma_f32_16x16x32_bf16 v[180:183], a[224:227], a[200:203], v[180:183]
ds_read_b128 a[244:247], v229 offset:18432
v_accvgpr_write_b32 a21, v153
v_mfma_f32_16x16x32_bf16 v[180:183], a[228:231], a[216:219], v[180:183]
v_exp_f32 v159, v159
v_mfma_f32_16x16x32_bf16 v[188:191], a[224:227], a[204:207], v[188:191]
s_waitcnt lgkmcnt(2)
v_cvt_pk_bf16_f32 v154, v156, v157
v_accvgpr_write_b32 a22, v154
v_mfma_f32_16x16x32_bf16 v[188:191], a[228:231], a[220:223], v[188:191]
buffer_load_dwordx4 v236, s[12:15], s30 offen offset:2048 nt lds
v_cvt_pk_bf16_f32 v155, v158, v159
v_accvgpr_write_b32 a23, v155
v_mfma_f32_16x16x32_bf16 v[128:131], a[232:235], a[128:131], v[192:195]
v_exp_f32 v160, v160
v_mfma_f32_16x16x32_bf16 v[128:131], a[236:239], a[144:147], v[128:131]
v_exp_f32 v161, v161
v_mfma_f32_16x16x32_bf16 v[136:139], a[232:235], a[132:135], v[196:199]
v_exp_f32 v162, v162
v_mfma_f32_16x16x32_bf16 v[136:139], a[236:239], a[148:151], v[136:139]
v_exp_f32 v163, v163
v_mfma_f32_16x16x32_bf16 v[144:147], a[232:235], a[136:139], v[200:203]
ds_read_b128 a[252:255], v228 offset:12416
v_cvt_pk_bf16_f32 v24, v160, v161
v_mfma_f32_16x16x32_bf16 v[144:147], a[236:239], a[152:155], v[144:147]
v_exp_f32 v164, v164
v_mfma_f32_16x16x32_bf16 v[152:155], a[232:235], a[140:143], v[204:207]
s_waitcnt lgkmcnt(1)
v_exp_f32 v165, v165
v_mfma_f32_16x16x32_bf16 v[152:155], a[236:239], a[156:159], v[152:155]
v_exp_f32 v166, v166
v_mfma_f32_16x16x32_bf16 v[132:135], a[240:243], a[128:131], v[192:195]
ds_read_b128 a[224:227], v229 offset:12416
v_cvt_pk_bf16_f32 v25, v162, v163
v_mfma_f32_16x16x32_bf16 v[132:135], a[244:247], a[144:147], v[132:135]
v_exp_f32 v167, v167
v_mfma_f32_16x16x32_bf16 v[140:143], a[240:243], a[132:135], v[196:199]
v_exp_f32 v168, v168
v_mfma_f32_16x16x32_bf16 v[140:143], a[244:247], a[148:151], v[140:143]
v_exp_f32 v169, v169
v_mfma_f32_16x16x32_bf16 v[148:151], a[240:243], a[136:139], v[200:203]
ds_read_b128 a[228:231], v228 offset:18560
v_cvt_pk_bf16_f32 v26, v164, v165
v_mfma_f32_16x16x32_bf16 v[148:151], a[244:247], a[152:155], v[148:151]
v_exp_f32 v170, v170
v_mfma_f32_16x16x32_bf16 v[156:159], a[240:243], a[140:143], v[204:207]
v_exp_f32 v171, v171
v_mfma_f32_16x16x32_bf16 v[156:159], a[244:247], a[156:159], v[156:159]
v_exp_f32 v172, v172
v_mfma_f32_16x16x32_bf16 v[208:211], v[224:227], v[16:19], v[208:211]
ds_read_b128 a[232:235], v229 offset:18560
v_cvt_pk_bf16_f32 v27, v166, v167
v_mfma_f32_16x16x32_bf16 v[212:215], v[224:227], v[20:23], v[212:215]
v_exp_f32 v173, v173
v_mfma_f32_16x16x32_bf16 v[216:219], v[224:227], a[16:19], v[216:219]
s_waitcnt lgkmcnt(2)
v_exp_f32 v174, v174
v_mfma_f32_16x16x32_bf16 v[240:243], v[224:227], a[20:23], v[240:243]
v_exp_f32 v175, v175
v_mfma_f32_16x16x32_bf16 v[128:131], a[252:255], a[160:163], v[128:131]
ds_read_b128 a[236:239], v228 offset:12544
v_cvt_pk_bf16_f32 v28, v168, v169
v_mfma_f32_16x16x32_bf16 v[128:131], a[224:227], a[176:179], v[128:131]
v_exp_f32 v176, v176
v_mfma_f32_16x16x32_bf16 v[136:139], a[252:255], a[164:167], v[136:139]
v_exp_f32 v177, v177
v_mfma_f32_16x16x32_bf16 v[136:139], a[224:227], a[180:183], v[136:139]
v_cvt_pk_bf16_f32 v29, v170, v171
v_cvt_pk_bf16_f32 v30, v172, v173
v_mfma_f32_16x16x32_bf16 v[144:147], a[252:255], a[168:171], v[144:147]
ds_read_b128 a[240:243], v229 offset:12544
v_cvt_pk_bf16_f32 v31, v174, v175
v_mfma_f32_16x16x32_bf16 v[144:147], a[224:227], a[184:187], v[144:147]
v_exp_f32 v178, v178
v_mfma_f32_16x16x32_bf16 v[152:155], a[252:255], a[172:175], v[152:155]
s_waitcnt lgkmcnt(2)
v_exp_f32 v179, v179
v_mfma_f32_16x16x32_bf16 v[152:155], a[224:227], a[188:191], v[152:155]
v_exp_f32 v180, v180
v_mfma_f32_16x16x32_bf16 v[132:135], a[228:231], a[160:163], v[132:135]
ds_read_b128 a[244:247], v228 offset:18688
v_cvt_pk_bf16_f32 v176, v176, v177
v_mfma_f32_16x16x32_bf16 v[132:135], a[232:235], a[176:179], v[132:135]
v_exp_f32 v181, v181
v_mfma_f32_16x16x32_bf16 v[140:143], a[228:231], a[164:167], v[140:143]
v_accvgpr_write_b32 a24, v176
v_cvt_pk_bf16_f32 v177, v178, v179
v_mfma_f32_16x16x32_bf16 v[140:143], a[232:235], a[180:183], v[140:143]
v_exp_f32 v182, v182
v_mfma_f32_16x16x32_bf16 v[148:151], a[228:231], a[168:171], v[148:151]
ds_read_b128 a[248:251], v229 offset:18688
v_accvgpr_write_b32 a25, v177
v_mfma_f32_16x16x32_bf16 v[148:151], a[232:235], a[184:187], v[148:151]
v_exp_f32 v183, v183
v_mfma_f32_16x16x32_bf16 v[156:159], a[228:231], a[172:175], v[156:159]
s_waitcnt vmcnt(16) lgkmcnt(2)
v_exp_f32 v184, v184
v_mfma_f32_16x16x32_bf16 v[156:159], a[232:235], a[188:191], v[156:159]
L_pg5:
s_cbranch_execz L_pg9
v_exp_f32 v185, v185
v_mfma_f32_16x16x32_bf16 v[128:131], a[236:239], a[192:195], v[128:131]
s_barrier
v_cvt_pk_bf16_f32 v178, v180, v181
v_accvgpr_write_b32 a26, v178
v_mfma_f32_16x16x32_bf16 v[128:131], a[240:243], a[208:211], v[128:131]
ds_read_b128 a[252:255], v228 offset:24576
v_cvt_pk_bf16_f32 v179, v182, v183
v_mfma_f32_16x16x32_bf16 v[136:139], a[236:239], a[196:199], v[136:139]
s_add_u32 m0, s28, 102400
v_exp_f32 v186, v186
v_mfma_f32_16x16x32_bf16 v[136:139], a[240:243], a[212:215], v[136:139]
v_exp_f32 v187, v187
v_mfma_f32_16x16x32_bf16 v[144:147], a[236:239], a[200:203], v[144:147]
s_mov_b32 s30, 135168
v_accvgpr_write_b32 a27, v179
v_cvt_pk_bf16_f32 v184, v184, v185
v_mfma_f32_16x16x32_bf16 v[144:147], a[240:243], a[216:219], v[144:147]
ds_read_b128 a[224:227], v229 offset:24576
v_accvgpr_write_b32 a28, v184
v_mfma_f32_16x16x32_bf16 v[152:155], a[236:239], a[204:207], v[152:155]
s_waitcnt lgkmcnt(2)
v_exp_f32 v188, v188
v_mfma_f32_16x16x32_bf16 v[152:155], a[240:243], a[220:223], v[152:155]
buffer_load_dwordx4 v234, s[12:15], s30 offen offset:0 nt lds
v_cvt_pk_bf16_f32 v185, v186, v187
v_mfma_f32_16x16x32_bf16 v[132:135], a[244:247], a[192:195], v[132:135]
ds_read_b128 a[228:231], v228 offset:30720
v_accvgpr_write_b32 a29, v185
v_mfma_f32_16x16x32_bf16 v[132:135], a[248:251], a[208:211], v[132:135]
v_exp_f32 v189, v189
v_mfma_f32_16x16x32_bf16 v[140:143], a[244:247], a[196:199], v[140:143]
buffer_load_dwordx4 v235, s[12:15], s30 offen offset:1024 nt lds
v_cvt_pk_bf16_f32 v186, v188, v189
v_mfma_f32_16x16x32_bf16 v[140:143], a[248:251], a[212:215], v[140:143]
v_exp_f32 v190, v190
v_mfma_f32_16x16x32_bf16 v[148:151], a[244:247], a[200:203], v[148:151]
ds_read_b128 a[232:235], v229 offset:30720
v_accvgpr_write_b32 a30, v186
v_mfma_f32_16x16x32_bf16 v[148:151], a[248:251], a[216:219], v[148:151]
v_exp_f32 v191, v191
v_mfma_f32_16x16x32_bf16 v[156:159], a[244:247], a[204:207], v[156:159]
s_waitcnt lgkmcnt(2)
v_cvt_pk_bf16_f32 v187, v190, v191
v_accvgpr_write_b32 a31, v187
v_mfma_f32_16x16x32_bf16 v[156:159], a[248:251], a[220:223], v[156:159]
buffer_load_dwordx4 v236, s[12:15], s30 offen offset:2048 nt lds
v_mfma_f32_16x16x32_bf16 v[160:163], a[252:255], a[128:131], v[192:195]
buffer_load_dword v244, v255, s[16:19], s91 offen offset:3200
v_mfma_f32_16x16x32_bf16 v[160:163], a[224:227], a[144:147], v[160:163]
v_exp_f32 v128, v128
v_mfma_f32_16x16x32_bf16 v[168:171], a[252:255], a[132:135], v[196:199]
v_exp_f32 v129, v129
v_mfma_f32_16x16x32_bf16 v[168:171], a[224:227], a[148:151], v[168:171]
v_exp_f32 v130, v130
v_mfma_f32_16x16x32_bf16 v[176:179], a[252:255], a[136:139], v[200:203]
ds_read_b128 a[240:243], v228 offset:24704
v_cvt_pk_bf16_f32 v32, v128, v129
v_mfma_f32_16x16x32_bf16 v[176:179], a[224:227], a[152:155], v[176:179]
v_exp_f32 v131, v131
v_mfma_f32_16x16x32_bf16 v[184:187], a[252:255], a[140:143], v[204:207]
s_waitcnt lgkmcnt(1)
v_exp_f32 v132, v132
v_mfma_f32_16x16x32_bf16 v[184:187], a[224:227], a[156:159], v[184:187]
v_exp_f32 v133, v133
v_mfma_f32_16x16x32_bf16 v[164:167], a[228:231], a[128:131], v[192:195]
ds_read_b128 a[244:247], v229 offset:24704
v_cvt_pk_bf16_f32 v33, v130, v131
v_mfma_f32_16x16x32_bf16 v[164:167], a[232:235], a[144:147], v[164:167]
v_exp_f32 v134, v134
v_mfma_f32_16x16x32_bf16 v[172:175], a[228:231], a[132:135], v[196:199]
v_exp_f32 v135, v135
v_mfma_f32_16x16x32_bf16 v[172:175], a[232:235], a[148:151], v[172:175]
v_exp_f32 v136, v136
v_mfma_f32_16x16x32_bf16 v[180:183], a[228:231], a[136:139], v[200:203]
ds_read_b128 a[248:251], v228 offset:30848
v_cvt_pk_bf16_f32 v34, v132, v133
v_mfma_f32_16x16x32_bf16 v[180:183], a[232:235], a[152:155], v[180:183]
v_exp_f32 v137, v137
v_mfma_f32_16x16x32_bf16 v[188:191], a[228:231], a[140:143], v[204:207]
v_exp_f32 v138, v138
v_mfma_f32_16x16x32_bf16 v[188:191], a[232:235], a[156:159], v[188:191]
v_exp_f32 v139, v139
v_mfma_f32_16x16x32_bf16 v[208:211], v[224:227], v[24:27], v[208:211]
ds_read_b128 a[252:255], v229 offset:30848
v_cvt_pk_bf16_f32 v35, v134, v135
v_mfma_f32_16x16x32_bf16 v[212:215], v[224:227], v[28:31], v[212:215]
v_exp_f32 v140, v140
v_mfma_f32_16x16x32_bf16 v[216:219], v[224:227], a[24:27], v[216:219]
s_waitcnt lgkmcnt(2)
v_exp_f32 v141, v141
v_mfma_f32_16x16x32_bf16 v[240:243], v[224:227], a[28:31], v[240:243]
v_exp_f32 v142, v142
v_mfma_f32_16x16x32_bf16 v[160:163], a[240:243], a[160:163], v[160:163]
ds_read_b128 a[224:227], v228 offset:24832
v_cvt_pk_bf16_f32 v36, v136, v137
v_mfma_f32_16x16x32_bf16 v[160:163], a[244:247], a[176:179], v[160:163]
v_exp_f32 v143, v143
v_mfma_f32_16x16x32_bf16 v[168:171], a[240:243], a[164:167], v[168:171]
v_exp_f32 v144, v144
v_mfma_f32_16x16x32_bf16 v[168:171], a[244:247], a[180:183], v[168:171]
v_exp_f32 v145, v145
v_mfma_f32_16x16x32_bf16 v[176:179], a[240:243], a[168:171], v[176:179]
ds_read_b128 a[228:231], v229 offset:24832
v_cvt_pk_bf16_f32 v37, v138, v139
v_mfma_f32_16x16x32_bf16 v[176:179], a[244:247], a[184:187], v[176:179]
v_exp_f32 v146, v146
v_mfma_f32_16x16x32_bf16 v[184:187], a[240:243], a[172:175], v[184:187]
s_waitcnt lgkmcnt(2)
v_exp_f32 v147, v147
v_mfma_f32_16x16x32_bf16 v[184:187], a[244:247], a[188:191], v[184:187]
v_cvt_pk_bf16_f32 v38, v140, v141
v_cvt_pk_bf16_f32 v39, v142, v143
v_mfma_f32_16x16x32_bf16 v[164:167], a[248:251], a[160:163], v[164:167]
ds_read_b128 a[232:235], v228 offset:30976
v_cvt_pk_bf16_f32 v144, v144, v145
v_mfma_f32_16x16x32_bf16 v[164:167], a[252:255], a[176:179], v[164:167]
v_exp_f32 v148, v148
v_mfma_f32_16x16x32_bf16 v[172:175], a[248:251], a[164:167], v[172:175]
v_exp_f32 v149, v149
v_mfma_f32_16x16x32_bf16 v[172:175], a[252:255], a[180:183], v[172:175]
v_accvgpr_write_b32 a32, v144
v_cvt_pk_bf16_f32 v145, v146, v147
v_mfma_f32_16x16x32_bf16 v[180:183], a[248:251], a[168:171], v[180:183]
ds_read_b128 a[236:239], v229 offset:30976
v_accvgpr_write_b32 a33, v145
v_mfma_f32_16x16x32_bf16 v[180:183], a[252:255], a[184:187], v[180:183]
v_exp_f32 v150, v150
v_mfma_f32_16x16x32_bf16 v[188:191], a[248:251], a[172:175], v[188:191]
s_waitcnt vmcnt(17) lgkmcnt(2)
v_exp_f32 v151, v151
v_mfma_f32_16x16x32_bf16 v[188:191], a[252:255], a[188:191], v[188:191]
v_exp_f32 v152, v152
v_mfma_f32_16x16x32_bf16 v[160:163], a[224:227], a[192:195], v[160:163]
s_barrier
v_exp_f32 v153, v153
v_mfma_f32_16x16x32_bf16 v[160:163], a[228:231], a[208:211], v[160:163]
ds_read_b128 a[240:243], v228 offset:36864
v_cvt_pk_bf16_f32 v146, v148, v149
v_mfma_f32_16x16x32_bf16 v[168:171], a[224:227], a[196:199], v[168:171]
s_add_u32 m0, s28, 114688
v_accvgpr_write_b32 a34, v146
v_cvt_pk_bf16_f32 v147, v150, v151
v_mfma_f32_16x16x32_bf16 v[168:171], a[228:231], a[212:215], v[168:171]
v_exp_f32 v154, v154
v_mfma_f32_16x16x32_bf16 v[176:179], a[224:227], a[200:203], v[176:179]
s_mov_b32 s30, 147456
v_exp_f32 v155, v155
v_mfma_f32_16x16x32_bf16 v[176:179], a[228:231], a[216:219], v[176:179]
ds_read_b128 a[244:247], v229 offset:36864
v_accvgpr_write_b32 a35, v147
v_mfma_f32_16x16x32_bf16 v[184:187], a[224:227], a[204:207], v[184:187]
s_waitcnt lgkmcnt(2)
v_exp_f32 v156, v156
v_mfma_f32_16x16x32_bf16 v[184:187], a[228:231], a[220:223], v[184:187]
buffer_load_dwordx4 v234, s[12:15], s30 offen offset:0 nt lds
v_cvt_pk_bf16_f32 v152, v152, v153
v_mfma_f32_16x16x32_bf16 v[164:167], a[232:235], a[192:195], v[164:167]
ds_read_b128 a[248:251], v228 offset:43008
v_accvgpr_write_b32 a36, v152
v_mfma_f32_16x16x32_bf16 v[164:167], a[236:239], a[208:211], v[164:167]
v_exp_f32 v157, v157
v_mfma_f32_16x16x32_bf16 v[172:175], a[232:235], a[196:199], v[172:175]
buffer_load_dwordx4 v235, s[12:15], s30 offen offset:1024 nt lds
v_cvt_pk_bf16_f32 v153, v154, v155
v_mfma_f32_16x16x32_bf16 v[172:175], a[236:239], a[212:215], v[172:175]
v_exp_f32 v158, v158
v_mfma_f32_16x16x32_bf16 v[180:183], a[232:235], a[200:203], v[180:183]
ds_read_b128 a[252:255], v229 offset:43008
v_accvgpr_write_b32 a37, v153
v_mfma_f32_16x16x32_bf16 v[180:183], a[236:239], a[216:219], v[180:183]
v_exp_f32 v159, v159
v_mfma_f32_16x16x32_bf16 v[188:191], a[232:235], a[204:207], v[188:191]
s_waitcnt lgkmcnt(2)
v_cvt_pk_bf16_f32 v154, v156, v157
v_accvgpr_write_b32 a38, v154
v_mfma_f32_16x16x32_bf16 v[188:191], a[236:239], a[220:223], v[188:191]
buffer_load_dwordx4 v236, s[12:15], s30 offen offset:2048 nt lds
v_cvt_pk_bf16_f32 v155, v158, v159
v_accvgpr_write_b32 a39, v155
v_mfma_f32_16x16x32_bf16 v[128:131], a[240:243], a[128:131], v[192:195]
v_exp_f32 v160, v160
v_mfma_f32_16x16x32_bf16 v[128:131], a[244:247], a[144:147], v[128:131]
v_exp_f32 v161, v161
v_mfma_f32_16x16x32_bf16 v[136:139], a[240:243], a[132:135], v[196:199]
v_exp_f32 v162, v162
v_mfma_f32_16x16x32_bf16 v[136:139], a[244:247], a[148:151], v[136:139]
v_exp_f32 v163, v163
v_mfma_f32_16x16x32_bf16 v[144:147], a[240:243], a[136:139], v[200:203]
ds_read_b128 a[228:231], v228 offset:36992
v_cvt_pk_bf16_f32 v40, v160, v161
v_mfma_f32_16x16x32_bf16 v[144:147], a[244:247], a[152:155], v[144:147]
v_exp_f32 v164, v164
v_mfma_f32_16x16x32_bf16 v[152:155], a[240:243], a[140:143], v[204:207]
s_waitcnt lgkmcnt(1)
v_exp_f32 v165, v165
v_mfma_f32_16x16x32_bf16 v[152:155], a[244:247], a[156:159], v[152:155]
v_exp_f32 v166, v166
v_mfma_f32_16x16x32_bf16 v[132:135], a[248:251], a[128:131], v[192:195]
ds_read_b128 a[232:235], v229 offset:36992
v_cvt_pk_bf16_f32 v41, v162, v163
v_mfma_f32_16x16x32_bf16 v[132:135], a[252:255], a[144:147], v[132:135]
v_exp_f32 v167, v167
v_mfma_f32_16x16x32_bf16 v[140:143], a[248:251], a[132:135], v[196:199]
v_exp_f32 v168, v168
v_mfma_f32_16x16x32_bf16 v[140:143], a[252:255], a[148:151], v[140:143]
v_exp_f32 v169, v169
v_mfma_f32_16x16x32_bf16 v[148:151], a[248:251], a[136:139], v[200:203]
ds_read_b128 a[236:239], v228 offset:43136
v_cvt_pk_bf16_f32 v42, v164, v165
v_mfma_f32_16x16x32_bf16 v[148:151], a[252:255], a[152:155], v[148:151]
v_exp_f32 v170, v170
v_mfma_f32_16x16x32_bf16 v[156:159], a[248:251], a[140:143], v[204:207]
v_exp_f32 v171, v171
v_mfma_f32_16x16x32_bf16 v[156:159], a[252:255], a[156:159], v[156:159]
v_exp_f32 v172, v172
v_mfma_f32_16x16x32_bf16 v[208:211], v[224:227], v[32:35], v[208:211]
ds_read_b128 a[240:243], v229 offset:43136
v_cvt_pk_bf16_f32 v43, v166, v167
v_mfma_f32_16x16x32_bf16 v[212:215], v[224:227], v[36:39], v[212:215]
v_exp_f32 v173, v173
v_mfma_f32_16x16x32_bf16 v[216:219], v[224:227], a[32:35], v[216:219]
s_waitcnt lgkmcnt(2)
v_exp_f32 v174, v174
v_mfma_f32_16x16x32_bf16 v[240:243], v[224:227], a[36:39], v[240:243]
v_exp_f32 v175, v175
v_mfma_f32_16x16x32_bf16 v[128:131], a[228:231], a[160:163], v[128:131]
ds_read_b128 a[244:247], v228 offset:37120
v_cvt_pk_bf16_f32 v44, v168, v169
v_mfma_f32_16x16x32_bf16 v[128:131], a[232:235], a[176:179], v[128:131]
v_exp_f32 v176, v176
v_mfma_f32_16x16x32_bf16 v[136:139], a[228:231], a[164:167], v[136:139]
v_exp_f32 v177, v177
v_mfma_f32_16x16x32_bf16 v[136:139], a[232:235], a[180:183], v[136:139]
v_cvt_pk_bf16_f32 v45, v170, v171
v_cvt_pk_bf16_f32 v46, v172, v173
v_mfma_f32_16x16x32_bf16 v[144:147], a[228:231], a[168:171], v[144:147]
ds_read_b128 a[248:251], v229 offset:37120
v_cvt_pk_bf16_f32 v47, v174, v175
v_mfma_f32_16x16x32_bf16 v[144:147], a[232:235], a[184:187], v[144:147]
v_exp_f32 v178, v178
v_mfma_f32_16x16x32_bf16 v[152:155], a[228:231], a[172:175], v[152:155]
s_waitcnt lgkmcnt(2)
v_exp_f32 v179, v179
v_mfma_f32_16x16x32_bf16 v[152:155], a[232:235], a[188:191], v[152:155]
v_exp_f32 v180, v180
v_mfma_f32_16x16x32_bf16 v[132:135], a[236:239], a[160:163], v[132:135]
ds_read_b128 a[252:255], v228 offset:43264
v_cvt_pk_bf16_f32 v176, v176, v177
v_mfma_f32_16x16x32_bf16 v[132:135], a[240:243], a[176:179], v[132:135]
v_exp_f32 v181, v181
v_mfma_f32_16x16x32_bf16 v[140:143], a[236:239], a[164:167], v[140:143]
v_accvgpr_write_b32 a40, v176
v_cvt_pk_bf16_f32 v177, v178, v179
v_mfma_f32_16x16x32_bf16 v[140:143], a[240:243], a[180:183], v[140:143]
v_exp_f32 v182, v182
v_mfma_f32_16x16x32_bf16 v[148:151], a[236:239], a[168:171], v[148:151]
ds_read_b128 a[224:227], v229 offset:43264
v_accvgpr_write_b32 a41, v177
v_mfma_f32_16x16x32_bf16 v[148:151], a[240:243], a[184:187], v[148:151]
v_exp_f32 v183, v183
v_mfma_f32_16x16x32_bf16 v[156:159], a[236:239], a[172:175], v[156:159]
s_waitcnt vmcnt(17) lgkmcnt(2)
v_exp_f32 v184, v184
v_mfma_f32_16x16x32_bf16 v[156:159], a[240:243], a[188:191], v[156:159]
v_exp_f32 v185, v185
v_mfma_f32_16x16x32_bf16 v[128:131], a[244:247], a[192:195], v[128:131]
s_barrier
v_cvt_pk_bf16_f32 v178, v180, v181
v_accvgpr_write_b32 a42, v178
v_mfma_f32_16x16x32_bf16 v[128:131], a[248:251], a[208:211], v[128:131]
ds_read_b128 a[228:231], v228 offset:49152
v_cvt_pk_bf16_f32 v179, v182, v183
v_mfma_f32_16x16x32_bf16 v[136:139], a[244:247], a[196:199], v[136:139]
s_add_u32 m0, s28, 126976
v_exp_f32 v186, v186
v_mfma_f32_16x16x32_bf16 v[136:139], a[248:251], a[212:215], v[136:139]
v_exp_f32 v187, v187
v_mfma_f32_16x16x32_bf16 v[144:147], a[244:247], a[200:203], v[144:147]
s_mov_b32 s30, 159744
v_accvgpr_write_b32 a43, v179
v_cvt_pk_bf16_f32 v184, v184, v185
v_mfma_f32_16x16x32_bf16 v[144:147], a[248:251], a[216:219], v[144:147]
ds_read_b128 a[232:235], v229 offset:49152
v_accvgpr_write_b32 a44, v184
v_mfma_f32_16x16x32_bf16 v[152:155], a[244:247], a[204:207], v[152:155]
s_waitcnt lgkmcnt(2)
v_exp_f32 v188, v188
v_mfma_f32_16x16x32_bf16 v[152:155], a[248:251], a[220:223], v[152:155]
buffer_load_dwordx4 v234, s[12:15], s30 offen offset:0 nt lds
v_cvt_pk_bf16_f32 v185, v186, v187
v_mfma_f32_16x16x32_bf16 v[132:135], a[252:255], a[192:195], v[132:135]
ds_read_b128 a[236:239], v228 offset:55296
v_accvgpr_write_b32 a45, v185
v_mfma_f32_16x16x32_bf16 v[132:135], a[224:227], a[208:211], v[132:135]
v_exp_f32 v189, v189
v_mfma_f32_16x16x32_bf16 v[140:143], a[252:255], a[196:199], v[140:143]
buffer_load_dwordx4 v235, s[12:15], s30 offen offset:1024 nt lds
v_cvt_pk_bf16_f32 v186, v188, v189
v_mfma_f32_16x16x32_bf16 v[140:143], a[224:227], a[212:215], v[140:143]
v_exp_f32 v190, v190
v_mfma_f32_16x16x32_bf16 v[148:151], a[252:255], a[200:203], v[148:151]
ds_read_b128 a[240:243], v229 offset:55296
v_accvgpr_write_b32 a46, v186
v_mfma_f32_16x16x32_bf16 v[148:151], a[224:227], a[216:219], v[148:151]
v_exp_f32 v191, v191
v_mfma_f32_16x16x32_bf16 v[156:159], a[252:255], a[204:207], v[156:159]
s_waitcnt lgkmcnt(2)
v_cvt_pk_bf16_f32 v187, v190, v191
v_accvgpr_write_b32 a47, v187
v_mfma_f32_16x16x32_bf16 v[156:159], a[224:227], a[220:223], v[156:159]
buffer_load_dwordx4 v236, s[12:15], s30 offen offset:2048 nt lds
v_mfma_f32_16x16x32_bf16 v[160:163], a[228:231], a[128:131], v[192:195]
v_exp_f32 v128, v128
v_mfma_f32_16x16x32_bf16 v[160:163], a[232:235], a[144:147], v[160:163]
v_exp_f32 v129, v129
v_mfma_f32_16x16x32_bf16 v[168:171], a[228:231], a[132:135], v[196:199]
v_exp_f32 v130, v130
v_mfma_f32_16x16x32_bf16 v[168:171], a[232:235], a[148:151], v[168:171]
v_exp_f32 v131, v131
v_mfma_f32_16x16x32_bf16 v[176:179], a[228:231], a[136:139], v[200:203]
ds_read_b128 a[248:251], v228 offset:49280
v_cvt_pk_bf16_f32 v48, v128, v129
v_mfma_f32_16x16x32_bf16 v[176:179], a[232:235], a[152:155], v[176:179]
v_exp_f32 v132, v132
v_mfma_f32_16x16x32_bf16 v[184:187], a[228:231], a[140:143], v[204:207]
s_waitcnt lgkmcnt(1)
v_exp_f32 v133, v133
v_mfma_f32_16x16x32_bf16 v[184:187], a[232:235], a[156:159], v[184:187]
v_exp_f32 v134, v134
v_mfma_f32_16x16x32_bf16 v[164:167], a[236:239], a[128:131], v[192:195]
ds_read_b128 a[252:255], v229 offset:49280
v_cvt_pk_bf16_f32 v49, v130, v131
v_mfma_f32_16x16x32_bf16 v[164:167], a[240:243], a[144:147], v[164:167]
v_exp_f32 v135, v135
v_mfma_f32_16x16x32_bf16 v[172:175], a[236:239], a[132:135], v[196:199]
v_exp_f32 v136, v136
v_mfma_f32_16x16x32_bf16 v[172:175], a[240:243], a[148:151], v[172:175]
v_exp_f32 v137, v137
v_mfma_f32_16x16x32_bf16 v[180:183], a[236:239], a[136:139], v[200:203]
ds_read_b128 a[224:227], v228 offset:55424
v_cvt_pk_bf16_f32 v50, v132, v133
v_mfma_f32_16x16x32_bf16 v[180:183], a[240:243], a[152:155], v[180:183]
v_exp_f32 v138, v138
v_mfma_f32_16x16x32_bf16 v[188:191], a[236:239], a[140:143], v[204:207]
v_exp_f32 v139, v139
v_mfma_f32_16x16x32_bf16 v[188:191], a[240:243], a[156:159], v[188:191]
v_exp_f32 v140, v140
v_mfma_f32_16x16x32_bf16 v[208:211], v[224:227], v[40:43], v[208:211]
ds_read_b128 a[228:231], v229 offset:55424
v_cvt_pk_bf16_f32 v51, v134, v135
v_mfma_f32_16x16x32_bf16 v[212:215], v[224:227], v[44:47], v[212:215]
v_exp_f32 v141, v141
v_mfma_f32_16x16x32_bf16 v[216:219], v[224:227], a[40:43], v[216:219]
s_waitcnt lgkmcnt(2)
v_exp_f32 v142, v142
v_mfma_f32_16x16x32_bf16 v[240:243], v[224:227], a[44:47], v[240:243]
v_exp_f32 v143, v143
v_mfma_f32_16x16x32_bf16 v[160:163], a[248:251], a[160:163], v[160:163]
ds_read_b128 a[232:235], v228 offset:49408
v_cvt_pk_bf16_f32 v52, v136, v137
v_mfma_f32_16x16x32_bf16 v[160:163], a[252:255], a[176:179], v[160:163]
v_exp_f32 v144, v144
v_mfma_f32_16x16x32_bf16 v[168:171], a[248:251], a[164:167], v[168:171]
buffer_load_dword v244, v254, s[76:79], s92 offen
v_cvt_pk_bf16_f32 v53, v138, v139
v_mfma_f32_16x16x32_bf16 v[168:171], a[252:255], a[180:183], v[168:171]
v_exp_f32 v145, v145
v_mfma_f32_16x16x32_bf16 v[176:179], a[248:251], a[168:171], v[176:179]
s_add_u32 s92, s92, 1920
v_exp_f32 v146, v146
v_mfma_f32_16x16x32_bf16 v[176:179], a[252:255], a[184:187], v[176:179]
ds_read_b128 a[236:239], v229 offset:49408
v_cvt_pk_bf16_f32 v54, v140, v141
v_mfma_f32_16x16x32_bf16 v[184:187], a[248:251], a[172:175], v[184:187]
s_waitcnt lgkmcnt(2)
v_exp_f32 v147, v147
v_mfma_f32_16x16x32_bf16 v[184:187], a[252:255], a[188:191], v[184:187]
v_cvt_pk_bf16_f32 v55, v142, v143
v_cvt_pk_bf16_f32 v144, v144, v145
v_mfma_f32_16x16x32_bf16 v[164:167], a[224:227], a[160:163], v[164:167]
ds_read_b128 a[240:243], v228 offset:55552
v_accvgpr_write_b32 a48, v144
v_mfma_f32_16x16x32_bf16 v[164:167], a[228:231], a[176:179], v[164:167]
v_exp_f32 v148, v148
v_mfma_f32_16x16x32_bf16 v[172:175], a[224:227], a[164:167], v[172:175]
v_exp_f32 v149, v149
v_mfma_f32_16x16x32_bf16 v[172:175], a[228:231], a[180:183], v[172:175]
v_exp_f32 v150, v150
v_mfma_f32_16x16x32_bf16 v[180:183], a[224:227], a[168:171], v[180:183]
ds_read_b128 a[244:247], v229 offset:55552
v_cvt_pk_bf16_f32 v145, v146, v147
v_mfma_f32_16x16x32_bf16 v[180:183], a[228:231], a[184:187], v[180:183]
v_exp_f32 v151, v151
v_mfma_f32_16x16x32_bf16 v[188:191], a[224:227], a[172:175], v[188:191]
s_waitcnt vmcnt(18) lgkmcnt(2)
v_accvgpr_write_b32 a49, v145
v_cvt_pk_bf16_f32 v146, v148, v149
v_mfma_f32_16x16x32_bf16 v[188:191], a[228:231], a[188:191], v[188:191]
v_add_u32 v228, 4294930432, v228
v_add_u32 v229, 4294930432, v229
v_mfma_f32_16x16x32_bf16 v[160:163], a[232:235], a[192:195], v[160:163]
s_barrier
v_exp_f32 v152, v152
v_mfma_f32_16x16x32_bf16 v[160:163], a[236:239], a[208:211], v[160:163]
ds_read_b128 a[248:251], v228 offset:0
v_accvgpr_write_b32 a50, v146
v_mfma_f32_16x16x32_bf16 v[168:171], a[232:235], a[196:199], v[168:171]
s_add_u32 m0, s28, 139264
v_exp_f32 v153, v153
v_mfma_f32_16x16x32_bf16 v[168:171], a[236:239], a[212:215], v[168:171]
v_exp_f32 v154, v154
v_mfma_f32_16x16x32_bf16 v[176:179], a[232:235], a[200:203], v[176:179]
s_mov_b32 s30, 172032
v_exp_f32 v155, v155
v_mfma_f32_16x16x32_bf16 v[176:179], a[236:239], a[216:219], v[176:179]
ds_read_b128 a[252:255], v229 offset:0
v_cvt_pk_bf16_f32 v147, v150, v151
v_mfma_f32_16x16x32_bf16 v[184:187], a[232:235], a[204:207], v[184:187]
s_waitcnt lgkmcnt(2)
v_accvgpr_write_b32 a51, v147
v_cvt_pk_bf16_f32 v152, v152, v153
v_mfma_f32_16x16x32_bf16 v[184:187], a[236:239], a[220:223], v[184:187]
buffer_load_dwordx4 v234, s[12:15], s30 offen offset:0 nt lds
v_accvgpr_write_b32 a52, v152
v_mfma_f32_16x16x32_bf16 v[164:167], a[240:243], a[192:195], v[164:167]
ds_read_b128 a[224:227], v228 offset:6144
v_cvt_pk_bf16_f32 v153, v154, v155
v_mfma_f32_16x16x32_bf16 v[164:167], a[244:247], a[208:211], v[164:167]
v_exp_f32 v156, v156
v_mfma_f32_16x16x32_bf16 v[172:175], a[240:243], a[196:199], v[172:175]
buffer_load_dwordx4 v235, s[12:15], s30 offen offset:1024 nt lds
v_accvgpr_write_b32 a53, v153
v_mfma_f32_16x16x32_bf16 v[172:175], a[244:247], a[212:215], v[172:175]
v_exp_f32 v157, v157
v_mfma_f32_16x16x32_bf16 v[180:183], a[240:243], a[200:203], v[180:183]
ds_read_b128 a[228:231], v229 offset:6144
v_cvt_pk_bf16_f32 v154, v156, v157
v_mfma_f32_16x16x32_bf16 v[180:183], a[244:247], a[216:219], v[180:183]
v_exp_f32 v158, v158
v_mfma_f32_16x16x32_bf16 v[188:191], a[240:243], a[204:207], v[188:191]
s_waitcnt lgkmcnt(2)
v_exp_f32 v159, v159
v_mfma_f32_16x16x32_bf16 v[188:191], a[244:247], a[220:223], v[188:191]
buffer_load_dwordx4 v236, s[12:15], s30 offen offset:2048 nt lds
v_accvgpr_write_b32 a54, v154
v_cvt_pk_bf16_f32 v155, v158, v159
v_accvgpr_write_b32 a55, v155
v_mfma_f32_16x16x32_bf16 v[128:131], a[248:251], a[128:131], v[192:195]
v_exp_f32 v160, v160
v_mfma_f32_16x16x32_bf16 v[128:131], a[252:255], a[144:147], v[128:131]
v_exp_f32 v161, v161
v_mfma_f32_16x16x32_bf16 v[136:139], a[248:251], a[132:135], v[196:199]
v_exp_f32 v162, v162
v_mfma_f32_16x16x32_bf16 v[136:139], a[252:255], a[148:151], v[136:139]
v_exp_f32 v163, v163
v_mfma_f32_16x16x32_bf16 v[144:147], a[248:251], a[136:139], v[200:203]
ds_read_b128 a[236:239], v228 offset:128
v_cvt_pk_bf16_f32 v56, v160, v161
v_mfma_f32_16x16x32_bf16 v[144:147], a[252:255], a[152:155], v[144:147]
v_exp_f32 v164, v164
v_mfma_f32_16x16x32_bf16 v[152:155], a[248:251], a[140:143], v[204:207]
s_waitcnt lgkmcnt(1)
v_exp_f32 v165, v165
v_mfma_f32_16x16x32_bf16 v[152:155], a[252:255], a[156:159], v[152:155]
v_exp_f32 v166, v166
v_mfma_f32_16x16x32_bf16 v[132:135], a[224:227], a[128:131], v[192:195]
ds_read_b128 a[240:243], v229 offset:128
v_cvt_pk_bf16_f32 v57, v162, v163
v_mfma_f32_16x16x32_bf16 v[132:135], a[228:231], a[144:147], v[132:135]
v_exp_f32 v167, v167
v_mfma_f32_16x16x32_bf16 v[140:143], a[224:227], a[132:135], v[196:199]
v_exp_f32 v168, v168
v_mfma_f32_16x16x32_bf16 v[140:143], a[228:231], a[148:151], v[140:143]
v_exp_f32 v169, v169
v_mfma_f32_16x16x32_bf16 v[148:151], a[224:227], a[136:139], v[200:203]
ds_read_b128 a[244:247], v228 offset:6272
v_cvt_pk_bf16_f32 v58, v164, v165
v_mfma_f32_16x16x32_bf16 v[148:151], a[228:231], a[152:155], v[148:151]
v_exp_f32 v170, v170
v_mfma_f32_16x16x32_bf16 v[156:159], a[224:227], a[140:143], v[204:207]
v_exp_f32 v171, v171
v_mfma_f32_16x16x32_bf16 v[156:159], a[228:231], a[156:159], v[156:159]
v_exp_f32 v172, v172
v_mfma_f32_16x16x32_bf16 v[208:211], v[224:227], v[48:51], v[208:211]
ds_read_b128 a[248:251], v229 offset:6272
v_cvt_pk_bf16_f32 v59, v166, v167
v_mfma_f32_16x16x32_bf16 v[212:215], v[224:227], v[52:55], v[212:215]
v_exp_f32 v173, v173
v_mfma_f32_16x16x32_bf16 v[216:219], v[224:227], a[48:51], v[216:219]
s_waitcnt lgkmcnt(2)
v_exp_f32 v174, v174
v_mfma_f32_16x16x32_bf16 v[240:243], v[224:227], a[52:55], v[240:243]
v_exp_f32 v175, v175
v_mfma_f32_16x16x32_bf16 v[128:131], a[236:239], a[160:163], v[128:131]
ds_read_b128 a[252:255], v228 offset:256
v_cvt_pk_bf16_f32 v60, v168, v169
v_mfma_f32_16x16x32_bf16 v[128:131], a[240:243], a[176:179], v[128:131]
v_exp_f32 v176, v176
v_mfma_f32_16x16x32_bf16 v[136:139], a[236:239], a[164:167], v[136:139]
v_exp_f32 v177, v177
v_mfma_f32_16x16x32_bf16 v[136:139], a[240:243], a[180:183], v[136:139]
v_cvt_pk_bf16_f32 v61, v170, v171
v_cvt_pk_bf16_f32 v62, v172, v173
v_mfma_f32_16x16x32_bf16 v[144:147], a[236:239], a[168:171], v[144:147]
ds_read_b128 a[224:227], v229 offset:256
v_cvt_pk_bf16_f32 v63, v174, v175
v_mfma_f32_16x16x32_bf16 v[144:147], a[240:243], a[184:187], v[144:147]
v_exp_f32 v178, v178
v_mfma_f32_16x16x32_bf16 v[152:155], a[236:239], a[172:175], v[152:155]
s_waitcnt lgkmcnt(2)
v_exp_f32 v179, v179
v_mfma_f32_16x16x32_bf16 v[152:155], a[240:243], a[188:191], v[152:155]
v_exp_f32 v180, v180
v_mfma_f32_16x16x32_bf16 v[132:135], a[244:247], a[160:163], v[132:135]
ds_read_b128 a[228:231], v228 offset:6400
v_cvt_pk_bf16_f32 v176, v176, v177
v_mfma_f32_16x16x32_bf16 v[132:135], a[248:251], a[176:179], v[132:135]
v_exp_f32 v181, v181
v_mfma_f32_16x16x32_bf16 v[140:143], a[244:247], a[164:167], v[140:143]
v_accvgpr_write_b32 a56, v176
v_cvt_pk_bf16_f32 v177, v178, v179
v_mfma_f32_16x16x32_bf16 v[140:143], a[248:251], a[180:183], v[140:143]
v_exp_f32 v182, v182
v_mfma_f32_16x16x32_bf16 v[148:151], a[244:247], a[168:171], v[148:151]
ds_read_b128 a[232:235], v229 offset:6400
v_accvgpr_write_b32 a57, v177
v_mfma_f32_16x16x32_bf16 v[148:151], a[248:251], a[184:187], v[148:151]
v_exp_f32 v183, v183
v_mfma_f32_16x16x32_bf16 v[156:159], a[244:247], a[172:175], v[156:159]
s_waitcnt vmcnt(17) lgkmcnt(2)
v_exp_f32 v184, v184
v_mfma_f32_16x16x32_bf16 v[156:159], a[248:251], a[188:191], v[156:159]
v_exp_f32 v185, v185
v_mfma_f32_16x16x32_bf16 v[128:131], a[252:255], a[192:195], v[128:131]
s_barrier
v_cvt_pk_bf16_f32 v178, v180, v181
v_accvgpr_write_b32 a58, v178
v_mfma_f32_16x16x32_bf16 v[128:131], a[224:227], a[208:211], v[128:131]
ds_read_b128 a[236:239], v228 offset:12288
v_cvt_pk_bf16_f32 v179, v182, v183
v_mfma_f32_16x16x32_bf16 v[136:139], a[252:255], a[196:199], v[136:139]
s_add_u32 m0, s28, 151552
v_exp_f32 v186, v186
v_mfma_f32_16x16x32_bf16 v[136:139], a[224:227], a[212:215], v[136:139]
v_exp_f32 v187, v187
v_mfma_f32_16x16x32_bf16 v[144:147], a[252:255], a[200:203], v[144:147]
s_mov_b32 s30, 184320
v_accvgpr_write_b32 a59, v179
v_cvt_pk_bf16_f32 v184, v184, v185
v_mfma_f32_16x16x32_bf16 v[144:147], a[224:227], a[216:219], v[144:147]
ds_read_b128 a[240:243], v229 offset:12288
v_accvgpr_write_b32 a60, v184
v_mfma_f32_16x16x32_bf16 v[152:155], a[252:255], a[204:207], v[152:155]
s_waitcnt lgkmcnt(2)
v_exp_f32 v188, v188
v_mfma_f32_16x16x32_bf16 v[152:155], a[224:227], a[220:223], v[152:155]
buffer_load_dwordx4 v234, s[12:15], s30 offen offset:0 nt lds
v_cvt_pk_bf16_f32 v185, v186, v187
v_mfma_f32_16x16x32_bf16 v[132:135], a[228:231], a[192:195], v[132:135]
ds_read_b128 a[244:247], v228 offset:18432
v_accvgpr_write_b32 a61, v185
v_mfma_f32_16x16x32_bf16 v[132:135], a[232:235], a[208:211], v[132:135]
v_exp_f32 v189, v189
v_mfma_f32_16x16x32_bf16 v[140:143], a[228:231], a[196:199], v[140:143]
buffer_load_dwordx4 v235, s[12:15], s30 offen offset:1024 nt lds
v_cvt_pk_bf16_f32 v186, v188, v189
v_mfma_f32_16x16x32_bf16 v[140:143], a[232:235], a[212:215], v[140:143]
v_exp_f32 v190, v190
v_mfma_f32_16x16x32_bf16 v[148:151], a[228:231], a[200:203], v[148:151]
ds_read_b128 a[248:251], v229 offset:18432
v_accvgpr_write_b32 a62, v186
v_mfma_f32_16x16x32_bf16 v[148:151], a[232:235], a[216:219], v[148:151]
v_exp_f32 v191, v191
v_mfma_f32_16x16x32_bf16 v[156:159], a[228:231], a[204:207], v[156:159]
s_waitcnt lgkmcnt(2)
v_cvt_pk_bf16_f32 v187, v190, v191
v_accvgpr_write_b32 a63, v187
v_mfma_f32_16x16x32_bf16 v[156:159], a[232:235], a[220:223], v[156:159]
buffer_load_dwordx4 v236, s[12:15], s30 offen offset:2048 nt lds
v_mfma_f32_16x16x32_bf16 v[160:163], a[236:239], a[128:131], v[192:195]
v_exp_f32 v128, v128
v_mfma_f32_16x16x32_bf16 v[160:163], a[240:243], a[144:147], v[160:163]
v_exp_f32 v129, v129
v_mfma_f32_16x16x32_bf16 v[168:171], a[236:239], a[132:135], v[196:199]
v_exp_f32 v130, v130
v_mfma_f32_16x16x32_bf16 v[168:171], a[240:243], a[148:151], v[168:171]
v_exp_f32 v131, v131
v_mfma_f32_16x16x32_bf16 v[176:179], a[236:239], a[136:139], v[200:203]
ds_read_b128 a[224:227], v228 offset:12416
v_cvt_pk_bf16_f32 v64, v128, v129
v_mfma_f32_16x16x32_bf16 v[176:179], a[240:243], a[152:155], v[176:179]
v_exp_f32 v132, v132
v_mfma_f32_16x16x32_bf16 v[184:187], a[236:239], a[140:143], v[204:207]
s_waitcnt lgkmcnt(1)
v_exp_f32 v133, v133
v_mfma_f32_16x16x32_bf16 v[184:187], a[240:243], a[156:159], v[184:187]
L_pg6:
s_cbranch_execz L_pg10
v_exp_f32 v134, v134
v_mfma_f32_16x16x32_bf16 v[164:167], a[244:247], a[128:131], v[192:195]
ds_read_b128 a[228:231], v229 offset:12416
v_cvt_pk_bf16_f32 v65, v130, v131
v_mfma_f32_16x16x32_bf16 v[164:167], a[248:251], a[144:147], v[164:167]
v_exp_f32 v135, v135
v_mfma_f32_16x16x32_bf16 v[172:175], a[244:247], a[132:135], v[196:199]
v_exp_f32 v136, v136
v_mfma_f32_16x16x32_bf16 v[172:175], a[248:251], a[148:151], v[172:175]
v_exp_f32 v137, v137
v_mfma_f32_16x16x32_bf16 v[180:183], a[244:247], a[136:139], v[200:203]
ds_read_b128 a[232:235], v228 offset:18560
v_cvt_pk_bf16_f32 v66, v132, v133
v_mfma_f32_16x16x32_bf16 v[180:183], a[248:251], a[152:155], v[180:183]
v_exp_f32 v138, v138
v_mfma_f32_16x16x32_bf16 v[188:191], a[244:247], a[140:143], v[204:207]
v_exp_f32 v139, v139
v_mfma_f32_16x16x32_bf16 v[188:191], a[248:251], a[156:159], v[188:191]
v_exp_f32 v140, v140
v_mfma_f32_16x16x32_bf16 v[208:211], v[224:227], v[56:59], v[208:211]
ds_read_b128 a[236:239], v229 offset:18560
v_cvt_pk_bf16_f32 v67, v134, v135
v_mfma_f32_16x16x32_bf16 v[212:215], v[224:227], v[60:63], v[212:215]
v_exp_f32 v141, v141
v_mfma_f32_16x16x32_bf16 v[216:219], v[224:227], a[56:59], v[216:219]
s_waitcnt lgkmcnt(2)
v_exp_f32 v142, v142
v_mfma_f32_16x16x32_bf16 v[240:243], v[224:227], a[60:63], v[240:243]
v_exp_f32 v143, v143
v_mfma_f32_16x16x32_bf16 v[160:163], a[224:227], a[160:163], v[160:163]
ds_read_b128 a[240:243], v228 offset:12544
v_cvt_pk_bf16_f32 v68, v136, v137
v_mfma_f32_16x16x32_bf16 v[160:163], a[228:231], a[176:179], v[160:163]
v_exp_f32 v144, v144
v_mfma_f32_16x16x32_bf16 v[168:171], a[224:227], a[164:167], v[168:171]
buffer_load_dword v244, v254, s[76:79], s92 offen
v_cvt_pk_bf16_f32 v69, v138, v139
v_mfma_f32_16x16x32_bf16 v[168:171], a[228:231], a[180:183], v[168:171]
v_exp_f32 v145, v145
v_mfma_f32_16x16x32_bf16 v[176:179], a[224:227], a[168:171], v[176:179]
s_add_u32 s92, s92, 1920
v_exp_f32 v146, v146
v_mfma_f32_16x16x32_bf16 v[176:179], a[228:231], a[184:187], v[176:179]
ds_read_b128 a[244:247], v229 offset:12544
v_cvt_pk_bf16_f32 v70, v140, v141
v_mfma_f32_16x16x32_bf16 v[184:187], a[224:227], a[172:175], v[184:187]
s_waitcnt lgkmcnt(2)
v_exp_f32 v147, v147
v_mfma_f32_16x16x32_bf16 v[184:187], a[228:231], a[188:191], v[184:187]
v_cvt_pk_bf16_f32 v71, v142, v143
v_cvt_pk_bf16_f32 v144, v144, v145
v_mfma_f32_16x16x32_bf16 v[164:167], a[232:235], a[160:163], v[164:167]
ds_read_b128 a[248:251], v228 offset:18688
v_accvgpr_write_b32 a64, v144
v_mfma_f32_16x16x32_bf16 v[164:167], a[236:239], a[176:179], v[164:167]
v_exp_f32 v148, v148
v_mfma_f32_16x16x32_bf16 v[172:175], a[232:235], a[164:167], v[172:175]
v_exp_f32 v149, v149
v_mfma_f32_16x16x32_bf16 v[172:175], a[236:239], a[180:183], v[172:175]
v_exp_f32 v150, v150
v_mfma_f32_16x16x32_bf16 v[180:183], a[232:235], a[168:171], v[180:183]
ds_read_b128 a[252:255], v229 offset:18688
v_cvt_pk_bf16_f32 v145, v146, v147
v_mfma_f32_16x16x32_bf16 v[180:183], a[236:239], a[184:187], v[180:183]
v_exp_f32 v151, v151
v_mfma_f32_16x16x32_bf16 v[188:191], a[232:235], a[172:175], v[188:191]
s_waitcnt vmcnt(18) lgkmcnt(2)
v_accvgpr_write_b32 a65, v145
v_cvt_pk_bf16_f32 v146, v148, v149
v_mfma_f32_16x16x32_bf16 v[188:191], a[236:239], a[188:191], v[188:191]
v_exp_f32 v152, v152
v_mfma_f32_16x16x32_bf16 v[160:163], a[240:243], a[192:195], v[160:163]
s_barrier
v_exp_f32 v153, v153
v_mfma_f32_16x16x32_bf16 v[160:163], a[244:247], a[208:211], v[160:163]
ds_read_b128 a[224:227], v228 offset:24576
v_accvgpr_write_b32 a66, v146
v_mfma_f32_16x16x32_bf16 v[168:171], a[240:243], a[196:199], v[168:171]
s_add_u32 m0, s29, 65536
v_exp_f32 v154, v154
v_mfma_f32_16x16x32_bf16 v[168:171], a[244:247], a[212:215], v[168:171]
v_exp_f32 v155, v155
v_mfma_f32_16x16x32_bf16 v[176:179], a[240:243], a[200:203], v[176:179]
s_mov_b32 s30, 128
v_cvt_pk_bf16_f32 v147, v150, v151
v_accvgpr_write_b32 a67, v147
v_mfma_f32_16x16x32_bf16 v[176:179], a[244:247], a[216:219], v[176:179]
ds_read_b128 a[228:231], v229 offset:24576
v_cvt_pk_bf16_f32 v152, v152, v153
v_mfma_f32_16x16x32_bf16 v[184:187], a[240:243], a[204:207], v[184:187]
s_waitcnt lgkmcnt(2)
v_exp_f32 v156, v156
v_mfma_f32_16x16x32_bf16 v[184:187], a[244:247], a[220:223], v[184:187]
buffer_load_dwordx4 v237, s[16:19], s30 offen lds
v_accvgpr_write_b32 a68, v152
v_mfma_f32_16x16x32_bf16 v[164:167], a[248:251], a[192:195], v[164:167]
s_add_u32 m0, s29, 69632
v_exp_f32 v157, v157
v_mfma_f32_16x16x32_bf16 v[164:167], a[252:255], a[208:211], v[164:167]
ds_read_b128 a[232:235], v228 offset:30720
v_cvt_pk_bf16_f32 v153, v154, v155
v_mfma_f32_16x16x32_bf16 v[172:175], a[248:251], a[196:199], v[172:175]
s_mov_b32 s30, 12416
v_exp_f32 v158, v158
v_mfma_f32_16x16x32_bf16 v[172:175], a[252:255], a[212:215], v[172:175]
v_exp_f32 v159, v159
v_mfma_f32_16x16x32_bf16 v[180:183], a[248:251], a[200:203], v[180:183]
ds_read_b128 a[236:239], v229 offset:30720
v_accvgpr_write_b32 a69, v153
v_mfma_f32_16x16x32_bf16 v[180:183], a[252:255], a[216:219], v[180:183]
v_cvt_pk_bf16_f32 v154, v156, v157
v_accvgpr_write_b32 a70, v154
v_mfma_f32_16x16x32_bf16 v[188:191], a[248:251], a[204:207], v[188:191]
s_waitcnt lgkmcnt(2)
v_cvt_pk_bf16_f32 v155, v158, v159
v_accvgpr_write_b32 a71, v155
v_mfma_f32_16x16x32_bf16 v[188:191], a[252:255], a[220:223], v[188:191]
buffer_load_dwordx4 v237, s[16:19], s30 offen lds
v_mfma_f32_16x16x32_bf16 v[128:131], a[224:227], a[128:131], v[192:195]
s_add_u32 m0, s29, 73728
v_exp_f32 v160, v160
v_mfma_f32_16x16x32_bf16 v[128:131], a[228:231], a[144:147], v[128:131]
v_exp_f32 v161, v161
v_mfma_f32_16x16x32_bf16 v[136:139], a[224:227], a[132:135], v[196:199]
s_mov_b32 s30, 24704
v_exp_f32 v162, v162
v_mfma_f32_16x16x32_bf16 v[136:139], a[228:231], a[148:151], v[136:139]
v_exp_f32 v163, v163
v_mfma_f32_16x16x32_bf16 v[144:147], a[224:227], a[136:139], v[200:203]
ds_read_b128 a[244:247], v228 offset:24704
v_cvt_pk_bf16_f32 v72, v160, v161
v_mfma_f32_16x16x32_bf16 v[144:147], a[228:231], a[152:155], v[144:147]
v_exp_f32 v164, v164
v_mfma_f32_16x16x32_bf16 v[152:155], a[224:227], a[140:143], v[204:207]
s_waitcnt lgkmcnt(1)
v_exp_f32 v165, v165
v_mfma_f32_16x16x32_bf16 v[152:155], a[228:231], a[156:159], v[152:155]
buffer_load_dwordx4 v237, s[16:19], s30 offen lds
v_cvt_pk_bf16_f32 v73, v162, v163
v_mfma_f32_16x16x32_bf16 v[132:135], a[232:235], a[128:131], v[192:195]
ds_read_b128 a[248:251], v229 offset:24704
v_cvt_pk_bf16_f32 v74, v164, v165
v_mfma_f32_16x16x32_bf16 v[132:135], a[236:239], a[144:147], v[132:135]
v_exp_f32 v166, v166
v_mfma_f32_16x16x32_bf16 v[140:143], a[232:235], a[132:135], v[196:199]
v_exp_f32 v167, v167
v_mfma_f32_16x16x32_bf16 v[140:143], a[236:239], a[148:151], v[140:143]
v_exp_f32 v168, v168
v_mfma_f32_16x16x32_bf16 v[148:151], a[232:235], a[136:139], v[200:203]
ds_read_b128 a[252:255], v228 offset:30848
v_cvt_pk_bf16_f32 v75, v166, v167
v_mfma_f32_16x16x32_bf16 v[148:151], a[236:239], a[152:155], v[148:151]
v_exp_f32 v169, v169
v_mfma_f32_16x16x32_bf16 v[156:159], a[232:235], a[140:143], v[204:207]
v_exp_f32 v170, v170
v_mfma_f32_16x16x32_bf16 v[156:159], a[236:239], a[156:159], v[156:159]
v_exp_f32 v171, v171
v_mfma_f32_16x16x32_bf16 v[208:211], v[224:227], v[64:67], v[208:211]
ds_read_b128 a[224:227], v229 offset:30848
v_cvt_pk_bf16_f32 v76, v168, v169
v_mfma_f32_16x16x32_bf16 v[212:215], v[224:227], v[68:71], v[212:215]
v_exp_f32 v172, v172
v_mfma_f32_16x16x32_bf16 v[216:219], v[224:227], a[64:67], v[216:219]
s_waitcnt lgkmcnt(2)
v_exp_f32 v173, v173
v_mfma_f32_16x16x32_bf16 v[240:243], v[224:227], a[68:71], v[240:243]
v_exp_f32 v174, v174
v_mfma_f32_16x16x32_bf16 v[128:131], a[244:247], a[160:163], v[128:131]
ds_read_b128 a[228:231], v228 offset:24832
v_cvt_pk_bf16_f32 v77, v170, v171
v_mfma_f32_16x16x32_bf16 v[128:131], a[248:251], a[176:179], v[128:131]
v_exp_f32 v175, v175
v_mfma_f32_16x16x32_bf16 v[136:139], a[244:247], a[164:167], v[136:139]
v_exp_f32 v176, v176
v_mfma_f32_16x16x32_bf16 v[136:139], a[248:251], a[180:183], v[136:139]
v_exp_f32 v177, v177
v_mfma_f32_16x16x32_bf16 v[144:147], a[244:247], a[168:171], v[144:147]
ds_read_b128 a[232:235], v229 offset:24832
v_cvt_pk_bf16_f32 v78, v172, v173
v_mfma_f32_16x16x32_bf16 v[144:147], a[248:251], a[184:187], v[144:147]
v_exp_f32 v178, v178
v_mfma_f32_16x16x32_bf16 v[152:155], a[244:247], a[172:175], v[152:155]
s_waitcnt lgkmcnt(2)
v_exp_f32 v179, v179
v_mfma_f32_16x16x32_bf16 v[152:155], a[248:251], a[188:191], v[152:155]
v_cvt_pk_bf16_f32 v79, v174, v175
v_cvt_pk_bf16_f32 v176, v176, v177
v_mfma_f32_16x16x32_bf16 v[132:135], a[252:255], a[160:163], v[132:135]
ds_read_b128 a[236:239], v228 offset:30976
v_accvgpr_write_b32 a72, v176
v_mfma_f32_16x16x32_bf16 v[132:135], a[224:227], a[176:179], v[132:135]
v_exp_f32 v180, v180
v_mfma_f32_16x16x32_bf16 v[140:143], a[252:255], a[164:167], v[140:143]
v_exp_f32 v181, v181
v_mfma_f32_16x16x32_bf16 v[140:143], a[224:227], a[180:183], v[140:143]
v_exp_f32 v182, v182
v_mfma_f32_16x16x32_bf16 v[148:151], a[252:255], a[168:171], v[148:151]
ds_read_b128 a[240:243], v229 offset:30976
v_cvt_pk_bf16_f32 v177, v178, v179
v_mfma_f32_16x16x32_bf16 v[148:151], a[224:227], a[184:187], v[148:151]
v_exp_f32 v183, v183
v_mfma_f32_16x16x32_bf16 v[156:159], a[252:255], a[172:175], v[156:159]
s_waitcnt vmcnt(18) lgkmcnt(2)
v_accvgpr_write_b32 a73, v177
v_cvt_pk_bf16_f32 v178, v180, v181
v_mfma_f32_16x16x32_bf16 v[156:159], a[224:227], a[188:191], v[156:159]
v_exp_f32 v184, v184
v_mfma_f32_16x16x32_bf16 v[128:131], a[228:231], a[192:195], v[128:131]
s_barrier
v_exp_f32 v185, v185
v_mfma_f32_16x16x32_bf16 v[128:131], a[232:235], a[208:211], v[128:131]
ds_read_b128 a[244:247], v228 offset:36864
v_accvgpr_write_b32 a74, v178
v_mfma_f32_16x16x32_bf16 v[136:139], a[228:231], a[196:199], v[136:139]
s_add_u32 m0, s29, 77824
v_exp_f32 v186, v186
v_mfma_f32_16x16x32_bf16 v[136:139], a[232:235], a[212:215], v[136:139]
v_exp_f32 v187, v187
v_mfma_f32_16x16x32_bf16 v[144:147], a[228:231], a[200:203], v[144:147]
s_mov_b32 s30, 36992
v_cvt_pk_bf16_f32 v179, v182, v183
v_accvgpr_write_b32 a75, v179
v_mfma_f32_16x16x32_bf16 v[144:147], a[232:235], a[216:219], v[144:147]
ds_read_b128 a[248:251], v229 offset:36864
v_cvt_pk_bf16_f32 v184, v184, v185
v_mfma_f32_16x16x32_bf16 v[152:155], a[228:231], a[204:207], v[152:155]
s_waitcnt lgkmcnt(2)
v_exp_f32 v188, v188
v_mfma_f32_16x16x32_bf16 v[152:155], a[232:235], a[220:223], v[152:155]
buffer_load_dwordx4 v237, s[16:19], s30 offen lds
v_accvgpr_write_b32 a76, v184
v_mfma_f32_16x16x32_bf16 v[132:135], a[236:239], a[192:195], v[132:135]
s_add_u32 m0, s29, 81920
v_exp_f32 v189, v189
v_mfma_f32_16x16x32_bf16 v[132:135], a[240:243], a[208:211], v[132:135]
ds_read_b128 a[252:255], v228 offset:43008
v_cvt_pk_bf16_f32 v185, v186, v187
v_mfma_f32_16x16x32_bf16 v[140:143], a[236:239], a[196:199], v[140:143]
s_mov_b32 s30, 49280
v_exp_f32 v190, v190
v_mfma_f32_16x16x32_bf16 v[140:143], a[240:243], a[212:215], v[140:143]
v_exp_f32 v191, v191
v_mfma_f32_16x16x32_bf16 v[148:151], a[236:239], a[200:203], v[148:151]
ds_read_b128 a[224:227], v229 offset:43008
v_accvgpr_write_b32 a77, v185
v_mfma_f32_16x16x32_bf16 v[148:151], a[240:243], a[216:219], v[148:151]
v_cvt_pk_bf16_f32 v186, v188, v189
v_accvgpr_write_b32 a78, v186
v_mfma_f32_16x16x32_bf16 v[156:159], a[236:239], a[204:207], v[156:159]
s_waitcnt lgkmcnt(2)
v_cvt_pk_bf16_f32 v187, v190, v191
v_accvgpr_write_b32 a79, v187
v_mfma_f32_16x16x32_bf16 v[156:159], a[240:243], a[220:223], v[156:159]
buffer_load_dwordx4 v237, s[16:19], s30 offen lds
v_mfma_f32_16x16x32_bf16 v[160:163], a[244:247], a[128:131], v[192:195]
s_add_u32 m0, s29, 86016
v_exp_f32 v128, v128
v_mfma_f32_16x16x32_bf16 v[160:163], a[248:251], a[144:147], v[160:163]
buffer_load_dword v244, v254, s[76:79], s92 offen
v_mfma_f32_16x16x32_bf16 v[168:171], a[244:247], a[132:135], v[196:199]
s_mov_b32 s30, 61568
v_exp_f32 v129, v129
v_mfma_f32_16x16x32_bf16 v[168:171], a[248:251], a[148:151], v[168:171]
v_exp_f32 v130, v130
v_mfma_f32_16x16x32_bf16 v[176:179], a[244:247], a[136:139], v[200:203]
s_add_u32 s92, s92, 1920
v_exp_f32 v131, v131
v_mfma_f32_16x16x32_bf16 v[176:179], a[248:251], a[152:155], v[176:179]
ds_read_b128 a[232:235], v228 offset:36992
v_cvt_pk_bf16_f32 v80, v128, v129
v_mfma_f32_16x16x32_bf16 v[184:187], a[244:247], a[140:143], v[204:207]
s_waitcnt lgkmcnt(1)
v_exp_f32 v132, v132
v_mfma_f32_16x16x32_bf16 v[184:187], a[248:251], a[156:159], v[184:187]
buffer_load_dwordx4 v237, s[16:19], s30 offen lds
v_cvt_pk_bf16_f32 v81, v130, v131
v_mfma_f32_16x16x32_bf16 v[164:167], a[252:255], a[128:131], v[192:195]
ds_read_b128 a[236:239], v229 offset:36992
v_mfma_f32_16x16x32_bf16 v[164:167], a[224:227], a[144:147], v[164:167]
v_exp_f32 v133, v133
v_mfma_f32_16x16x32_bf16 v[172:175], a[252:255], a[132:135], v[196:199]
v_exp_f32 v134, v134
v_mfma_f32_16x16x32_bf16 v[172:175], a[224:227], a[148:151], v[172:175]
v_exp_f32 v135, v135
v_mfma_f32_16x16x32_bf16 v[180:183], a[252:255], a[136:139], v[200:203]
ds_read_b128 a[240:243], v228 offset:43136
v_cvt_pk_bf16_f32 v82, v132, v133
v_mfma_f32_16x16x32_bf16 v[180:183], a[224:227], a[152:155], v[180:183]
v_exp_f32 v136, v136
v_mfma_f32_16x16x32_bf16 v[188:191], a[252:255], a[140:143], v[204:207]
v_exp_f32 v137, v137
v_mfma_f32_16x16x32_bf16 v[188:191], a[224:227], a[156:159], v[188:191]
v_exp_f32 v138, v138
v_mfma_f32_16x16x32_bf16 v[208:211], v[224:227], v[72:75], v[208:211]
ds_read_b128 a[244:247], v229 offset:43136
v_cvt_pk_bf16_f32 v83, v134, v135
v_mfma_f32_16x16x32_bf16 v[212:215], v[224:227], v[76:79], v[212:215]
v_exp_f32 v139, v139
v_mfma_f32_16x16x32_bf16 v[216:219], v[224:227], a[72:75], v[216:219]
s_waitcnt lgkmcnt(2)
v_exp_f32 v140, v140
v_mfma_f32_16x16x32_bf16 v[240:243], v[224:227], a[76:79], v[240:243]
v_exp_f32 v141, v141
v_mfma_f32_16x16x32_bf16 v[160:163], a[232:235], a[160:163], v[160:163]
ds_read_b128 a[248:251], v228 offset:37120
v_cvt_pk_bf16_f32 v84, v136, v137
v_mfma_f32_16x16x32_bf16 v[160:163], a[236:239], a[176:179], v[160:163]
v_exp_f32 v142, v142
v_mfma_f32_16x16x32_bf16 v[168:171], a[232:235], a[164:167], v[168:171]
v_exp_f32 v143, v143
v_mfma_f32_16x16x32_bf16 v[168:171], a[236:239], a[180:183], v[168:171]
v_exp_f32 v144, v144
v_mfma_f32_16x16x32_bf16 v[176:179], a[232:235], a[168:171], v[176:179]
ds_read_b128 a[252:255], v229 offset:37120
v_cvt_pk_bf16_f32 v85, v138, v139
v_mfma_f32_16x16x32_bf16 v[176:179], a[236:239], a[184:187], v[176:179]
v_exp_f32 v145, v145
v_mfma_f32_16x16x32_bf16 v[184:187], a[232:235], a[172:175], v[184:187]
s_waitcnt lgkmcnt(2)
v_exp_f32 v146, v146
v_mfma_f32_16x16x32_bf16 v[184:187], a[236:239], a[188:191], v[184:187]
v_exp_f32 v147, v147
v_mfma_f32_16x16x32_bf16 v[164:167], a[240:243], a[160:163], v[164:167]
ds_read_b128 a[224:227], v228 offset:43264
v_cvt_pk_bf16_f32 v86, v140, v141
v_mfma_f32_16x16x32_bf16 v[164:167], a[244:247], a[176:179], v[164:167]
v_cvt_pk_bf16_f32 v87, v142, v143
v_cvt_pk_bf16_f32 v144, v144, v145
v_mfma_f32_16x16x32_bf16 v[172:175], a[240:243], a[164:167], v[172:175]
v_exp_f32 v148, v148
v_mfma_f32_16x16x32_bf16 v[172:175], a[244:247], a[180:183], v[172:175]
v_exp_f32 v149, v149
v_mfma_f32_16x16x32_bf16 v[180:183], a[240:243], a[168:171], v[180:183]
ds_read_b128 a[228:231], v229 offset:43264
v_accvgpr_write_b32 a80, v144
v_mfma_f32_16x16x32_bf16 v[180:183], a[244:247], a[184:187], v[180:183]
v_exp_f32 v150, v150
v_mfma_f32_16x16x32_bf16 v[188:191], a[240:243], a[172:175], v[188:191]
s_waitcnt vmcnt(18) lgkmcnt(2)
v_exp_f32 v151, v151
v_mfma_f32_16x16x32_bf16 v[188:191], a[244:247], a[188:191], v[188:191]
v_add_u32 v228, 36864, v228
v_add_u32 v229, 36864, v229
v_mfma_f32_16x16x32_bf16 v[160:163], a[248:251], a[192:195], v[160:163]
s_barrier
v_cvt_pk_bf16_f32 v145, v146, v147
v_accvgpr_write_b32 a81, v145
v_mfma_f32_16x16x32_bf16 v[160:163], a[252:255], a[208:211], v[160:163]
ds_read_b128 a[232:235], v228 offset:12288
v_cvt_pk_bf16_f32 v146, v148, v149
v_mfma_f32_16x16x32_bf16 v[168:171], a[248:251], a[196:199], v[168:171]
s_add_u32 m0, s29, 90112
v_exp_f32 v152, v152
v_mfma_f32_16x16x32_bf16 v[168:171], a[252:255], a[212:215], v[168:171]
v_exp_f32 v153, v153
v_mfma_f32_16x16x32_bf16 v[176:179], a[248:251], a[200:203], v[176:179]
s_mov_b32 s30, 73856
v_accvgpr_write_b32 a82, v146
v_cvt_pk_bf16_f32 v147, v150, v151
v_mfma_f32_16x16x32_bf16 v[176:179], a[252:255], a[216:219], v[176:179]
ds_read_b128 a[236:239], v229 offset:12288
v_accvgpr_write_b32 a83, v147
v_mfma_f32_16x16x32_bf16 v[184:187], a[248:251], a[204:207], v[184:187]
s_waitcnt lgkmcnt(2)
v_exp_f32 v154, v154
v_mfma_f32_16x16x32_bf16 v[184:187], a[252:255], a[220:223], v[184:187]
buffer_load_dwordx4 v237, s[16:19], s30 offen lds
v_cvt_pk_bf16_f32 v152, v152, v153
v_mfma_f32_16x16x32_bf16 v[164:167], a[224:227], a[192:195], v[164:167]
s_add_u32 m0, s29, 94208
v_exp_f32 v155, v155
v_mfma_f32_16x16x32_bf16 v[164:167], a[228:231], a[208:211], v[164:167]
ds_read_b128 a[240:243], v228 offset:18432
v_accvgpr_write_b32 a84, v152
v_mfma_f32_16x16x32_bf16 v[172:175], a[224:227], a[196:199], v[172:175]
s_mov_b32 s30, 86144
v_exp_f32 v156, v156
v_mfma_f32_16x16x32_bf16 v[172:175], a[228:231], a[212:215], v[172:175]
v_exp_f32 v157, v157
v_mfma_f32_16x16x32_bf16 v[180:183], a[224:227], a[200:203], v[180:183]
ds_read_b128 a[244:247], v229 offset:18432
v_cvt_pk_bf16_f32 v153, v154, v155
v_mfma_f32_16x16x32_bf16 v[180:183], a[228:231], a[216:219], v[180:183]
v_exp_f32 v158, v158
v_mfma_f32_16x16x32_bf16 v[188:191], a[224:227], a[204:207], v[188:191]
s_waitcnt lgkmcnt(2)
v_exp_f32 v159, v159
v_mfma_f32_16x16x32_bf16 v[188:191], a[228:231], a[220:223], v[188:191]
buffer_load_dwordx4 v237, s[16:19], s30 offen lds
v_accvgpr_write_b32 a85, v153
v_cvt_pk_bf16_f32 v154, v156, v157
v_accvgpr_write_b32 a86, v154
v_cvt_pk_bf16_f32 v155, v158, v159
v_accvgpr_write_b32 a87, v155
v_mfma_f32_16x16x32_bf16 v[128:131], a[232:235], a[128:131], v[192:195]
s_add_u32 m0, s29, 98304
v_exp_f32 v160, v160
v_mfma_f32_16x16x32_bf16 v[128:131], a[236:239], a[144:147], v[128:131]
v_exp_f32 v161, v161
v_mfma_f32_16x16x32_bf16 v[136:139], a[232:235], a[132:135], v[196:199]
s_mov_b32 s30, 98432
v_exp_f32 v162, v162
v_mfma_f32_16x16x32_bf16 v[136:139], a[236:239], a[148:151], v[136:139]
v_exp_f32 v163, v163
v_mfma_f32_16x16x32_bf16 v[144:147], a[232:235], a[136:139], v[200:203]
ds_read_b128 a[252:255], v228 offset:12416
v_cvt_pk_bf16_f32 v88, v160, v161
v_mfma_f32_16x16x32_bf16 v[144:147], a[236:239], a[152:155], v[144:147]
v_exp_f32 v164, v164
v_mfma_f32_16x16x32_bf16 v[152:155], a[232:235], a[140:143], v[204:207]
s_waitcnt lgkmcnt(1)
v_exp_f32 v165, v165
v_mfma_f32_16x16x32_bf16 v[152:155], a[236:239], a[156:159], v[152:155]
buffer_load_dwordx4 v237, s[16:19], s30 offen lds
v_cvt_pk_bf16_f32 v89, v162, v163
v_mfma_f32_16x16x32_bf16 v[132:135], a[240:243], a[128:131], v[192:195]
ds_read_b128 a[224:227], v229 offset:12416
v_cvt_pk_bf16_f32 v90, v164, v165
v_mfma_f32_16x16x32_bf16 v[132:135], a[244:247], a[144:147], v[132:135]
v_exp_f32 v166, v166
v_mfma_f32_16x16x32_bf16 v[140:143], a[240:243], a[132:135], v[196:199]
v_exp_f32 v167, v167
v_mfma_f32_16x16x32_bf16 v[140:143], a[244:247], a[148:151], v[140:143]
v_exp_f32 v168, v168
v_mfma_f32_16x16x32_bf16 v[148:151], a[240:243], a[136:139], v[200:203]
ds_read_b128 a[228:231], v228 offset:18560
v_cvt_pk_bf16_f32 v91, v166, v167
v_mfma_f32_16x16x32_bf16 v[148:151], a[244:247], a[152:155], v[148:151]
v_exp_f32 v169, v169
v_mfma_f32_16x16x32_bf16 v[156:159], a[240:243], a[140:143], v[204:207]
v_exp_f32 v170, v170
v_mfma_f32_16x16x32_bf16 v[156:159], a[244:247], a[156:159], v[156:159]
v_exp_f32 v171, v171
v_mfma_f32_16x16x32_bf16 v[208:211], v[224:227], v[80:83], v[208:211]
ds_read_b128 a[232:235], v229 offset:18560
v_cvt_pk_bf16_f32 v92, v168, v169
v_mfma_f32_16x16x32_bf16 v[212:215], v[224:227], v[84:87], v[212:215]
v_exp_f32 v172, v172
v_mfma_f32_16x16x32_bf16 v[216:219], v[224:227], a[80:83], v[216:219]
s_waitcnt lgkmcnt(2)
v_exp_f32 v173, v173
v_mfma_f32_16x16x32_bf16 v[240:243], v[224:227], a[84:87], v[240:243]
v_exp_f32 v174, v174
v_mfma_f32_16x16x32_bf16 v[128:131], a[252:255], a[160:163], v[128:131]
ds_read_b128 a[236:239], v228 offset:12544
v_cvt_pk_bf16_f32 v93, v170, v171
v_mfma_f32_16x16x32_bf16 v[128:131], a[224:227], a[176:179], v[128:131]
v_exp_f32 v175, v175
v_mfma_f32_16x16x32_bf16 v[136:139], a[252:255], a[164:167], v[136:139]
v_exp_f32 v176, v176
v_mfma_f32_16x16x32_bf16 v[136:139], a[224:227], a[180:183], v[136:139]
v_exp_f32 v177, v177
v_mfma_f32_16x16x32_bf16 v[144:147], a[252:255], a[168:171], v[144:147]
ds_read_b128 a[240:243], v229 offset:12544
v_cvt_pk_bf16_f32 v94, v172, v173
v_mfma_f32_16x16x32_bf16 v[144:147], a[224:227], a[184:187], v[144:147]
v_exp_f32 v178, v178
v_mfma_f32_16x16x32_bf16 v[152:155], a[252:255], a[172:175], v[152:155]
s_waitcnt lgkmcnt(2)
v_exp_f32 v179, v179
v_mfma_f32_16x16x32_bf16 v[152:155], a[224:227], a[188:191], v[152:155]
buffer_load_dword v244, v254, s[76:79], s92 offen
v_cvt_pk_bf16_f32 v95, v174, v175
v_mfma_f32_16x16x32_bf16 v[132:135], a[228:231], a[160:163], v[132:135]
s_add_u32 s92, s92, 1920
v_exp_f32 v180, v180
v_mfma_f32_16x16x32_bf16 v[132:135], a[232:235], a[176:179], v[132:135]
ds_read_b128 a[244:247], v228 offset:18688
v_cvt_pk_bf16_f32 v176, v176, v177
v_mfma_f32_16x16x32_bf16 v[140:143], a[228:231], a[164:167], v[140:143]
v_exp_f32 v181, v181
v_mfma_f32_16x16x32_bf16 v[140:143], a[232:235], a[180:183], v[140:143]
v_accvgpr_write_b32 a88, v176
v_cvt_pk_bf16_f32 v177, v178, v179
v_mfma_f32_16x16x32_bf16 v[148:151], a[228:231], a[168:171], v[148:151]
ds_read_b128 a[248:251], v229 offset:18688
v_accvgpr_write_b32 a89, v177
v_mfma_f32_16x16x32_bf16 v[148:151], a[232:235], a[184:187], v[148:151]
v_exp_f32 v182, v182
v_mfma_f32_16x16x32_bf16 v[156:159], a[228:231], a[172:175], v[156:159]
s_waitcnt vmcnt(19) lgkmcnt(2)
v_exp_f32 v183, v183
v_mfma_f32_16x16x32_bf16 v[156:159], a[232:235], a[188:191], v[156:159]
v_exp_f32 v184, v184
v_mfma_f32_16x16x32_bf16 v[128:131], a[236:239], a[192:195], v[128:131]
s_barrier
v_exp_f32 v185, v185
v_mfma_f32_16x16x32_bf16 v[128:131], a[240:243], a[208:211], v[128:131]
ds_read_b128 a[252:255], v228 offset:24576
v_cvt_pk_bf16_f32 v178, v180, v181
v_mfma_f32_16x16x32_bf16 v[136:139], a[236:239], a[196:199], v[136:139]
s_add_u32 m0, s29, 102400
v_accvgpr_write_b32 a90, v178
v_cvt_pk_bf16_f32 v179, v182, v183
v_mfma_f32_16x16x32_bf16 v[136:139], a[240:243], a[212:215], v[136:139]
v_exp_f32 v186, v186
v_mfma_f32_16x16x32_bf16 v[144:147], a[236:239], a[200:203], v[144:147]
s_mov_b32 s30, 110720
v_exp_f32 v187, v187
v_mfma_f32_16x16x32_bf16 v[144:147], a[240:243], a[216:219], v[144:147]
ds_read_b128 a[224:227], v229 offset:24576
v_accvgpr_write_b32 a91, v179
v_mfma_f32_16x16x32_bf16 v[152:155], a[236:239], a[204:207], v[152:155]
s_waitcnt lgkmcnt(2)
v_exp_f32 v188, v188
v_mfma_f32_16x16x32_bf16 v[152:155], a[240:243], a[220:223], v[152:155]
buffer_load_dwordx4 v237, s[16:19], s30 offen lds
v_cvt_pk_bf16_f32 v184, v184, v185
v_mfma_f32_16x16x32_bf16 v[132:135], a[244:247], a[192:195], v[132:135]
s_add_u32 m0, s29, 106496
v_exp_f32 v189, v189
v_mfma_f32_16x16x32_bf16 v[132:135], a[248:251], a[208:211], v[132:135]
ds_read_b128 a[228:231], v228 offset:30720
v_accvgpr_write_b32 a92, v184
v_mfma_f32_16x16x32_bf16 v[140:143], a[244:247], a[196:199], v[140:143]
s_mov_b32 s30, 123008
v_exp_f32 v190, v190
v_mfma_f32_16x16x32_bf16 v[140:143], a[248:251], a[212:215], v[140:143]
v_exp_f32 v191, v191
v_mfma_f32_16x16x32_bf16 v[148:151], a[244:247], a[200:203], v[148:151]
ds_read_b128 a[232:235], v229 offset:30720
v_cvt_pk_bf16_f32 v185, v186, v187
v_mfma_f32_16x16x32_bf16 v[148:151], a[248:251], a[216:219], v[148:151]
v_accvgpr_write_b32 a93, v185
v_cvt_pk_bf16_f32 v186, v188, v189
v_mfma_f32_16x16x32_bf16 v[156:159], a[244:247], a[204:207], v[156:159]
s_waitcnt lgkmcnt(2)
v_accvgpr_write_b32 a94, v186
v_cvt_pk_bf16_f32 v187, v190, v191
v_mfma_f32_16x16x32_bf16 v[156:159], a[248:251], a[220:223], v[156:159]
buffer_load_dwordx4 v237, s[16:19], s30 offen lds
v_accvgpr_write_b32 a95, v187
v_mfma_f32_16x16x32_bf16 v[160:163], a[252:255], a[128:131], v[192:195]
s_add_u32 m0, s29, 110592
v_exp_f32 v128, v128
v_mfma_f32_16x16x32_bf16 v[160:163], a[224:227], a[144:147], v[160:163]
v_exp_f32 v129, v129
v_mfma_f32_16x16x32_bf16 v[168:171], a[252:255], a[132:135], v[196:199]
s_mov_b32 s30, 135296
v_exp_f32 v130, v130
v_mfma_f32_16x16x32_bf16 v[168:171], a[224:227], a[148:151], v[168:171]
v_exp_f32 v131, v131
v_mfma_f32_16x16x32_bf16 v[176:179], a[252:255], a[136:139], v[200:203]
ds_read_b128 a[240:243], v228 offset:24704
v_cvt_pk_bf16_f32 v96, v128, v129
v_mfma_f32_16x16x32_bf16 v[176:179], a[224:227], a[152:155], v[176:179]
v_exp_f32 v132, v132
v_mfma_f32_16x16x32_bf16 v[184:187], a[252:255], a[140:143], v[204:207]
s_waitcnt lgkmcnt(1)
v_exp_f32 v133, v133
v_mfma_f32_16x16x32_bf16 v[184:187], a[224:227], a[156:159], v[184:187]
buffer_load_dwordx4 v237, s[16:19], s30 offen lds
v_cvt_pk_bf16_f32 v97, v130, v131
v_mfma_f32_16x16x32_bf16 v[164:167], a[228:231], a[128:131], v[192:195]
ds_read_b128 a[244:247], v229 offset:24704
v_cvt_pk_bf16_f32 v98, v132, v133
v_mfma_f32_16x16x32_bf16 v[164:167], a[232:235], a[144:147], v[164:167]
v_exp_f32 v134, v134
v_mfma_f32_16x16x32_bf16 v[172:175], a[228:231], a[132:135], v[196:199]
v_exp_f32 v135, v135
v_mfma_f32_16x16x32_bf16 v[172:175], a[232:235], a[148:151], v[172:175]
v_exp_f32 v136, v136
v_mfma_f32_16x16x32_bf16 v[180:183], a[228:231], a[136:139], v[200:203]
ds_read_b128 a[248:251], v228 offset:30848
v_cvt_pk_bf16_f32 v99, v134, v135
v_mfma_f32_16x16x32_bf16 v[180:183], a[232:235], a[152:155], v[180:183]
v_exp_f32 v137, v137
v_mfma_f32_16x16x32_bf16 v[188:191], a[228:231], a[140:143], v[204:207]
v_exp_f32 v138, v138
v_mfma_f32_16x16x32_bf16 v[188:191], a[232:235], a[156:159], v[188:191]
v_exp_f32 v139, v139
v_mfma_f32_16x16x32_bf16 v[208:211], v[224:227], v[88:91], v[208:211]
ds_read_b128 a[252:255], v229 offset:30848
v_cvt_pk_bf16_f32 v100, v136, v137
v_mfma_f32_16x16x32_bf16 v[212:215], v[224:227], v[92:95], v[212:215]
v_exp_f32 v140, v140
v_mfma_f32_16x16x32_bf16 v[216:219], v[224:227], a[88:91], v[216:219]
s_waitcnt lgkmcnt(2)
v_exp_f32 v141, v141
v_mfma_f32_16x16x32_bf16 v[240:243], v[224:227], a[92:95], v[240:243]
v_exp_f32 v142, v142
v_mfma_f32_16x16x32_bf16 v[160:163], a[240:243], a[160:163], v[160:163]
ds_read_b128 a[224:227], v228 offset:24832
v_cvt_pk_bf16_f32 v101, v138, v139
v_mfma_f32_16x16x32_bf16 v[160:163], a[244:247], a[176:179], v[160:163]
v_exp_f32 v143, v143
v_mfma_f32_16x16x32_bf16 v[168:171], a[240:243], a[164:167], v[168:171]
v_exp_f32 v144, v144
v_mfma_f32_16x16x32_bf16 v[168:171], a[244:247], a[180:183], v[168:171]
v_exp_f32 v145, v145
v_mfma_f32_16x16x32_bf16 v[176:179], a[240:243], a[168:171], v[176:179]
ds_read_b128 a[228:231], v229 offset:24832
v_cvt_pk_bf16_f32 v102, v140, v141
v_mfma_f32_16x16x32_bf16 v[176:179], a[244:247], a[184:187], v[176:179]
v_exp_f32 v146, v146
v_mfma_f32_16x16x32_bf16 v[184:187], a[240:243], a[172:175], v[184:187]
s_waitcnt lgkmcnt(2)
v_exp_f32 v147, v147
v_mfma_f32_16x16x32_bf16 v[184:187], a[244:247], a[188:191], v[184:187]
L_pg7:
s_cbranch_execz L_pg11
v_cvt_pk_bf16_f32 v103, v142, v143
v_cvt_pk_bf16_f32 v144, v144, v145
v_mfma_f32_16x16x32_bf16 v[164:167], a[248:251], a[160:163], v[164:167]
ds_read_b128 a[232:235], v228 offset:30976
v_accvgpr_write_b32 a96, v144
v_mfma_f32_16x16x32_bf16 v[164:167], a[252:255], a[176:179], v[164:167]
v_exp_f32 v148, v148
v_mfma_f32_16x16x32_bf16 v[172:175], a[248:251], a[164:167], v[172:175]
v_exp_f32 v149, v149
v_mfma_f32_16x16x32_bf16 v[172:175], a[252:255], a[180:183], v[172:175]
v_exp_f32 v150, v150
v_mfma_f32_16x16x32_bf16 v[180:183], a[248:251], a[168:171], v[180:183]
ds_read_b128 a[236:239], v229 offset:30976
v_cvt_pk_bf16_f32 v145, v146, v147
v_mfma_f32_16x16x32_bf16 v[180:183], a[252:255], a[184:187], v[180:183]
v_exp_f32 v151, v151
v_mfma_f32_16x16x32_bf16 v[188:191], a[248:251], a[172:175], v[188:191]
s_waitcnt vmcnt(18) lgkmcnt(2)
v_accvgpr_write_b32 a97, v145
v_cvt_pk_bf16_f32 v146, v148, v149
v_mfma_f32_16x16x32_bf16 v[188:191], a[252:255], a[188:191], v[188:191]
v_exp_f32 v152, v152
v_mfma_f32_16x16x32_bf16 v[160:163], a[224:227], a[192:195], v[160:163]
s_barrier
v_exp_f32 v153, v153
v_mfma_f32_16x16x32_bf16 v[160:163], a[228:231], a[208:211], v[160:163]
ds_read_b128 a[240:243], v228 offset:36864
v_accvgpr_write_b32 a98, v146
v_mfma_f32_16x16x32_bf16 v[168:171], a[224:227], a[196:199], v[168:171]
s_add_u32 m0, s29, 114688
v_exp_f32 v154, v154
v_mfma_f32_16x16x32_bf16 v[168:171], a[228:231], a[212:215], v[168:171]
v_exp_f32 v155, v155
v_mfma_f32_16x16x32_bf16 v[176:179], a[224:227], a[200:203], v[176:179]
s_mov_b32 s30, 147584
v_cvt_pk_bf16_f32 v147, v150, v151
v_accvgpr_write_b32 a99, v147
v_mfma_f32_16x16x32_bf16 v[176:179], a[228:231], a[216:219], v[176:179]
ds_read_b128 a[244:247], v229 offset:36864
v_cvt_pk_bf16_f32 v152, v152, v153
v_mfma_f32_16x16x32_bf16 v[184:187], a[224:227], a[204:207], v[184:187]
s_waitcnt lgkmcnt(2)
v_exp_f32 v156, v156
v_mfma_f32_16x16x32_bf16 v[184:187], a[228:231], a[220:223], v[184:187]
buffer_load_dwordx4 v237, s[16:19], s30 offen lds
v_accvgpr_write_b32 a100, v152
v_mfma_f32_16x16x32_bf16 v[164:167], a[232:235], a[192:195], v[164:167]
s_add_u32 m0, s29, 118784
v_exp_f32 v157, v157
v_mfma_f32_16x16x32_bf16 v[164:167], a[236:239], a[208:211], v[164:167]
ds_read_b128 a[248:251], v228 offset:43008
v_cvt_pk_bf16_f32 v153, v154, v155
v_mfma_f32_16x16x32_bf16 v[172:175], a[232:235], a[196:199], v[172:175]
s_mov_b32 s30, 159872
v_exp_f32 v158, v158
v_mfma_f32_16x16x32_bf16 v[172:175], a[236:239], a[212:215], v[172:175]
v_exp_f32 v159, v159
v_mfma_f32_16x16x32_bf16 v[180:183], a[232:235], a[200:203], v[180:183]
ds_read_b128 a[252:255], v229 offset:43008
v_accvgpr_write_b32 a101, v153
v_mfma_f32_16x16x32_bf16 v[180:183], a[236:239], a[216:219], v[180:183]
v_cvt_pk_bf16_f32 v154, v156, v157
v_accvgpr_write_b32 a102, v154
v_mfma_f32_16x16x32_bf16 v[188:191], a[232:235], a[204:207], v[188:191]
s_waitcnt lgkmcnt(2)
v_cvt_pk_bf16_f32 v155, v158, v159
v_accvgpr_write_b32 a103, v155
v_mfma_f32_16x16x32_bf16 v[188:191], a[236:239], a[220:223], v[188:191]
buffer_load_dwordx4 v237, s[16:19], s30 offen lds
v_mfma_f32_16x16x32_bf16 v[128:131], a[240:243], a[128:131], v[192:195]
s_add_u32 m0, s29, 122880
v_exp_f32 v160, v160
v_mfma_f32_16x16x32_bf16 v[128:131], a[244:247], a[144:147], v[128:131]
v_exp_f32 v161, v161
v_mfma_f32_16x16x32_bf16 v[136:139], a[240:243], a[132:135], v[196:199]
s_mov_b32 s30, 172160
v_exp_f32 v162, v162
v_mfma_f32_16x16x32_bf16 v[136:139], a[244:247], a[148:151], v[136:139]
v_exp_f32 v163, v163
v_mfma_f32_16x16x32_bf16 v[144:147], a[240:243], a[136:139], v[200:203]
ds_read_b128 a[228:231], v228 offset:36992
v_cvt_pk_bf16_f32 v104, v160, v161
v_mfma_f32_16x16x32_bf16 v[144:147], a[244:247], a[152:155], v[144:147]
v_exp_f32 v164, v164
v_mfma_f32_16x16x32_bf16 v[152:155], a[240:243], a[140:143], v[204:207]
s_waitcnt lgkmcnt(1)
v_exp_f32 v165, v165
v_mfma_f32_16x16x32_bf16 v[152:155], a[244:247], a[156:159], v[152:155]
buffer_load_dwordx4 v237, s[16:19], s30 offen lds
v_cvt_pk_bf16_f32 v105, v162, v163
v_mfma_f32_16x16x32_bf16 v[132:135], a[248:251], a[128:131], v[192:195]
ds_read_b128 a[232:235], v229 offset:36992
v_cvt_pk_bf16_f32 v106, v164, v165
v_mfma_f32_16x16x32_bf16 v[132:135], a[252:255], a[144:147], v[132:135]
v_exp_f32 v166, v166
v_mfma_f32_16x16x32_bf16 v[140:143], a[248:251], a[132:135], v[196:199]
v_exp_f32 v167, v167
v_mfma_f32_16x16x32_bf16 v[140:143], a[252:255], a[148:151], v[140:143]
v_exp_f32 v168, v168
v_mfma_f32_16x16x32_bf16 v[148:151], a[248:251], a[136:139], v[200:203]
ds_read_b128 a[236:239], v228 offset:43136
v_cvt_pk_bf16_f32 v107, v166, v167
v_mfma_f32_16x16x32_bf16 v[148:151], a[252:255], a[152:155], v[148:151]
v_exp_f32 v169, v169
v_mfma_f32_16x16x32_bf16 v[156:159], a[248:251], a[140:143], v[204:207]
v_exp_f32 v170, v170
v_mfma_f32_16x16x32_bf16 v[156:159], a[252:255], a[156:159], v[156:159]
v_exp_f32 v171, v171
v_mfma_f32_16x16x32_bf16 v[208:211], v[224:227], v[96:99], v[208:211]
ds_read_b128 a[240:243], v229 offset:43136
v_cvt_pk_bf16_f32 v108, v168, v169
v_mfma_f32_16x16x32_bf16 v[212:215], v[224:227], v[100:103], v[212:215]
v_exp_f32 v172, v172
v_mfma_f32_16x16x32_bf16 v[216:219], v[224:227], a[96:99], v[216:219]
s_waitcnt lgkmcnt(2)
v_exp_f32 v173, v173
v_mfma_f32_16x16x32_bf16 v[240:243], v[224:227], a[100:103], v[240:243]
v_exp_f32 v174, v174
v_mfma_f32_16x16x32_bf16 v[128:131], a[228:231], a[160:163], v[128:131]
ds_read_b128 a[244:247], v228 offset:37120
v_cvt_pk_bf16_f32 v109, v170, v171
v_mfma_f32_16x16x32_bf16 v[128:131], a[232:235], a[176:179], v[128:131]
v_exp_f32 v175, v175
v_mfma_f32_16x16x32_bf16 v[136:139], a[228:231], a[164:167], v[136:139]
v_exp_f32 v176, v176
v_mfma_f32_16x16x32_bf16 v[136:139], a[232:235], a[180:183], v[136:139]
v_exp_f32 v177, v177
v_mfma_f32_16x16x32_bf16 v[144:147], a[228:231], a[168:171], v[144:147]
ds_read_b128 a[248:251], v229 offset:37120
v_cvt_pk_bf16_f32 v110, v172, v173
v_mfma_f32_16x16x32_bf16 v[144:147], a[232:235], a[184:187], v[144:147]
v_exp_f32 v178, v178
v_mfma_f32_16x16x32_bf16 v[152:155], a[228:231], a[172:175], v[152:155]
s_waitcnt lgkmcnt(2)
v_exp_f32 v179, v179
v_mfma_f32_16x16x32_bf16 v[152:155], a[232:235], a[188:191], v[152:155]
v_cvt_pk_bf16_f32 v111, v174, v175
v_cvt_pk_bf16_f32 v176, v176, v177
v_mfma_f32_16x16x32_bf16 v[132:135], a[236:239], a[160:163], v[132:135]
ds_read_b128 a[252:255], v228 offset:43264
v_accvgpr_write_b32 a104, v176
v_mfma_f32_16x16x32_bf16 v[132:135], a[240:243], a[176:179], v[132:135]
v_exp_f32 v180, v180
v_mfma_f32_16x16x32_bf16 v[140:143], a[236:239], a[164:167], v[140:143]
v_exp_f32 v181, v181
v_mfma_f32_16x16x32_bf16 v[140:143], a[240:243], a[180:183], v[140:143]
v_exp_f32 v182, v182
v_mfma_f32_16x16x32_bf16 v[148:151], a[236:239], a[168:171], v[148:151]
ds_read_b128 a[224:227], v229 offset:43264
v_cvt_pk_bf16_f32 v177, v178, v179
v_mfma_f32_16x16x32_bf16 v[148:151], a[240:243], a[184:187], v[148:151]
v_exp_f32 v183, v183
v_mfma_f32_16x16x32_bf16 v[156:159], a[236:239], a[172:175], v[156:159]
s_waitcnt vmcnt(18) lgkmcnt(2)
v_accvgpr_write_b32 a105, v177
v_cvt_pk_bf16_f32 v178, v180, v181
v_mfma_f32_16x16x32_bf16 v[156:159], a[240:243], a[188:191], v[156:159]
v_exp_f32 v184, v184
v_mfma_f32_16x16x32_bf16 v[128:131], a[244:247], a[192:195], v[128:131]
s_barrier
v_exp_f32 v185, v185
v_mfma_f32_16x16x32_bf16 v[128:131], a[248:251], a[208:211], v[128:131]
ds_read_b128 a[228:231], v228 offset:49152
v_accvgpr_write_b32 a106, v178
v_mfma_f32_16x16x32_bf16 v[136:139], a[244:247], a[196:199], v[136:139]
s_add_u32 m0, s29, 126976
v_exp_f32 v186, v186
v_mfma_f32_16x16x32_bf16 v[136:139], a[248:251], a[212:215], v[136:139]
v_exp_f32 v187, v187
v_mfma_f32_16x16x32_bf16 v[144:147], a[244:247], a[200:203], v[144:147]
s_mov_b32 s30, 184448
v_cvt_pk_bf16_f32 v179, v182, v183
v_accvgpr_write_b32 a107, v179
v_mfma_f32_16x16x32_bf16 v[144:147], a[248:251], a[216:219], v[144:147]
ds_read_b128 a[232:235], v229 offset:49152
v_cvt_pk_bf16_f32 v184, v184, v185
v_mfma_f32_16x16x32_bf16 v[152:155], a[244:247], a[204:207], v[152:155]
s_waitcnt lgkmcnt(2)
v_exp_f32 v188, v188
v_mfma_f32_16x16x32_bf16 v[152:155], a[248:251], a[220:223], v[152:155]
buffer_load_dwordx4 v237, s[16:19], s30 offen lds
v_accvgpr_write_b32 a108, v184
v_mfma_f32_16x16x32_bf16 v[132:135], a[252:255], a[192:195], v[132:135]
ds_read_b128 a[236:239], v228 offset:55296
v_cvt_pk_bf16_f32 v185, v186, v187
v_mfma_f32_16x16x32_bf16 v[132:135], a[224:227], a[208:211], v[132:135]
v_exp_f32 v189, v189
v_mfma_f32_16x16x32_bf16 v[140:143], a[252:255], a[196:199], v[140:143]
v_exp_f32 v190, v190
v_mfma_f32_16x16x32_bf16 v[140:143], a[224:227], a[212:215], v[140:143]
v_exp_f32 v191, v191
v_mfma_f32_16x16x32_bf16 v[148:151], a[252:255], a[200:203], v[148:151]
ds_read_b128 a[240:243], v229 offset:55296
v_accvgpr_write_b32 a109, v185
v_mfma_f32_16x16x32_bf16 v[148:151], a[224:227], a[216:219], v[148:151]
v_cvt_pk_bf16_f32 v186, v188, v189
v_accvgpr_write_b32 a110, v186
v_mfma_f32_16x16x32_bf16 v[156:159], a[252:255], a[204:207], v[156:159]
s_waitcnt lgkmcnt(2)
v_cvt_pk_bf16_f32 v187, v190, v191
v_accvgpr_write_b32 a111, v187
v_mfma_f32_16x16x32_bf16 v[156:159], a[224:227], a[220:223], v[156:159]
v_mfma_f32_16x16x32_bf16 v[160:163], a[228:231], a[128:131], v[192:195]
v_exp_f32 v128, v128
v_mfma_f32_16x16x32_bf16 v[160:163], a[232:235], a[144:147], v[160:163]
v_exp_f32 v129, v129
v_mfma_f32_16x16x32_bf16 v[168:171], a[228:231], a[132:135], v[196:199]
v_exp_f32 v130, v130
v_mfma_f32_16x16x32_bf16 v[168:171], a[232:235], a[148:151], v[168:171]
v_exp_f32 v131, v131
v_mfma_f32_16x16x32_bf16 v[176:179], a[228:231], a[136:139], v[200:203]
ds_read_b128 a[248:251], v228 offset:49280
v_cvt_pk_bf16_f32 v112, v128, v129
v_mfma_f32_16x16x32_bf16 v[176:179], a[232:235], a[152:155], v[176:179]
v_exp_f32 v132, v132
v_mfma_f32_16x16x32_bf16 v[184:187], a[228:231], a[140:143], v[204:207]
s_waitcnt lgkmcnt(1)
v_exp_f32 v133, v133
v_mfma_f32_16x16x32_bf16 v[184:187], a[232:235], a[156:159], v[184:187]
v_exp_f32 v134, v134
v_mfma_f32_16x16x32_bf16 v[164:167], a[236:239], a[128:131], v[192:195]
s_mov_b64 s[80:81], s[84:85]
v_exp_f32 v135, v135
v_mfma_f32_16x16x32_bf16 v[164:167], a[240:243], a[144:147], v[164:167]
ds_read_b128 a[252:255], v229 offset:49280
v_cvt_pk_bf16_f32 v113, v130, v131
v_mfma_f32_16x16x32_bf16 v[172:175], a[236:239], a[132:135], v[196:199]
buffer_load_dword v244, v254, s[80:83], s90 offen
v_cvt_pk_bf16_f32 v114, v132, v133
v_mfma_f32_16x16x32_bf16 v[172:175], a[240:243], a[148:151], v[172:175]
v_exp_f32 v136, v136
v_mfma_f32_16x16x32_bf16 v[180:183], a[236:239], a[136:139], v[200:203]
ds_read_b128 a[224:227], v228 offset:55424
v_cvt_pk_bf16_f32 v115, v134, v135
v_mfma_f32_16x16x32_bf16 v[180:183], a[240:243], a[152:155], v[180:183]
v_exp_f32 v137, v137
v_mfma_f32_16x16x32_bf16 v[188:191], a[236:239], a[140:143], v[204:207]
v_exp_f32 v138, v138
v_mfma_f32_16x16x32_bf16 v[188:191], a[240:243], a[156:159], v[188:191]
v_exp_f32 v139, v139
v_mfma_f32_16x16x32_bf16 v[208:211], v[224:227], v[104:107], v[208:211]
ds_read_b128 a[228:231], v229 offset:55424
v_cvt_pk_bf16_f32 v116, v136, v137
v_mfma_f32_16x16x32_bf16 v[212:215], v[224:227], v[108:111], v[212:215]
v_exp_f32 v140, v140
v_mfma_f32_16x16x32_bf16 v[216:219], v[224:227], a[104:107], v[216:219]
s_waitcnt lgkmcnt(2)
v_exp_f32 v141, v141
v_mfma_f32_16x16x32_bf16 v[240:243], v[224:227], a[108:111], v[240:243]
v_exp_f32 v142, v142
v_mfma_f32_16x16x32_bf16 v[160:163], a[248:251], a[160:163], v[160:163]
ds_read_b128 a[232:235], v228 offset:49408
v_cvt_pk_bf16_f32 v117, v138, v139
v_mfma_f32_16x16x32_bf16 v[160:163], a[252:255], a[176:179], v[160:163]
v_exp_f32 v143, v143
v_mfma_f32_16x16x32_bf16 v[168:171], a[248:251], a[164:167], v[168:171]
v_exp_f32 v144, v144
v_mfma_f32_16x16x32_bf16 v[168:171], a[252:255], a[180:183], v[168:171]
v_exp_f32 v145, v145
v_mfma_f32_16x16x32_bf16 v[176:179], a[248:251], a[168:171], v[176:179]
ds_read_b128 a[236:239], v229 offset:49408
v_cvt_pk_bf16_f32 v118, v140, v141
v_mfma_f32_16x16x32_bf16 v[176:179], a[252:255], a[184:187], v[176:179]
v_exp_f32 v146, v146
v_mfma_f32_16x16x32_bf16 v[184:187], a[248:251], a[172:175], v[184:187]
s_waitcnt lgkmcnt(2)
v_exp_f32 v147, v147
v_mfma_f32_16x16x32_bf16 v[184:187], a[252:255], a[188:191], v[184:187]
v_cvt_pk_bf16_f32 v119, v142, v143
v_cvt_pk_bf16_f32 v144, v144, v145
v_mfma_f32_16x16x32_bf16 v[164:167], a[224:227], a[160:163], v[164:167]
ds_read_b128 a[240:243], v228 offset:55552
v_accvgpr_write_b32 a112, v144
v_mfma_f32_16x16x32_bf16 v[164:167], a[228:231], a[176:179], v[164:167]
v_exp_f32 v148, v148
v_mfma_f32_16x16x32_bf16 v[172:175], a[224:227], a[164:167], v[172:175]
v_exp_f32 v149, v149
v_mfma_f32_16x16x32_bf16 v[172:175], a[228:231], a[180:183], v[172:175]
v_exp_f32 v150, v150
v_mfma_f32_16x16x32_bf16 v[180:183], a[224:227], a[168:171], v[180:183]
ds_read_b128 a[244:247], v229 offset:55552
v_cvt_pk_bf16_f32 v145, v146, v147
v_mfma_f32_16x16x32_bf16 v[180:183], a[228:231], a[184:187], v[180:183]
v_exp_f32 v151, v151
v_mfma_f32_16x16x32_bf16 v[188:191], a[224:227], a[172:175], v[188:191]
s_waitcnt lgkmcnt(2)
v_accvgpr_write_b32 a113, v145
v_cvt_pk_bf16_f32 v146, v148, v149
v_mfma_f32_16x16x32_bf16 v[188:191], a[228:231], a[188:191], v[188:191]
v_exp_f32 v152, v152
v_mfma_f32_16x16x32_bf16 v[160:163], a[232:235], a[192:195], v[160:163]
ds_read_b64_tr_b16 a[248:249], v230 offset:0
v_accvgpr_write_b32 a114, v146
v_mfma_f32_16x16x32_bf16 v[160:163], a[236:239], a[208:211], v[160:163]
v_exp_f32 v153, v153
v_mfma_f32_16x16x32_bf16 v[168:171], a[232:235], a[196:199], v[168:171]
ds_read_b64_tr_b16 a[250:251], v230 offset:2048
v_cvt_pk_bf16_f32 v147, v150, v151
v_mfma_f32_16x16x32_bf16 v[168:171], a[236:239], a[212:215], v[168:171]
v_exp_f32 v154, v154
v_mfma_f32_16x16x32_bf16 v[176:179], a[232:235], a[200:203], v[176:179]
ds_read_b64_tr_b16 a[252:253], v230 offset:4096
v_accvgpr_write_b32 a115, v147
v_mfma_f32_16x16x32_bf16 v[176:179], a[236:239], a[216:219], v[176:179]
v_exp_f32 v155, v155
v_mfma_f32_16x16x32_bf16 v[184:187], a[232:235], a[204:207], v[184:187]
s_waitcnt lgkmcnt(3)
v_exp_f32 v156, v156
v_mfma_f32_16x16x32_bf16 v[184:187], a[236:239], a[220:223], v[184:187]
ds_read_b64_tr_b16 a[254:255], v230 offset:6144
v_cvt_pk_bf16_f32 v152, v152, v153
v_mfma_f32_16x16x32_bf16 v[164:167], a[240:243], a[192:195], v[164:167]
v_exp_f32 v157, v157
v_mfma_f32_16x16x32_bf16 v[164:167], a[244:247], a[208:211], v[164:167]
v_accvgpr_write_b32 a116, v152
v_cvt_pk_bf16_f32 v153, v154, v155
v_mfma_f32_16x16x32_bf16 v[172:175], a[240:243], a[196:199], v[172:175]
v_exp_f32 v158, v158
v_mfma_f32_16x16x32_bf16 v[172:175], a[244:247], a[212:215], v[172:175]
v_exp_f32 v159, v159
v_mfma_f32_16x16x32_bf16 v[180:183], a[240:243], a[200:203], v[180:183]
ds_read_b64_tr_b16 a[228:229], v223 offset:0
v_accvgpr_write_b32 a117, v153
v_mfma_f32_16x16x32_bf16 v[180:183], a[244:247], a[216:219], v[180:183]
v_cvt_pk_bf16_f32 v154, v156, v157
v_accvgpr_write_b32 a118, v154
v_mfma_f32_16x16x32_bf16 v[188:191], a[240:243], a[204:207], v[188:191]
s_waitcnt lgkmcnt(1)
v_cvt_pk_bf16_f32 v155, v158, v159
v_accvgpr_write_b32 a119, v155
v_mfma_f32_16x16x32_bf16 v[188:191], a[244:247], a[220:223], v[188:191]
ds_read_b64_tr_b16 a[230:231], v223 offset:2048
v_mfma_f32_16x16x32_bf16 v[128:131], a[248:251], v[0:3], 0
ds_read_b64_tr_b16 a[232:233], v223 offset:4096
v_mfma_f32_16x16x32_bf16 v[128:131], a[252:255], v[8:11], v[128:131]
v_exp_f32 v160, v160
v_mfma_f32_16x16x32_bf16 v[136:139], a[248:251], v[4:7], 0
ds_read_b64_tr_b16 a[234:235], v223 offset:6144
v_mfma_f32_16x16x32_bf16 v[136:139], a[252:255], v[12:15], v[136:139]
v_exp_f32 v161, v161
v_mfma_f32_16x16x32_bf16 v[144:147], a[248:251], a[0:3], 0
ds_read_b64_tr_b16 a[236:237], v230 offset:8192
v_cvt_pk_bf16_f32 v120, v160, v161
v_mfma_f32_16x16x32_bf16 v[144:147], a[252:255], a[8:11], v[144:147]
v_exp_f32 v162, v162
v_mfma_f32_16x16x32_bf16 v[152:155], a[248:251], a[4:7], 0
ds_read_b64_tr_b16 a[238:239], v230 offset:10240
v_mfma_f32_16x16x32_bf16 v[152:155], a[252:255], a[12:15], v[152:155]
v_exp_f32 v163, v163
v_mfma_f32_16x16x32_bf16 v[208:211], v[224:227], v[112:115], v[208:211]
ds_read_b64_tr_b16 a[240:241], v230 offset:12288
v_cvt_pk_bf16_f32 v121, v162, v163
v_mfma_f32_16x16x32_bf16 v[212:215], v[224:227], v[116:119], v[212:215]
v_exp_f32 v164, v164
v_mfma_f32_16x16x32_bf16 v[216:219], v[224:227], a[112:115], v[216:219]
s_waitcnt lgkmcnt(3)
v_exp_f32 v165, v165
v_mfma_f32_16x16x32_bf16 v[240:243], v[224:227], a[116:119], v[240:243]
ds_read_b64_tr_b16 a[242:243], v230 offset:14336
v_cvt_pk_bf16_f32 v122, v164, v165
v_mfma_f32_16x16x32_bf16 v[132:135], a[228:231], v[0:3], 0
ds_read_b64_tr_b16 a[244:245], v223 offset:8192
v_mfma_f32_16x16x32_bf16 v[132:135], a[232:235], v[8:11], v[132:135]
v_exp_f32 v166, v166
v_mfma_f32_16x16x32_bf16 v[140:143], a[228:231], v[4:7], 0
ds_read_b64_tr_b16 a[246:247], v223 offset:10240
v_mfma_f32_16x16x32_bf16 v[140:143], a[232:235], v[12:15], v[140:143]
v_exp_f32 v167, v167
v_mfma_f32_16x16x32_bf16 v[148:151], a[228:231], a[0:3], 0
ds_read_b64_tr_b16 a[248:249], v223 offset:12288
v_cvt_pk_bf16_f32 v123, v166, v167
v_mfma_f32_16x16x32_bf16 v[148:151], a[232:235], a[8:11], v[148:151]
v_exp_f32 v168, v168
v_mfma_f32_16x16x32_bf16 v[156:159], a[228:231], a[4:7], 0
s_waitcnt lgkmcnt(3)
v_exp_f32 v169, v169
v_mfma_f32_16x16x32_bf16 v[156:159], a[232:235], a[12:15], v[156:159]
ds_read_b64_tr_b16 a[250:251], v223 offset:14336
v_cvt_pk_bf16_f32 v124, v168, v169
v_mfma_f32_16x16x32_bf16 v[128:131], a[236:239], v[16:19], v[128:131]
ds_read_b64_tr_b16 a[252:253], v230 offset:16384
v_mfma_f32_16x16x32_bf16 v[128:131], a[240:243], v[24:27], v[128:131]
v_exp_f32 v170, v170
v_mfma_f32_16x16x32_bf16 v[136:139], a[236:239], v[20:23], v[136:139]
ds_read_b64_tr_b16 a[254:255], v230 offset:18432
v_mfma_f32_16x16x32_bf16 v[136:139], a[240:243], v[28:31], v[136:139]
v_exp_f32 v171, v171
v_mfma_f32_16x16x32_bf16 v[144:147], a[236:239], a[16:19], v[144:147]
ds_read_b64_tr_b16 a[224:225], v230 offset:20480
v_cvt_pk_bf16_f32 v125, v170, v171
v_mfma_f32_16x16x32_bf16 v[144:147], a[240:243], a[24:27], v[144:147]
v_exp_f32 v172, v172
v_mfma_f32_16x16x32_bf16 v[152:155], a[236:239], a[20:23], v[152:155]
s_waitcnt lgkmcnt(3)
v_exp_f32 v173, v173
v_mfma_f32_16x16x32_bf16 v[152:155], a[240:243], a[28:31], v[152:155]
ds_read_b64_tr_b16 a[226:227], v230 offset:22528
v_cvt_pk_bf16_f32 v126, v172, v173
v_mfma_f32_16x16x32_bf16 v[132:135], a[244:247], v[16:19], v[132:135]
ds_read_b64_tr_b16 a[228:229], v223 offset:16384
v_mfma_f32_16x16x32_bf16 v[132:135], a[248:251], v[24:27], v[132:135]
v_exp_f32 v174, v174
v_mfma_f32_16x16x32_bf16 v[140:143], a[244:247], v[20:23], v[140:143]
ds_read_b64_tr_b16 a[230:231], v223 offset:18432
v_mfma_f32_16x16x32_bf16 v[140:143], a[248:251], v[28:31], v[140:143]
v_exp_f32 v175, v175
v_mfma_f32_16x16x32_bf16 v[148:151], a[244:247], a[16:19], v[148:151]
ds_read_b64_tr_b16 a[232:233], v223 offset:20480
v_cvt_pk_bf16_f32 v127, v174, v175
v_mfma_f32_16x16x32_bf16 v[148:151], a[248:251], a[24:27], v[148:151]
v_exp_f32 v176, v176
v_mfma_f32_16x16x32_bf16 v[156:159], a[244:247], a[20:23], v[156:159]
s_waitcnt lgkmcnt(3)
v_exp_f32 v177, v177
v_mfma_f32_16x16x32_bf16 v[156:159], a[248:251], a[28:31], v[156:159]
ds_read_b64_tr_b16 a[234:235], v223 offset:22528
v_cvt_pk_bf16_f32 v176, v176, v177
v_mfma_f32_16x16x32_bf16 v[128:131], a[252:255], v[32:35], v[128:131]
s_mov_b64 s[80:81], s[86:87]
v_exp_f32 v178, v178
v_mfma_f32_16x16x32_bf16 v[128:131], a[224:227], v[40:43], v[128:131]
ds_read_b64_tr_b16 a[236:237], v230 offset:24576
v_accvgpr_write_b32 a120, v176
v_mfma_f32_16x16x32_bf16 v[136:139], a[252:255], v[36:39], v[136:139]
ds_read_b64_tr_b16 a[238:239], v230 offset:26624
buffer_load_dword v244, v254, s[80:83], s90 offen
v_mfma_f32_16x16x32_bf16 v[136:139], a[224:227], v[44:47], v[136:139]
v_exp_f32 v179, v179
v_mfma_f32_16x16x32_bf16 v[144:147], a[252:255], a[32:35], v[144:147]
ds_read_b64_tr_b16 a[240:241], v230 offset:28672
v_cvt_pk_bf16_f32 v177, v178, v179
v_mfma_f32_16x16x32_bf16 v[144:147], a[224:227], a[40:43], v[144:147]
v_exp_f32 v180, v180
v_mfma_f32_16x16x32_bf16 v[152:155], a[252:255], a[36:39], v[152:155]
s_waitcnt lgkmcnt(3)
v_exp_f32 v181, v181
v_mfma_f32_16x16x32_bf16 v[152:155], a[224:227], a[44:47], v[152:155]
ds_read_b64_tr_b16 a[242:243], v230 offset:30720
v_accvgpr_write_b32 a121, v177
v_mfma_f32_16x16x32_bf16 v[132:135], a[228:231], v[32:35], v[132:135]
ds_read_b64_tr_b16 a[244:245], v223 offset:24576
v_cvt_pk_bf16_f32 v178, v180, v181
v_mfma_f32_16x16x32_bf16 v[132:135], a[232:235], v[40:43], v[132:135]
v_exp_f32 v182, v182
v_mfma_f32_16x16x32_bf16 v[140:143], a[228:231], v[36:39], v[140:143]
ds_read_b64_tr_b16 a[246:247], v223 offset:26624
v_accvgpr_write_b32 a122, v178
v_mfma_f32_16x16x32_bf16 v[140:143], a[232:235], v[44:47], v[140:143]
v_exp_f32 v183, v183
v_mfma_f32_16x16x32_bf16 v[148:151], a[228:231], a[32:35], v[148:151]
ds_read_b64_tr_b16 a[248:249], v223 offset:28672
v_cvt_pk_bf16_f32 v179, v182, v183
v_mfma_f32_16x16x32_bf16 v[148:151], a[232:235], a[40:43], v[148:151]
v_exp_f32 v184, v184
v_mfma_f32_16x16x32_bf16 v[156:159], a[228:231], a[36:39], v[156:159]
s_waitcnt lgkmcnt(3)
v_exp_f32 v185, v185
v_mfma_f32_16x16x32_bf16 v[156:159], a[232:235], a[44:47], v[156:159]
ds_read_b64_tr_b16 a[250:251], v223 offset:30720
v_accvgpr_write_b32 a123, v179
v_mfma_f32_16x16x32_bf16 v[128:131], a[236:239], v[48:51], v[128:131]
v_exp_f32 v186, v186
v_mfma_f32_16x16x32_bf16 v[128:131], a[240:243], v[56:59], v[128:131]
v_exp_f32 v187, v187
v_mfma_f32_16x16x32_bf16 v[136:139], a[236:239], v[52:55], v[136:139]
v_exp_f32 v188, v188
v_mfma_f32_16x16x32_bf16 v[136:139], a[240:243], v[60:63], v[136:139]
v_exp_f32 v189, v189
v_mfma_f32_16x16x32_bf16 v[144:147], a[236:239], a[48:51], v[144:147]
ds_read_b64_tr_b16 a[224:225], v230 offset:32768
v_cvt_pk_bf16_f32 v184, v184, v185
v_mfma_f32_16x16x32_bf16 v[144:147], a[240:243], a[56:59], v[144:147]
v_accvgpr_write_b32 a124, v184
v_cvt_pk_bf16_f32 v185, v186, v187
v_mfma_f32_16x16x32_bf16 v[152:155], a[236:239], a[52:55], v[152:155]
s_waitcnt lgkmcnt(1)
v_exp_f32 v190, v190
v_mfma_f32_16x16x32_bf16 v[152:155], a[240:243], a[60:63], v[152:155]
ds_read_b64_tr_b16 a[226:227], v230 offset:34816
v_accvgpr_write_b32 a125, v185
v_mfma_f32_16x16x32_bf16 v[132:135], a[244:247], v[48:51], v[132:135]
ds_read_b64_tr_b16 a[228:229], v230 offset:36864
v_cvt_pk_bf16_f32 v186, v188, v189
v_mfma_f32_16x16x32_bf16 v[132:135], a[248:251], v[56:59], v[132:135]
v_exp_f32 v191, v191
v_mfma_f32_16x16x32_bf16 v[140:143], a[244:247], v[52:55], v[140:143]
ds_read_b64_tr_b16 a[230:231], v230 offset:38912
v_accvgpr_write_b32 a126, v186
v_mfma_f32_16x16x32_bf16 v[140:143], a[248:251], v[60:63], v[140:143]
v_cvt_pk_bf16_f32 v187, v190, v191
v_accvgpr_write_b32 a127, v187
v_mfma_f32_16x16x32_bf16 v[148:151], a[244:247], a[48:51], v[148:151]
ds_read_b64_tr_b16 a[232:233], v223 offset:32768
v_mfma_f32_16x16x32_bf16 v[148:151], a[248:251], a[56:59], v[148:151]
v_mfma_f32_16x16x32_bf16 v[156:159], a[244:247], a[52:55], v[156:159]
ds_read_b64_tr_b16 a[234:235], v223 offset:34816
v_mfma_f32_16x16x32_bf16 v[156:159], a[248:251], a[60:63], v[156:159]
v_mfma_f32_16x16x32_bf16 v[208:211], v[224:227], v[120:123], v[208:211]
ds_read_b64_tr_b16 a[236:237], v223 offset:36864
v_mfma_f32_16x16x32_bf16 v[212:215], v[224:227], v[124:127], v[212:215]
v_mfma_f32_16x16x32_bf16 v[216:219], v[224:227], a[120:123], v[216:219]
s_waitcnt lgkmcnt(3)
v_mfma_f32_16x16x32_bf16 v[240:243], v[224:227], a[124:127], v[240:243]
ds_read_b64_tr_b16 a[238:239], v223 offset:38912
v_mfma_f32_16x16x32_bf16 v[128:131], a[224:227], v[64:67], v[128:131]
ds_read_b64_tr_b16 a[240:241], v230 offset:40960
v_mfma_f32_16x16x32_bf16 v[128:131], a[228:231], v[72:75], v[128:131]
v_mfma_f32_16x16x32_bf16 v[136:139], a[224:227], v[68:71], v[136:139]
ds_read_b64_tr_b16 a[242:243], v230 offset:43008
v_mfma_f32_16x16x32_bf16 v[136:139], a[228:231], v[76:79], v[136:139]
v_mfma_f32_16x16x32_bf16 v[144:147], a[224:227], a[64:67], v[144:147]
ds_read_b64_tr_b16 a[244:245], v230 offset:45056
v_mov_b32 v245, 0x62800000
v_mov_b32 v252, 131072
v_mfma_f32_16x16x32_bf16 v[144:147], a[228:231], a[72:75], v[144:147]
v_lshl_add_u32 v253, s36, 2, v252
v_add_f32 v248, v208, v212
v_mfma_f32_16x16x32_bf16 v[152:155], a[224:227], a[68:71], v[152:155]
s_waitcnt lgkmcnt(3)
ds_read_b64_tr_b16 a[246:247], v230 offset:47104
v_add_f32 v249, v216, v240
v_mfma_f32_16x16x32_bf16 v[152:155], a[228:231], a[76:79], v[152:155]
v_add_f32 v248, v248, v249
v_cmp_nle_f32 s[48:49], v248, v245
v_mfma_f32_16x16x32_bf16 v[132:135], a[232:235], v[64:67], v[132:135]
ds_read_b64_tr_b16 a[248:249], v223 offset:40960
v_rcp_f32 v246, v208
v_mfma_f32_16x16x32_bf16 v[132:135], a[236:239], v[72:75], v[132:135]
v_rcp_f32 v247, v212
v_mfma_f32_16x16x32_bf16 v[140:143], a[232:235], v[68:71], v[140:143]
ds_read_b64_tr_b16 a[250:251], v223 offset:43008
v_rcp_f32 v220, v216
v_mfma_f32_16x16x32_bf16 v[140:143], a[236:239], v[76:79], v[140:143]
v_rcp_f32 v221, v240
v_mfma_f32_16x16x32_bf16 v[148:151], a[232:235], a[64:67], v[148:151]
ds_read_b64_tr_b16 a[252:253], v223 offset:45056
s_or_b32 s48, s48, s49
v_mfma_f32_16x16x32_bf16 v[148:151], a[236:239], a[72:75], v[148:151]
v_mov_b32 v245, s48
v_mfma_f32_16x16x32_bf16 v[156:159], a[232:235], a[68:71], v[156:159]
s_waitcnt lgkmcnt(3)
ds_read_b64_tr_b16 a[254:255], v223 offset:47104
v_mfma_f32_16x16x32_bf16 v[156:159], a[236:239], a[76:79], v[156:159]
ds_write_b32 v253, v245
v_mfma_f32_16x16x32_bf16 v[128:131], a[240:243], v[80:83], v[128:131]
ds_read_b64_tr_b16 a[224:225], v230 offset:49152
v_mfma_f32_16x16x32_bf16 v[128:131], a[244:247], v[88:91], v[128:131]
v_mfma_f32_16x16x32_bf16 v[136:139], a[240:243], v[84:87], v[136:139]
ds_read_b64_tr_b16 a[226:227], v230 offset:51200
v_mfma_f32_16x16x32_bf16 v[136:139], a[244:247], v[92:95], v[136:139]
v_mfma_f32_16x16x32_bf16 v[144:147], a[240:243], a[80:83], v[144:147]
ds_read_b64_tr_b16 a[228:229], v230 offset:53248
v_mfma_f32_16x16x32_bf16 v[144:147], a[244:247], a[88:91], v[144:147]
v_mfma_f32_16x16x32_bf16 v[152:155], a[240:243], a[84:87], v[152:155]
s_waitcnt vmcnt(2) lgkmcnt(3)
v_mfma_f32_16x16x32_bf16 v[152:155], a[244:247], a[92:95], v[152:155]
ds_read_b64_tr_b16 a[230:231], v230 offset:55296
v_mfma_f32_16x16x32_bf16 v[132:135], a[248:251], v[80:83], v[132:135]
s_barrier
v_mfma_f32_16x16x32_bf16 v[132:135], a[252:255], v[88:91], v[132:135]
ds_read_b64_tr_b16 a[232:233], v223 offset:49152
v_mfma_f32_16x16x32_bf16 v[140:143], a[248:251], v[84:87], v[140:143]
ds_read_b64_tr_b16 a[234:235], v223 offset:51200
v_mfma_f32_16x16x32_bf16 v[140:143], a[252:255], v[92:95], v[140:143]
ds_read_b128 v[248:251], v252
v_mfma_f32_16x16x32_bf16 v[148:151], a[248:251], a[80:83], v[148:151]
ds_read_b64_tr_b16 a[236:237], v223 offset:53248
v_mfma_f32_16x16x32_bf16 v[148:151], a[252:255], a[88:91], v[148:151]
v_mfma_f32_16x16x32_bf16 v[156:159], a[248:251], a[84:87], v[156:159]
s_waitcnt lgkmcnt(4)
v_mfma_f32_16x16x32_bf16 v[156:159], a[252:255], a[92:95], v[156:159]
ds_read_b64_tr_b16 a[238:239], v223 offset:55296
v_mfma_f32_16x16x32_bf16 v[128:131], a[224:227], v[96:99], v[128:131]
ds_read_b64_tr_b16 a[240:241], v230 offset:57344
v_mfma_f32_16x16x32_bf16 v[128:131], a[228:231], v[104:107], v[128:131]
v_mfma_f32_16x16x32_bf16 v[136:139], a[224:227], v[100:103], v[136:139]
ds_read_b64_tr_b16 a[242:243], v230 offset:59392
v_mfma_f32_16x16x32_bf16 v[136:139], a[228:231], v[108:111], v[136:139]
v_mfma_f32_16x16x32_bf16 v[144:147], a[224:227], a[96:99], v[144:147]
ds_read_b64_tr_b16 a[244:245], v230 offset:61440
v_mfma_f32_16x16x32_bf16 v[144:147], a[228:231], a[104:107], v[144:147]
v_mfma_f32_16x16x32_bf16 v[152:155], a[224:227], a[100:103], v[152:155]
s_waitcnt lgkmcnt(3)
v_mfma_f32_16x16x32_bf16 v[152:155], a[228:231], a[108:111], v[152:155]
ds_read_b64_tr_b16 a[246:247], v230 offset:63488
v_mfma_f32_16x16x32_bf16 v[132:135], a[232:235], v[96:99], v[132:135]
L_pg8:
s_cbranch_execz L_pg12
ds_read_b64_tr_b16 a[248:249], v223 offset:57344
v_mfma_f32_16x16x32_bf16 v[132:135], a[236:239], v[104:107], v[132:135]
v_mfma_f32_16x16x32_bf16 v[140:143], a[232:235], v[100:103], v[140:143]
ds_read_b64_tr_b16 a[250:251], v223 offset:59392
v_mfma_f32_16x16x32_bf16 v[140:143], a[236:239], v[108:111], v[140:143]
v_mfma_f32_16x16x32_bf16 v[148:151], a[232:235], a[96:99], v[148:151]
s_mov_b64 s[80:81], s[88:89]
ds_read_b64_tr_b16 a[252:253], v223 offset:61440
v_or3_b32 v248, v248, v249, v250
v_mfma_f32_16x16x32_bf16 v[148:151], a[236:239], a[104:107], v[148:151]
v_or_b32 v248, v248, v251
s_nop 0
v_readfirstlane_b32 s48, v248
v_mfma_f32_16x16x32_bf16 v[156:159], a[232:235], a[100:103], v[156:159]
s_waitcnt lgkmcnt(3)
ds_read_b64_tr_b16 a[254:255], v223 offset:63488
buffer_load_dword v244, v254, s[80:83], s90 offen
v_mfma_f32_16x16x32_bf16 v[156:159], a[236:239], a[108:111], v[156:159]
v_xor_b32 v230, 64, v230
v_xor_b32 v223, 64, v223
v_mfma_f32_16x16x32_bf16 v[128:131], a[240:243], v[112:115], v[128:131]
ds_read_b64_tr_b16 a[224:225], v230 offset:0
v_mfma_f32_16x16x32_bf16 v[128:131], a[244:247], v[120:123], v[128:131]
v_mfma_f32_16x16x32_bf16 v[136:139], a[240:243], v[116:119], v[136:139]
ds_read_b64_tr_b16 a[226:227], v230 offset:2048
v_mfma_f32_16x16x32_bf16 v[136:139], a[244:247], v[124:127], v[136:139]
v_mfma_f32_16x16x32_bf16 v[144:147], a[240:243], a[112:115], v[144:147]
ds_read_b64_tr_b16 a[228:229], v230 offset:4096
v_mfma_f32_16x16x32_bf16 v[144:147], a[244:247], a[120:123], v[144:147]
v_mfma_f32_16x16x32_bf16 v[152:155], a[240:243], a[116:119], v[152:155]
s_waitcnt lgkmcnt(3)
v_mfma_f32_16x16x32_bf16 v[152:155], a[244:247], a[124:127], v[152:155]
ds_read_b64_tr_b16 a[230:231], v230 offset:6144
v_mfma_f32_16x16x32_bf16 v[132:135], a[248:251], v[112:115], v[132:135]
ds_read_b64_tr_b16 a[232:233], v223 offset:0
v_mfma_f32_16x16x32_bf16 v[132:135], a[252:255], v[120:123], v[132:135]
v_mfma_f32_16x16x32_bf16 v[140:143], a[248:251], v[116:119], v[140:143]
ds_read_b64_tr_b16 a[234:235], v223 offset:2048
v_mfma_f32_16x16x32_bf16 v[140:143], a[252:255], v[124:127], v[140:143]
v_mfma_f32_16x16x32_bf16 v[148:151], a[248:251], a[112:115], v[148:151]
ds_read_b64_tr_b16 a[236:237], v223 offset:4096
v_mfma_f32_16x16x32_bf16 v[148:151], a[252:255], a[120:123], v[148:151]
s_andn2_b32 s48, s48, s35
v_mfma_f32_16x16x32_bf16 v[156:159], a[248:251], a[116:119], v[156:159]
s_waitcnt lgkmcnt(3)
v_mfma_f32_16x16x32_bf16 v[156:159], a[252:255], a[124:127], v[156:159]
ds_read_b64_tr_b16 a[238:239], v223 offset:6144
s_cmp_lg_u32 s48, 0
s_cbranch_scc1 L_att_redo
v_mfma_f32_16x16x32_bf16 v[160:163], a[224:227], v[0:3], 0
ds_read_b64_tr_b16 a[240:241], v230 offset:8192
v_mfma_f32_16x16x32_bf16 v[160:163], a[228:231], v[8:11], v[160:163]
v_mfma_f32_16x16x32_bf16 v[168:171], a[224:227], v[4:7], 0
ds_read_b64_tr_b16 a[242:243], v230 offset:10240
v_mfma_f32_16x16x32_bf16 v[168:171], a[228:231], v[12:15], v[168:171]
v_mfma_f32_16x16x32_bf16 v[176:179], a[224:227], a[0:3], 0
s_mov_b32 s31, s33
v_mfma_f32_16x16x32_bf16 v[176:179], a[228:231], a[8:11], v[176:179]
ds_read_b64_tr_b16 a[244:245], v230 offset:12288
v_mfma_f32_16x16x32_bf16 v[184:187], a[224:227], a[4:7], 0
s_waitcnt lgkmcnt(3)
ds_read_b64_tr_b16 a[246:247], v230 offset:14336
v_mul_f32 v128, v246, v128
v_mfma_f32_16x16x32_bf16 v[184:187], a[228:231], a[12:15], v[184:187]
v_mul_f32 v129, v246, v129
v_mul_f32 v130, v246, v130
v_mfma_f32_16x16x32_bf16 v[164:167], a[232:235], v[0:3], 0
ds_read_b64_tr_b16 a[248:249], v223 offset:8192
v_mul_f32 v131, v246, v131
v_mfma_f32_16x16x32_bf16 v[164:167], a[236:239], v[8:11], v[164:167]
v_mul_f32 v132, v246, v132
v_mul_f32 v133, v246, v133
v_mfma_f32_16x16x32_bf16 v[172:175], a[232:235], v[4:7], 0
ds_read_b64_tr_b16 a[250:251], v223 offset:10240
v_mul_f32 v134, v246, v134
v_mfma_f32_16x16x32_bf16 v[172:175], a[236:239], v[12:15], v[172:175]
v_mul_f32 v135, v246, v135
v_cvt_pk_bf16_f32 v128, v128, v129
v_mfma_f32_16x16x32_bf16 v[180:183], a[232:235], a[0:3], 0
ds_read_b64_tr_b16 a[252:253], v223 offset:12288
v_cvt_pk_bf16_f32 v129, v130, v131
v_mfma_f32_16x16x32_bf16 v[180:183], a[236:239], a[8:11], v[180:183]
v_cvt_pk_bf16_f32 v130, v132, v133
v_cvt_pk_bf16_f32 v131, v134, v135
v_mfma_f32_16x16x32_bf16 v[188:191], a[232:235], a[4:7], 0
s_waitcnt lgkmcnt(3)
ds_read_b64_tr_b16 a[254:255], v223 offset:14336
v_mfma_f32_16x16x32_bf16 v[188:191], a[236:239], a[12:15], v[188:191]
buffer_store_dwordx4 v[128:131], v238, s[24:27], s31 offen offset:0 sc1
v_mfma_f32_16x16x32_bf16 v[160:163], a[240:243], v[16:19], v[160:163]
ds_read_b64_tr_b16 a[224:225], v230 offset:16384
v_accvgpr_write_b32 a128, v128
v_mfma_f32_16x16x32_bf16 v[160:163], a[244:247], v[24:27], v[160:163]
v_accvgpr_write_b32 a129, v129
v_accvgpr_write_b32 a130, v130
v_mfma_f32_16x16x32_bf16 v[168:171], a[240:243], v[20:23], v[168:171]
ds_read_b64_tr_b16 a[226:227], v230 offset:18432
v_accvgpr_write_b32 a131, v131
v_mfma_f32_16x16x32_bf16 v[168:171], a[244:247], v[28:31], v[168:171]
v_mul_f32 v136, v247, v136
v_mul_f32 v137, v247, v137
v_mfma_f32_16x16x32_bf16 v[176:179], a[240:243], a[16:19], v[176:179]
ds_read_b64_tr_b16 a[228:229], v230 offset:20480
v_mul_f32 v138, v247, v138
v_mfma_f32_16x16x32_bf16 v[176:179], a[244:247], a[24:27], v[176:179]
v_mul_f32 v139, v247, v139
v_mul_f32 v140, v247, v140
v_mfma_f32_16x16x32_bf16 v[184:187], a[240:243], a[20:23], v[184:187]
s_waitcnt lgkmcnt(3)
ds_read_b64_tr_b16 a[230:231], v230 offset:22528
v_mul_f32 v141, v247, v141
v_mfma_f32_16x16x32_bf16 v[184:187], a[244:247], a[28:31], v[184:187]
v_mul_f32 v142, v247, v142
v_mul_f32 v143, v247, v143
v_mfma_f32_16x16x32_bf16 v[164:167], a[248:251], v[16:19], v[164:167]
ds_read_b64_tr_b16 a[232:233], v223 offset:16384
v_cvt_pk_bf16_f32 v136, v136, v137
v_mfma_f32_16x16x32_bf16 v[164:167], a[252:255], v[24:27], v[164:167]
v_cvt_pk_bf16_f32 v137, v138, v139
v_cvt_pk_bf16_f32 v138, v140, v141
v_mfma_f32_16x16x32_bf16 v[172:175], a[248:251], v[20:23], v[172:175]
ds_read_b64_tr_b16 a[234:235], v223 offset:18432
v_mfma_f32_16x16x32_bf16 v[172:175], a[252:255], v[28:31], v[172:175]
v_cvt_pk_bf16_f32 v139, v142, v143
v_mfma_f32_16x16x32_bf16 v[180:183], a[248:251], a[16:19], v[180:183]
ds_read_b64_tr_b16 a[236:237], v223 offset:20480
v_mfma_f32_16x16x32_bf16 v[180:183], a[252:255], a[24:27], v[180:183]
buffer_store_dwordx4 v[136:139], v238, s[24:27], s31 offen offset:1024 sc1
v_mfma_f32_16x16x32_bf16 v[188:191], a[248:251], a[20:23], v[188:191]
s_waitcnt lgkmcnt(3)
ds_read_b64_tr_b16 a[238:239], v223 offset:22528
v_accvgpr_write_b32 a132, v136
v_mfma_f32_16x16x32_bf16 v[188:191], a[252:255], a[28:31], v[188:191]
v_accvgpr_write_b32 a133, v137
v_accvgpr_write_b32 a134, v138
v_mfma_f32_16x16x32_bf16 v[160:163], a[224:227], v[32:35], v[160:163]
ds_read_b64_tr_b16 a[240:241], v230 offset:24576
v_accvgpr_write_b32 a135, v139
v_mfma_f32_16x16x32_bf16 v[160:163], a[228:231], v[40:43], v[160:163]
v_mul_f32 v144, v220, v144
v_mul_f32 v145, v220, v145
v_mfma_f32_16x16x32_bf16 v[168:171], a[224:227], v[36:39], v[168:171]
ds_read_b64_tr_b16 a[242:243], v230 offset:26624
v_mul_f32 v146, v220, v146
v_mfma_f32_16x16x32_bf16 v[168:171], a[228:231], v[44:47], v[168:171]
v_mul_f32 v147, v220, v147
v_mul_f32 v148, v220, v148
v_mfma_f32_16x16x32_bf16 v[176:179], a[224:227], a[32:35], v[176:179]
ds_read_b64_tr_b16 a[244:245], v230 offset:28672
v_mul_f32 v149, v220, v149
v_mfma_f32_16x16x32_bf16 v[176:179], a[228:231], a[40:43], v[176:179]
v_mul_f32 v150, v220, v150
v_mul_f32 v151, v220, v151
v_mfma_f32_16x16x32_bf16 v[184:187], a[224:227], a[36:39], v[184:187]
s_waitcnt lgkmcnt(3)
ds_read_b64_tr_b16 a[246:247], v230 offset:30720
v_cvt_pk_bf16_f32 v144, v144, v145
v_mfma_f32_16x16x32_bf16 v[184:187], a[228:231], a[44:47], v[184:187]
v_cvt_pk_bf16_f32 v145, v146, v147
v_cvt_pk_bf16_f32 v146, v148, v149
v_mfma_f32_16x16x32_bf16 v[164:167], a[232:235], v[32:35], v[164:167]
ds_read_b64_tr_b16 a[248:249], v223 offset:24576
v_mfma_f32_16x16x32_bf16 v[164:167], a[236:239], v[40:43], v[164:167]
v_cvt_pk_bf16_f32 v147, v150, v151
v_mfma_f32_16x16x32_bf16 v[172:175], a[232:235], v[36:39], v[172:175]
ds_read_b64_tr_b16 a[250:251], v223 offset:26624
v_mfma_f32_16x16x32_bf16 v[172:175], a[236:239], v[44:47], v[172:175]
buffer_store_dwordx4 v[144:147], v238, s[24:27], s31 offen offset:2048 sc1
v_mfma_f32_16x16x32_bf16 v[180:183], a[232:235], a[32:35], v[180:183]
ds_read_b64_tr_b16 a[252:253], v223 offset:28672
v_accvgpr_write_b32 a136, v144
v_mfma_f32_16x16x32_bf16 v[180:183], a[236:239], a[40:43], v[180:183]
v_accvgpr_write_b32 a137, v145
v_accvgpr_write_b32 a138, v146
v_mfma_f32_16x16x32_bf16 v[188:191], a[232:235], a[36:39], v[188:191]
s_waitcnt lgkmcnt(3)
ds_read_b64_tr_b16 a[254:255], v223 offset:30720
v_accvgpr_write_b32 a139, v147
v_mfma_f32_16x16x32_bf16 v[188:191], a[236:239], a[44:47], v[188:191]
v_mul_f32 v152, v221, v152
v_mul_f32 v153, v221, v153
v_mfma_f32_16x16x32_bf16 v[160:163], a[240:243], v[48:51], v[160:163]
ds_read_b64_tr_b16 a[224:225], v230 offset:32768
v_mul_f32 v154, v221, v154
v_mfma_f32_16x16x32_bf16 v[160:163], a[244:247], v[56:59], v[160:163]
v_mul_f32 v155, v221, v155
v_mul_f32 v156, v221, v156
v_mfma_f32_16x16x32_bf16 v[168:171], a[240:243], v[52:55], v[168:171]
ds_read_b64_tr_b16 a[226:227], v230 offset:34816
v_mul_f32 v157, v221, v157
v_mfma_f32_16x16x32_bf16 v[168:171], a[244:247], v[60:63], v[168:171]
v_mul_f32 v158, v221, v158
v_mul_f32 v159, v221, v159
v_mfma_f32_16x16x32_bf16 v[176:179], a[240:243], a[48:51], v[176:179]
ds_read_b64_tr_b16 a[228:229], v230 offset:36864
v_cvt_pk_bf16_f32 v152, v152, v153
v_mfma_f32_16x16x32_bf16 v[176:179], a[244:247], a[56:59], v[176:179]
v_cvt_pk_bf16_f32 v153, v154, v155
v_cvt_pk_bf16_f32 v154, v156, v157
v_mfma_f32_16x16x32_bf16 v[184:187], a[240:243], a[52:55], v[184:187]
s_waitcnt lgkmcnt(3)
ds_read_b64_tr_b16 a[230:231], v230 offset:38912
v_mfma_f32_16x16x32_bf16 v[184:187], a[244:247], a[60:63], v[184:187]
v_cvt_pk_bf16_f32 v155, v158, v159
v_mfma_f32_16x16x32_bf16 v[164:167], a[248:251], v[48:51], v[164:167]
ds_read_b64_tr_b16 a[232:233], v223 offset:32768
v_mfma_f32_16x16x32_bf16 v[164:167], a[252:255], v[56:59], v[164:167]
buffer_store_dwordx4 v[152:155], v238, s[24:27], s31 offen offset:3072 sc1
v_mfma_f32_16x16x32_bf16 v[172:175], a[248:251], v[52:55], v[172:175]
ds_read_b64_tr_b16 a[234:235], v223 offset:34816
v_accvgpr_write_b32 a140, v152
v_mfma_f32_16x16x32_bf16 v[172:175], a[252:255], v[60:63], v[172:175]
v_accvgpr_write_b32 a141, v153
v_accvgpr_write_b32 a142, v154
v_mfma_f32_16x16x32_bf16 v[180:183], a[248:251], a[48:51], v[180:183]
ds_read_b64_tr_b16 a[236:237], v223 offset:36864
v_mfma_f32_16x16x32_bf16 v[180:183], a[252:255], a[56:59], v[180:183]
v_accvgpr_write_b32 a143, v155
v_mfma_f32_16x16x32_bf16 v[188:191], a[248:251], a[52:55], v[188:191]
s_waitcnt lgkmcnt(3)
s_add_u32 s31, s33, 4096
v_mfma_f32_16x16x32_bf16 v[188:191], a[252:255], a[60:63], v[188:191]
ds_read_b64_tr_b16 a[238:239], v223 offset:38912
v_mfma_f32_16x16x32_bf16 v[160:163], a[224:227], v[64:67], v[160:163]
ds_read_b64_tr_b16 a[240:241], v230 offset:40960
v_lshrrev_b32 v192, 4, v238
v_mfma_f32_16x16x32_bf16 v[160:163], a[228:231], v[72:75], v[160:163]
v_bfe_u32 v193, v238, 8, 1
v_lshrrev_b32 v194, 9, v238
v_mfma_f32_16x16x32_bf16 v[168:171], a[224:227], v[68:71], v[168:171]
ds_read_b64_tr_b16 a[242:243], v230 offset:43008
v_bfe_u32 v195, v238, 6, 2
v_mfma_f32_16x16x32_bf16 v[168:171], a[228:231], v[76:79], v[168:171]
v_lshl_add_u32 v195, v194, 2, v195
v_lshl_add_u32 v195, v193, 4, v195
v_mfma_f32_16x16x32_bf16 v[176:179], a[224:227], a[64:67], v[176:179]
ds_read_b64_tr_b16 a[244:245], v230 offset:45056
v_mul_u32_u24 v195, 320, v195
v_mfma_f32_16x16x32_bf16 v[176:179], a[228:231], a[72:75], v[176:179]
v_and_b32 v196, 3, v192
v_lshl_add_u32 v195, v196, 3, v195
v_mfma_f32_16x16x32_bf16 v[184:187], a[224:227], a[68:71], v[184:187]
s_waitcnt lgkmcnt(3)
ds_read_b64_tr_b16 a[246:247], v230 offset:47104
v_lshl_add_u32 v224, v193, 5, v195
v_mfma_f32_16x16x32_bf16 v[184:187], a[228:231], a[76:79], v[184:187]
v_xor_b32 v196, 1, v193
v_lshl_add_u32 v225, v196, 5, v195
v_mfma_f32_16x16x32_bf16 v[164:167], a[232:235], v[64:67], v[164:167]
ds_read_b64_tr_b16 a[248:249], v223 offset:40960
v_lshl_add_u32 v195, v193, 1, v194
v_mfma_f32_16x16x32_bf16 v[164:167], a[236:239], v[72:75], v[164:167]
v_and_b32 v196, 0xf0, v238
v_lshl_add_u32 v242, v195, 8, v196
v_mfma_f32_16x16x32_bf16 v[172:175], a[232:235], v[68:71], v[172:175]
ds_read_b64_tr_b16 a[250:251], v223 offset:43008
v_lshlrev_b32 v255, 3, v238
v_mfma_f32_16x16x32_bf16 v[172:175], a[236:239], v[76:79], v[172:175]
v_min_u32 v195, 1, v192
v_lshlrev_b32 v240, 30, v195
v_mfma_f32_16x16x32_bf16 v[180:183], a[232:235], a[64:67], v[180:183]
ds_read_b64_tr_b16 a[252:253], v223 offset:45056
v_min_u32 v195, 2, v192
v_mfma_f32_16x16x32_bf16 v[180:183], a[236:239], a[72:75], v[180:183]
v_add_u32 v195, s3, v195
v_and_b32 v195, 3, v195
v_mfma_f32_16x16x32_bf16 v[188:191], a[232:235], a[68:71], v[188:191]
s_waitcnt lgkmcnt(3)
ds_read_b64_tr_b16 a[254:255], v223 offset:47104
v_lshl_add_u32 v236, v195, 7, s4
v_mfma_f32_16x16x32_bf16 v[188:191], a[236:239], a[76:79], v[188:191]
v_mov_b32 v193, s36
v_and_b32 v193, 1, v193
v_mfma_f32_16x16x32_bf16 v[160:163], a[240:243], v[80:83], v[160:163]
ds_read_b64_tr_b16 a[224:225], v230 offset:49152
v_lshlrev_b32 v193, 1, v193
v_mfma_f32_16x16x32_bf16 v[160:163], a[244:247], v[88:91], v[160:163]
v_add_u32 v226, 61440, v224
v_add_u32 v227, 61440, v225
v_mfma_f32_16x16x32_bf16 v[168:171], a[240:243], v[84:87], v[168:171]
ds_read_b64_tr_b16 a[226:227], v230 offset:51200
v_add_u32 v228, 122880, v224
v_mfma_f32_16x16x32_bf16 v[168:171], a[244:247], v[92:95], v[168:171]
v_add_u32 v229, 122880, v225
v_add_u32 v195, 0, v192
v_mfma_f32_16x16x32_bf16 v[176:179], a[240:243], a[80:83], v[176:179]
ds_read_b64_tr_b16 a[228:229], v230 offset:53248
v_mul_u32_u24 v196, 3277, v195
v_mfma_f32_16x16x32_bf16 v[176:179], a[244:247], a[88:91], v[176:179]
v_lshrrev_b32 v196, 16, v196
v_mul_u32_u24 v197, 20, v196
v_mfma_f32_16x16x32_bf16 v[184:187], a[240:243], a[84:87], v[184:187]
s_waitcnt lgkmcnt(3)
ds_read_b64_tr_b16 a[230:231], v230 offset:55296
v_sub_u32 v197, v195, v197
v_mfma_f32_16x16x32_bf16 v[184:187], a[244:247], a[92:95], v[184:187]
v_xor_b32 v197, v197, v193
v_mul_u32_u24 v196, 1280, v196
v_mfma_f32_16x16x32_bf16 v[164:167], a[248:251], v[80:83], v[164:167]
ds_read_b64_tr_b16 a[232:233], v223 offset:49152
v_lshl_add_u32 v196, v197, 4, v196
v_mfma_f32_16x16x32_bf16 v[164:167], a[252:255], v[88:91], v[164:167]
v_subrev_u32 v231, 0, v196
v_add_u32 v195, 64, v192
v_mfma_f32_16x16x32_bf16 v[172:175], a[248:251], v[84:87], v[172:175]
ds_read_b64_tr_b16 a[234:235], v223 offset:51200
v_mul_u32_u24 v196, 3277, v195
v_mfma_f32_16x16x32_bf16 v[172:175], a[252:255], v[92:95], v[172:175]
v_lshrrev_b32 v196, 16, v196
v_mul_u32_u24 v197, 20, v196
v_mfma_f32_16x16x32_bf16 v[180:183], a[248:251], a[80:83], v[180:183]
ds_read_b64_tr_b16 a[236:237], v223 offset:53248
v_sub_u32 v197, v195, v197
v_mfma_f32_16x16x32_bf16 v[180:183], a[252:255], a[88:91], v[180:183]
v_xor_b32 v197, v197, v193
v_mul_u32_u24 v196, 1280, v196
v_mfma_f32_16x16x32_bf16 v[188:191], a[248:251], a[84:87], v[188:191]
s_waitcnt lgkmcnt(3)
ds_read_b64_tr_b16 a[238:239], v223 offset:55296
v_lshl_add_u32 v196, v197, 4, v196
v_mfma_f32_16x16x32_bf16 v[188:191], a[252:255], a[92:95], v[188:191]
v_subrev_u32 v232, 1024, v196
v_add_u32 v195, 128, v192
v_mfma_f32_16x16x32_bf16 v[160:163], a[224:227], v[96:99], v[160:163]
ds_read_b64_tr_b16 a[240:241], v230 offset:57344
v_mul_u32_u24 v196, 3277, v195
v_mfma_f32_16x16x32_bf16 v[160:163], a[228:231], v[104:107], v[160:163]
v_lshrrev_b32 v196, 16, v196
v_mul_u32_u24 v197, 20, v196
v_mfma_f32_16x16x32_bf16 v[168:171], a[224:227], v[100:103], v[168:171]
ds_read_b64_tr_b16 a[242:243], v230 offset:59392
v_sub_u32 v197, v195, v197
v_mfma_f32_16x16x32_bf16 v[168:171], a[228:231], v[108:111], v[168:171]
v_xor_b32 v197, v197, v193
v_mul_u32_u24 v196, 1280, v196
v_mfma_f32_16x16x32_bf16 v[176:179], a[224:227], a[96:99], v[176:179]
ds_read_b64_tr_b16 a[244:245], v230 offset:61440
v_lshl_add_u32 v196, v197, 4, v196
v_mfma_f32_16x16x32_bf16 v[176:179], a[228:231], a[104:107], v[176:179]
v_subrev_u32 v233, 2048, v196
v_add_u32 v195, 192, v192
v_mfma_f32_16x16x32_bf16 v[184:187], a[224:227], a[100:103], v[184:187]
s_waitcnt lgkmcnt(3)
ds_read_b64_tr_b16 a[246:247], v230 offset:63488
v_mul_u32_u24 v196, 3277, v195
v_mfma_f32_16x16x32_bf16 v[184:187], a[228:231], a[108:111], v[184:187]
v_lshrrev_b32 v196, 16, v196
v_mul_u32_u24 v197, 20, v196
v_mfma_f32_16x16x32_bf16 v[164:167], a[232:235], v[96:99], v[164:167]
ds_read_b64_tr_b16 a[248:249], v223 offset:57344
v_sub_u32 v197, v195, v197
v_mfma_f32_16x16x32_bf16 v[164:167], a[236:239], v[104:107], v[164:167]
v_xor_b32 v197, v197, v193
v_mul_u32_u24 v196, 1280, v196
v_mfma_f32_16x16x32_bf16 v[172:175], a[232:235], v[100:103], v[172:175]
ds_read_b64_tr_b16 a[250:251], v223 offset:59392
v_lshl_add_u32 v196, v197, 4, v196
v_mfma_f32_16x16x32_bf16 v[172:175], a[236:239], v[108:111], v[172:175]
v_subrev_u32 v234, 3072, v196
v_add_u32 v195, 256, v192
v_mfma_f32_16x16x32_bf16 v[180:183], a[232:235], a[96:99], v[180:183]
ds_read_b64_tr_b16 a[252:253], v223 offset:61440
v_mul_u32_u24 v196, 3277, v195
v_mfma_f32_16x16x32_bf16 v[180:183], a[236:239], a[104:107], v[180:183]
v_lshrrev_b32 v196, 16, v196
v_mul_u32_u24 v197, 20, v196
v_mfma_f32_16x16x32_bf16 v[188:191], a[232:235], a[100:103], v[188:191]
s_waitcnt lgkmcnt(3)
ds_read_b64_tr_b16 a[254:255], v223 offset:63488
v_sub_u32 v197, v195, v197
v_mfma_f32_16x16x32_bf16 v[188:191], a[236:239], a[108:111], v[188:191]
v_xor_b32 v230, 65600, v230
v_xor_b32 v223, 65600, v223
v_mfma_f32_16x16x32_bf16 v[160:163], a[240:243], v[112:115], v[160:163]
ds_read_b64_tr_b16 a[224:225], v230 offset:0
v_xor_b32 v197, v197, v193
v_mfma_f32_16x16x32_bf16 v[160:163], a[244:247], v[120:123], v[160:163]
v_mul_u32_u24 v196, 1280, v196
v_lshl_add_u32 v196, v197, 4, v196
v_mfma_f32_16x16x32_bf16 v[168:171], a[240:243], v[116:119], v[168:171]
ds_read_b64_tr_b16 a[226:227], v230 offset:2048
v_mfma_f32_16x16x32_bf16 v[168:171], a[244:247], v[124:127], v[168:171]
v_subrev_u32 v235, 0, v196
v_mfma_f32_16x16x32_bf16 v[176:179], a[240:243], a[112:115], v[176:179]
ds_read_b64_tr_b16 a[228:229], v230 offset:4096
v_mfma_f32_16x16x32_bf16 v[176:179], a[244:247], a[120:123], v[176:179]
v_mfma_f32_16x16x32_bf16 v[184:187], a[240:243], a[116:119], v[184:187]
s_waitcnt lgkmcnt(3)
v_mfma_f32_16x16x32_bf16 v[184:187], a[244:247], a[124:127], v[184:187]
ds_read_b64_tr_b16 a[230:231], v230 offset:6144
v_mfma_f32_16x16x32_bf16 v[164:167], a[248:251], v[112:115], v[164:167]
ds_read_b64_tr_b16 a[232:233], v223 offset:0
v_mfma_f32_16x16x32_bf16 v[164:167], a[252:255], v[120:123], v[164:167]
v_mfma_f32_16x16x32_bf16 v[172:175], a[248:251], v[116:119], v[172:175]
ds_read_b64_tr_b16 a[234:235], v223 offset:2048
v_mfma_f32_16x16x32_bf16 v[172:175], a[252:255], v[124:127], v[172:175]
v_mfma_f32_16x16x32_bf16 v[180:183], a[248:251], a[112:115], v[180:183]
ds_read_b64_tr_b16 a[236:237], v223 offset:4096
v_mfma_f32_16x16x32_bf16 v[180:183], a[252:255], a[120:123], v[180:183]
v_mfma_f32_16x16x32_bf16 v[188:191], a[248:251], a[116:119], v[188:191]
s_waitcnt lgkmcnt(3)
v_mfma_f32_16x16x32_bf16 v[188:191], a[252:255], a[124:127], v[188:191]
ds_read_b64_tr_b16 a[238:239], v223 offset:6144
v_mfma_f32_16x16x32_bf16 v[128:131], a[224:227], v[0:3], 0
ds_read_b64_tr_b16 a[240:241], v230 offset:8192
v_mfma_f32_16x16x32_bf16 v[128:131], a[228:231], v[8:11], v[128:131]
v_mfma_f32_16x16x32_bf16 v[136:139], a[224:227], v[4:7], 0
ds_read_b64_tr_b16 a[242:243], v230 offset:10240
v_mfma_f32_16x16x32_bf16 v[136:139], a[228:231], v[12:15], v[136:139]
v_mfma_f32_16x16x32_bf16 v[144:147], a[224:227], a[0:3], 0
s_barrier
v_mfma_f32_16x16x32_bf16 v[144:147], a[228:231], a[8:11], v[144:147]
ds_read_b64_tr_b16 a[244:245], v230 offset:12288
v_mfma_f32_16x16x32_bf16 v[152:155], a[224:227], a[4:7], 0
s_waitcnt lgkmcnt(3)
ds_read_b64_tr_b16 a[246:247], v230 offset:14336
v_mul_f32 v160, v246, v160
v_mfma_f32_16x16x32_bf16 v[152:155], a[228:231], a[12:15], v[152:155]
v_mul_f32 v161, v246, v161
v_mul_f32 v162, v246, v162
v_mfma_f32_16x16x32_bf16 v[132:135], a[232:235], v[0:3], 0
s_add_u32 m0, s29, 0
ds_read_b64_tr_b16 a[248:249], v223 offset:8192
v_mul_f32 v163, v246, v163
v_mfma_f32_16x16x32_bf16 v[132:135], a[236:239], v[8:11], v[132:135]
v_mul_f32 v164, v246, v164
v_mul_f32 v165, v246, v165
v_mfma_f32_16x16x32_bf16 v[140:143], a[232:235], v[4:7], 0
s_mov_b32 s30, 256
ds_read_b64_tr_b16 a[250:251], v223 offset:10240
v_mul_f32 v166, v246, v166
v_mfma_f32_16x16x32_bf16 v[140:143], a[236:239], v[12:15], v[140:143]
v_mul_f32 v167, v246, v167
v_cvt_pk_bf16_f32 v160, v160, v161
v_mfma_f32_16x16x32_bf16 v[148:151], a[232:235], a[0:3], 0
ds_read_b64_tr_b16 a[252:253], v223 offset:12288
buffer_load_dwordx4 v237, s[16:19], s30 offen lds
v_mfma_f32_16x16x32_bf16 v[148:151], a[236:239], a[8:11], v[148:151]
v_cvt_pk_bf16_f32 v161, v162, v163
v_cvt_pk_bf16_f32 v162, v164, v165
v_mfma_f32_16x16x32_bf16 v[156:159], a[232:235], a[4:7], 0
s_waitcnt lgkmcnt(3)
ds_read_b64_tr_b16 a[254:255], v223 offset:14336
v_mfma_f32_16x16x32_bf16 v[156:159], a[236:239], a[12:15], v[156:159]
v_cvt_pk_bf16_f32 v163, v166, v167
v_mfma_f32_16x16x32_bf16 v[128:131], a[240:243], v[16:19], v[128:131]
s_add_u32 m0, s29, 4096
ds_read_b64_tr_b16 a[224:225], v230 offset:16384
v_mfma_f32_16x16x32_bf16 v[128:131], a[244:247], v[24:27], v[128:131]
buffer_store_dwordx4 v[160:163], v238, s[24:27], s31 offen offset:0 sc1
v_mfma_f32_16x16x32_bf16 v[136:139], a[240:243], v[20:23], v[136:139]
s_mov_b32 s30, 12544
ds_read_b64_tr_b16 a[226:227], v230 offset:18432
v_accvgpr_write_b32 a144, v160
v_mfma_f32_16x16x32_bf16 v[136:139], a[244:247], v[28:31], v[136:139]
v_accvgpr_write_b32 a145, v161
v_accvgpr_write_b32 a146, v162
v_mfma_f32_16x16x32_bf16 v[144:147], a[240:243], a[16:19], v[144:147]
ds_read_b64_tr_b16 a[228:229], v230 offset:20480
buffer_load_dwordx4 v237, s[16:19], s30 offen lds
v_mfma_f32_16x16x32_bf16 v[144:147], a[244:247], a[24:27], v[144:147]
v_accvgpr_write_b32 a147, v163
v_mul_f32 v168, v247, v168
v_mfma_f32_16x16x32_bf16 v[152:155], a[240:243], a[20:23], v[152:155]
s_waitcnt lgkmcnt(3)
ds_read_b64_tr_b16 a[230:231], v230 offset:22528
v_mul_f32 v169, v247, v169
v_mfma_f32_16x16x32_bf16 v[152:155], a[244:247], a[28:31], v[152:155]
v_mul_f32 v170, v247, v170
v_mul_f32 v171, v247, v171
v_mfma_f32_16x16x32_bf16 v[132:135], a[248:251], v[16:19], v[132:135]
s_add_u32 m0, s29, 8192
ds_read_b64_tr_b16 a[232:233], v223 offset:16384
v_mul_f32 v172, v247, v172
v_mfma_f32_16x16x32_bf16 v[132:135], a[252:255], v[24:27], v[132:135]
v_mul_f32 v173, v247, v173
v_mul_f32 v174, v247, v174
v_mfma_f32_16x16x32_bf16 v[140:143], a[248:251], v[20:23], v[140:143]
s_mov_b32 s30, 24832
ds_read_b64_tr_b16 a[234:235], v223 offset:18432
v_mul_f32 v175, v247, v175
v_mfma_f32_16x16x32_bf16 v[140:143], a[252:255], v[28:31], v[140:143]
v_cvt_pk_bf16_f32 v168, v168, v169
v_cvt_pk_bf16_f32 v169, v170, v171
v_mfma_f32_16x16x32_bf16 v[148:151], a[248:251], a[16:19], v[148:151]
ds_read_b64_tr_b16 a[236:237], v223 offset:20480
buffer_load_dwordx4 v237, s[16:19], s30 offen lds
v_mfma_f32_16x16x32_bf16 v[148:151], a[252:255], a[24:27], v[148:151]
v_cvt_pk_bf16_f32 v170, v172, v173
v_cvt_pk_bf16_f32 v171, v174, v175
v_mfma_f32_16x16x32_bf16 v[156:159], a[248:251], a[20:23], v[156:159]
s_waitcnt lgkmcnt(3)
v_mfma_f32_16x16x32_bf16 v[156:159], a[252:255], a[28:31], v[156:159]
ds_read_b64_tr_b16 a[238:239], v223 offset:22528
v_mfma_f32_16x16x32_bf16 v[128:131], a[224:227], v[32:35], v[128:131]
s_add_u32 m0, s29, 12288
ds_read_b64_tr_b16 a[240:241], v230 offset:24576
v_mfma_f32_16x16x32_bf16 v[128:131], a[228:231], v[40:43], v[128:131]
buffer_store_dwordx4 v[168:171], v238, s[24:27], s31 offen offset:1024 sc1
v_mfma_f32_16x16x32_bf16 v[136:139], a[224:227], v[36:39], v[136:139]
s_mov_b32 s30, 37120
ds_read_b64_tr_b16 a[242:243], v230 offset:26624
v_accvgpr_write_b32 a148, v168
v_mfma_f32_16x16x32_bf16 v[136:139], a[228:231], v[44:47], v[136:139]
v_accvgpr_write_b32 a149, v169
v_accvgpr_write_b32 a150, v170
v_mfma_f32_16x16x32_bf16 v[144:147], a[224:227], a[32:35], v[144:147]
ds_read_b64_tr_b16 a[244:245], v230 offset:28672
buffer_load_dwordx4 v237, s[16:19], s30 offen lds
v_mfma_f32_16x16x32_bf16 v[144:147], a[228:231], a[40:43], v[144:147]
v_accvgpr_write_b32 a151, v171
v_mul_f32 v176, v220, v176
v_mfma_f32_16x16x32_bf16 v[152:155], a[224:227], a[36:39], v[152:155]
s_waitcnt lgkmcnt(3)
ds_read_b64_tr_b16 a[246:247], v230 offset:30720
v_mul_f32 v177, v220, v177
v_mfma_f32_16x16x32_bf16 v[152:155], a[228:231], a[44:47], v[152:155]
v_mul_f32 v178, v220, v178
v_mul_f32 v179, v220, v179
v_mfma_f32_16x16x32_bf16 v[132:135], a[232:235], v[32:35], v[132:135]
s_add_u32 m0, s29, 16384
ds_read_b64_tr_b16 a[248:249], v223 offset:24576
v_mul_f32 v180, v220, v180
v_mfma_f32_16x16x32_bf16 v[132:135], a[236:239], v[40:43], v[132:135]
v_mul_f32 v181, v220, v181
v_mul_f32 v182, v220, v182
v_mfma_f32_16x16x32_bf16 v[140:143], a[232:235], v[36:39], v[140:143]
s_mov_b32 s30, 49408
ds_read_b64_tr_b16 a[250:251], v223 offset:26624
v_mul_f32 v183, v220, v183
v_mfma_f32_16x16x32_bf16 v[140:143], a[236:239], v[44:47], v[140:143]
v_cvt_pk_bf16_f32 v176, v176, v177
v_cvt_pk_bf16_f32 v177, v178, v179
v_mfma_f32_16x16x32_bf16 v[148:151], a[232:235], a[32:35], v[148:151]
ds_read_b64_tr_b16 a[252:253], v223 offset:28672
buffer_load_dwordx4 v237, s[16:19], s30 offen lds
v_mfma_f32_16x16x32_bf16 v[148:151], a[236:239], a[40:43], v[148:151]
v_cvt_pk_bf16_f32 v178, v180, v181
v_cvt_pk_bf16_f32 v179, v182, v183
v_mfma_f32_16x16x32_bf16 v[156:159], a[232:235], a[36:39], v[156:159]
s_waitcnt lgkmcnt(3)
v_mfma_f32_16x16x32_bf16 v[156:159], a[236:239], a[44:47], v[156:159]
ds_read_b64_tr_b16 a[254:255], v223 offset:30720
v_mfma_f32_16x16x32_bf16 v[128:131], a[240:243], v[48:51], v[128:131]
s_add_u32 m0, s29, 20480
ds_read_b64_tr_b16 a[224:225], v230 offset:32768
v_mfma_f32_16x16x32_bf16 v[128:131], a[244:247], v[56:59], v[128:131]
buffer_store_dwordx4 v[176:179], v238, s[24:27], s31 offen offset:2048 sc1
v_mfma_f32_16x16x32_bf16 v[136:139], a[240:243], v[52:55], v[136:139]
s_mov_b32 s30, 61696
ds_read_b64_tr_b16 a[226:227], v230 offset:34816
v_accvgpr_write_b32 a152, v176
v_mfma_f32_16x16x32_bf16 v[136:139], a[244:247], v[60:63], v[136:139]
v_accvgpr_write_b32 a153, v177
v_accvgpr_write_b32 a154, v178
v_mfma_f32_16x16x32_bf16 v[144:147], a[240:243], a[48:51], v[144:147]
ds_read_b64_tr_b16 a[228:229], v230 offset:36864
buffer_load_dwordx4 v237, s[16:19], s30 offen lds
v_mfma_f32_16x16x32_bf16 v[144:147], a[244:247], a[56:59], v[144:147]
v_accvgpr_write_b32 a155, v179
v_mul_f32 v184, v221, v184
v_mfma_f32_16x16x32_bf16 v[152:155], a[240:243], a[52:55], v[152:155]
s_waitcnt lgkmcnt(3)
ds_read_b64_tr_b16 a[230:231], v230 offset:38912
v_mul_f32 v185, v221, v185
v_mfma_f32_16x16x32_bf16 v[152:155], a[244:247], a[60:63], v[152:155]
v_mul_f32 v186, v221, v186
v_mul_f32 v187, v221, v187
v_mfma_f32_16x16x32_bf16 v[132:135], a[248:251], v[48:51], v[132:135]
s_add_u32 m0, s29, 24576
ds_read_b64_tr_b16 a[232:233], v223 offset:32768
v_mul_f32 v188, v221, v188
v_mfma_f32_16x16x32_bf16 v[132:135], a[252:255], v[56:59], v[132:135]
v_mul_f32 v189, v221, v189
v_mul_f32 v190, v221, v190
v_mfma_f32_16x16x32_bf16 v[140:143], a[248:251], v[52:55], v[140:143]
s_mov_b32 s30, 73984
ds_read_b64_tr_b16 a[234:235], v223 offset:34816
v_mul_f32 v191, v221, v191
v_mfma_f32_16x16x32_bf16 v[140:143], a[252:255], v[60:63], v[140:143]
L_pg9:
s_cbranch_execz L_pg13
v_cvt_pk_bf16_f32 v184, v184, v185
v_cvt_pk_bf16_f32 v185, v186, v187
v_mfma_f32_16x16x32_bf16 v[148:151], a[248:251], a[48:51], v[148:151]
ds_read_b64_tr_b16 a[236:237], v223 offset:36864
buffer_load_dwordx4 v237, s[16:19], s30 offen lds
v_mfma_f32_16x16x32_bf16 v[148:151], a[252:255], a[56:59], v[148:151]
v_cvt_pk_bf16_f32 v186, v188, v189
v_cvt_pk_bf16_f32 v187, v190, v191
v_mfma_f32_16x16x32_bf16 v[156:159], a[248:251], a[52:55], v[156:159]
s_waitcnt lgkmcnt(3)
v_mfma_f32_16x16x32_bf16 v[156:159], a[252:255], a[60:63], v[156:159]
ds_read_b64_tr_b16 a[238:239], v223 offset:38912
v_mfma_f32_16x16x32_bf16 v[128:131], a[224:227], v[64:67], v[128:131]
s_add_u32 m0, s29, 28672
ds_read_b64_tr_b16 a[240:241], v230 offset:40960
v_mfma_f32_16x16x32_bf16 v[128:131], a[228:231], v[72:75], v[128:131]
buffer_store_dwordx4 v[184:187], v238, s[24:27], s31 offen offset:3072 sc1
v_mfma_f32_16x16x32_bf16 v[136:139], a[224:227], v[68:71], v[136:139]
s_mov_b32 s30, 86272
ds_read_b64_tr_b16 a[242:243], v230 offset:43008
v_accvgpr_write_b32 a156, v184
v_mfma_f32_16x16x32_bf16 v[136:139], a[228:231], v[76:79], v[136:139]
v_accvgpr_write_b32 a157, v185
v_accvgpr_write_b32 a158, v186
v_mfma_f32_16x16x32_bf16 v[144:147], a[224:227], a[64:67], v[144:147]
ds_read_b64_tr_b16 a[244:245], v230 offset:45056
buffer_load_dwordx4 v237, s[16:19], s30 offen lds
v_mfma_f32_16x16x32_bf16 v[144:147], a[228:231], a[72:75], v[144:147]
v_accvgpr_write_b32 a159, v187
v_mfma_f32_16x16x32_bf16 v[152:155], a[224:227], a[68:71], v[152:155]
s_waitcnt lgkmcnt(3)
s_add_u32 s31, s33, 8192
v_mfma_f32_16x16x32_bf16 v[152:155], a[228:231], a[76:79], v[152:155]
ds_read_b64_tr_b16 a[246:247], v230 offset:47104
v_mfma_f32_16x16x32_bf16 v[132:135], a[232:235], v[64:67], v[132:135]
s_add_u32 m0, s29, 32768
v_mfma_f32_16x16x32_bf16 v[132:135], a[236:239], v[72:75], v[132:135]
ds_read_b64_tr_b16 a[248:249], v223 offset:40960
v_mfma_f32_16x16x32_bf16 v[140:143], a[232:235], v[68:71], v[140:143]
s_mov_b32 s30, 98560
v_mfma_f32_16x16x32_bf16 v[140:143], a[236:239], v[76:79], v[140:143]
ds_read_b64_tr_b16 a[250:251], v223 offset:43008
v_mfma_f32_16x16x32_bf16 v[148:151], a[232:235], a[64:67], v[148:151]
ds_read_b64_tr_b16 a[252:253], v223 offset:45056
v_mfma_f32_16x16x32_bf16 v[148:151], a[236:239], a[72:75], v[148:151]
buffer_load_dwordx4 v237, s[16:19], s30 offen lds
v_mfma_f32_16x16x32_bf16 v[156:159], a[232:235], a[68:71], v[156:159]
s_waitcnt lgkmcnt(3)
v_mfma_f32_16x16x32_bf16 v[156:159], a[236:239], a[76:79], v[156:159]
ds_read_b64_tr_b16 a[254:255], v223 offset:47104
v_mfma_f32_16x16x32_bf16 v[128:131], a[240:243], v[80:83], v[128:131]
s_add_u32 m0, s29, 36864
v_mfma_f32_16x16x32_bf16 v[128:131], a[244:247], v[88:91], v[128:131]
ds_read_b64_tr_b16 a[224:225], v230 offset:49152
v_mfma_f32_16x16x32_bf16 v[136:139], a[240:243], v[84:87], v[136:139]
s_mov_b32 s30, 110848
v_mfma_f32_16x16x32_bf16 v[136:139], a[244:247], v[92:95], v[136:139]
ds_read_b64_tr_b16 a[226:227], v230 offset:51200
v_mfma_f32_16x16x32_bf16 v[144:147], a[240:243], a[80:83], v[144:147]
ds_read_b64_tr_b16 a[228:229], v230 offset:53248
v_mfma_f32_16x16x32_bf16 v[144:147], a[244:247], a[88:91], v[144:147]
buffer_load_dwordx4 v237, s[16:19], s30 offen lds
v_mfma_f32_16x16x32_bf16 v[152:155], a[240:243], a[84:87], v[152:155]
s_waitcnt lgkmcnt(3)
v_mfma_f32_16x16x32_bf16 v[152:155], a[244:247], a[92:95], v[152:155]
ds_read_b64_tr_b16 a[230:231], v230 offset:55296
v_mfma_f32_16x16x32_bf16 v[132:135], a[248:251], v[80:83], v[132:135]
s_add_u32 m0, s29, 40960
v_mfma_f32_16x16x32_bf16 v[132:135], a[252:255], v[88:91], v[132:135]
ds_read_b64_tr_b16 a[232:233], v223 offset:49152
v_mfma_f32_16x16x32_bf16 v[140:143], a[248:251], v[84:87], v[140:143]
s_mov_b32 s30, 123136
v_mfma_f32_16x16x32_bf16 v[140:143], a[252:255], v[92:95], v[140:143]
ds_read_b64_tr_b16 a[234:235], v223 offset:51200
v_mfma_f32_16x16x32_bf16 v[148:151], a[248:251], a[80:83], v[148:151]
ds_read_b64_tr_b16 a[236:237], v223 offset:53248
v_mfma_f32_16x16x32_bf16 v[148:151], a[252:255], a[88:91], v[148:151]
buffer_load_dwordx4 v237, s[16:19], s30 offen lds
v_mfma_f32_16x16x32_bf16 v[156:159], a[248:251], a[84:87], v[156:159]
s_waitcnt lgkmcnt(3)
v_mfma_f32_16x16x32_bf16 v[156:159], a[252:255], a[92:95], v[156:159]
ds_read_b64_tr_b16 a[238:239], v223 offset:55296
v_mfma_f32_16x16x32_bf16 v[128:131], a[224:227], v[96:99], v[128:131]
s_add_u32 m0, s29, 45056
v_mfma_f32_16x16x32_bf16 v[128:131], a[228:231], v[104:107], v[128:131]
ds_read_b64_tr_b16 a[240:241], v230 offset:57344
v_mfma_f32_16x16x32_bf16 v[136:139], a[224:227], v[100:103], v[136:139]
s_mov_b32 s30, 135424
v_mfma_f32_16x16x32_bf16 v[136:139], a[228:231], v[108:111], v[136:139]
ds_read_b64_tr_b16 a[242:243], v230 offset:59392
v_mfma_f32_16x16x32_bf16 v[144:147], a[224:227], a[96:99], v[144:147]
ds_read_b64_tr_b16 a[244:245], v230 offset:61440
v_mfma_f32_16x16x32_bf16 v[144:147], a[228:231], a[104:107], v[144:147]
buffer_load_dwordx4 v237, s[16:19], s30 offen lds
v_mfma_f32_16x16x32_bf16 v[152:155], a[224:227], a[100:103], v[152:155]
s_waitcnt lgkmcnt(3)
v_mfma_f32_16x16x32_bf16 v[152:155], a[228:231], a[108:111], v[152:155]
ds_read_b64_tr_b16 a[246:247], v230 offset:63488
v_mfma_f32_16x16x32_bf16 v[132:135], a[232:235], v[96:99], v[132:135]
s_add_u32 m0, s29, 49152
v_mfma_f32_16x16x32_bf16 v[132:135], a[236:239], v[104:107], v[132:135]
ds_read_b64_tr_b16 a[248:249], v223 offset:57344
v_mfma_f32_16x16x32_bf16 v[140:143], a[232:235], v[100:103], v[140:143]
s_mov_b32 s30, 147712
v_mfma_f32_16x16x32_bf16 v[140:143], a[236:239], v[108:111], v[140:143]
ds_read_b64_tr_b16 a[250:251], v223 offset:59392
v_mfma_f32_16x16x32_bf16 v[148:151], a[232:235], a[96:99], v[148:151]
ds_read_b64_tr_b16 a[252:253], v223 offset:61440
v_mfma_f32_16x16x32_bf16 v[148:151], a[236:239], a[104:107], v[148:151]
buffer_load_dwordx4 v237, s[16:19], s30 offen lds
v_mfma_f32_16x16x32_bf16 v[156:159], a[232:235], a[100:103], v[156:159]
s_waitcnt lgkmcnt(3)
ds_read_b64_tr_b16 a[254:255], v223 offset:63488
v_mfma_f32_16x16x32_bf16 v[156:159], a[236:239], a[108:111], v[156:159]
v_xor_b32 v230, 64, v230
v_xor_b32 v223, 64, v223
v_mfma_f32_16x16x32_bf16 v[128:131], a[240:243], v[112:115], v[128:131]
s_add_u32 m0, s29, 53248
v_mfma_f32_16x16x32_bf16 v[128:131], a[244:247], v[120:123], v[128:131]
ds_read_b64_tr_b16 a[224:225], v230 offset:0
v_mfma_f32_16x16x32_bf16 v[136:139], a[240:243], v[116:119], v[136:139]
s_mov_b32 s30, 160000
v_mfma_f32_16x16x32_bf16 v[136:139], a[244:247], v[124:127], v[136:139]
ds_read_b64_tr_b16 a[226:227], v230 offset:2048
v_mfma_f32_16x16x32_bf16 v[144:147], a[240:243], a[112:115], v[144:147]
ds_read_b64_tr_b16 a[228:229], v230 offset:4096
v_mfma_f32_16x16x32_bf16 v[144:147], a[244:247], a[120:123], v[144:147]
buffer_load_dwordx4 v237, s[16:19], s30 offen lds
v_mfma_f32_16x16x32_bf16 v[152:155], a[240:243], a[116:119], v[152:155]
s_waitcnt lgkmcnt(3)
v_mfma_f32_16x16x32_bf16 v[152:155], a[244:247], a[124:127], v[152:155]
ds_read_b64_tr_b16 a[230:231], v230 offset:6144
v_mfma_f32_16x16x32_bf16 v[132:135], a[248:251], v[112:115], v[132:135]
s_add_u32 m0, s29, 57344
v_mfma_f32_16x16x32_bf16 v[132:135], a[252:255], v[120:123], v[132:135]
ds_read_b64_tr_b16 a[232:233], v223 offset:0
v_mfma_f32_16x16x32_bf16 v[140:143], a[248:251], v[116:119], v[140:143]
s_mov_b32 s30, 172288
v_mfma_f32_16x16x32_bf16 v[140:143], a[252:255], v[124:127], v[140:143]
ds_read_b64_tr_b16 a[234:235], v223 offset:2048
v_mfma_f32_16x16x32_bf16 v[148:151], a[248:251], a[112:115], v[148:151]
ds_read_b64_tr_b16 a[236:237], v223 offset:4096
v_mfma_f32_16x16x32_bf16 v[148:151], a[252:255], a[120:123], v[148:151]
buffer_load_dwordx4 v237, s[16:19], s30 offen lds
v_mfma_f32_16x16x32_bf16 v[156:159], a[248:251], a[116:119], v[156:159]
s_waitcnt lgkmcnt(3)
v_mfma_f32_16x16x32_bf16 v[156:159], a[252:255], a[124:127], v[156:159]
ds_read_b64_tr_b16 a[238:239], v223 offset:6144
v_mfma_f32_16x16x32_bf16 v[160:163], a[224:227], v[0:3], 0
s_add_u32 m0, s29, 61440
v_mfma_f32_16x16x32_bf16 v[160:163], a[228:231], v[8:11], v[160:163]
ds_read_b64_tr_b16 a[240:241], v230 offset:8192
v_mfma_f32_16x16x32_bf16 v[168:171], a[224:227], v[4:7], 0
s_mov_b32 s30, 184576
v_mfma_f32_16x16x32_bf16 v[168:171], a[228:231], v[12:15], v[168:171]
ds_read_b64_tr_b16 a[242:243], v230 offset:10240
v_mfma_f32_16x16x32_bf16 v[176:179], a[224:227], a[0:3], 0
ds_read_b64_tr_b16 a[244:245], v230 offset:12288
v_mfma_f32_16x16x32_bf16 v[176:179], a[228:231], a[8:11], v[176:179]
buffer_load_dwordx4 v237, s[16:19], s30 offen lds
v_mfma_f32_16x16x32_bf16 v[184:187], a[224:227], a[4:7], 0
s_waitcnt lgkmcnt(3)
ds_read_b64_tr_b16 a[246:247], v230 offset:14336
v_mul_f32 v128, v246, v128
v_mfma_f32_16x16x32_bf16 v[184:187], a[228:231], a[12:15], v[184:187]
v_mul_f32 v129, v246, v129
v_mul_f32 v130, v246, v130
v_mfma_f32_16x16x32_bf16 v[164:167], a[232:235], v[0:3], 0
ds_read_b64_tr_b16 a[248:249], v223 offset:8192
v_mul_f32 v131, v246, v131
v_mfma_f32_16x16x32_bf16 v[164:167], a[236:239], v[8:11], v[164:167]
v_mul_f32 v132, v246, v132
v_mul_f32 v133, v246, v133
v_mfma_f32_16x16x32_bf16 v[172:175], a[232:235], v[4:7], 0
ds_read_b64_tr_b16 a[250:251], v223 offset:10240
v_mul_f32 v134, v246, v134
v_mfma_f32_16x16x32_bf16 v[172:175], a[236:239], v[12:15], v[172:175]
v_mul_f32 v135, v246, v135
v_cvt_pk_bf16_f32 v128, v128, v129
v_mfma_f32_16x16x32_bf16 v[180:183], a[232:235], a[0:3], 0
ds_read_b64_tr_b16 a[252:253], v223 offset:12288
v_cvt_pk_bf16_f32 v129, v130, v131
v_mfma_f32_16x16x32_bf16 v[180:183], a[236:239], a[8:11], v[180:183]
v_cvt_pk_bf16_f32 v130, v132, v133
v_cvt_pk_bf16_f32 v131, v134, v135
v_mfma_f32_16x16x32_bf16 v[188:191], a[232:235], a[4:7], 0
s_waitcnt lgkmcnt(3)
ds_read_b64_tr_b16 a[254:255], v223 offset:14336
v_mfma_f32_16x16x32_bf16 v[188:191], a[236:239], a[12:15], v[188:191]
buffer_store_dwordx4 v[128:131], v238, s[24:27], s31 offen offset:0 sc1
v_mfma_f32_16x16x32_bf16 v[160:163], a[240:243], v[16:19], v[160:163]
ds_read_b64_tr_b16 a[224:225], v230 offset:16384
v_accvgpr_write_b32 a160, v128
v_mfma_f32_16x16x32_bf16 v[160:163], a[244:247], v[24:27], v[160:163]
v_accvgpr_write_b32 a161, v129
v_accvgpr_write_b32 a162, v130
v_mfma_f32_16x16x32_bf16 v[168:171], a[240:243], v[20:23], v[168:171]
ds_read_b64_tr_b16 a[226:227], v230 offset:18432
v_accvgpr_write_b32 a163, v131
v_mfma_f32_16x16x32_bf16 v[168:171], a[244:247], v[28:31], v[168:171]
v_mul_f32 v136, v247, v136
v_mul_f32 v137, v247, v137
v_mfma_f32_16x16x32_bf16 v[176:179], a[240:243], a[16:19], v[176:179]
ds_read_b64_tr_b16 a[228:229], v230 offset:20480
v_mul_f32 v138, v247, v138
v_mfma_f32_16x16x32_bf16 v[176:179], a[244:247], a[24:27], v[176:179]
v_mul_f32 v139, v247, v139
v_mul_f32 v140, v247, v140
v_mfma_f32_16x16x32_bf16 v[184:187], a[240:243], a[20:23], v[184:187]
s_waitcnt lgkmcnt(3)
ds_read_b64_tr_b16 a[230:231], v230 offset:22528
v_mul_f32 v141, v247, v141
v_mfma_f32_16x16x32_bf16 v[184:187], a[244:247], a[28:31], v[184:187]
v_mul_f32 v142, v247, v142
v_mul_f32 v143, v247, v143
v_mfma_f32_16x16x32_bf16 v[164:167], a[248:251], v[16:19], v[164:167]
ds_read_b64_tr_b16 a[232:233], v223 offset:16384
v_cvt_pk_bf16_f32 v136, v136, v137
v_mfma_f32_16x16x32_bf16 v[164:167], a[252:255], v[24:27], v[164:167]
v_cvt_pk_bf16_f32 v137, v138, v139
v_cvt_pk_bf16_f32 v138, v140, v141
v_mfma_f32_16x16x32_bf16 v[172:175], a[248:251], v[20:23], v[172:175]
ds_read_b64_tr_b16 a[234:235], v223 offset:18432
v_mfma_f32_16x16x32_bf16 v[172:175], a[252:255], v[28:31], v[172:175]
v_cvt_pk_bf16_f32 v139, v142, v143
v_mfma_f32_16x16x32_bf16 v[180:183], a[248:251], a[16:19], v[180:183]
ds_read_b64_tr_b16 a[236:237], v223 offset:20480
v_mfma_f32_16x16x32_bf16 v[180:183], a[252:255], a[24:27], v[180:183]
buffer_store_dwordx4 v[136:139], v238, s[24:27], s31 offen offset:1024 sc1
v_mfma_f32_16x16x32_bf16 v[188:191], a[248:251], a[20:23], v[188:191]
s_waitcnt lgkmcnt(3)
ds_read_b64_tr_b16 a[238:239], v223 offset:22528
v_accvgpr_write_b32 a164, v136
v_mfma_f32_16x16x32_bf16 v[188:191], a[252:255], a[28:31], v[188:191]
v_accvgpr_write_b32 a165, v137
v_accvgpr_write_b32 a166, v138
v_add_u32_e64 v241, s51, 2
v_mfma_f32_16x16x32_bf16 v[160:163], a[224:227], v[32:35], v[160:163]
ds_read_b64_tr_b16 a[240:241], v230 offset:24576
s_waitcnt vmcnt(11)
buffer_store_dword v241, v240, s[24:27], s34 offen sc1
v_mfma_f32_16x16x32_bf16 v[160:163], a[228:231], v[40:43], v[160:163]
v_accvgpr_write_b32 a167, v139
v_mul_f32 v144, v220, v144
v_mul_f32 v145, v220, v145
v_mfma_f32_16x16x32_bf16 v[168:171], a[224:227], v[36:39], v[168:171]
ds_read_b64_tr_b16 a[242:243], v230 offset:26624
v_mul_f32 v146, v220, v146
v_mfma_f32_16x16x32_bf16 v[168:171], a[228:231], v[44:47], v[168:171]
v_mul_f32 v147, v220, v147
v_mul_f32 v148, v220, v148
v_mfma_f32_16x16x32_bf16 v[176:179], a[224:227], a[32:35], v[176:179]
ds_read_b64_tr_b16 a[244:245], v230 offset:28672
v_mul_f32 v149, v220, v149
v_mfma_f32_16x16x32_bf16 v[176:179], a[228:231], a[40:43], v[176:179]
v_mul_f32 v150, v220, v150
v_mul_f32 v151, v220, v151
v_mfma_f32_16x16x32_bf16 v[184:187], a[224:227], a[36:39], v[184:187]
s_waitcnt lgkmcnt(3)
ds_read_b64_tr_b16 a[246:247], v230 offset:30720
v_cvt_pk_bf16_f32 v144, v144, v145
v_mfma_f32_16x16x32_bf16 v[184:187], a[228:231], a[44:47], v[184:187]
v_cvt_pk_bf16_f32 v145, v146, v147
v_cvt_pk_bf16_f32 v146, v148, v149
v_mfma_f32_16x16x32_bf16 v[164:167], a[232:235], v[32:35], v[164:167]
ds_read_b64_tr_b16 a[248:249], v223 offset:24576
v_mfma_f32_16x16x32_bf16 v[164:167], a[236:239], v[40:43], v[164:167]
v_cvt_pk_bf16_f32 v147, v150, v151
v_mfma_f32_16x16x32_bf16 v[172:175], a[232:235], v[36:39], v[172:175]
ds_read_b64_tr_b16 a[250:251], v223 offset:26624
v_mfma_f32_16x16x32_bf16 v[172:175], a[236:239], v[44:47], v[172:175]
buffer_store_dwordx4 v[144:147], v238, s[24:27], s31 offen offset:2048 sc1
v_mfma_f32_16x16x32_bf16 v[180:183], a[232:235], a[32:35], v[180:183]
ds_read_b64_tr_b16 a[252:253], v223 offset:28672
v_accvgpr_write_b32 a168, v144
v_mfma_f32_16x16x32_bf16 v[180:183], a[236:239], a[40:43], v[180:183]
v_accvgpr_write_b32 a169, v145
v_accvgpr_write_b32 a170, v146
v_mfma_f32_16x16x32_bf16 v[188:191], a[232:235], a[36:39], v[188:191]
s_waitcnt lgkmcnt(3)
ds_read_b64_tr_b16 a[254:255], v223 offset:30720
v_accvgpr_write_b32 a171, v147
v_mfma_f32_16x16x32_bf16 v[188:191], a[236:239], a[44:47], v[188:191]
v_mul_f32 v152, v221, v152
v_mul_f32 v153, v221, v153
v_mfma_f32_16x16x32_bf16 v[160:163], a[240:243], v[48:51], v[160:163]
ds_read_b64_tr_b16 a[224:225], v230 offset:32768
v_mul_f32 v154, v221, v154
v_mfma_f32_16x16x32_bf16 v[160:163], a[244:247], v[56:59], v[160:163]
v_mul_f32 v155, v221, v155
v_mul_f32 v156, v221, v156
v_mfma_f32_16x16x32_bf16 v[168:171], a[240:243], v[52:55], v[168:171]
ds_read_b64_tr_b16 a[226:227], v230 offset:34816
v_mul_f32 v157, v221, v157
v_mfma_f32_16x16x32_bf16 v[168:171], a[244:247], v[60:63], v[168:171]
v_mul_f32 v158, v221, v158
v_mul_f32 v159, v221, v159
v_mfma_f32_16x16x32_bf16 v[176:179], a[240:243], a[48:51], v[176:179]
ds_read_b64_tr_b16 a[228:229], v230 offset:36864
v_cvt_pk_bf16_f32 v152, v152, v153
v_mfma_f32_16x16x32_bf16 v[176:179], a[244:247], a[56:59], v[176:179]
v_cvt_pk_bf16_f32 v153, v154, v155
v_cvt_pk_bf16_f32 v154, v156, v157
v_mfma_f32_16x16x32_bf16 v[184:187], a[240:243], a[52:55], v[184:187]
s_waitcnt lgkmcnt(3)
ds_read_b64_tr_b16 a[230:231], v230 offset:38912
v_mfma_f32_16x16x32_bf16 v[184:187], a[244:247], a[60:63], v[184:187]
v_cvt_pk_bf16_f32 v155, v158, v159
v_mfma_f32_16x16x32_bf16 v[164:167], a[248:251], v[48:51], v[164:167]
ds_read_b64_tr_b16 a[232:233], v223 offset:32768
v_mfma_f32_16x16x32_bf16 v[164:167], a[252:255], v[56:59], v[164:167]
buffer_store_dwordx4 v[152:155], v238, s[24:27], s31 offen offset:3072 sc1
v_mfma_f32_16x16x32_bf16 v[172:175], a[248:251], v[52:55], v[172:175]
ds_read_b64_tr_b16 a[234:235], v223 offset:34816
v_accvgpr_write_b32 a172, v152
v_mfma_f32_16x16x32_bf16 v[172:175], a[252:255], v[60:63], v[172:175]
v_accvgpr_write_b32 a173, v153
v_accvgpr_write_b32 a174, v154
v_mfma_f32_16x16x32_bf16 v[180:183], a[248:251], a[48:51], v[180:183]
ds_read_b64_tr_b16 a[236:237], v223 offset:36864
v_mfma_f32_16x16x32_bf16 v[180:183], a[252:255], a[56:59], v[180:183]
v_accvgpr_write_b32 a175, v155
v_mfma_f32_16x16x32_bf16 v[188:191], a[248:251], a[52:55], v[188:191]
s_waitcnt lgkmcnt(3)
s_add_u32 s31, s33, 12288
v_mfma_f32_16x16x32_bf16 v[188:191], a[252:255], a[60:63], v[188:191]
ds_read_b64_tr_b16 a[238:239], v223 offset:38912
v_mfma_f32_16x16x32_bf16 v[160:163], a[224:227], v[64:67], v[160:163]
ds_read_b64_tr_b16 a[240:241], v230 offset:40960
v_mfma_f32_16x16x32_bf16 v[160:163], a[228:231], v[72:75], v[160:163]
v_mfma_f32_16x16x32_bf16 v[168:171], a[224:227], v[68:71], v[168:171]
ds_read_b64_tr_b16 a[242:243], v230 offset:43008
v_mfma_f32_16x16x32_bf16 v[168:171], a[228:231], v[76:79], v[168:171]
v_mfma_f32_16x16x32_bf16 v[176:179], a[224:227], a[64:67], v[176:179]
s_add_u32 m0, s47, 143360
v_mfma_f32_16x16x32_bf16 v[176:179], a[228:231], a[72:75], v[176:179]
ds_read_b64_tr_b16 a[244:245], v230 offset:45056
v_mfma_f32_16x16x32_bf16 v[184:187], a[224:227], a[68:71], v[184:187]
s_waitcnt lgkmcnt(3)
v_mfma_f32_16x16x32_bf16 v[184:187], a[228:231], a[76:79], v[184:187]
ds_read_b64_tr_b16 a[246:247], v230 offset:47104
v_mfma_f32_16x16x32_bf16 v[164:167], a[232:235], v[64:67], v[164:167]
s_add_u32 s30, s40, 0
v_mfma_f32_16x16x32_bf16 v[164:167], a[236:239], v[72:75], v[164:167]
ds_read_b64_tr_b16 a[248:249], v223 offset:40960
v_mfma_f32_16x16x32_bf16 v[172:175], a[232:235], v[68:71], v[172:175]
ds_read_b64_tr_b16 a[250:251], v223 offset:43008
v_mfma_f32_16x16x32_bf16 v[172:175], a[236:239], v[76:79], v[172:175]
buffer_load_dwordx4 v231, s[52:55], s30 offen offset:0 lds
v_mfma_f32_16x16x32_bf16 v[180:183], a[232:235], a[64:67], v[180:183]
ds_read_b64_tr_b16 a[252:253], v223 offset:45056
v_mfma_f32_16x16x32_bf16 v[180:183], a[236:239], a[72:75], v[180:183]
v_mfma_f32_16x16x32_bf16 v[188:191], a[232:235], a[68:71], v[188:191]
s_waitcnt lgkmcnt(3)
v_mfma_f32_16x16x32_bf16 v[188:191], a[236:239], a[76:79], v[188:191]
ds_read_b64_tr_b16 a[254:255], v223 offset:47104
v_mfma_f32_16x16x32_bf16 v[160:163], a[240:243], v[80:83], v[160:163]
ds_read_b64_tr_b16 a[224:225], v230 offset:49152
v_mfma_f32_16x16x32_bf16 v[160:163], a[244:247], v[88:91], v[160:163]
buffer_load_dwordx4 v232, s[52:55], s30 offen offset:1024 lds
v_mfma_f32_16x16x32_bf16 v[168:171], a[240:243], v[84:87], v[168:171]
ds_read_b64_tr_b16 a[226:227], v230 offset:51200
v_mfma_f32_16x16x32_bf16 v[168:171], a[244:247], v[92:95], v[168:171]
v_mfma_f32_16x16x32_bf16 v[176:179], a[240:243], a[80:83], v[176:179]
ds_read_b64_tr_b16 a[228:229], v230 offset:53248
v_mfma_f32_16x16x32_bf16 v[176:179], a[244:247], a[88:91], v[176:179]
v_mfma_f32_16x16x32_bf16 v[184:187], a[240:243], a[84:87], v[184:187]
s_waitcnt lgkmcnt(3)
ds_read_b64_tr_b16 a[230:231], v230 offset:55296
v_mfma_f32_16x16x32_bf16 v[184:187], a[244:247], a[92:95], v[184:187]
buffer_load_dwordx4 v233, s[52:55], s30 offen offset:2048 lds
v_mfma_f32_16x16x32_bf16 v[164:167], a[248:251], v[80:83], v[164:167]
ds_read_b64_tr_b16 a[232:233], v223 offset:49152
v_mfma_f32_16x16x32_bf16 v[164:167], a[252:255], v[88:91], v[164:167]
v_mfma_f32_16x16x32_bf16 v[172:175], a[248:251], v[84:87], v[172:175]
ds_read_b64_tr_b16 a[234:235], v223 offset:51200
v_mfma_f32_16x16x32_bf16 v[172:175], a[252:255], v[92:95], v[172:175]
v_mfma_f32_16x16x32_bf16 v[180:183], a[248:251], a[80:83], v[180:183]
ds_read_b64_tr_b16 a[236:237], v223 offset:53248
v_mfma_f32_16x16x32_bf16 v[180:183], a[252:255], a[88:91], v[180:183]
buffer_load_dwordx4 v234, s[52:55], s30 offen offset:3072 lds
v_mfma_f32_16x16x32_bf16 v[188:191], a[248:251], a[84:87], v[188:191]
s_waitcnt lgkmcnt(3)
v_mfma_f32_16x16x32_bf16 v[188:191], a[252:255], a[92:95], v[188:191]
ds_read_b64_tr_b16 a[238:239], v223 offset:55296
v_mfma_f32_16x16x32_bf16 v[160:163], a[224:227], v[96:99], v[160:163]
s_add_u32 m0, s47, 147456
v_mfma_f32_16x16x32_bf16 v[160:163], a[228:231], v[104:107], v[160:163]
ds_read_b64_tr_b16 a[240:241], v230 offset:57344
v_mfma_f32_16x16x32_bf16 v[168:171], a[224:227], v[100:103], v[168:171]
ds_read_b64_tr_b16 a[242:243], v230 offset:59392
v_mfma_f32_16x16x32_bf16 v[168:171], a[228:231], v[108:111], v[168:171]
buffer_load_dwordx4 v235, s[52:55], s30 offen offset:0 lds
v_mfma_f32_16x16x32_bf16 v[176:179], a[224:227], a[96:99], v[176:179]
ds_read_b64_tr_b16 a[244:245], v230 offset:61440
v_mfma_f32_16x16x32_bf16 v[176:179], a[228:231], a[104:107], v[176:179]
v_mfma_f32_16x16x32_bf16 v[184:187], a[224:227], a[100:103], v[184:187]
s_waitcnt lgkmcnt(3)
v_mfma_f32_16x16x32_bf16 v[184:187], a[228:231], a[108:111], v[184:187]
ds_read_b64_tr_b16 a[246:247], v230 offset:63488
v_mfma_f32_16x16x32_bf16 v[164:167], a[232:235], v[96:99], v[164:167]
ds_read_b64_tr_b16 a[248:249], v223 offset:57344
v_mfma_f32_16x16x32_bf16 v[164:167], a[236:239], v[104:107], v[164:167]
v_mfma_f32_16x16x32_bf16 v[172:175], a[232:235], v[100:103], v[172:175]
ds_read_b64_tr_b16 a[250:251], v223 offset:59392
v_mfma_f32_16x16x32_bf16 v[172:175], a[236:239], v[108:111], v[172:175]
v_mfma_f32_16x16x32_bf16 v[180:183], a[232:235], a[96:99], v[180:183]
ds_read_b64_tr_b16 a[252:253], v223 offset:61440
v_mfma_f32_16x16x32_bf16 v[180:183], a[236:239], a[104:107], v[180:183]
v_mfma_f32_16x16x32_bf16 v[188:191], a[232:235], a[100:103], v[188:191]
s_waitcnt vmcnt(10) lgkmcnt(3)
ds_read_b64_tr_b16 a[254:255], v223 offset:63488
v_mfma_f32_16x16x32_bf16 v[188:191], a[236:239], a[108:111], v[188:191]
v_xor_b32 v230, 65600, v230
v_xor_b32 v223, 65600, v223
v_mfma_f32_16x16x32_bf16 v[160:163], a[240:243], v[112:115], v[160:163]
s_barrier
v_mfma_f32_16x16x32_bf16 v[160:163], a[244:247], v[120:123], v[160:163]
ds_read_b64_tr_b16 a[224:225], v230 offset:0
v_mfma_f32_16x16x32_bf16 v[168:171], a[240:243], v[116:119], v[168:171]
ds_read_b64_tr_b16 a[226:227], v230 offset:2048
v_mfma_f32_16x16x32_bf16 v[168:171], a[244:247], v[124:127], v[168:171]
v_mfma_f32_16x16x32_bf16 v[176:179], a[240:243], a[112:115], v[176:179]
ds_read_b64_tr_b16 a[228:229], v230 offset:4096
v_mfma_f32_16x16x32_bf16 v[176:179], a[244:247], a[120:123], v[176:179]
v_mfma_f32_16x16x32_bf16 v[184:187], a[240:243], a[116:119], v[184:187]
s_waitcnt lgkmcnt(3)
v_mfma_f32_16x16x32_bf16 v[184:187], a[244:247], a[124:127], v[184:187]
ds_read_b64_tr_b16 a[230:231], v230 offset:6144
v_mfma_f32_16x16x32_bf16 v[164:167], a[248:251], v[112:115], v[164:167]
ds_read_b64_tr_b16 a[232:233], v223 offset:0
v_mfma_f32_16x16x32_bf16 v[164:167], a[252:255], v[120:123], v[164:167]
v_mfma_f32_16x16x32_bf16 v[172:175], a[248:251], v[116:119], v[172:175]
ds_read_b64_tr_b16 a[234:235], v223 offset:2048
v_mfma_f32_16x16x32_bf16 v[172:175], a[252:255], v[124:127], v[172:175]
v_mfma_f32_16x16x32_bf16 v[180:183], a[248:251], a[112:115], v[180:183]
ds_read_b64_tr_b16 a[236:237], v223 offset:4096
v_mfma_f32_16x16x32_bf16 v[180:183], a[252:255], a[120:123], v[180:183]
v_mfma_f32_16x16x32_bf16 v[188:191], a[248:251], a[116:119], v[188:191]
s_waitcnt lgkmcnt(3)
v_mfma_f32_16x16x32_bf16 v[188:191], a[252:255], a[124:127], v[188:191]
ds_read_b64_tr_b16 a[238:239], v223 offset:6144
v_mfma_f32_16x16x32_bf16 v[128:131], a[224:227], v[0:3], 0
ds_read_b64_tr_b16 a[240:241], v230 offset:8192
v_mfma_f32_16x16x32_bf16 v[128:131], a[228:231], v[8:11], v[128:131]
v_mfma_f32_16x16x32_bf16 v[136:139], a[224:227], v[4:7], 0
ds_read_b64_tr_b16 a[242:243], v230 offset:10240
v_mfma_f32_16x16x32_bf16 v[136:139], a[228:231], v[12:15], v[136:139]
v_mfma_f32_16x16x32_bf16 v[144:147], a[224:227], a[0:3], 0
s_barrier
v_mfma_f32_16x16x32_bf16 v[144:147], a[228:231], a[8:11], v[144:147]
ds_read_b64_tr_b16 a[244:245], v230 offset:12288
v_mfma_f32_16x16x32_bf16 v[152:155], a[224:227], a[4:7], 0
s_waitcnt lgkmcnt(3)
ds_read_b64_tr_b16 a[246:247], v230 offset:14336
v_mul_f32 v160, v246, v160
v_mfma_f32_16x16x32_bf16 v[152:155], a[228:231], a[12:15], v[152:155]
v_mul_f32 v161, v246, v161
v_mul_f32 v162, v246, v162
v_mfma_f32_16x16x32_bf16 v[132:135], a[232:235], v[0:3], 0
s_add_u32 m0, s47, 81920
ds_read_b64_tr_b16 a[248:249], v223 offset:8192
v_mul_f32 v163, v246, v163
v_mfma_f32_16x16x32_bf16 v[132:135], a[236:239], v[8:11], v[132:135]
v_mul_f32 v164, v246, v164
v_mul_f32 v165, v246, v165
v_mfma_f32_16x16x32_bf16 v[140:143], a[232:235], v[4:7], 0
s_add_u32 s30, s40, 81920
ds_read_b64_tr_b16 a[250:251], v223 offset:10240
v_mul_f32 v166, v246, v166
v_mfma_f32_16x16x32_bf16 v[140:143], a[236:239], v[12:15], v[140:143]
v_mul_f32 v167, v246, v167
v_cvt_pk_bf16_f32 v160, v160, v161
v_mfma_f32_16x16x32_bf16 v[148:151], a[232:235], a[0:3], 0
ds_read_b64_tr_b16 a[252:253], v223 offset:12288
v_cvt_pk_bf16_f32 v161, v162, v163
v_mfma_f32_16x16x32_bf16 v[148:151], a[236:239], a[8:11], v[148:151]
v_cvt_pk_bf16_f32 v162, v164, v165
v_cvt_pk_bf16_f32 v163, v166, v167
v_mfma_f32_16x16x32_bf16 v[156:159], a[232:235], a[4:7], 0
s_waitcnt lgkmcnt(3)
ds_read_b64_tr_b16 a[254:255], v223 offset:14336
v_mfma_f32_16x16x32_bf16 v[156:159], a[236:239], a[12:15], v[156:159]
buffer_store_dwordx4 v[160:163], v238, s[24:27], s31 offen offset:0 sc1
v_mfma_f32_16x16x32_bf16 v[128:131], a[240:243], v[16:19], v[128:131]
ds_read_b64_tr_b16 a[224:225], v230 offset:16384
v_accvgpr_write_b32 a176, v160
v_mfma_f32_16x16x32_bf16 v[128:131], a[244:247], v[24:27], v[128:131]
v_accvgpr_write_b32 a177, v161
v_accvgpr_write_b32 a178, v162
v_mfma_f32_16x16x32_bf16 v[136:139], a[240:243], v[20:23], v[136:139]
ds_read_b64_tr_b16 a[226:227], v230 offset:18432
buffer_load_dwordx4 v231, s[52:55], s30 offen offset:0 lds
v_accvgpr_write_b32 a179, v163
v_mfma_f32_16x16x32_bf16 v[136:139], a[244:247], v[28:31], v[136:139]
v_mul_f32 v168, v247, v168
v_mul_f32 v169, v247, v169
v_mfma_f32_16x16x32_bf16 v[144:147], a[240:243], a[16:19], v[144:147]
ds_read_b64_tr_b16 a[228:229], v230 offset:20480
v_mul_f32 v170, v247, v170
v_mfma_f32_16x16x32_bf16 v[144:147], a[244:247], a[24:27], v[144:147]
v_mul_f32 v171, v247, v171
v_mul_f32 v172, v247, v172
v_mfma_f32_16x16x32_bf16 v[152:155], a[240:243], a[20:23], v[152:155]
s_waitcnt lgkmcnt(3)
ds_read_b64_tr_b16 a[230:231], v230 offset:22528
v_mul_f32 v173, v247, v173
v_mfma_f32_16x16x32_bf16 v[152:155], a[244:247], a[28:31], v[152:155]
v_mul_f32 v174, v247, v174
v_mul_f32 v175, v247, v175
v_mfma_f32_16x16x32_bf16 v[132:135], a[248:251], v[16:19], v[132:135]
ds_read_b64_tr_b16 a[232:233], v223 offset:16384
buffer_load_dwordx4 v232, s[52:55], s30 offen offset:1024 lds
v_cvt_pk_bf16_f32 v168, v168, v169
v_mfma_f32_16x16x32_bf16 v[132:135], a[252:255], v[24:27], v[132:135]
v_cvt_pk_bf16_f32 v169, v170, v171
v_cvt_pk_bf16_f32 v170, v172, v173
v_mfma_f32_16x16x32_bf16 v[140:143], a[248:251], v[20:23], v[140:143]
ds_read_b64_tr_b16 a[234:235], v223 offset:18432
v_mfma_f32_16x16x32_bf16 v[140:143], a[252:255], v[28:31], v[140:143]
v_cvt_pk_bf16_f32 v171, v174, v175
v_mfma_f32_16x16x32_bf16 v[148:151], a[248:251], a[16:19], v[148:151]
ds_read_b64_tr_b16 a[236:237], v223 offset:20480
v_mfma_f32_16x16x32_bf16 v[148:151], a[252:255], a[24:27], v[148:151]
buffer_store_dwordx4 v[168:171], v238, s[24:27], s31 offen offset:1024 sc1
v_mfma_f32_16x16x32_bf16 v[156:159], a[248:251], a[20:23], v[156:159]
s_waitcnt lgkmcnt(3)
ds_read_b64_tr_b16 a[238:239], v223 offset:22528
v_accvgpr_write_b32 a180, v168
v_mfma_f32_16x16x32_bf16 v[156:159], a[252:255], a[28:31], v[156:159]
v_accvgpr_write_b32 a181, v169
v_accvgpr_write_b32 a182, v170
v_mfma_f32_16x16x32_bf16 v[128:131], a[224:227], v[32:35], v[128:131]
ds_read_b64_tr_b16 a[240:241], v230 offset:24576
buffer_load_dwordx4 v233, s[52:55], s30 offen offset:2048 lds
v_accvgpr_write_b32 a183, v171
v_mfma_f32_16x16x32_bf16 v[128:131], a[228:231], v[40:43], v[128:131]
v_mul_f32 v176, v220, v176
v_mul_f32 v177, v220, v177
v_mfma_f32_16x16x32_bf16 v[136:139], a[224:227], v[36:39], v[136:139]
ds_read_b64_tr_b16 a[242:243], v230 offset:26624
v_mul_f32 v178, v220, v178
v_mfma_f32_16x16x32_bf16 v[136:139], a[228:231], v[44:47], v[136:139]
v_mul_f32 v179, v220, v179
v_mul_f32 v180, v220, v180
v_mfma_f32_16x16x32_bf16 v[144:147], a[224:227], a[32:35], v[144:147]
ds_read_b64_tr_b16 a[244:245], v230 offset:28672
v_mul_f32 v181, v220, v181
v_mfma_f32_16x16x32_bf16 v[144:147], a[228:231], a[40:43], v[144:147]
v_mul_f32 v182, v220, v182
v_mul_f32 v183, v220, v183
v_mfma_f32_16x16x32_bf16 v[152:155], a[224:227], a[36:39], v[152:155]
s_waitcnt lgkmcnt(3)
ds_read_b64_tr_b16 a[246:247], v230 offset:30720
buffer_load_dwordx4 v234, s[52:55], s30 offen offset:3072 lds
v_mfma_f32_16x16x32_bf16 v[152:155], a[228:231], a[44:47], v[152:155]
v_cvt_pk_bf16_f32 v176, v176, v177
v_cvt_pk_bf16_f32 v177, v178, v179
v_cvt_pk_bf16_f32 v178, v180, v181
v_mfma_f32_16x16x32_bf16 v[132:135], a[232:235], v[32:35], v[132:135]
L_pg10:
s_cbranch_execz L_pg14
s_add_u32 m0, s47, 86016
ds_read_b64_tr_b16 a[248:249], v223 offset:24576
v_mfma_f32_16x16x32_bf16 v[132:135], a[236:239], v[40:43], v[132:135]
v_cvt_pk_bf16_f32 v179, v182, v183
v_mfma_f32_16x16x32_bf16 v[140:143], a[232:235], v[36:39], v[140:143]
ds_read_b64_tr_b16 a[250:251], v223 offset:26624
v_mfma_f32_16x16x32_bf16 v[140:143], a[236:239], v[44:47], v[140:143]
buffer_store_dwordx4 v[176:179], v238, s[24:27], s31 offen offset:2048 sc1
v_mfma_f32_16x16x32_bf16 v[148:151], a[232:235], a[32:35], v[148:151]
ds_read_b64_tr_b16 a[252:253], v223 offset:28672
v_accvgpr_write_b32 a184, v176
v_mfma_f32_16x16x32_bf16 v[148:151], a[236:239], a[40:43], v[148:151]
v_accvgpr_write_b32 a185, v177
v_accvgpr_write_b32 a186, v178
v_mfma_f32_16x16x32_bf16 v[156:159], a[232:235], a[36:39], v[156:159]
s_waitcnt lgkmcnt(3)
ds_read_b64_tr_b16 a[254:255], v223 offset:30720
buffer_load_dwordx4 v235, s[52:55], s30 offen offset:0 lds
v_mfma_f32_16x16x32_bf16 v[156:159], a[236:239], a[44:47], v[156:159]
v_accvgpr_write_b32 a187, v179
v_mul_f32 v184, v221, v184
v_mul_f32 v185, v221, v185
v_mfma_f32_16x16x32_bf16 v[128:131], a[240:243], v[48:51], v[128:131]
ds_read_b64_tr_b16 a[224:225], v230 offset:32768
v_mul_f32 v186, v221, v186
v_mfma_f32_16x16x32_bf16 v[128:131], a[244:247], v[56:59], v[128:131]
v_mul_f32 v187, v221, v187
v_mul_f32 v188, v221, v188
v_mfma_f32_16x16x32_bf16 v[136:139], a[240:243], v[52:55], v[136:139]
ds_read_b64_tr_b16 a[226:227], v230 offset:34816
v_mul_f32 v189, v221, v189
v_mfma_f32_16x16x32_bf16 v[136:139], a[244:247], v[60:63], v[136:139]
v_mul_f32 v190, v221, v190
v_mul_f32 v191, v221, v191
v_mfma_f32_16x16x32_bf16 v[144:147], a[240:243], a[48:51], v[144:147]
s_add_u32 m0, s47, 102400
ds_read_b64_tr_b16 a[228:229], v230 offset:36864
v_cvt_pk_bf16_f32 v184, v184, v185
v_mfma_f32_16x16x32_bf16 v[144:147], a[244:247], a[56:59], v[144:147]
v_cvt_pk_bf16_f32 v185, v186, v187
v_cvt_pk_bf16_f32 v186, v188, v189
v_mfma_f32_16x16x32_bf16 v[152:155], a[240:243], a[52:55], v[152:155]
s_waitcnt lgkmcnt(3)
ds_read_b64_tr_b16 a[230:231], v230 offset:38912
v_mfma_f32_16x16x32_bf16 v[152:155], a[244:247], a[60:63], v[152:155]
v_cvt_pk_bf16_f32 v187, v190, v191
v_mfma_f32_16x16x32_bf16 v[132:135], a[248:251], v[48:51], v[132:135]
s_add_u32 s30, s40, 163840
ds_read_b64_tr_b16 a[232:233], v223 offset:32768
v_mfma_f32_16x16x32_bf16 v[132:135], a[252:255], v[56:59], v[132:135]
buffer_store_dwordx4 v[184:187], v238, s[24:27], s31 offen offset:3072 sc1
v_mfma_f32_16x16x32_bf16 v[140:143], a[248:251], v[52:55], v[140:143]
ds_read_b64_tr_b16 a[234:235], v223 offset:34816
v_accvgpr_write_b32 a188, v184
v_mfma_f32_16x16x32_bf16 v[140:143], a[252:255], v[60:63], v[140:143]
v_accvgpr_write_b32 a189, v185
v_accvgpr_write_b32 a190, v186
v_mfma_f32_16x16x32_bf16 v[148:151], a[248:251], a[48:51], v[148:151]
ds_read_b64_tr_b16 a[236:237], v223 offset:36864
buffer_load_dword v239, v236, s[24:27], 0 offen sc1
v_mfma_f32_16x16x32_bf16 v[148:151], a[252:255], a[56:59], v[148:151]
v_accvgpr_write_b32 a191, v187
v_mfma_f32_16x16x32_bf16 v[156:159], a[248:251], a[52:55], v[156:159]
s_waitcnt lgkmcnt(3)
s_add_u32 s31, s33, 16384
v_mfma_f32_16x16x32_bf16 v[156:159], a[252:255], a[60:63], v[156:159]
ds_read_b64_tr_b16 a[238:239], v223 offset:38912
v_mfma_f32_16x16x32_bf16 v[128:131], a[224:227], v[64:67], v[128:131]
ds_read_b64_tr_b16 a[240:241], v230 offset:40960
v_mfma_f32_16x16x32_bf16 v[128:131], a[228:231], v[72:75], v[128:131]
buffer_load_dwordx4 v231, s[52:55], s30 offen offset:0 lds
v_mfma_f32_16x16x32_bf16 v[136:139], a[224:227], v[68:71], v[136:139]
ds_read_b64_tr_b16 a[242:243], v230 offset:43008
v_mfma_f32_16x16x32_bf16 v[136:139], a[228:231], v[76:79], v[136:139]
v_mfma_f32_16x16x32_bf16 v[144:147], a[224:227], a[64:67], v[144:147]
ds_read_b64_tr_b16 a[244:245], v230 offset:45056
v_mfma_f32_16x16x32_bf16 v[144:147], a[228:231], a[72:75], v[144:147]
v_mfma_f32_16x16x32_bf16 v[152:155], a[224:227], a[68:71], v[152:155]
s_waitcnt lgkmcnt(3)
ds_read_b64_tr_b16 a[246:247], v230 offset:47104
v_mfma_f32_16x16x32_bf16 v[152:155], a[228:231], a[76:79], v[152:155]
buffer_load_dwordx4 v232, s[52:55], s30 offen offset:1024 lds
v_mfma_f32_16x16x32_bf16 v[132:135], a[232:235], v[64:67], v[132:135]
ds_read_b64_tr_b16 a[248:249], v223 offset:40960
v_mfma_f32_16x16x32_bf16 v[132:135], a[236:239], v[72:75], v[132:135]
v_mfma_f32_16x16x32_bf16 v[140:143], a[232:235], v[68:71], v[140:143]
ds_read_b64_tr_b16 a[250:251], v223 offset:43008
v_mfma_f32_16x16x32_bf16 v[140:143], a[236:239], v[76:79], v[140:143]
v_mfma_f32_16x16x32_bf16 v[148:151], a[232:235], a[64:67], v[148:151]
ds_read_b64_tr_b16 a[252:253], v223 offset:45056
v_mfma_f32_16x16x32_bf16 v[148:151], a[236:239], a[72:75], v[148:151]
buffer_load_dwordx4 v233, s[52:55], s30 offen offset:2048 lds
v_mfma_f32_16x16x32_bf16 v[156:159], a[232:235], a[68:71], v[156:159]
s_waitcnt lgkmcnt(3)
v_mfma_f32_16x16x32_bf16 v[156:159], a[236:239], a[76:79], v[156:159]
ds_read_b64_tr_b16 a[254:255], v223 offset:47104
v_mfma_f32_16x16x32_bf16 v[128:131], a[240:243], v[80:83], v[128:131]
ds_read_b64_tr_b16 a[224:225], v230 offset:49152
v_mfma_f32_16x16x32_bf16 v[128:131], a[244:247], v[88:91], v[128:131]
v_mfma_f32_16x16x32_bf16 v[136:139], a[240:243], v[84:87], v[136:139]
ds_read_b64_tr_b16 a[226:227], v230 offset:51200
v_mfma_f32_16x16x32_bf16 v[136:139], a[244:247], v[92:95], v[136:139]
buffer_load_dwordx4 v234, s[52:55], s30 offen offset:3072 lds
v_mfma_f32_16x16x32_bf16 v[144:147], a[240:243], a[80:83], v[144:147]
s_add_u32 m0, s47, 106496
v_mfma_f32_16x16x32_bf16 v[144:147], a[244:247], a[88:91], v[144:147]
ds_read_b64_tr_b16 a[228:229], v230 offset:53248
v_mfma_f32_16x16x32_bf16 v[152:155], a[240:243], a[84:87], v[152:155]
s_waitcnt lgkmcnt(3)
v_mfma_f32_16x16x32_bf16 v[152:155], a[244:247], a[92:95], v[152:155]
ds_read_b64_tr_b16 a[230:231], v230 offset:55296
v_mfma_f32_16x16x32_bf16 v[132:135], a[248:251], v[80:83], v[132:135]
ds_read_b64_tr_b16 a[232:233], v223 offset:49152
v_mfma_f32_16x16x32_bf16 v[132:135], a[252:255], v[88:91], v[132:135]
buffer_load_dwordx4 v235, s[52:55], s30 offen offset:0 lds
v_mfma_f32_16x16x32_bf16 v[140:143], a[248:251], v[84:87], v[140:143]
ds_read_b64_tr_b16 a[234:235], v223 offset:51200
v_mfma_f32_16x16x32_bf16 v[140:143], a[252:255], v[92:95], v[140:143]
v_mfma_f32_16x16x32_bf16 v[148:151], a[248:251], a[80:83], v[148:151]
ds_read_b64_tr_b16 a[236:237], v223 offset:53248
v_mfma_f32_16x16x32_bf16 v[148:151], a[252:255], a[88:91], v[148:151]
v_mfma_f32_16x16x32_bf16 v[156:159], a[248:251], a[84:87], v[156:159]
s_waitcnt lgkmcnt(3)
v_mfma_f32_16x16x32_bf16 v[156:159], a[252:255], a[92:95], v[156:159]
ds_read_b64_tr_b16 a[238:239], v223 offset:55296
v_mfma_f32_16x16x32_bf16 v[128:131], a[224:227], v[96:99], v[128:131]
s_add_u32 m0, s47, 122880
v_mfma_f32_16x16x32_bf16 v[128:131], a[228:231], v[104:107], v[128:131]
ds_read_b64_tr_b16 a[240:241], v230 offset:57344
v_mfma_f32_16x16x32_bf16 v[136:139], a[224:227], v[100:103], v[136:139]
s_add_u32 s30, s41, 0
v_mfma_f32_16x16x32_bf16 v[136:139], a[228:231], v[108:111], v[136:139]
ds_read_b64_tr_b16 a[242:243], v230 offset:59392
v_mfma_f32_16x16x32_bf16 v[144:147], a[224:227], a[96:99], v[144:147]
ds_read_b64_tr_b16 a[244:245], v230 offset:61440
v_mfma_f32_16x16x32_bf16 v[144:147], a[228:231], a[104:107], v[144:147]
buffer_load_dwordx4 v231, s[52:55], s30 offen offset:0 lds
v_mfma_f32_16x16x32_bf16 v[152:155], a[224:227], a[100:103], v[152:155]
s_waitcnt lgkmcnt(3)
v_mfma_f32_16x16x32_bf16 v[152:155], a[228:231], a[108:111], v[152:155]
ds_read_b64_tr_b16 a[246:247], v230 offset:63488
v_mfma_f32_16x16x32_bf16 v[132:135], a[232:235], v[96:99], v[132:135]
ds_read_b64_tr_b16 a[248:249], v223 offset:57344
v_mfma_f32_16x16x32_bf16 v[132:135], a[236:239], v[104:107], v[132:135]
v_mfma_f32_16x16x32_bf16 v[140:143], a[232:235], v[100:103], v[140:143]
ds_read_b64_tr_b16 a[250:251], v223 offset:59392
v_mfma_f32_16x16x32_bf16 v[140:143], a[236:239], v[108:111], v[140:143]
buffer_load_dwordx4 v232, s[52:55], s30 offen offset:1024 lds
v_mfma_f32_16x16x32_bf16 v[148:151], a[232:235], a[96:99], v[148:151]
ds_read_b64_tr_b16 a[252:253], v223 offset:61440
v_mfma_f32_16x16x32_bf16 v[148:151], a[236:239], a[104:107], v[148:151]
v_mfma_f32_16x16x32_bf16 v[156:159], a[232:235], a[100:103], v[156:159]
s_waitcnt lgkmcnt(3)
ds_read_b64_tr_b16 a[254:255], v223 offset:63488
v_mfma_f32_16x16x32_bf16 v[156:159], a[236:239], a[108:111], v[156:159]
v_xor_b32 v230, 64, v230
v_xor_b32 v223, 64, v223
v_mfma_f32_16x16x32_bf16 v[128:131], a[240:243], v[112:115], v[128:131]
ds_read_b64_tr_b16 a[224:225], v230 offset:0
v_mfma_f32_16x16x32_bf16 v[128:131], a[244:247], v[120:123], v[128:131]
buffer_load_dwordx4 v233, s[52:55], s30 offen offset:2048 lds
v_mfma_f32_16x16x32_bf16 v[136:139], a[240:243], v[116:119], v[136:139]
ds_read_b64_tr_b16 a[226:227], v230 offset:2048
v_mfma_f32_16x16x32_bf16 v[136:139], a[244:247], v[124:127], v[136:139]
v_mfma_f32_16x16x32_bf16 v[144:147], a[240:243], a[112:115], v[144:147]
ds_read_b64_tr_b16 a[228:229], v230 offset:4096
v_mfma_f32_16x16x32_bf16 v[144:147], a[244:247], a[120:123], v[144:147]
v_mfma_f32_16x16x32_bf16 v[152:155], a[240:243], a[116:119], v[152:155]
s_waitcnt lgkmcnt(3)
ds_read_b64_tr_b16 a[230:231], v230 offset:6144
v_mfma_f32_16x16x32_bf16 v[152:155], a[244:247], a[124:127], v[152:155]
buffer_load_dwordx4 v234, s[52:55], s30 offen offset:3072 lds
v_mfma_f32_16x16x32_bf16 v[132:135], a[248:251], v[112:115], v[132:135]
s_add_u32 m0, s47, 126976
v_mfma_f32_16x16x32_bf16 v[132:135], a[252:255], v[120:123], v[132:135]
ds_read_b64_tr_b16 a[232:233], v223 offset:0
v_mfma_f32_16x16x32_bf16 v[140:143], a[248:251], v[116:119], v[140:143]
ds_read_b64_tr_b16 a[234:235], v223 offset:2048
v_mfma_f32_16x16x32_bf16 v[140:143], a[252:255], v[124:127], v[140:143]
v_mfma_f32_16x16x32_bf16 v[148:151], a[248:251], a[112:115], v[148:151]
ds_read_b64_tr_b16 a[236:237], v223 offset:4096
v_mfma_f32_16x16x32_bf16 v[148:151], a[252:255], a[120:123], v[148:151]
buffer_load_dwordx4 v235, s[52:55], s30 offen offset:0 lds
v_mfma_f32_16x16x32_bf16 v[156:159], a[248:251], a[116:119], v[156:159]
s_waitcnt lgkmcnt(3)
v_mfma_f32_16x16x32_bf16 v[156:159], a[252:255], a[124:127], v[156:159]
ds_read_b64_tr_b16 a[238:239], v223 offset:6144
v_mfma_f32_16x16x32_bf16 v[160:163], a[224:227], v[0:3], 0
ds_read_b64_tr_b16 a[240:241], v230 offset:8192
v_mfma_f32_16x16x32_bf16 v[160:163], a[228:231], v[8:11], v[160:163]
v_mfma_f32_16x16x32_bf16 v[168:171], a[224:227], v[4:7], 0
ds_read_b64_tr_b16 a[242:243], v230 offset:10240
v_mfma_f32_16x16x32_bf16 v[168:171], a[228:231], v[12:15], v[168:171]
v_mfma_f32_16x16x32_bf16 v[176:179], a[224:227], a[0:3], 0
ds_read_b64_tr_b16 a[244:245], v230 offset:12288
v_mfma_f32_16x16x32_bf16 v[176:179], a[228:231], a[8:11], v[176:179]
s_waitcnt vmcnt(10)
v_subrev_u32 v239, s51, v239
v_mfma_f32_16x16x32_bf16 v[184:187], a[224:227], a[4:7], 0
s_waitcnt lgkmcnt(3)
ds_read_b64_tr_b16 a[246:247], v230 offset:14336
v_mul_f32 v128, v246, v128
v_mfma_f32_16x16x32_bf16 v[184:187], a[228:231], a[12:15], v[184:187]
v_mul_f32 v129, v246, v129
v_mul_f32 v130, v246, v130
v_mfma_f32_16x16x32_bf16 v[164:167], a[232:235], v[0:3], 0
ds_read_b64_tr_b16 a[248:249], v223 offset:8192
v_mul_f32 v131, v246, v131
v_mul_f32 v132, v246, v132
v_mfma_f32_16x16x32_bf16 v[164:167], a[236:239], v[8:11], v[164:167]
v_mul_f32 v133, v246, v133
v_cmp_lt_u32 vcc, 2, v239
v_mfma_f32_16x16x32_bf16 v[172:175], a[232:235], v[4:7], 0
ds_read_b64_tr_b16 a[250:251], v223 offset:10240
v_mul_f32 v134, v246, v134
v_mfma_f32_16x16x32_bf16 v[172:175], a[236:239], v[12:15], v[172:175]
v_mul_f32 v135, v246, v135
v_cvt_pk_bf16_f32 v128, v128, v129
v_mfma_f32_16x16x32_bf16 v[180:183], a[232:235], a[0:3], 0
ds_read_b64_tr_b16 a[252:253], v223 offset:12288
v_cvt_pk_bf16_f32 v129, v130, v131
v_mfma_f32_16x16x32_bf16 v[180:183], a[236:239], a[8:11], v[180:183]
v_cvt_pk_bf16_f32 v130, v132, v133
v_cvt_pk_bf16_f32 v131, v134, v135
v_mfma_f32_16x16x32_bf16 v[188:191], a[232:235], a[4:7], 0
s_waitcnt lgkmcnt(3)
ds_read_b64_tr_b16 a[254:255], v223 offset:14336
v_mfma_f32_16x16x32_bf16 v[188:191], a[236:239], a[12:15], v[188:191]
buffer_store_dwordx4 v[128:131], v238, s[24:27], s31 offen offset:0 sc1
s_cbranch_vccnz L_slow_o1
L_back_o1:
v_mfma_f32_16x16x32_bf16 v[160:163], a[240:243], v[16:19], v[160:163]
ds_read_b64_tr_b16 a[224:225], v230 offset:16384
v_accvgpr_write_b32 a192, v128
v_mfma_f32_16x16x32_bf16 v[160:163], a[244:247], v[24:27], v[160:163]
v_accvgpr_write_b32 a193, v129
v_accvgpr_write_b32 a194, v130
v_mfma_f32_16x16x32_bf16 v[168:171], a[240:243], v[20:23], v[168:171]
s_add_u32 s32, s44, 0
ds_read_b64_tr_b16 a[226:227], v230 offset:18432
v_accvgpr_write_b32 a195, v131
v_mfma_f32_16x16x32_bf16 v[168:171], a[244:247], v[28:31], v[168:171]
v_mul_f32 v136, v247, v136
v_mul_f32 v137, v247, v137
v_mfma_f32_16x16x32_bf16 v[176:179], a[240:243], a[16:19], v[176:179]
ds_read_b64_tr_b16 a[228:229], v230 offset:20480
buffer_load_dwordx4 a[0:3], v238, s[24:27], s32 offen offset:0 sc1
v_mul_f32 v138, v247, v138
v_mfma_f32_16x16x32_bf16 v[176:179], a[244:247], a[24:27], v[176:179]
v_mul_f32 v139, v247, v139
v_mul_f32 v140, v247, v140
v_mfma_f32_16x16x32_bf16 v[184:187], a[240:243], a[20:23], v[184:187]
s_waitcnt lgkmcnt(3)
ds_read_b64_tr_b16 a[230:231], v230 offset:22528
v_mul_f32 v141, v247, v141
v_mfma_f32_16x16x32_bf16 v[184:187], a[244:247], a[28:31], v[184:187]
v_mul_f32 v142, v247, v142
v_mul_f32 v143, v247, v143
v_mfma_f32_16x16x32_bf16 v[164:167], a[248:251], v[16:19], v[164:167]
ds_read_b64_tr_b16 a[232:233], v223 offset:16384
v_cvt_pk_bf16_f32 v136, v136, v137
v_mfma_f32_16x16x32_bf16 v[164:167], a[252:255], v[24:27], v[164:167]
v_cvt_pk_bf16_f32 v137, v138, v139
v_cvt_pk_bf16_f32 v138, v140, v141
v_mfma_f32_16x16x32_bf16 v[172:175], a[248:251], v[20:23], v[172:175]
ds_read_b64_tr_b16 a[234:235], v223 offset:18432
v_mfma_f32_16x16x32_bf16 v[172:175], a[252:255], v[28:31], v[172:175]
v_cvt_pk_bf16_f32 v139, v142, v143
v_mfma_f32_16x16x32_bf16 v[180:183], a[248:251], a[16:19], v[180:183]
ds_read_b64_tr_b16 a[236:237], v223 offset:20480
v_mfma_f32_16x16x32_bf16 v[180:183], a[252:255], a[24:27], v[180:183]
buffer_store_dwordx4 v[136:139], v238, s[24:27], s31 offen offset:1024 sc1
v_mfma_f32_16x16x32_bf16 v[188:191], a[248:251], a[20:23], v[188:191]
s_waitcnt lgkmcnt(3)
ds_read_b64_tr_b16 a[238:239], v223 offset:22528
v_accvgpr_write_b32 a196, v136
v_mfma_f32_16x16x32_bf16 v[188:191], a[252:255], a[28:31], v[188:191]
v_accvgpr_write_b32 a197, v137
v_accvgpr_write_b32 a198, v138
v_mfma_f32_16x16x32_bf16 v[160:163], a[224:227], v[32:35], v[160:163]
ds_read_b64_tr_b16 a[240:241], v230 offset:24576
buffer_load_dwordx4 a[4:7], v238, s[24:27], s32 offen offset:1024 sc1
v_accvgpr_write_b32 a199, v139
v_mfma_f32_16x16x32_bf16 v[160:163], a[228:231], v[40:43], v[160:163]
v_mul_f32 v144, v220, v144
v_mul_f32 v145, v220, v145
v_mfma_f32_16x16x32_bf16 v[168:171], a[224:227], v[36:39], v[168:171]
ds_read_b64_tr_b16 a[242:243], v230 offset:26624
v_mul_f32 v146, v220, v146
v_mfma_f32_16x16x32_bf16 v[168:171], a[228:231], v[44:47], v[168:171]
v_mul_f32 v147, v220, v147
v_mul_f32 v148, v220, v148
v_mfma_f32_16x16x32_bf16 v[176:179], a[224:227], a[32:35], v[176:179]
ds_read_b64_tr_b16 a[244:245], v230 offset:28672
v_mul_f32 v149, v220, v149
v_mfma_f32_16x16x32_bf16 v[176:179], a[228:231], a[40:43], v[176:179]
v_mul_f32 v150, v220, v150
v_mul_f32 v151, v220, v151
v_mfma_f32_16x16x32_bf16 v[184:187], a[224:227], a[36:39], v[184:187]
s_waitcnt lgkmcnt(3)
ds_read_b64_tr_b16 a[246:247], v230 offset:30720
v_cvt_pk_bf16_f32 v144, v144, v145
v_mfma_f32_16x16x32_bf16 v[184:187], a[228:231], a[44:47], v[184:187]
v_cvt_pk_bf16_f32 v145, v146, v147
v_cvt_pk_bf16_f32 v146, v148, v149
v_mfma_f32_16x16x32_bf16 v[164:167], a[232:235], v[32:35], v[164:167]
s_add_u32 s32, s44, 0
ds_read_b64_tr_b16 a[248:249], v223 offset:24576
v_mfma_f32_16x16x32_bf16 v[164:167], a[236:239], v[40:43], v[164:167]
v_cvt_pk_bf16_f32 v147, v150, v151
v_mfma_f32_16x16x32_bf16 v[172:175], a[232:235], v[36:39], v[172:175]
ds_read_b64_tr_b16 a[250:251], v223 offset:26624
v_mfma_f32_16x16x32_bf16 v[172:175], a[236:239], v[44:47], v[172:175]
buffer_store_dwordx4 v[144:147], v238, s[24:27], s31 offen offset:2048 sc1
v_mfma_f32_16x16x32_bf16 v[180:183], a[232:235], a[32:35], v[180:183]
ds_read_b64_tr_b16 a[252:253], v223 offset:28672
v_accvgpr_write_b32 a200, v144
v_mfma_f32_16x16x32_bf16 v[180:183], a[236:239], a[40:43], v[180:183]
v_accvgpr_write_b32 a201, v145
v_accvgpr_write_b32 a202, v146
v_mfma_f32_16x16x32_bf16 v[188:191], a[232:235], a[36:39], v[188:191]
s_waitcnt lgkmcnt(3)
ds_read_b64_tr_b16 a[254:255], v223 offset:30720
buffer_load_dwordx4 a[8:11], v238, s[24:27], s32 offen offset:2048 sc1
v_mfma_f32_16x16x32_bf16 v[188:191], a[236:239], a[44:47], v[188:191]
v_accvgpr_write_b32 a203, v147
v_mul_f32 v152, v221, v152
v_mul_f32 v153, v221, v153
v_mfma_f32_16x16x32_bf16 v[160:163], a[240:243], v[48:51], v[160:163]
ds_read_b64_tr_b16 a[224:225], v230 offset:32768
v_mul_f32 v154, v221, v154
v_mfma_f32_16x16x32_bf16 v[160:163], a[244:247], v[56:59], v[160:163]
v_mul_f32 v155, v221, v155
v_mul_f32 v156, v221, v156
v_mfma_f32_16x16x32_bf16 v[168:171], a[240:243], v[52:55], v[168:171]
ds_read_b64_tr_b16 a[226:227], v230 offset:34816
v_mul_f32 v157, v221, v157
v_mfma_f32_16x16x32_bf16 v[168:171], a[244:247], v[60:63], v[168:171]
v_mul_f32 v158, v221, v158
v_mul_f32 v159, v221, v159
v_mfma_f32_16x16x32_bf16 v[176:179], a[240:243], a[48:51], v[176:179]
ds_read_b64_tr_b16 a[228:229], v230 offset:36864
buffer_load_dwordx4 a[12:15], v238, s[24:27], s32 offen offset:3072 sc1
v_cvt_pk_bf16_f32 v152, v152, v153
v_mfma_f32_16x16x32_bf16 v[176:179], a[244:247], a[56:59], v[176:179]
v_cvt_pk_bf16_f32 v153, v154, v155
v_cvt_pk_bf16_f32 v154, v156, v157
v_mfma_f32_16x16x32_bf16 v[184:187], a[240:243], a[52:55], v[184:187]
s_waitcnt lgkmcnt(3)
ds_read_b64_tr_b16 a[230:231], v230 offset:38912
v_mfma_f32_16x16x32_bf16 v[184:187], a[244:247], a[60:63], v[184:187]
v_cvt_pk_bf16_f32 v155, v158, v159
v_mfma_f32_16x16x32_bf16 v[164:167], a[248:251], v[48:51], v[164:167]
ds_read_b64_tr_b16 a[232:233], v223 offset:32768
v_mfma_f32_16x16x32_bf16 v[164:167], a[252:255], v[56:59], v[164:167]
buffer_store_dwordx4 v[152:155], v238, s[24:27], s31 offen offset:3072 sc1
v_mfma_f32_16x16x32_bf16 v[172:175], a[248:251], v[52:55], v[172:175]
s_add_u32 s32, s44, 4096
ds_read_b64_tr_b16 a[234:235], v223 offset:34816
v_accvgpr_write_b32 a204, v152
v_mfma_f32_16x16x32_bf16 v[172:175], a[252:255], v[60:63], v[172:175]
v_accvgpr_write_b32 a205, v153
v_accvgpr_write_b32 a206, v154
v_mfma_f32_16x16x32_bf16 v[180:183], a[248:251], a[48:51], v[180:183]
ds_read_b64_tr_b16 a[236:237], v223 offset:36864
buffer_load_dwordx4 a[16:19], v238, s[24:27], s32 offen offset:0 sc1
v_mfma_f32_16x16x32_bf16 v[180:183], a[252:255], a[56:59], v[180:183]
v_accvgpr_write_b32 a207, v155
v_mfma_f32_16x16x32_bf16 v[188:191], a[248:251], a[52:55], v[188:191]
s_waitcnt lgkmcnt(3)
s_add_u32 s31, s33, 20480
v_mfma_f32_16x16x32_bf16 v[188:191], a[252:255], a[60:63], v[188:191]
ds_read_b64_tr_b16 a[238:239], v223 offset:38912
v_mfma_f32_16x16x32_bf16 v[160:163], a[224:227], v[64:67], v[160:163]
ds_read_b64_tr_b16 a[240:241], v230 offset:40960
v_mfma_f32_16x16x32_bf16 v[160:163], a[228:231], v[72:75], v[160:163]
v_mfma_f32_16x16x32_bf16 v[168:171], a[224:227], v[68:71], v[168:171]
ds_read_b64_tr_b16 a[242:243], v230 offset:43008
v_mfma_f32_16x16x32_bf16 v[168:171], a[228:231], v[76:79], v[168:171]
buffer_load_dwordx4 a[20:23], v238, s[24:27], s32 offen offset:1024 sc1
v_mfma_f32_16x16x32_bf16 v[176:179], a[224:227], a[64:67], v[176:179]
ds_read_b64_tr_b16 a[244:245], v230 offset:45056
v_mfma_f32_16x16x32_bf16 v[176:179], a[228:231], a[72:75], v[176:179]
v_mfma_f32_16x16x32_bf16 v[184:187], a[224:227], a[68:71], v[184:187]
s_waitcnt lgkmcnt(3)
v_mfma_f32_16x16x32_bf16 v[184:187], a[228:231], a[76:79], v[184:187]
ds_read_b64_tr_b16 a[246:247], v230 offset:47104
v_mfma_f32_16x16x32_bf16 v[164:167], a[232:235], v[64:67], v[164:167]
s_add_u32 s32, s44, 4096
v_mfma_f32_16x16x32_bf16 v[164:167], a[236:239], v[72:75], v[164:167]
ds_read_b64_tr_b16 a[248:249], v223 offset:40960
v_mfma_f32_16x16x32_bf16 v[172:175], a[232:235], v[68:71], v[172:175]
ds_read_b64_tr_b16 a[250:251], v223 offset:43008
v_mfma_f32_16x16x32_bf16 v[172:175], a[236:239], v[76:79], v[172:175]
buffer_load_dwordx4 a[24:27], v238, s[24:27], s32 offen offset:2048 sc1
v_mfma_f32_16x16x32_bf16 v[180:183], a[232:235], a[64:67], v[180:183]
ds_read_b64_tr_b16 a[252:253], v223 offset:45056
v_mfma_f32_16x16x32_bf16 v[180:183], a[236:239], a[72:75], v[180:183]
v_mfma_f32_16x16x32_bf16 v[188:191], a[232:235], a[68:71], v[188:191]
s_waitcnt lgkmcnt(3)
ds_read_b64_tr_b16 a[254:255], v223 offset:47104
v_mfma_f32_16x16x32_bf16 v[188:191], a[236:239], a[76:79], v[188:191]
v_add_u32_e64 v241, s51, 1
v_mfma_f32_16x16x32_bf16 v[160:163], a[240:243], v[80:83], v[160:163]
ds_read_b64_tr_b16 a[224:225], v230 offset:49152
v_mfma_f32_16x16x32_bf16 v[160:163], a[244:247], v[88:91], v[160:163]
buffer_store_dword v241, v240, s[24:27], s34 offen sc1
v_mfma_f32_16x16x32_bf16 v[168:171], a[240:243], v[84:87], v[168:171]
ds_read_b64_tr_b16 a[226:227], v230 offset:51200
v_mfma_f32_16x16x32_bf16 v[168:171], a[244:247], v[92:95], v[168:171]
v_mfma_f32_16x16x32_bf16 v[176:179], a[240:243], a[80:83], v[176:179]
ds_read_b64_tr_b16 a[228:229], v230 offset:53248
v_mfma_f32_16x16x32_bf16 v[176:179], a[244:247], a[88:91], v[176:179]
buffer_load_dwordx4 a[28:31], v238, s[24:27], s32 offen offset:3072 sc1
v_mfma_f32_16x16x32_bf16 v[184:187], a[240:243], a[84:87], v[184:187]
s_waitcnt lgkmcnt(3)
v_mfma_f32_16x16x32_bf16 v[184:187], a[244:247], a[92:95], v[184:187]
ds_read_b64_tr_b16 a[230:231], v230 offset:55296
v_mfma_f32_16x16x32_bf16 v[164:167], a[248:251], v[80:83], v[164:167]
ds_read_b64_tr_b16 a[232:233], v223 offset:49152
v_mfma_f32_16x16x32_bf16 v[164:167], a[252:255], v[88:91], v[164:167]
v_mfma_f32_16x16x32_bf16 v[172:175], a[248:251], v[84:87], v[172:175]
s_add_u32 s32, s45, 0
v_mfma_f32_16x16x32_bf16 v[172:175], a[252:255], v[92:95], v[172:175]
ds_read_b64_tr_b16 a[234:235], v223 offset:51200
v_mfma_f32_16x16x32_bf16 v[180:183], a[248:251], a[80:83], v[180:183]
ds_read_b64_tr_b16 a[236:237], v223 offset:53248
v_mfma_f32_16x16x32_bf16 v[180:183], a[252:255], a[88:91], v[180:183]
buffer_load_dwordx4 a[32:35], v238, s[24:27], s32 offen offset:0 sc1
v_mfma_f32_16x16x32_bf16 v[188:191], a[248:251], a[84:87], v[188:191]
s_waitcnt lgkmcnt(3)
v_mfma_f32_16x16x32_bf16 v[188:191], a[252:255], a[92:95], v[188:191]
ds_read_b64_tr_b16 a[238:239], v223 offset:55296
v_mfma_f32_16x16x32_bf16 v[160:163], a[224:227], v[96:99], v[160:163]
ds_read_b64_tr_b16 a[240:241], v230 offset:57344
v_mfma_f32_16x16x32_bf16 v[160:163], a[228:231], v[104:107], v[160:163]
v_mfma_f32_16x16x32_bf16 v[168:171], a[224:227], v[100:103], v[168:171]
ds_read_b64_tr_b16 a[242:243], v230 offset:59392
v_mfma_f32_16x16x32_bf16 v[168:171], a[228:231], v[108:111], v[168:171]
buffer_load_dwordx4 a[36:39], v238, s[24:27], s32 offen offset:1024 sc1
v_mfma_f32_16x16x32_bf16 v[176:179], a[224:227], a[96:99], v[176:179]
ds_read_b64_tr_b16 a[244:245], v230 offset:61440
v_mfma_f32_16x16x32_bf16 v[176:179], a[228:231], a[104:107], v[176:179]
v_mfma_f32_16x16x32_bf16 v[184:187], a[224:227], a[100:103], v[184:187]
s_waitcnt lgkmcnt(3)
v_mfma_f32_16x16x32_bf16 v[184:187], a[228:231], a[108:111], v[184:187]
ds_read_b64_tr_b16 a[246:247], v230 offset:63488
v_mfma_f32_16x16x32_bf16 v[164:167], a[232:235], v[96:99], v[164:167]
ds_read_b64_tr_b16 a[248:249], v223 offset:57344
v_mfma_f32_16x16x32_bf16 v[164:167], a[236:239], v[104:107], v[164:167]
v_mfma_f32_16x16x32_bf16 v[172:175], a[232:235], v[100:103], v[172:175]
ds_read_b64_tr_b16 a[250:251], v223 offset:59392
v_mfma_f32_16x16x32_bf16 v[172:175], a[236:239], v[108:111], v[172:175]
v_mfma_f32_16x16x32_bf16 v[180:183], a[232:235], a[96:99], v[180:183]
ds_read_b64_tr_b16 a[252:253], v223 offset:61440
v_mfma_f32_16x16x32_bf16 v[180:183], a[236:239], a[104:107], v[180:183]
v_mfma_f32_16x16x32_bf16 v[188:191], a[232:235], a[100:103], v[188:191]
s_waitcnt lgkmcnt(3)
v_mfma_f32_16x16x32_bf16 v[188:191], a[236:239], a[108:111], v[188:191]
ds_read_b64_tr_b16 a[254:255], v223 offset:63488
v_mfma_f32_16x16x32_bf16 v[160:163], a[240:243], v[112:115], v[160:163]
s_barrier
v_mfma_f32_16x16x32_bf16 v[160:163], a[244:247], v[120:123], v[160:163]
ds_read_b64_tr_b16 a[224:225], v228 offset:20480
v_mfma_f32_16x16x32_bf16 v[168:171], a[240:243], v[116:119], v[168:171]
ds_read_b64_tr_b16 a[226:227], v228 offset:23040
v_mfma_f32_16x16x32_bf16 v[168:171], a[244:247], v[124:127], v[168:171]
v_mfma_f32_16x16x32_bf16 v[176:179], a[240:243], a[112:115], v[176:179]
ds_read_b64_tr_b16 a[228:229], v228 offset:30720
v_mfma_f32_16x16x32_bf16 v[176:179], a[244:247], a[120:123], v[176:179]
v_mfma_f32_16x16x32_bf16 v[184:187], a[240:243], a[116:119], v[184:187]
s_waitcnt lgkmcnt(3)
v_mfma_f32_16x16x32_bf16 v[184:187], a[244:247], a[124:127], v[184:187]
ds_read_b64_tr_b16 a[230:231], v228 offset:33280
v_mfma_f32_16x16x32_bf16 v[164:167], a[248:251], v[112:115], v[164:167]
ds_read_b64_tr_b16 a[232:233], v229 offset:20480
v_mfma_f32_16x16x32_bf16 v[164:167], a[252:255], v[120:123], v[164:167]
v_mfma_f32_16x16x32_bf16 v[172:175], a[248:251], v[116:119], v[172:175]
ds_read_b64_tr_b16 a[234:235], v229 offset:23040
v_mfma_f32_16x16x32_bf16 v[172:175], a[252:255], v[124:127], v[172:175]
v_mfma_f32_16x16x32_bf16 v[180:183], a[248:251], a[112:115], v[180:183]
ds_read_b64_tr_b16 a[236:237], v229 offset:30720
v_mfma_f32_16x16x32_bf16 v[180:183], a[252:255], a[120:123], v[180:183]
v_mfma_f32_16x16x32_bf16 v[188:191], a[248:251], a[116:119], v[188:191]
s_waitcnt lgkmcnt(3)
ds_read_b64_tr_b16 a[238:239], v229 offset:33280
v_mfma_f32_16x16x32_bf16 v[188:191], a[252:255], a[124:127], v[188:191]
ds_read_b64_tr_b16 a[240:241], v228 offset:20544
ds_read_b64_tr_b16 a[242:243], v228 offset:23104
v_mfma_f32_16x16x32_bf16 v[0:3], a[224:227], a[128:131], 0
s_barrier
ds_read_b64_tr_b16 a[244:245], v228 offset:30784
v_mfma_f32_16x16x32_bf16 v[0:3], a[228:231], a[144:147], v[0:3]
s_add_u32 m0, s47, 0
v_mfma_f32_16x16x32_bf16 v[8:11], a[224:227], a[132:135], 0
s_add_u32 s30, s42, 0
ds_read_b64_tr_b16 a[246:247], v228 offset:33344
v_mfma_f32_16x16x32_bf16 v[8:11], a[228:231], a[148:151], v[8:11]
buffer_load_dwordx4 v231, s[52:55], s30 offen offset:0 lds
v_mul_f32 v160, v246, v160
v_mfma_f32_16x16x32_bf16 v[80:83], a[224:227], a[136:139], 0
ds_read_b64_tr_b16 a[248:249], v229 offset:20544
v_mul_f32 v161, v246, v161
v_mfma_f32_16x16x32_bf16 v[80:83], a[228:231], a[152:155], v[80:83]
v_mul_f32 v162, v246, v162
v_mul_f32 v163, v246, v163
v_mfma_f32_16x16x32_bf16 v[88:91], a[224:227], a[140:143], 0
ds_read_b64_tr_b16 a[250:251], v229 offset:23104
v_mul_f32 v164, v246, v164
v_mfma_f32_16x16x32_bf16 v[88:91], a[228:231], a[156:159], v[88:91]
s_waitcnt lgkmcnt(6)
v_mul_f32 v165, v246, v165
v_mul_f32 v166, v246, v166
v_mfma_f32_16x16x32_bf16 v[4:7], a[232:235], a[128:131], 0
ds_read_b64_tr_b16 a[252:253], v229 offset:30784
buffer_load_dwordx4 v232, s[52:55], s30 offen offset:1024 lds
v_mfma_f32_16x16x32_bf16 v[4:7], a[236:239], a[144:147], v[4:7]
v_mul_f32 v167, v246, v167
v_cvt_pk_bf16_f32 v160, v160, v161
v_mfma_f32_16x16x32_bf16 v[12:15], a[232:235], a[132:135], 0
ds_read_b64_tr_b16 a[254:255], v229 offset:33344
v_cvt_pk_bf16_f32 v161, v162, v163
v_mfma_f32_16x16x32_bf16 v[12:15], a[236:239], a[148:151], v[12:15]
v_cvt_pk_bf16_f32 v162, v164, v165
v_cvt_pk_bf16_f32 v163, v166, v167
v_mfma_f32_16x16x32_bf16 v[84:87], a[232:235], a[136:139], 0
ds_read_b64_tr_b16 a[224:225], v228 offset:20608
v_mfma_f32_16x16x32_bf16 v[84:87], a[236:239], a[152:155], v[84:87]
buffer_load_dwordx4 v233, s[52:55], s30 offen offset:2048 lds
v_mfma_f32_16x16x32_bf16 v[92:95], a[232:235], a[140:143], 0
ds_read_b64_tr_b16 a[226:227], v228 offset:23168
v_mfma_f32_16x16x32_bf16 v[92:95], a[236:239], a[156:159], v[92:95]
s_waitcnt lgkmcnt(6)
v_mfma_f32_16x16x32_bf16 v[16:19], a[240:243], a[128:131], 0
ds_read_b64_tr_b16 a[228:229], v228 offset:30848
v_mfma_f32_16x16x32_bf16 v[16:19], a[244:247], a[144:147], v[16:19]
v_mfma_f32_16x16x32_bf16 v[24:27], a[240:243], a[132:135], 0
ds_read_b64_tr_b16 a[230:231], v228 offset:33408
buffer_load_dwordx4 v234, s[52:55], s30 offen offset:3072 lds
v_mfma_f32_16x16x32_bf16 v[24:27], a[244:247], a[148:151], v[24:27]
v_mfma_f32_16x16x32_bf16 v[96:99], a[240:243], a[136:139], 0
s_add_u32 m0, s47, 4096
ds_read_b64_tr_b16 a[232:233], v229 offset:20608
v_mfma_f32_16x16x32_bf16 v[96:99], a[244:247], a[152:155], v[96:99]
v_mfma_f32_16x16x32_bf16 v[104:107], a[240:243], a[140:143], 0
ds_read_b64_tr_b16 a[234:235], v229 offset:23168
v_mfma_f32_16x16x32_bf16 v[104:107], a[244:247], a[156:159], v[104:107]
s_waitcnt lgkmcnt(6)
buffer_load_dwordx4 v235, s[52:55], s30 offen offset:0 lds
v_mfma_f32_16x16x32_bf16 v[20:23], a[248:251], a[128:131], 0
s_add_u32 m0, s47, 20480
ds_read_b64_tr_b16 a[236:237], v229 offset:30848
v_mfma_f32_16x16x32_bf16 v[20:23], a[252:255], a[144:147], v[20:23]
s_add_u32 s30, s43, 0
v_mfma_f32_16x16x32_bf16 v[28:31], a[248:251], a[132:135], 0
ds_read_b64_tr_b16 a[238:239], v229 offset:33408
v_mfma_f32_16x16x32_bf16 v[28:31], a[252:255], a[148:151], v[28:31]
L_pg11:
s_cbranch_execz L_pg15
v_mfma_f32_16x16x32_bf16 v[100:103], a[248:251], a[136:139], 0
ds_read_b64_tr_b16 a[240:241], v228 offset:20672
buffer_load_dwordx4 v231, s[52:55], s30 offen offset:0 lds
v_mfma_f32_16x16x32_bf16 v[100:103], a[252:255], a[152:155], v[100:103]
v_mfma_f32_16x16x32_bf16 v[108:111], a[248:251], a[140:143], 0
ds_read_b64_tr_b16 a[242:243], v228 offset:23232
v_mfma_f32_16x16x32_bf16 v[108:111], a[252:255], a[156:159], v[108:111]
s_waitcnt lgkmcnt(6)
v_mfma_f32_16x16x32_bf16 v[32:35], a[224:227], a[128:131], 0
ds_read_b64_tr_b16 a[244:245], v228 offset:30912
v_mfma_f32_16x16x32_bf16 v[32:35], a[228:231], a[144:147], v[32:35]
buffer_load_dwordx4 v232, s[52:55], s30 offen offset:1024 lds
v_mfma_f32_16x16x32_bf16 v[40:43], a[224:227], a[132:135], 0
ds_read_b64_tr_b16 a[246:247], v228 offset:33472
v_mfma_f32_16x16x32_bf16 v[40:43], a[228:231], a[148:151], v[40:43]
v_mfma_f32_16x16x32_bf16 v[112:115], a[224:227], a[136:139], 0
ds_read_b64_tr_b16 a[248:249], v229 offset:20672
v_mfma_f32_16x16x32_bf16 v[112:115], a[228:231], a[152:155], v[112:115]
v_mfma_f32_16x16x32_bf16 v[120:123], a[224:227], a[140:143], 0
ds_read_b64_tr_b16 a[250:251], v229 offset:23232
buffer_load_dwordx4 v233, s[52:55], s30 offen offset:2048 lds
v_mfma_f32_16x16x32_bf16 v[120:123], a[228:231], a[156:159], v[120:123]
s_waitcnt lgkmcnt(6)
v_mfma_f32_16x16x32_bf16 v[36:39], a[232:235], a[128:131], 0
ds_read_b64_tr_b16 a[252:253], v229 offset:30912
v_mfma_f32_16x16x32_bf16 v[36:39], a[236:239], a[144:147], v[36:39]
v_mfma_f32_16x16x32_bf16 v[44:47], a[232:235], a[132:135], 0
ds_read_b64_tr_b16 a[254:255], v229 offset:33472
v_mfma_f32_16x16x32_bf16 v[44:47], a[236:239], a[148:151], v[44:47]
buffer_load_dwordx4 v234, s[52:55], s30 offen offset:3072 lds
v_mfma_f32_16x16x32_bf16 v[116:119], a[232:235], a[136:139], 0
s_add_u32 m0, s47, 24576
ds_read_b64_tr_b16 a[224:225], v228 offset:20736
v_mfma_f32_16x16x32_bf16 v[116:119], a[236:239], a[152:155], v[116:119]
v_mfma_f32_16x16x32_bf16 v[124:127], a[232:235], a[140:143], 0
ds_read_b64_tr_b16 a[226:227], v228 offset:23296
v_mfma_f32_16x16x32_bf16 v[124:127], a[236:239], a[156:159], v[124:127]
s_waitcnt lgkmcnt(6)
v_mfma_f32_16x16x32_bf16 v[48:51], a[240:243], a[128:131], 0
ds_read_b64_tr_b16 a[228:229], v228 offset:30976
buffer_load_dwordx4 v235, s[52:55], s30 offen offset:0 lds
v_mfma_f32_16x16x32_bf16 v[48:51], a[244:247], a[144:147], v[48:51]
s_add_u32 s32, s45, 4096
v_mfma_f32_16x16x32_bf16 v[56:59], a[240:243], a[132:135], 0
ds_read_b64_tr_b16 a[230:231], v228 offset:33536
v_mfma_f32_16x16x32_bf16 v[56:59], a[244:247], a[148:151], v[56:59]
v_mfma_f32_16x16x32_bf16 v[128:131], a[240:243], a[136:139], 0
ds_read_b64_tr_b16 a[232:233], v229 offset:20736
buffer_store_dwordx4 v[160:163], v238, s[24:27], s31 offen offset:0 sc1
v_mfma_f32_16x16x32_bf16 v[128:131], a[244:247], a[152:155], v[128:131]
v_accvgpr_write_b32 a208, v160
v_accvgpr_write_b32 a209, v161
v_mfma_f32_16x16x32_bf16 v[136:139], a[240:243], a[140:143], 0
ds_read_b64_tr_b16 a[234:235], v229 offset:23296
v_accvgpr_write_b32 a210, v162
v_mfma_f32_16x16x32_bf16 v[136:139], a[244:247], a[156:159], v[136:139]
s_waitcnt lgkmcnt(6)
v_accvgpr_write_b32 a211, v163
v_mul_f32 v168, v247, v168
v_mfma_f32_16x16x32_bf16 v[52:55], a[248:251], a[128:131], 0
ds_read_b64_tr_b16 a[236:237], v229 offset:30976
v_mul_f32 v169, v247, v169
v_mfma_f32_16x16x32_bf16 v[52:55], a[252:255], a[144:147], v[52:55]
v_mul_f32 v170, v247, v170
v_mul_f32 v171, v247, v171
v_mfma_f32_16x16x32_bf16 v[60:63], a[248:251], a[132:135], 0
ds_read_b64_tr_b16 a[238:239], v229 offset:33536
v_mul_f32 v172, v247, v172
v_mfma_f32_16x16x32_bf16 v[60:63], a[252:255], a[148:151], v[60:63]
v_mul_f32 v173, v247, v173
v_mul_f32 v174, v247, v174
v_mfma_f32_16x16x32_bf16 v[132:135], a[248:251], a[136:139], 0
s_barrier
ds_read_b64_tr_b16 a[240:241], v226 offset:20480
v_mfma_f32_16x16x32_bf16 v[132:135], a[252:255], a[152:155], v[132:135]
s_mov_b32 s16, s58
v_mul_f32 v175, v247, v175
v_cvt_pk_bf16_f32 v168, v168, v169
v_mfma_f32_16x16x32_bf16 v[140:143], a[248:251], a[140:143], 0
ds_read_b64_tr_b16 a[242:243], v226 offset:23040
v_cvt_pk_bf16_f32 v169, v170, v171
v_mfma_f32_16x16x32_bf16 v[140:143], a[252:255], a[156:159], v[140:143]
s_waitcnt lgkmcnt(6)
v_cvt_pk_bf16_f32 v170, v172, v173
v_cvt_pk_bf16_f32 v171, v174, v175
v_mfma_f32_16x16x32_bf16 v[64:67], a[224:227], a[128:131], 0
s_mov_b32 s17, s59
ds_read_b64_tr_b16 a[244:245], v226 offset:30720
buffer_store_dwordx4 v[168:171], v238, s[24:27], s31 offen offset:1024 sc1
v_mfma_f32_16x16x32_bf16 v[64:67], a[228:231], a[144:147], v[64:67]
v_accvgpr_write_b32 a212, v168
v_accvgpr_write_b32 a213, v169
v_mfma_f32_16x16x32_bf16 v[72:75], a[224:227], a[132:135], 0
ds_read_b64_tr_b16 a[246:247], v226 offset:33280
v_accvgpr_write_b32 a214, v170
v_mfma_f32_16x16x32_bf16 v[72:75], a[228:231], a[148:151], v[72:75]
v_accvgpr_write_b32 a215, v171
v_mul_f32 v176, v220, v176
v_mfma_f32_16x16x32_bf16 v[144:147], a[224:227], a[136:139], 0
s_mov_b32 s18, 2621440
ds_read_b64_tr_b16 a[248:249], v227 offset:20480
v_mul_f32 v177, v220, v177
v_mfma_f32_16x16x32_bf16 v[144:147], a[228:231], a[152:155], v[144:147]
v_mul_f32 v178, v220, v178
v_mul_f32 v179, v220, v179
v_mfma_f32_16x16x32_bf16 v[152:155], a[224:227], a[140:143], 0
ds_read_b64_tr_b16 a[250:251], v227 offset:23040
v_mul_f32 v180, v220, v180
v_mfma_f32_16x16x32_bf16 v[152:155], a[228:231], a[156:159], v[152:155]
s_waitcnt lgkmcnt(6)
v_mul_f32 v181, v220, v181
v_mul_f32 v182, v220, v182
v_mfma_f32_16x16x32_bf16 v[68:71], a[232:235], a[128:131], 0
s_mov_b32 s19, 0x20000
ds_read_b64_tr_b16 a[252:253], v227 offset:30720
v_mul_f32 v183, v220, v183
v_mfma_f32_16x16x32_bf16 v[68:71], a[236:239], a[144:147], v[68:71]
v_cvt_pk_bf16_f32 v176, v176, v177
v_cvt_pk_bf16_f32 v177, v178, v179
v_mfma_f32_16x16x32_bf16 v[76:79], a[232:235], a[132:135], 0
ds_read_b64_tr_b16 a[254:255], v227 offset:33280
v_cvt_pk_bf16_f32 v178, v180, v181
v_mfma_f32_16x16x32_bf16 v[76:79], a[236:239], a[148:151], v[76:79]
v_cvt_pk_bf16_f32 v179, v182, v183
v_mfma_f32_16x16x32_bf16 v[148:151], a[232:235], a[136:139], 0
s_and_b32 s76, s2, 0
ds_read_b64_tr_b16 a[224:225], v226 offset:20544
buffer_store_dwordx4 v[176:179], v238, s[24:27], s31 offen offset:2048 sc1
v_mfma_f32_16x16x32_bf16 v[148:151], a[236:239], a[152:155], v[148:151]
v_accvgpr_write_b32 a216, v176
v_accvgpr_write_b32 a217, v177
v_mfma_f32_16x16x32_bf16 v[156:159], a[232:235], a[140:143], 0
ds_read_b64_tr_b16 a[226:227], v226 offset:23104
v_accvgpr_write_b32 a218, v178
v_mfma_f32_16x16x32_bf16 v[156:159], a[236:239], a[156:159], v[156:159]
s_waitcnt lgkmcnt(6)
v_accvgpr_write_b32 a219, v179
v_mul_f32 v184, v221, v184
v_mfma_f32_16x16x32_bf16 v[0:3], a[240:243], a[160:163], v[0:3]
s_lshr_b32 s81, s2, 5
ds_read_b64_tr_b16 a[228:229], v226 offset:30784
v_mul_f32 v185, v221, v185
v_mfma_f32_16x16x32_bf16 v[0:3], a[244:247], a[176:179], v[0:3]
v_mul_f32 v186, v221, v186
v_mul_f32 v187, v221, v187
v_mfma_f32_16x16x32_bf16 v[8:11], a[240:243], a[164:167], v[8:11]
ds_read_b64_tr_b16 a[230:231], v226 offset:33344
v_mul_f32 v188, v221, v188
v_mfma_f32_16x16x32_bf16 v[8:11], a[244:247], a[180:183], v[8:11]
v_mul_f32 v189, v221, v189
v_mul_f32 v190, v221, v190
v_mfma_f32_16x16x32_bf16 v[80:83], a[240:243], a[168:171], v[80:83]
s_add_u32 s76, s76, s81
ds_read_b64_tr_b16 a[232:233], v227 offset:20544
v_mul_f32 v191, v221, v191
v_mfma_f32_16x16x32_bf16 v[80:83], a[244:247], a[184:187], v[80:83]
v_cvt_pk_bf16_f32 v184, v184, v185
v_cvt_pk_bf16_f32 v185, v186, v187
v_mfma_f32_16x16x32_bf16 v[88:91], a[240:243], a[172:175], v[88:91]
ds_read_b64_tr_b16 a[234:235], v227 offset:23104
v_cvt_pk_bf16_f32 v186, v188, v189
v_mfma_f32_16x16x32_bf16 v[88:91], a[244:247], a[188:191], v[88:91]
s_waitcnt lgkmcnt(6)
v_cvt_pk_bf16_f32 v187, v190, v191
v_mfma_f32_16x16x32_bf16 v[4:7], a[248:251], a[160:163], v[4:7]
s_and_b32 s77, s2, 7
ds_read_b64_tr_b16 a[236:237], v227 offset:30784
buffer_store_dwordx4 v[184:187], v238, s[24:27], s31 offen offset:3072 sc1
v_mfma_f32_16x16x32_bf16 v[4:7], a[252:255], a[176:179], v[4:7]
v_accvgpr_write_b32 a220, v184
v_accvgpr_write_b32 a221, v185
v_mfma_f32_16x16x32_bf16 v[12:15], a[248:251], a[164:167], v[12:15]
ds_read_b64_tr_b16 a[238:239], v227 offset:33344
buffer_load_dword v239, v236, s[24:27], 0 offen sc1
v_accvgpr_write_b32 a222, v186
v_mfma_f32_16x16x32_bf16 v[12:15], a[252:255], a[180:183], v[12:15]
v_accvgpr_write_b32 a223, v187
v_mfma_f32_16x16x32_bf16 v[84:87], a[248:251], a[168:171], v[84:87]
s_lshl_b32 s77, s77, 2
ds_read_b64_tr_b16 a[240:241], v226 offset:20608
v_lshrrev_b32 v214, 4, v238
v_mfma_f32_16x16x32_bf16 v[84:87], a[252:255], a[184:187], v[84:87]
v_mfma_f32_16x16x32_bf16 v[92:95], a[248:251], a[172:175], v[92:95]
ds_read_b64_tr_b16 a[242:243], v226 offset:23168
v_mov_b32 v215, s36
v_mfma_f32_16x16x32_bf16 v[92:95], a[252:255], a[188:191], v[92:95]
s_waitcnt lgkmcnt(6)
buffer_load_dwordx4 a[40:43], v238, s[24:27], s32 offen offset:0 sc1
v_mfma_f32_16x16x32_bf16 v[16:19], a[224:227], a[160:163], v[16:19]
s_bfe_u32 s81, s2, 131075
ds_read_b64_tr_b16 a[244:245], v226 offset:30848
v_and_b32 v216, 3, v214
v_mfma_f32_16x16x32_bf16 v[16:19], a[228:231], a[176:179], v[16:19]
v_mfma_f32_16x16x32_bf16 v[24:27], a[224:227], a[164:167], v[24:27]
ds_read_b64_tr_b16 a[246:247], v226 offset:33408
v_bfe_u32 v218, v214, 2, 2
v_mfma_f32_16x16x32_bf16 v[24:27], a[228:231], a[180:183], v[24:27]
v_mfma_f32_16x16x32_bf16 v[96:99], a[224:227], a[168:171], v[96:99]
s_add_u32 s77, s77, s81
ds_read_b64_tr_b16 a[248:249], v227 offset:20608
v_lshrrev_b32 v219, 8, v242
v_mfma_f32_16x16x32_bf16 v[96:99], a[228:231], a[184:187], v[96:99]
buffer_load_dwordx4 a[44:47], v238, s[24:27], s32 offen offset:1024 sc1
v_mfma_f32_16x16x32_bf16 v[104:107], a[224:227], a[172:175], v[104:107]
s_add_u32 s32, s46, 0
ds_read_b64_tr_b16 a[250:251], v227 offset:23168
v_lshlrev_b32 v219, 6, v219
v_mfma_f32_16x16x32_bf16 v[104:107], a[228:231], a[188:191], v[104:107]
s_waitcnt lgkmcnt(6)
v_mfma_f32_16x16x32_bf16 v[20:23], a[232:235], a[160:163], v[20:23]
s_lshl_b32 s50, s76, 5
ds_read_b64_tr_b16 a[252:253], v227 offset:30848
v_lshl_add_u32 v219, v216, 4, v219
v_mfma_f32_16x16x32_bf16 v[20:23], a[236:239], a[176:179], v[20:23]
v_mfma_f32_16x16x32_bf16 v[28:31], a[232:235], a[164:167], v[28:31]
ds_read_b64_tr_b16 a[254:255], v227 offset:33408
v_mul_u32_u24 v217, 40960, v218
v_mfma_f32_16x16x32_bf16 v[28:31], a[236:239], a[180:183], v[28:31]
buffer_load_dwordx4 a[48:51], v238, s[24:27], s32 offen offset:0 sc1
v_mfma_f32_16x16x32_bf16 v[100:103], a[232:235], a[168:171], v[100:103]
s_add_u32 s50, s50, s77
ds_read_b64_tr_b16 a[224:225], v226 offset:20672
v_add_u32 v237, v217, v219
v_mfma_f32_16x16x32_bf16 v[100:103], a[236:239], a[184:187], v[100:103]
v_mfma_f32_16x16x32_bf16 v[108:111], a[232:235], a[172:175], v[108:111]
ds_read_b64_tr_b16 a[226:227], v226 offset:23232
v_lshrrev_b32 v217, 2, v214
v_mfma_f32_16x16x32_bf16 v[108:111], a[236:239], a[188:191], v[108:111]
s_waitcnt lgkmcnt(6)
v_mfma_f32_16x16x32_bf16 v[32:35], a[240:243], a[160:163], v[32:35]
s_lshl_b32 s50, s50, 7
ds_read_b64_tr_b16 a[228:229], v226 offset:30912
v_and_b32_e64 v219, s2, 1
v_mfma_f32_16x16x32_bf16 v[32:35], a[244:247], a[176:179], v[32:35]
buffer_load_dwordx4 a[52:55], v238, s[24:27], s32 offen offset:1024 sc1
v_mfma_f32_16x16x32_bf16 v[40:43], a[240:243], a[164:167], v[40:43]
s_add_u32 s32, s46, 4096
ds_read_b64_tr_b16 a[230:231], v226 offset:33472
v_lshl_add_u32 v219, v219, 2, v216
v_mfma_f32_16x16x32_bf16 v[40:43], a[244:247], a[180:183], v[40:43]
v_mfma_f32_16x16x32_bf16 v[112:115], a[240:243], a[168:171], v[112:115]
s_add_u32 s50, s50, 3407872
ds_read_b64_tr_b16 a[232:233], v227 offset:20672
v_mul_u32_u24 v210, 2560, v215
v_mfma_f32_16x16x32_bf16 v[112:115], a[244:247], a[184:187], v[112:115]
v_mfma_f32_16x16x32_bf16 v[120:123], a[240:243], a[172:175], v[120:123]
ds_read_b64_tr_b16 a[234:235], v227 offset:23232
v_lshl_add_u32 v211, v219, 3, v210
v_mfma_f32_16x16x32_bf16 v[120:123], a[244:247], a[188:191], v[120:123]
s_waitcnt lgkmcnt(6)
buffer_load_dwordx4 a[56:59], v238, s[24:27], s32 offen offset:0 sc1
v_mfma_f32_16x16x32_bf16 v[36:39], a[248:251], a[160:163], v[36:39]
s_lshl_b32 s49, s2, 7
ds_read_b64_tr_b16 a[236:237], v227 offset:30912
v_lshl_add_u32 v210, v219, 4, v210
v_mfma_f32_16x16x32_bf16 v[36:39], a[252:255], a[176:179], v[36:39]
v_mfma_f32_16x16x32_bf16 v[44:47], a[248:251], a[164:167], v[44:47]
ds_read_b64_tr_b16 a[238:239], v227 offset:33472
v_lshl_add_u32 v210, v217, 7, v210
v_mfma_f32_16x16x32_bf16 v[44:47], a[252:255], a[180:183], v[44:47]
v_mfma_f32_16x16x32_bf16 v[116:119], a[248:251], a[168:171], v[116:119]
s_add_u32 s49, s49, 3276800
ds_read_b64_tr_b16 a[240:241], v226 offset:20736
v_and_b32 v219, 1, v217
v_mfma_f32_16x16x32_bf16 v[116:119], a[252:255], a[184:187], v[116:119]
buffer_load_dwordx4 a[60:63], v238, s[24:27], s32 offen offset:1024 sc1
v_mfma_f32_16x16x32_bf16 v[124:127], a[248:251], a[172:175], v[124:127]
s_add_u32 m0, s47, 40960
ds_read_b64_tr_b16 a[242:243], v226 offset:23296
v_lshl_add_u32 v211, v219, 2, v211
v_mfma_f32_16x16x32_bf16 v[124:127], a[252:255], a[188:191], v[124:127]
s_waitcnt lgkmcnt(6)
v_mfma_f32_16x16x32_bf16 v[48:51], a[224:227], a[160:163], v[48:51]
s_lshl_b32 s81, s36, 28
ds_read_b64_tr_b16 a[244:245], v226 offset:30976
v_and_b32 v219, 2, v217
v_mfma_f32_16x16x32_bf16 v[48:51], a[228:231], a[176:179], v[48:51]
s_add_u32 s30, s41, 81920
v_mfma_f32_16x16x32_bf16 v[56:59], a[224:227], a[164:167], v[56:59]
ds_read_b64_tr_b16 a[246:247], v226 offset:33536
v_lshl_add_u32 v211, v219, 7, v211
v_mfma_f32_16x16x32_bf16 v[56:59], a[228:231], a[180:183], v[56:59]
buffer_load_dwordx4 v231, s[52:55], s30 offen offset:0 lds
v_mfma_f32_16x16x32_bf16 v[128:131], a[224:227], a[168:171], v[128:131]
s_add_u32 s50, s50, s81
ds_read_b64_tr_b16 a[248:249], v227 offset:20736
v_and_b32 v219, 12, v217
v_mfma_f32_16x16x32_bf16 v[128:131], a[228:231], a[184:187], v[128:131]
v_mfma_f32_16x16x32_bf16 v[136:139], a[224:227], a[172:175], v[136:139]
ds_read_b64_tr_b16 a[250:251], v227 offset:23296
v_lshl_add_u32 v211, v219, 4, v211
v_mfma_f32_16x16x32_bf16 v[136:139], a[228:231], a[188:191], v[136:139]
s_waitcnt lgkmcnt(6)
v_mfma_f32_16x16x32_bf16 v[52:55], a[232:235], a[160:163], v[52:55]
s_add_u32 s49, s49, s81
ds_read_b64_tr_b16 a[252:253], v227 offset:30976
v_mul_u32_u24 v219, 640, v215
v_mfma_f32_16x16x32_bf16 v[52:55], a[236:239], a[176:179], v[52:55]
buffer_load_dwordx4 v232, s[52:55], s30 offen offset:1024 lds
v_mfma_f32_16x16x32_bf16 v[60:63], a[232:235], a[164:167], v[60:63]
ds_read_b64_tr_b16 a[254:255], v227 offset:33536
v_lshl_add_u32 v212, v217, 5, v219
v_mfma_f32_16x16x32_bf16 v[60:63], a[236:239], a[180:183], v[60:63]
s_waitcnt vmcnt(43)
v_mfma_f32_16x16x32_bf16 v[132:135], a[232:235], a[168:171], v[132:135]
s_barrier
ds_read_b64_tr_b16 a[224:225], v226 offset:40960
v_mfma_f32_16x16x32_bf16 v[132:135], a[236:239], a[184:187], v[132:135]
s_lshl_b32 s76, s76, 2
v_lshl_add_u32 v213, v217, 3, v219
v_mfma_f32_16x16x32_bf16 v[140:143], a[232:235], a[172:175], v[140:143]
ds_read_b64_tr_b16 a[226:227], v226 offset:43520
v_add_u32_e64 v241, s51, 0
v_mfma_f32_16x16x32_bf16 v[140:143], a[236:239], a[188:191], v[140:143]
s_waitcnt lgkmcnt(6)
s_waitcnt vmcnt(9)
buffer_store_dword v241, v240, s[24:27], s34 offen sc1
v_mfma_f32_16x16x32_bf16 v[64:67], a[240:243], a[160:163], v[64:67]
s_add_u32 s76, s76, s36
ds_read_b64_tr_b16 a[228:229], v226 offset:51200
v_lshlrev_b32 v254, 5, v216
v_mfma_f32_16x16x32_bf16 v[64:67], a[244:247], a[176:179], v[64:67]
v_mfma_f32_16x16x32_bf16 v[72:75], a[240:243], a[164:167], v[72:75]
ds_read_b64_tr_b16 a[230:231], v226 offset:53760
v_add_u32 v254, 81664, v254
v_mfma_f32_16x16x32_bf16 v[72:75], a[244:247], a[180:183], v[72:75]
buffer_load_dwordx4 v233, s[52:55], s30 offen offset:2048 lds
v_mfma_f32_16x16x32_bf16 v[144:147], a[240:243], a[168:171], v[144:147]
s_mul_i32 s81, s77, 96
ds_read_b64_tr_b16 a[232:233], v227 offset:40960
v_lshl_add_u32 v253, v215, 3, v254
v_mfma_f32_16x16x32_bf16 v[144:147], a[244:247], a[184:187], v[144:147]
v_mfma_f32_16x16x32_bf16 v[152:155], a[240:243], a[172:175], v[152:155]
ds_read_b64_tr_b16 a[234:235], v227 offset:43520
v_lshrrev_b32 v217, 4, v214
v_mfma_f32_16x16x32_bf16 v[152:155], a[244:247], a[188:191], v[152:155]
s_waitcnt lgkmcnt(6)
v_mfma_f32_16x16x32_bf16 v[68:71], a[248:251], a[160:163], v[68:71]
s_sub_u32 s82, 1966080, s81
ds_read_b64_tr_b16 a[236:237], v227 offset:51200
v_lshlrev_b32 v219, 6, v217
v_mfma_f32_16x16x32_bf16 v[68:71], a[252:255], a[176:179], v[68:71]
buffer_load_dwordx4 v234, s[52:55], s30 offen offset:3072 lds
v_mfma_f32_16x16x32_bf16 v[76:79], a[248:251], a[164:167], v[76:79]
s_add_u32 m0, s47, 45056
ds_read_b64_tr_b16 a[238:239], v227 offset:53760
v_lshl_add_u32 v219, v216, 4, v219
v_mfma_f32_16x16x32_bf16 v[76:79], a[252:255], a[180:183], v[76:79]
v_mfma_f32_16x16x32_bf16 v[148:151], a[248:251], a[168:171], v[148:151]
ds_read_b64_tr_b16 a[240:241], v226 offset:41024
v_lshl_add_u32 v251, v218, 2, v219
v_mfma_f32_16x16x32_bf16 v[148:151], a[252:255], a[184:187], v[148:151]
s_cmp_ge_u32 s36, 2
s_cselect_b64 s[84:85], s[86:87], s[84:85]
v_mfma_f32_16x16x32_bf16 v[156:159], a[248:251], a[172:175], v[156:159]
ds_read_b64_tr_b16 a[242:243], v226 offset:43584
s_waitcnt vmcnt(11)
v_subrev_u32 v239, s51, v239
v_mfma_f32_16x16x32_bf16 v[156:159], a[252:255], a[188:191], v[156:159]
s_waitcnt lgkmcnt(6)
buffer_load_dwordx4 v235, s[52:55], s30 offen offset:0 lds
v_lshl_add_u32 v246, v218, 8, v219
v_mfma_f32_16x16x32_bf16 v[0:3], a[224:227], a[192:195], v[0:3]
ds_read_b64_tr_b16 a[244:245], v226 offset:51264
v_cmp_lt_u32 vcc, 1, v239
v_mfma_f32_16x16x32_bf16 v[0:3], a[228:231], a[208:211], v[0:3]
s_add_u32 s8, s84, s81
s_addc_u32 s9, s85, 0
v_add_u32 v247, 20480, v246
v_mfma_f32_16x16x32_bf16 v[8:11], a[224:227], a[196:199], v[8:11]
ds_read_b64_tr_b16 a[246:247], v226 offset:53824
v_mfma_f32_16x16x32_bf16 v[8:11], a[228:231], a[212:215], v[8:11]
v_mul_u32_u24 v219, 5120, v215
s_cbranch_vccnz L_slow_o2
L_back_o2:
v_mfma_f32_16x16x32_bf16 v[80:83], a[224:227], a[200:203], v[80:83]
s_mov_b32 s10, s82
ds_read_b64_tr_b16 a[248:249], v227 offset:41024
v_mfma_f32_16x16x32_bf16 v[80:83], a[228:231], a[216:219], v[80:83]
s_add_u32 s32, s44, 8192
v_add_u32 v252, v219, v251
v_mfma_f32_16x16x32_bf16 v[88:91], a[224:227], a[204:207], v[88:91]
ds_read_b64_tr_b16 a[250:251], v227 offset:43584
buffer_load_dwordx4 a[64:67], v238, s[24:27], s32 offen offset:0 sc1
v_mfma_f32_16x16x32_bf16 v[88:91], a[228:231], a[220:223], v[88:91]
s_waitcnt lgkmcnt(6)
v_lshl_add_u32 v219, v217, 10, v219
v_mfma_f32_16x16x32_bf16 v[4:7], a[232:235], a[192:195], v[4:7]
s_mov_b32 s11, 0x20000
ds_read_b64_tr_b16 a[252:253], v227 offset:51264
v_mfma_f32_16x16x32_bf16 v[4:7], a[236:239], a[208:211], v[4:7]
v_and_b32 v250, 0xf0, v238
v_mfma_f32_16x16x32_bf16 v[12:15], a[232:235], a[196:199], v[12:15]
ds_read_b64_tr_b16 a[254:255], v227 offset:53824
v_mfma_f32_16x16x32_bf16 v[12:15], a[236:239], a[212:215], v[12:15]
buffer_load_dwordx4 a[68:71], v238, s[24:27], s32 offen offset:1024 sc1
v_add_u32 v250, v219, v250
v_mfma_f32_16x16x32_bf16 v[84:87], a[232:235], a[200:203], v[84:87]
s_lshr_b32 s83, s2, 3
ds_read_b64_tr_b16 a[224:225], v226 offset:41088
v_mfma_f32_16x16x32_bf16 v[84:87], a[236:239], a[216:219], v[84:87]
s_add_u32 s32, s44, 12288
v_lshrrev_b32 v219, 1, v217
v_mfma_f32_16x16x32_bf16 v[92:95], a[232:235], a[204:207], v[92:95]
ds_read_b64_tr_b16 a[226:227], v226 offset:43648
v_mfma_f32_16x16x32_bf16 v[92:95], a[236:239], a[220:223], v[92:95]
s_waitcnt lgkmcnt(6)
v_and_b32 v217, 1, v217
v_mfma_f32_16x16x32_bf16 v[16:19], a[240:243], a[192:195], v[16:19]
s_lshr_b32 s81, s2, 1
ds_read_b64_tr_b16 a[228:229], v226 offset:51328
buffer_load_dwordx4 a[72:75], v238, s[24:27], s32 offen offset:0 sc1
v_mfma_f32_16x16x32_bf16 v[16:19], a[244:247], a[208:211], v[16:19]
v_and_b32 v221, 0xf0, v238
v_mfma_f32_16x16x32_bf16 v[24:27], a[240:243], a[196:199], v[24:27]
ds_read_b64_tr_b16 a[230:231], v226 offset:53888
v_mfma_f32_16x16x32_bf16 v[24:27], a[244:247], a[212:215], v[24:27]
v_lshl_add_u32 v221, v219, 8, v221
v_mfma_f32_16x16x32_bf16 v[96:99], a[240:243], a[200:203], v[96:99]
s_and_b32 s81, s81, 3
ds_read_b64_tr_b16 a[232:233], v227 offset:41088
v_mfma_f32_16x16x32_bf16 v[96:99], a[244:247], a[216:219], v[96:99]
buffer_load_dwordx4 a[76:79], v238, s[24:27], s32 offen offset:1024 sc1
v_lshlrev_b32 v219, 4, v219
v_mfma_f32_16x16x32_bf16 v[104:107], a[240:243], a[204:207], v[104:107]
s_add_u32 m0, s47, 61440
ds_read_b64_tr_b16 a[234:235], v227 offset:43648
v_mfma_f32_16x16x32_bf16 v[104:107], a[244:247], a[220:223], v[104:107]
s_waitcnt lgkmcnt(6)
v_lshl_add_u32 v219, v217, 2, v219
v_mfma_f32_16x16x32_bf16 v[20:23], a[248:251], a[192:195], v[20:23]
s_mul_i32 s81, s81, 28
ds_read_b64_tr_b16 a[236:237], v227 offset:51328
v_mfma_f32_16x16x32_bf16 v[20:23], a[252:255], a[208:211], v[20:23]
s_add_u32 s30, s42, 81920
v_add_u32 v219, v219, v218
v_mfma_f32_16x16x32_bf16 v[28:31], a[248:251], a[196:199], v[28:31]
ds_read_b64_tr_b16 a[238:239], v227 offset:53888
buffer_load_dwordx4 v231, s[52:55], s30 offen offset:0 lds
v_mfma_f32_16x16x32_bf16 v[28:31], a[252:255], a[212:215], v[28:31]
v_mul_u32_u24 v219, 96, v219
v_mfma_f32_16x16x32_bf16 v[100:103], a[248:251], a[200:203], v[100:103]
s_add_u32 s83, s83, s81
ds_read_b64_tr_b16 a[240:241], v226 offset:41152
v_mfma_f32_16x16x32_bf16 v[100:103], a[252:255], a[216:219], v[100:103]
v_lshl_add_u32 v230, v216, 3, v219
v_mfma_f32_16x16x32_bf16 v[108:111], a[248:251], a[204:207], v[108:111]
ds_read_b64_tr_b16 a[242:243], v226 offset:43712
v_mfma_f32_16x16x32_bf16 v[108:111], a[252:255], a[220:223], v[108:111]
s_waitcnt lgkmcnt(6)
buffer_load_dwordx4 v232, s[52:55], s30 offen offset:1024 lds
v_add_u32 v223, 61440, v230
v_mfma_f32_16x16x32_bf16 v[32:35], a[224:227], a[192:195], v[32:35]
s_cmp_ge_u32 s2, 224
s_cselect_b32 s83, 110, s83
ds_read_b64_tr_b16 a[244:245], v226 offset:51392
v_mfma_f32_16x16x32_bf16 v[32:35], a[228:231], a[208:211], v[32:35]
v_mul_u32_u24 v217, 49152, v217
v_mfma_f32_16x16x32_bf16 v[40:43], a[224:227], a[196:199], v[40:43]
ds_read_b64_tr_b16 a[246:247], v226 offset:53952
v_mfma_f32_16x16x32_bf16 v[40:43], a[228:231], a[212:215], v[40:43]
v_add_u32 v221, v221, v217
v_mfma_f32_16x16x32_bf16 v[112:115], a[224:227], a[200:203], v[112:115]
s_mul_i32 s78, s83, 205
ds_read_b64_tr_b16 a[248:249], v227 offset:41152
buffer_load_dwordx4 v233, s[52:55], s30 offen offset:2048 lds
v_mfma_f32_16x16x32_bf16 v[112:115], a[228:231], a[216:219], v[112:115]
v_and_b32 v216, 1, v215
v_mfma_f32_16x16x32_bf16 v[120:123], a[224:227], a[204:207], v[120:123]
ds_read_b64_tr_b16 a[250:251], v227 offset:43712
v_mfma_f32_16x16x32_bf16 v[120:123], a[228:231], a[220:223], v[120:123]
s_waitcnt lgkmcnt(6)
v_lshlrev_b32 v216, 5, v216
v_mfma_f32_16x16x32_bf16 v[36:39], a[232:235], a[192:195], v[36:39]
s_lshr_b32 s78, s78, 10
ds_read_b64_tr_b16 a[252:253], v227 offset:51392
v_mfma_f32_16x16x32_bf16 v[36:39], a[236:239], a[208:211], v[36:39]
buffer_load_dwordx4 v234, s[52:55], s30 offen offset:3072 lds
v_add_u32 v217, 0, v214
v_mfma_f32_16x16x32_bf16 v[44:47], a[232:235], a[196:199], v[44:47]
s_add_u32 m0, s47, 65536
ds_read_b64_tr_b16 a[254:255], v227 offset:53952
v_mfma_f32_16x16x32_bf16 v[44:47], a[236:239], a[212:215], v[44:47]
v_mul_u32_u24 v218, 10923, v217
v_mfma_f32_16x16x32_bf16 v[116:119], a[232:235], a[200:203], v[116:119]
s_mul_i32 s81, s78, 5
ds_read_b64_tr_b16 a[224:225], v226 offset:41216
v_mfma_f32_16x16x32_bf16 v[116:119], a[236:239], a[216:219], v[116:119]
v_lshrrev_b32 v218, 16, v218
v_mfma_f32_16x16x32_bf16 v[124:127], a[232:235], a[204:207], v[124:127]
ds_read_b64_tr_b16 a[226:227], v226 offset:43776
buffer_load_dwordx4 v235, s[52:55], s30 offen offset:0 lds
v_mfma_f32_16x16x32_bf16 v[124:127], a[236:239], a[220:223], v[124:127]
s_waitcnt lgkmcnt(6)
v_mul_u32_u24 v219, 6, v218
v_mfma_f32_16x16x32_bf16 v[48:51], a[240:243], a[192:195], v[48:51]
s_sub_u32 s79, s83, s81
ds_read_b64_tr_b16 a[228:229], v226 offset:51456
v_mfma_f32_16x16x32_bf16 v[48:51], a[244:247], a[208:211], v[48:51]
s_add_u32 s32, s45, 8192
v_sub_u32 v217, v217, v219
v_mfma_f32_16x16x32_bf16 v[56:59], a[240:243], a[196:199], v[56:59]
ds_read_b64_tr_b16 a[230:231], v226 offset:54016
v_mfma_f32_16x16x32_bf16 v[56:59], a[244:247], a[212:215], v[56:59]
buffer_load_dwordx4 a[80:83], v238, s[24:27], s32 offen offset:0 sc1
v_lshrrev_b32 v219, 1, v218
v_mfma_f32_16x16x32_bf16 v[128:131], a[240:243], a[200:203], v[128:131]
s_and_b32 s81, s2, 1
ds_read_b64_tr_b16 a[232:233], v227 offset:41216
v_mfma_f32_16x16x32_bf16 v[128:131], a[244:247], a[216:219], v[128:131]
v_xor_b32 v219, v219, v218
v_mfma_f32_16x16x32_bf16 v[136:139], a[240:243], a[204:207], v[136:139]
ds_read_b64_tr_b16 a[234:235], v227 offset:43776
v_mfma_f32_16x16x32_bf16 v[136:139], a[244:247], a[220:223], v[136:139]
s_waitcnt lgkmcnt(6)
v_and_b32 v219, 4, v219
v_mfma_f32_16x16x32_bf16 v[52:55], a[248:251], a[192:195], v[52:55]
s_mul_i32 s81, s81, 5
ds_read_b64_tr_b16 a[236:237], v227 offset:51456
buffer_load_dwordx4 a[84:87], v238, s[24:27], s32 offen offset:1024 sc1
v_mfma_f32_16x16x32_bf16 v[52:55], a[252:255], a[208:211], v[52:55]
s_add_u32 s32, s45, 12288
v_mul_u32_u24 v219, 3, v219
v_mfma_f32_16x16x32_bf16 v[60:63], a[248:251], a[196:199], v[60:63]
ds_read_b64_tr_b16 a[238:239], v227 offset:54016
v_mfma_f32_16x16x32_bf16 v[60:63], a[252:255], a[212:215], v[60:63]
v_xor_b32 v218, v218, v219
v_mfma_f32_16x16x32_bf16 v[132:135], a[248:251], a[200:203], v[132:135]
s_barrier
ds_read_b64_tr_b16 a[240:241], v228 offset:0
v_mfma_f32_16x16x32_bf16 v[132:135], a[252:255], a[216:219], v[132:135]
s_add_u32 s79, s79, s81
buffer_load_dwordx4 a[88:91], v238, s[24:27], s32 offen offset:0 sc1
v_add_u32 v218, v218, v216
v_mfma_f32_16x16x32_bf16 v[140:143], a[248:251], a[204:207], v[140:143]
ds_read_b64_tr_b16 a[242:243], v228 offset:2560
v_mfma_f32_16x16x32_bf16 v[140:143], a[252:255], a[220:223], v[140:143]
s_waitcnt lgkmcnt(6)
v_mul_u32_u24 v218, 3072, v218
v_mfma_f32_16x16x32_bf16 v[64:67], a[224:227], a[192:195], v[64:67]
s_lshl_b32 s81, s79, 7
ds_read_b64_tr_b16 a[244:245], v228 offset:10240
v_mfma_f32_16x16x32_bf16 v[64:67], a[228:231], a[208:211], v[64:67]
v_lshl_add_u32 v218, v217, 4, v218
v_mfma_f32_16x16x32_bf16 v[72:75], a[224:227], a[196:199], v[72:75]
ds_read_b64_tr_b16 a[246:247], v228 offset:12800
buffer_load_dwordx4 a[92:95], v238, s[24:27], s32 offen offset:1024 sc1
v_mfma_f32_16x16x32_bf16 v[72:75], a[228:231], a[212:215], v[72:75]
v_add_u32 v243, 0, v218
v_mfma_f32_16x16x32_bf16 v[144:147], a[224:227], a[200:203], v[144:147]
s_sub_u32 s82, 1966080, s81
ds_read_b64_tr_b16 a[248:249], v229 offset:0
v_mfma_f32_16x16x32_bf16 v[144:147], a[228:231], a[216:219], v[144:147]
s_add_u32 m0, s47, 81920
v_add_u32 v217, 64, v214
v_mfma_f32_16x16x32_bf16 v[152:155], a[224:227], a[204:207], v[152:155]
s_add_u32 s30, s43, 81920
ds_read_b64_tr_b16 a[250:251], v229 offset:2560
v_mfma_f32_16x16x32_bf16 v[152:155], a[228:231], a[220:223], v[152:155]
s_waitcnt lgkmcnt(6)
buffer_load_dwordx4 v231, s[52:55], s30 offen offset:0 lds
v_mul_u32_u24 v218, 10923, v217
v_mfma_f32_16x16x32_bf16 v[68:71], a[232:235], a[192:195], v[68:71]
s_cmp_ge_u32 s78, 22
s_cselect_b32 s82, 0, s82
ds_read_b64_tr_b16 a[252:253], v229 offset:10240
v_mfma_f32_16x16x32_bf16 v[68:71], a[236:239], a[208:211], v[68:71]
v_lshrrev_b32 v218, 16, v218
v_mfma_f32_16x16x32_bf16 v[76:79], a[232:235], a[196:199], v[76:79]
ds_read_b64_tr_b16 a[254:255], v229 offset:12800
v_mfma_f32_16x16x32_bf16 v[76:79], a[236:239], a[212:215], v[76:79]
v_mul_u32_u24 v219, 6, v218
v_mfma_f32_16x16x32_bf16 v[148:151], a[232:235], a[200:203], v[148:151]
s_add_u32 s12, s88, s81
s_addc_u32 s13, s89, 0
ds_read_b64_tr_b16 a[224:225], v228 offset:64
v_mfma_f32_16x16x32_bf16 v[148:151], a[236:239], a[216:219], v[148:151]
v_sub_u32 v217, v217, v219
v_mfma_f32_16x16x32_bf16 v[156:159], a[232:235], a[204:207], v[156:159]
ds_read_b64_tr_b16 a[226:227], v228 offset:2624
v_mfma_f32_16x16x32_bf16 v[156:159], a[236:239], a[220:223], v[156:159]
L_pg12:
s_cbranch_execz L_ret_A
s_waitcnt lgkmcnt(6)
v_lshrrev_b32 v219, 1, v218
v_mfma_f32_16x16x32_bf16 v[0:3], a[240:243], a[0:3], v[0:3]
s_mov_b32 s14, s82
ds_read_b64_tr_b16 a[228:229], v228 offset:10304
buffer_load_dword v239, v236, s[24:27], 0 offen sc1
v_mfma_f32_16x16x32_bf16 v[0:3], a[244:247], a[16:19], v[0:3]
v_xor_b32 v219, v219, v218
v_mfma_f32_16x16x32_bf16 v[8:11], a[240:243], a[4:7], v[8:11]
ds_read_b64_tr_b16 a[230:231], v228 offset:12864
v_mfma_f32_16x16x32_bf16 v[8:11], a[244:247], a[20:23], v[8:11]
v_and_b32 v219, 4, v219
v_mfma_f32_16x16x32_bf16 v[80:83], a[240:243], a[8:11], v[80:83]
s_mov_b32 s15, 0x20000
ds_read_b64_tr_b16 a[232:233], v229 offset:64
buffer_load_dwordx4 v232, s[52:55], s30 offen offset:1024 lds
v_mfma_f32_16x16x32_bf16 v[80:83], a[244:247], a[24:27], v[80:83]
v_mul_u32_u24 v219, 3, v219
v_mfma_f32_16x16x32_bf16 v[88:91], a[240:243], a[12:15], v[88:91]
ds_read_b64_tr_b16 a[234:235], v229 offset:2624
v_mfma_f32_16x16x32_bf16 v[88:91], a[244:247], a[28:31], v[88:91]
s_waitcnt lgkmcnt(6)
v_xor_b32 v218, v218, v219
v_mfma_f32_16x16x32_bf16 v[4:7], a[248:251], a[0:3], v[4:7]
s_lshl_b32 s29, s36, 12
ds_read_b64_tr_b16 a[236:237], v229 offset:10304
v_mfma_f32_16x16x32_bf16 v[4:7], a[252:255], a[16:19], v[4:7]
buffer_load_dwordx4 v233, s[52:55], s30 offen offset:2048 lds
v_add_u32 v218, v218, v216
v_mfma_f32_16x16x32_bf16 v[12:15], a[248:251], a[4:7], v[12:15]
ds_read_b64_tr_b16 a[238:239], v229 offset:12864
v_mfma_f32_16x16x32_bf16 v[12:15], a[252:255], a[20:23], v[12:15]
v_mul_u32_u24 v218, 3072, v218
v_mfma_f32_16x16x32_bf16 v[84:87], a[248:251], a[8:11], v[84:87]
s_lshr_b32 s91, s2, 3
ds_read_b64_tr_b16 a[240:241], v228 offset:128
v_mfma_f32_16x16x32_bf16 v[84:87], a[252:255], a[24:27], v[84:87]
v_lshl_add_u32 v218, v217, 4, v218
v_mfma_f32_16x16x32_bf16 v[92:95], a[248:251], a[12:15], v[92:95]
ds_read_b64_tr_b16 a[242:243], v228 offset:2688
buffer_load_dwordx4 v234, s[52:55], s30 offen offset:3072 lds
v_mfma_f32_16x16x32_bf16 v[92:95], a[252:255], a[28:31], v[92:95]
s_waitcnt lgkmcnt(6)
v_add_u32 v244, 4294966272, v218
v_mfma_f32_16x16x32_bf16 v[16:19], a[224:227], a[0:3], v[16:19]
s_lshl_b32 s91, s91, 4
ds_read_b64_tr_b16 a[244:245], v228 offset:10368
v_mfma_f32_16x16x32_bf16 v[16:19], a[228:231], a[16:19], v[16:19]
s_add_u32 m0, s47, 86016
v_add_u32 v217, 128, v214
v_mfma_f32_16x16x32_bf16 v[24:27], a[224:227], a[4:7], v[24:27]
ds_read_b64_tr_b16 a[246:247], v228 offset:12928
v_mfma_f32_16x16x32_bf16 v[24:27], a[228:231], a[20:23], v[24:27]
buffer_load_dwordx4 v235, s[52:55], s30 offen offset:0 lds
v_mul_u32_u24 v218, 10923, v217
v_mfma_f32_16x16x32_bf16 v[96:99], a[224:227], a[8:11], v[96:99]
s_and_b32 s81, s2, 6
ds_read_b64_tr_b16 a[248:249], v229 offset:128
v_mfma_f32_16x16x32_bf16 v[96:99], a[228:231], a[24:27], v[96:99]
s_add_u32 m0, s47, 143360
v_lshrrev_b32 v218, 16, v218
v_mfma_f32_16x16x32_bf16 v[104:107], a[224:227], a[12:15], v[104:107]
s_add_u32 s30, s41, 163840
ds_read_b64_tr_b16 a[250:251], v229 offset:2688
v_mfma_f32_16x16x32_bf16 v[104:107], a[228:231], a[28:31], v[104:107]
s_waitcnt lgkmcnt(6)
v_mul_u32_u24 v219, 6, v218
v_mfma_f32_16x16x32_bf16 v[20:23], a[232:235], a[0:3], v[20:23]
s_add_u32 s91, s91, s81
ds_read_b64_tr_b16 a[252:253], v229 offset:10368
buffer_load_dwordx4 v231, s[52:55], s30 offen offset:0 lds
v_mfma_f32_16x16x32_bf16 v[20:23], a[236:239], a[16:19], v[20:23]
v_sub_u32 v217, v217, v219
v_mfma_f32_16x16x32_bf16 v[28:31], a[232:235], a[4:7], v[28:31]
ds_read_b64_tr_b16 a[254:255], v229 offset:12928
v_mfma_f32_16x16x32_bf16 v[28:31], a[236:239], a[20:23], v[28:31]
v_lshrrev_b32 v219, 1, v218
v_mfma_f32_16x16x32_bf16 v[100:103], a[232:235], a[8:11], v[100:103]
s_mul_i32 s91, s91, 5120
ds_read_b64_tr_b16 a[224:225], v228 offset:192
v_mfma_f32_16x16x32_bf16 v[100:103], a[236:239], a[24:27], v[100:103]
buffer_load_dwordx4 v232, s[52:55], s30 offen offset:1024 lds
v_xor_b32 v219, v219, v218
v_mfma_f32_16x16x32_bf16 v[108:111], a[232:235], a[12:15], v[108:111]
ds_read_b64_tr_b16 a[226:227], v228 offset:2752
v_mfma_f32_16x16x32_bf16 v[108:111], a[236:239], a[28:31], v[108:111]
s_waitcnt lgkmcnt(6)
v_and_b32 v219, 4, v219
v_mfma_f32_16x16x32_bf16 v[32:35], a[240:243], a[0:3], v[32:35]
s_mul_i32 s92, s2, 40960
ds_read_b64_tr_b16 a[228:229], v228 offset:10432
v_mfma_f32_16x16x32_bf16 v[32:35], a[244:247], a[16:19], v[32:35]
v_mul_u32_u24 v219, 3, v219
v_mfma_f32_16x16x32_bf16 v[40:43], a[240:243], a[4:7], v[40:43]
ds_read_b64_tr_b16 a[230:231], v228 offset:12992
buffer_load_dwordx4 v233, s[52:55], s30 offen offset:2048 lds
v_mfma_f32_16x16x32_bf16 v[40:43], a[244:247], a[20:23], v[40:43]
v_xor_b32 v218, v218, v219
v_mfma_f32_16x16x32_bf16 v[112:115], a[240:243], a[8:11], v[112:115]
s_mul_i32 s81, s36, 10240
ds_read_b64_tr_b16 a[232:233], v229 offset:192
v_mfma_f32_16x16x32_bf16 v[112:115], a[244:247], a[24:27], v[112:115]
v_add_u32 v218, v218, v216
v_mfma_f32_16x16x32_bf16 v[120:123], a[240:243], a[12:15], v[120:123]
ds_read_b64_tr_b16 a[234:235], v229 offset:2752
v_mfma_f32_16x16x32_bf16 v[120:123], a[244:247], a[28:31], v[120:123]
s_waitcnt lgkmcnt(6)
buffer_load_dwordx4 v234, s[52:55], s30 offen offset:3072 lds
v_mul_u32_u24 v218, 3072, v218
v_mfma_f32_16x16x32_bf16 v[36:39], a[248:251], a[0:3], v[36:39]
s_add_u32 s92, s92, s81
ds_read_b64_tr_b16 a[236:237], v229 offset:10432
v_mfma_f32_16x16x32_bf16 v[36:39], a[252:255], a[16:19], v[36:39]
s_add_u32 m0, s47, 147456
v_lshl_add_u32 v218, v217, 4, v218
v_mfma_f32_16x16x32_bf16 v[44:47], a[248:251], a[4:7], v[44:47]
ds_read_b64_tr_b16 a[238:239], v229 offset:12992
v_mfma_f32_16x16x32_bf16 v[44:47], a[252:255], a[20:23], v[44:47]
v_add_u32 v245, 4294965248, v218
v_mfma_f32_16x16x32_bf16 v[116:119], a[248:251], a[8:11], v[116:119]
s_add_u32 s92, s92, 33554432
ds_read_b64_tr_b16 a[240:241], v228 offset:256
buffer_load_dwordx4 v235, s[52:55], s30 offen offset:0 lds
v_mfma_f32_16x16x32_bf16 v[116:119], a[252:255], a[24:27], v[116:119]
s_add_u32 s32, s46, 8192
v_lshrrev_b32 v216, 3, v214
v_mfma_f32_16x16x32_bf16 v[124:127], a[248:251], a[12:15], v[124:127]
ds_read_b64_tr_b16 a[242:243], v228 offset:2816
v_mfma_f32_16x16x32_bf16 v[124:127], a[252:255], a[28:31], v[124:127]
s_waitcnt lgkmcnt(6)
v_and_b32 v217, 2, v216
v_mfma_f32_16x16x32_bf16 v[48:51], a[224:227], a[0:3], v[48:51]
s_lshr_b32 s90, s2, 3
ds_read_b64_tr_b16 a[244:245], v228 offset:10496
v_mfma_f32_16x16x32_bf16 v[48:51], a[228:231], a[16:19], v[48:51]
buffer_load_dwordx4 a[96:99], v238, s[24:27], s32 offen offset:0 sc1
v_or_b32 v217, 0, v217
v_mfma_f32_16x16x32_bf16 v[56:59], a[224:227], a[4:7], v[56:59]
ds_read_b64_tr_b16 a[246:247], v228 offset:13056
v_mfma_f32_16x16x32_bf16 v[56:59], a[228:231], a[20:23], v[56:59]
v_and_b32 v218, 7, v214
v_mfma_f32_16x16x32_bf16 v[128:131], a[224:227], a[8:11], v[128:131]
s_lshl_b32 s90, s90, 2
ds_read_b64_tr_b16 a[248:249], v229 offset:256
v_mfma_f32_16x16x32_bf16 v[128:131], a[228:231], a[24:27], v[128:131]
v_xor_b32 v217, v217, v218
v_mfma_f32_16x16x32_bf16 v[136:139], a[224:227], a[12:15], v[136:139]
ds_read_b64_tr_b16 a[250:251], v229 offset:2816
buffer_load_dwordx4 a[100:103], v238, s[24:27], s32 offen offset:1024 sc1
v_mfma_f32_16x16x32_bf16 v[136:139], a[228:231], a[28:31], v[136:139]
s_waitcnt lgkmcnt(6)
v_lshl_add_u32 v216, v215, 5, v216
v_mfma_f32_16x16x32_bf16 v[52:55], a[232:235], a[0:3], v[52:55]
s_add_u32 s90, s90, s36
ds_read_b64_tr_b16 a[252:253], v229 offset:10496
v_mfma_f32_16x16x32_bf16 v[52:55], a[236:239], a[16:19], v[52:55]
s_add_u32 s32, s46, 12288
v_add_u32 v216, 0, v216
v_mfma_f32_16x16x32_bf16 v[60:63], a[232:235], a[4:7], v[60:63]
ds_read_b64_tr_b16 a[254:255], v229 offset:13056
v_mfma_f32_16x16x32_bf16 v[60:63], a[236:239], a[20:23], v[60:63]
buffer_load_dwordx4 a[104:107], v238, s[24:27], s32 offen offset:0 sc1
v_mul_u32_u24 v216, 1280, v216
v_mfma_f32_16x16x32_bf16 v[132:135], a[232:235], a[8:11], v[132:135]
s_barrier
ds_read_b64_tr_b16 a[224:225], v224 offset:0
v_mfma_f32_16x16x32_bf16 v[132:135], a[236:239], a[24:27], v[132:135]
s_lshl_b32 s90, s90, 10
v_lshl_add_u32 v216, v217, 4, v216
v_mfma_f32_16x16x32_bf16 v[140:143], a[232:235], a[12:15], v[140:143]
ds_read_b64_tr_b16 a[226:227], v224 offset:2560
v_mfma_f32_16x16x32_bf16 v[140:143], a[236:239], a[28:31], v[140:143]
s_waitcnt lgkmcnt(6)
v_subrev_u32 v248, 0, v216
v_mfma_f32_16x16x32_bf16 v[64:67], a[240:243], a[0:3], v[64:67]
s_add_u32 s90, s90, 3145728
ds_read_b64_tr_b16 a[228:229], v224 offset:10240
buffer_load_dwordx4 a[108:111], v238, s[24:27], s32 offen offset:1024 sc1
v_mfma_f32_16x16x32_bf16 v[64:67], a[244:247], a[16:19], v[64:67]
s_add_u32 m0, s47, 102400
v_lshrrev_b32 v216, 3, v214
v_mfma_f32_16x16x32_bf16 v[72:75], a[240:243], a[4:7], v[72:75]
s_add_u32 s30, s42, 163840
ds_read_b64_tr_b16 a[230:231], v224 offset:12800
v_mfma_f32_16x16x32_bf16 v[72:75], a[244:247], a[20:23], v[72:75]
v_and_b32 v217, 2, v216
v_mfma_f32_16x16x32_bf16 v[144:147], a[240:243], a[8:11], v[144:147]
s_mul_i32 s48, s76, 81920
ds_read_b64_tr_b16 a[232:233], v225 offset:0
v_mfma_f32_16x16x32_bf16 v[144:147], a[244:247], a[24:27], v[144:147]
buffer_load_dwordx4 v231, s[52:55], s30 offen offset:0 lds
v_or_b32 v217, 4, v217
v_mfma_f32_16x16x32_bf16 v[152:155], a[240:243], a[12:15], v[152:155]
ds_read_b64_tr_b16 a[234:235], v225 offset:2560
s_waitcnt vmcnt(14)
v_cmp_ne_u32 vcc, s51, v239
v_mfma_f32_16x16x32_bf16 v[152:155], a[244:247], a[28:31], v[152:155]
s_waitcnt lgkmcnt(6)
v_and_b32 v218, 7, v214
v_mfma_f32_16x16x32_bf16 v[68:71], a[248:251], a[0:3], v[68:71]
s_add_u32 s48, s48, 54525952
ds_read_b64_tr_b16 a[236:237], v225 offset:10240
v_mfma_f32_16x16x32_bf16 v[68:71], a[252:255], a[16:19], v[68:71]
v_xor_b32 v217, v217, v218
s_cbranch_vccnz L_slow_o3
L_back_o3:
v_mfma_f32_16x16x32_bf16 v[76:79], a[248:251], a[4:7], v[76:79]
ds_read_b64_tr_b16 a[238:239], v225 offset:12800
buffer_load_dwordx4 v232, s[52:55], s30 offen offset:1024 lds
v_mfma_f32_16x16x32_bf16 v[76:79], a[252:255], a[20:23], v[76:79]
v_lshl_add_u32 v216, v215, 5, v216
v_mfma_f32_16x16x32_bf16 v[148:151], a[248:251], a[8:11], v[148:151]
s_mul_i32 s80, s76, 196608
ds_read_b64_tr_b16 a[240:241], v224 offset:64
v_mfma_f32_16x16x32_bf16 v[148:151], a[252:255], a[24:27], v[148:151]
v_add_u32 v216, 8, v216
v_mfma_f32_16x16x32_bf16 v[156:159], a[248:251], a[12:15], v[156:159]
ds_read_b64_tr_b16 a[242:243], v224 offset:2624
v_mfma_f32_16x16x32_bf16 v[156:159], a[252:255], a[28:31], v[156:159]
s_waitcnt lgkmcnt(6)
buffer_load_dwordx4 v233, s[52:55], s30 offen offset:2048 lds
v_mul_u32_u24 v216, 1280, v216
v_mfma_f32_16x16x32_bf16 v[0:3], a[224:227], a[32:35], v[0:3]
s_mul_i32 s81, s77, 1536
ds_read_b64_tr_b16 a[244:245], v224 offset:10304
v_mfma_f32_16x16x32_bf16 v[0:3], a[228:231], a[40:43], v[0:3]
ds_read_b64_tr_b16 a[246:247], v224 offset:12864
v_lshl_add_u32 v216, v217, 4, v216
v_mfma_f32_16x16x32_bf16 v[8:11], a[224:227], a[36:39], v[8:11]
ds_read_b64_tr_b16 a[248:249], v225 offset:64
v_mfma_f32_16x16x32_bf16 v[8:11], a[228:231], a[44:47], v[8:11]
s_waitcnt lgkmcnt(5)
ds_read_b64_tr_b16 a[250:251], v225 offset:2624
v_subrev_u32 v249, 1024, v216
v_mfma_f32_16x16x32_bf16 v[4:7], a[232:235], a[32:35], v[4:7]
s_add_u32 s80, s80, s81
ds_read_b64_tr_b16 a[252:253], v225 offset:10304
buffer_load_dwordx4 v234, s[52:55], s30 offen offset:3072 lds
v_mfma_f32_16x16x32_bf16 v[4:7], a[236:239], a[40:43], v[4:7]
ds_read_b64_tr_b16 a[254:255], v225 offset:12864
v_mfma_f32_16x16x32_bf16 v[12:15], a[232:235], a[36:39], v[12:15]
s_add_u32 m0, s47, 106496
ds_read_b64_tr_b16 a[224:225], v224 offset:128
v_mfma_f32_16x16x32_bf16 v[12:15], a[236:239], a[44:47], v[12:15]
s_waitcnt lgkmcnt(5)
ds_read_b64_tr_b16 a[226:227], v224 offset:2688
v_mfma_f32_16x16x32_bf16 v[16:19], a[240:243], a[32:35], v[16:19]
s_add_u32 s80, s80, 62914560
ds_read_b64_tr_b16 a[228:229], v224 offset:10368
v_mfma_f32_16x16x32_bf16 v[16:19], a[244:247], a[40:43], v[16:19]
ds_read_b64_tr_b16 a[230:231], v224 offset:12928
buffer_load_dwordx4 v235, s[52:55], s30 offen offset:0 lds
v_mfma_f32_16x16x32_bf16 v[24:27], a[240:243], a[36:39], v[24:27]
s_add_u32 s32, s44, 16384
ds_read_b64_tr_b16 a[232:233], v225 offset:128
v_mfma_f32_16x16x32_bf16 v[24:27], a[244:247], a[44:47], v[24:27]
s_waitcnt lgkmcnt(5)
ds_read_b64_tr_b16 a[234:235], v225 offset:2688
v_mfma_f32_16x16x32_bf16 v[20:23], a[248:251], a[32:35], v[20:23]
s_lshl_b32 s82, s76, 10
ds_read_b64_tr_b16 a[236:237], v225 offset:10368
v_mfma_f32_16x16x32_bf16 v[20:23], a[252:255], a[40:43], v[20:23]
ds_read_b64_tr_b16 a[238:239], v225 offset:12928
v_mfma_f32_16x16x32_bf16 v[28:31], a[248:251], a[36:39], v[28:31]
ds_read_b64_tr_b16 a[240:241], v224 offset:192
buffer_load_dwordx4 a[112:115], v238, s[24:27], s32 offen offset:0 sc1
v_mfma_f32_16x16x32_bf16 v[28:31], a[252:255], a[44:47], v[28:31]
s_waitcnt lgkmcnt(5)
ds_read_b64_tr_b16 a[242:243], v224 offset:2752
v_mfma_f32_16x16x32_bf16 v[32:35], a[224:227], a[32:35], v[32:35]
s_add_u32 s82, s82, 3276800
ds_read_b64_tr_b16 a[244:245], v224 offset:10432
v_mfma_f32_16x16x32_bf16 v[32:35], a[228:231], a[40:43], v[32:35]
ds_read_b64_tr_b16 a[246:247], v224 offset:12992
v_mfma_f32_16x16x32_bf16 v[40:43], a[224:227], a[36:39], v[40:43]
ds_read_b64_tr_b16 a[248:249], v225 offset:192
v_mfma_f32_16x16x32_bf16 v[40:43], a[228:231], a[44:47], v[40:43]
s_waitcnt lgkmcnt(5)
ds_read_b64_tr_b16 a[250:251], v225 offset:2752
buffer_load_dwordx4 a[116:119], v238, s[24:27], s32 offen offset:1024 sc1
v_mfma_f32_16x16x32_bf16 v[36:39], a[232:235], a[32:35], v[36:39]
s_add_u32 s32, s44, 20480
ds_read_b64_tr_b16 a[252:253], v225 offset:10432
v_mfma_f32_16x16x32_bf16 v[36:39], a[236:239], a[40:43], v[36:39]
ds_read_b64_tr_b16 a[254:255], v225 offset:12992
v_bfe_u32 v255, v238, 4, 3
v_mfma_f32_16x16x32_bf16 v[44:47], a[232:235], a[36:39], v[44:47]
ds_read_b64_tr_b16 a[224:225], v224 offset:256
v_lshl_add_u32 v236, v255, 7, s90
v_mfma_f32_16x16x32_bf16 v[44:47], a[236:239], a[44:47], v[44:47]
s_waitcnt lgkmcnt(5)
ds_read_b64_tr_b16 a[226:227], v224 offset:2816
v_lshl_add_u32 v255, v255, 7, s82
v_mfma_f32_16x16x32_bf16 v[48:51], a[240:243], a[32:35], v[48:51]
s_lshl_b32 s81, s36, 15
ds_read_b64_tr_b16 a[228:229], v224 offset:10496
buffer_load_dwordx4 a[120:123], v238, s[24:27], s32 offen offset:0 sc1
v_mfma_f32_16x16x32_bf16 v[48:51], a[244:247], a[40:43], v[48:51]
ds_read_b64_tr_b16 a[230:231], v224 offset:13056
v_mfma_f32_16x16x32_bf16 v[56:59], a[240:243], a[36:39], v[56:59]
s_add_u32 s81, s81, 3538944
ds_read_b64_tr_b16 a[232:233], v225 offset:256
v_mfma_f32_16x16x32_bf16 v[56:59], a[244:247], a[44:47], v[56:59]
s_waitcnt lgkmcnt(5)
ds_read_b64_tr_b16 a[234:235], v225 offset:2816
v_lshrrev_b32 v220, 9, v238
v_mfma_f32_16x16x32_bf16 v[52:55], a[248:251], a[32:35], v[52:55]
ds_read_b64_tr_b16 a[236:237], v225 offset:10496
v_mul_u32_u24 v220, 12288, v220
v_mfma_f32_16x16x32_bf16 v[52:55], a[252:255], a[40:43], v[52:55]
ds_read_b64_tr_b16 a[238:239], v225 offset:13056
v_lshl_add_u32 v220, v238, 3, v220
v_mfma_f32_16x16x32_bf16 v[60:63], a[248:251], a[36:39], v[60:63]
s_barrier
ds_read_b64_tr_b16 a[240:241], v224 offset:20480
v_mfma_f32_16x16x32_bf16 v[60:63], a[252:255], a[44:47], v[60:63]
s_waitcnt lgkmcnt(5)
ds_read_b64_tr_b16 a[242:243], v224 offset:23040
v_add_u32 v220, s81, v220
v_mfma_f32_16x16x32_bf16 v[64:67], a[224:227], a[32:35], v[64:67]
s_or_b32 s81, s2, s36
s_cselect_b32 s81, 0x40000000, 0
ds_read_b64_tr_b16 a[244:245], v224 offset:30720
v_mfma_f32_16x16x32_bf16 v[64:67], a[228:231], a[40:43], v[64:67]
ds_read_b64_tr_b16 a[246:247], v224 offset:33280
v_mfma_f32_16x16x32_bf16 v[72:75], a[224:227], a[36:39], v[72:75]
s_add_u32 s81, s81, 3862528
ds_read_b64_tr_b16 a[248:249], v225 offset:20480
v_mfma_f32_16x16x32_bf16 v[72:75], a[228:231], a[44:47], v[72:75]
s_waitcnt lgkmcnt(5)
ds_read_b64_tr_b16 a[250:251], v225 offset:23040
v_mfma_f32_16x16x32_bf16 v[68:71], a[232:235], a[32:35], v[68:71]
ds_read_b64_tr_b16 a[252:253], v225 offset:30720
buffer_load_dword v239, v220, s[24:27], 0 offen sc1
v_mfma_f32_16x16x32_bf16 v[68:71], a[236:239], a[40:43], v[68:71]
ds_read_b64_tr_b16 a[254:255], v225 offset:33280
v_mfma_f32_16x16x32_bf16 v[76:79], a[232:235], a[36:39], v[76:79]
ds_read_b64_tr_b16 a[224:225], v224 offset:20544
v_mfma_f32_16x16x32_bf16 v[76:79], a[236:239], a[44:47], v[76:79]
s_waitcnt lgkmcnt(5)
ds_read_b64_tr_b16 a[226:227], v224 offset:23104
v_mfma_f32_16x16x32_bf16 v[0:3], a[240:243], a[48:51], v[0:3]
ds_read_b64_tr_b16 a[228:229], v224 offset:30784
buffer_load_dwordx4 a[124:127], v238, s[24:27], s32 offen offset:1024 sc1
v_mfma_f32_16x16x32_bf16 v[0:3], a[244:247], a[56:59], v[0:3]
ds_read_b64_tr_b16 a[230:231], v224 offset:33344
v_mfma_f32_16x16x32_bf16 v[8:11], a[240:243], a[52:55], v[8:11]
s_add_u32 m0, s47, 122880
ds_read_b64_tr_b16 a[232:233], v225 offset:20544
v_mfma_f32_16x16x32_bf16 v[8:11], a[244:247], a[60:63], v[8:11]
s_waitcnt lgkmcnt(5)
ds_read_b64_tr_b16 a[234:235], v225 offset:23104
v_mfma_f32_16x16x32_bf16 v[4:7], a[248:251], a[48:51], v[4:7]
s_add_u32 s30, s43, 163840
ds_read_b64_tr_b16 a[236:237], v225 offset:30784
v_mfma_f32_16x16x32_bf16 v[4:7], a[252:255], a[56:59], v[4:7]
ds_read_b64_tr_b16 a[238:239], v225 offset:33344
buffer_load_dwordx4 v231, s[52:55], s30 offen offset:0 lds
v_mfma_f32_16x16x32_bf16 v[12:15], a[248:251], a[52:55], v[12:15]
ds_read_b64_tr_b16 a[240:241], v224 offset:20608
v_mfma_f32_16x16x32_bf16 v[12:15], a[252:255], a[60:63], v[12:15]
s_waitcnt lgkmcnt(5)
ds_read_b64_tr_b16 a[242:243], v224 offset:23168
v_mfma_f32_16x16x32_bf16 v[16:19], a[224:227], a[48:51], v[16:19]
ds_read_b64_tr_b16 a[244:245], v224 offset:30848
v_mfma_f32_16x16x32_bf16 v[16:19], a[228:231], a[56:59], v[16:19]
ds_read_b64_tr_b16 a[246:247], v224 offset:33408
v_mfma_f32_16x16x32_bf16 v[24:27], a[224:227], a[52:55], v[24:27]
ds_read_b64_tr_b16 a[248:249], v225 offset:20608
buffer_load_dwordx4 v232, s[52:55], s30 offen offset:1024 lds
v_mfma_f32_16x16x32_bf16 v[24:27], a[228:231], a[60:63], v[24:27]
s_waitcnt lgkmcnt(5)
ds_read_b64_tr_b16 a[250:251], v225 offset:23168
v_mfma_f32_16x16x32_bf16 v[20:23], a[232:235], a[48:51], v[20:23]
ds_read_b64_tr_b16 a[252:253], v225 offset:30848
v_mfma_f32_16x16x32_bf16 v[20:23], a[236:239], a[56:59], v[20:23]
ds_read_b64_tr_b16 a[254:255], v225 offset:33408
v_mfma_f32_16x16x32_bf16 v[28:31], a[232:235], a[52:55], v[28:31]
ds_read_b64_tr_b16 a[224:225], v224 offset:20672
v_mfma_f32_16x16x32_bf16 v[28:31], a[236:239], a[60:63], v[28:31]
s_waitcnt lgkmcnt(5)
ds_read_b64_tr_b16 a[226:227], v224 offset:23232
buffer_load_dwordx4 v233, s[52:55], s30 offen offset:2048 lds
v_mfma_f32_16x16x32_bf16 v[32:35], a[240:243], a[48:51], v[32:35]
ds_read_b64_tr_b16 a[228:229], v224 offset:30912
v_mfma_f32_16x16x32_bf16 v[32:35], a[244:247], a[56:59], v[32:35]
ds_read_b64_tr_b16 a[230:231], v224 offset:33472
v_mfma_f32_16x16x32_bf16 v[40:43], a[240:243], a[52:55], v[40:43]
ds_read_b64_tr_b16 a[232:233], v225 offset:20672
v_mfma_f32_16x16x32_bf16 v[40:43], a[244:247], a[60:63], v[40:43]
s_waitcnt lgkmcnt(5)
ds_read_b64_tr_b16 a[234:235], v225 offset:23232
v_mfma_f32_16x16x32_bf16 v[36:39], a[248:251], a[48:51], v[36:39]
ds_read_b64_tr_b16 a[236:237], v225 offset:30912
buffer_load_dwordx4 v234, s[52:55], s30 offen offset:3072 lds
v_mfma_f32_16x16x32_bf16 v[36:39], a[252:255], a[56:59], v[36:39]
ds_read_b64_tr_b16 a[238:239], v225 offset:33472
v_mfma_f32_16x16x32_bf16 v[44:47], a[248:251], a[52:55], v[44:47]
s_add_u32 m0, s47, 126976
ds_read_b64_tr_b16 a[240:241], v224 offset:20736
v_mfma_f32_16x16x32_bf16 v[44:47], a[252:255], a[60:63], v[44:47]
s_waitcnt lgkmcnt(5)
ds_read_b64_tr_b16 a[242:243], v224 offset:23296
v_mfma_f32_16x16x32_bf16 v[48:51], a[224:227], a[48:51], v[48:51]
ds_read_b64_tr_b16 a[244:245], v224 offset:30976
v_mfma_f32_16x16x32_bf16 v[48:51], a[228:231], a[56:59], v[48:51]
ds_read_b64_tr_b16 a[246:247], v224 offset:33536
buffer_load_dwordx4 v235, s[52:55], s30 offen offset:0 lds
v_mfma_f32_16x16x32_bf16 v[56:59], a[224:227], a[52:55], v[56:59]
s_add_u32 s32, s45, 16384
ds_read_b64_tr_b16 a[248:249], v225 offset:20736
v_mfma_f32_16x16x32_bf16 v[56:59], a[228:231], a[60:63], v[56:59]
s_waitcnt lgkmcnt(5)
ds_read_b64_tr_b16 a[250:251], v225 offset:23296
v_mfma_f32_16x16x32_bf16 v[52:55], a[232:235], a[48:51], v[52:55]
ds_read_b64_tr_b16 a[252:253], v225 offset:30976
v_mfma_f32_16x16x32_bf16 v[52:55], a[236:239], a[56:59], v[52:55]
ds_read_b64_tr_b16 a[254:255], v225 offset:33536
v_mfma_f32_16x16x32_bf16 v[60:63], a[232:235], a[52:55], v[60:63]
s_barrier
ds_read_b64_tr_b16 a[224:225], v224 offset:40960
v_mfma_f32_16x16x32_bf16 v[60:63], a[236:239], a[60:63], v[60:63]
s_waitcnt lgkmcnt(5)
ds_read_b64_tr_b16 a[226:227], v224 offset:43520
buffer_load_dwordx4 a[128:131], v238, s[24:27], s32 offen offset:0 sc1
v_mfma_f32_16x16x32_bf16 v[64:67], a[240:243], a[48:51], v[64:67]
ds_read_b64_tr_b16 a[228:229], v224 offset:51200
v_mfma_f32_16x16x32_bf16 v[64:67], a[244:247], a[56:59], v[64:67]
ds_read_b64_tr_b16 a[230:231], v224 offset:53760
v_mfma_f32_16x16x32_bf16 v[72:75], a[240:243], a[52:55], v[72:75]
ds_read_b64_tr_b16 a[232:233], v225 offset:40960
v_mfma_f32_16x16x32_bf16 v[72:75], a[244:247], a[60:63], v[72:75]
s_waitcnt lgkmcnt(5)
ds_read_b64_tr_b16 a[234:235], v225 offset:43520
v_mfma_f32_16x16x32_bf16 v[68:71], a[248:251], a[48:51], v[68:71]
ds_read_b64_tr_b16 a[236:237], v225 offset:51200
buffer_load_dwordx4 a[132:135], v238, s[24:27], s32 offen offset:1024 sc1
v_mfma_f32_16x16x32_bf16 v[68:71], a[252:255], a[56:59], v[68:71]
ds_read_b64_tr_b16 a[238:239], v225 offset:53760
v_mfma_f32_16x16x32_bf16 v[76:79], a[248:251], a[52:55], v[76:79]
s_add_u32 s32, s45, 20480
ds_read_b64_tr_b16 a[240:241], v224 offset:41024
v_mfma_f32_16x16x32_bf16 v[76:79], a[252:255], a[60:63], v[76:79]
s_waitcnt lgkmcnt(5)
ds_read_b64_tr_b16 a[242:243], v224 offset:43584
s_waitcnt vmcnt(8)
v_subrev_u32 v239, s51, v239
v_mfma_f32_16x16x32_bf16 v[0:3], a[224:227], a[64:67], v[0:3]
ds_read_b64_tr_b16 a[244:245], v224 offset:51264
v_mfma_f32_16x16x32_bf16 v[0:3], a[228:231], a[72:75], v[0:3]
ds_read_b64_tr_b16 a[246:247], v224 offset:53824
v_cmp_lt_u32 vcc, 2, v239
v_mfma_f32_16x16x32_bf16 v[8:11], a[224:227], a[68:71], v[8:11]
ds_read_b64_tr_b16 a[248:249], v225 offset:41024
buffer_load_dwordx4 a[136:139], v238, s[24:27], s32 offen offset:0 sc1
v_mfma_f32_16x16x32_bf16 v[8:11], a[228:231], a[76:79], v[8:11]
s_waitcnt lgkmcnt(5)
ds_read_b64_tr_b16 a[250:251], v225 offset:43584
v_mfma_f32_16x16x32_bf16 v[4:7], a[232:235], a[64:67], v[4:7]
ds_read_b64_tr_b16 a[252:253], v225 offset:51264
s_cbranch_vccnz L_slow_m
L_back_m:
v_mfma_f32_16x16x32_bf16 v[4:7], a[236:239], a[72:75], v[4:7]
ds_read_b64_tr_b16 a[254:255], v225 offset:53824
v_mfma_f32_16x16x32_bf16 v[12:15], a[232:235], a[68:71], v[12:15]
ds_read_b64_tr_b16 a[224:225], v224 offset:41088
v_mfma_f32_16x16x32_bf16 v[12:15], a[236:239], a[76:79], v[12:15]
s_waitcnt lgkmcnt(5)
ds_read_b64_tr_b16 a[226:227], v224 offset:43648
buffer_load_dwordx4 a[140:143], v238, s[24:27], s32 offen offset:1024 sc1
v_mfma_f32_16x16x32_bf16 v[16:19], a[240:243], a[64:67], v[16:19]
s_add_u32 s32, s46, 16384
ds_read_b64_tr_b16 a[228:229], v224 offset:51328
v_mfma_f32_16x16x32_bf16 v[16:19], a[244:247], a[72:75], v[16:19]
ds_read_b64_tr_b16 a[230:231], v224 offset:53888
v_mfma_f32_16x16x32_bf16 v[24:27], a[240:243], a[68:71], v[24:27]
ds_read_b64_tr_b16 a[232:233], v225 offset:41088
v_mfma_f32_16x16x32_bf16 v[24:27], a[244:247], a[76:79], v[24:27]
s_waitcnt lgkmcnt(5)
ds_read_b64_tr_b16 a[234:235], v225 offset:43648
v_mfma_f32_16x16x32_bf16 v[20:23], a[248:251], a[64:67], v[20:23]
ds_read_b64_tr_b16 a[236:237], v225 offset:51328
buffer_load_dwordx4 a[144:147], v238, s[24:27], s32 offen offset:0 sc1
v_mfma_f32_16x16x32_bf16 v[20:23], a[252:255], a[72:75], v[20:23]
ds_read_b64_tr_b16 a[238:239], v225 offset:53888
v_mfma_f32_16x16x32_bf16 v[28:31], a[248:251], a[68:71], v[28:31]
ds_read_b64_tr_b16 a[240:241], v224 offset:41152
v_mfma_f32_16x16x32_bf16 v[28:31], a[252:255], a[76:79], v[28:31]
s_waitcnt lgkmcnt(5)
ds_read_b64_tr_b16 a[242:243], v224 offset:43712
v_mfma_f32_16x16x32_bf16 v[32:35], a[224:227], a[64:67], v[32:35]
ds_read_b64_tr_b16 a[244:245], v224 offset:51392
v_mfma_f32_16x16x32_bf16 v[32:35], a[228:231], a[72:75], v[32:35]
ds_read_b64_tr_b16 a[246:247], v224 offset:53952
buffer_load_dwordx4 a[148:151], v238, s[24:27], s32 offen offset:1024 sc1
v_mfma_f32_16x16x32_bf16 v[40:43], a[224:227], a[68:71], v[40:43]
s_add_u32 s32, s46, 20480
ds_read_b64_tr_b16 a[248:249], v225 offset:41152
v_mfma_f32_16x16x32_bf16 v[40:43], a[228:231], a[76:79], v[40:43]
s_waitcnt lgkmcnt(5)
ds_read_b64_tr_b16 a[250:251], v225 offset:43712
v_mfma_f32_16x16x32_bf16 v[36:39], a[232:235], a[64:67], v[36:39]
ds_read_b64_tr_b16 a[252:253], v225 offset:51392
v_mfma_f32_16x16x32_bf16 v[36:39], a[236:239], a[72:75], v[36:39]
ds_read_b64_tr_b16 a[254:255], v225 offset:53952
v_mfma_f32_16x16x32_bf16 v[44:47], a[232:235], a[68:71], v[44:47]
ds_read_b64_tr_b16 a[224:225], v224 offset:41216
buffer_load_dwordx4 a[152:155], v238, s[24:27], s32 offen offset:0 sc1
v_mfma_f32_16x16x32_bf16 v[44:47], a[236:239], a[76:79], v[44:47]
s_waitcnt lgkmcnt(5)
ds_read_b64_tr_b16 a[226:227], v224 offset:43776
v_mfma_f32_16x16x32_bf16 v[48:51], a[240:243], a[64:67], v[48:51]
ds_read_b64_tr_b16 a[228:229], v224 offset:51456
v_mfma_f32_16x16x32_bf16 v[48:51], a[244:247], a[72:75], v[48:51]
ds_read_b64_tr_b16 a[230:231], v224 offset:54016
v_mfma_f32_16x16x32_bf16 v[56:59], a[240:243], a[68:71], v[56:59]
ds_read_b64_tr_b16 a[232:233], v225 offset:41216
v_mfma_f32_16x16x32_bf16 v[56:59], a[244:247], a[76:79], v[56:59]
s_waitcnt lgkmcnt(5)
ds_read_b64_tr_b16 a[234:235], v225 offset:43776
buffer_load_dwordx4 a[156:159], v238, s[24:27], s32 offen offset:1024 sc1
v_mfma_f32_16x16x32_bf16 v[52:55], a[248:251], a[64:67], v[52:55]
s_add_u32 s32, s45, 0
ds_read_b64_tr_b16 a[236:237], v225 offset:51456
v_mfma_f32_16x16x32_bf16 v[52:55], a[252:255], a[72:75], v[52:55]
ds_read_b64_tr_b16 a[238:239], v225 offset:54016
v_mfma_f32_16x16x32_bf16 v[60:63], a[248:251], a[68:71], v[60:63]
s_barrier
ds_read_b64_tr_b16 a[240:241], v226 offset:0
v_mfma_f32_16x16x32_bf16 v[60:63], a[252:255], a[76:79], v[60:63]
s_waitcnt lgkmcnt(5)
ds_read_b64_tr_b16 a[242:243], v226 offset:2560
buffer_store_dword v241, v240, s[24:27], s81 offen sc1
v_mfma_f32_16x16x32_bf16 v[64:67], a[224:227], a[64:67], v[64:67]
ds_read_b64_tr_b16 a[244:245], v226 offset:10240
v_mfma_f32_16x16x32_bf16 v[64:67], a[228:231], a[72:75], v[64:67]
ds_read_b64_tr_b16 a[246:247], v226 offset:12800
v_mfma_f32_16x16x32_bf16 v[72:75], a[224:227], a[68:71], v[72:75]
ds_read_b64_tr_b16 a[248:249], v227 offset:0
v_mfma_f32_16x16x32_bf16 v[72:75], a[228:231], a[76:79], v[72:75]
s_waitcnt lgkmcnt(5)
ds_read_b64_tr_b16 a[250:251], v227 offset:2560
buffer_load_dwordx4 a[160:163], v238, s[24:27], s32 offen offset:2048 sc1
v_mfma_f32_16x16x32_bf16 v[68:71], a[232:235], a[64:67], v[68:71]
ds_read_b64_tr_b16 a[252:253], v227 offset:10240
v_mfma_f32_16x16x32_bf16 v[68:71], a[236:239], a[72:75], v[68:71]
ds_read_b64_tr_b16 a[254:255], v227 offset:12800
v_mfma_f32_16x16x32_bf16 v[76:79], a[232:235], a[68:71], v[76:79]
ds_read_b64_tr_b16 a[224:225], v226 offset:64
v_mfma_f32_16x16x32_bf16 v[76:79], a[236:239], a[76:79], v[76:79]
s_waitcnt lgkmcnt(5)
ds_read_b64_tr_b16 a[226:227], v226 offset:2624
v_mfma_f32_16x16x32_bf16 v[0:3], a[240:243], a[80:83], v[0:3]
ds_read_b64_tr_b16 a[228:229], v226 offset:10304
buffer_load_dwordx4 a[164:167], v238, s[24:27], s32 offen offset:3072 sc1
v_mfma_f32_16x16x32_bf16 v[0:3], a[244:247], a[88:91], v[0:3]
ds_read_b64_tr_b16 a[230:231], v226 offset:12864
v_mfma_f32_16x16x32_bf16 v[8:11], a[240:243], a[84:87], v[8:11]
s_add_u32 s32, s45, 4096
ds_read_b64_tr_b16 a[232:233], v227 offset:64
v_mfma_f32_16x16x32_bf16 v[8:11], a[244:247], a[92:95], v[8:11]
s_waitcnt lgkmcnt(5)
ds_read_b64_tr_b16 a[234:235], v227 offset:2624
v_mfma_f32_16x16x32_bf16 v[4:7], a[248:251], a[80:83], v[4:7]
L_pg13:
s_cbranch_execz L_ret_A
ds_read_b64_tr_b16 a[236:237], v227 offset:10304
v_mfma_f32_16x16x32_bf16 v[4:7], a[252:255], a[88:91], v[4:7]
ds_read_b64_tr_b16 a[238:239], v227 offset:12864
buffer_load_dwordx4 a[168:171], v238, s[24:27], s32 offen offset:2048 sc1
v_mfma_f32_16x16x32_bf16 v[12:15], a[248:251], a[84:87], v[12:15]
ds_read_b64_tr_b16 a[240:241], v226 offset:128
v_mfma_f32_16x16x32_bf16 v[12:15], a[252:255], a[92:95], v[12:15]
s_waitcnt lgkmcnt(5)
ds_read_b64_tr_b16 a[242:243], v226 offset:2688
v_mfma_f32_16x16x32_bf16 v[16:19], a[224:227], a[80:83], v[16:19]
ds_read_b64_tr_b16 a[244:245], v226 offset:10368
v_mfma_f32_16x16x32_bf16 v[16:19], a[228:231], a[88:91], v[16:19]
ds_read_b64_tr_b16 a[246:247], v226 offset:12928
v_mfma_f32_16x16x32_bf16 v[24:27], a[224:227], a[84:87], v[24:27]
ds_read_b64_tr_b16 a[248:249], v227 offset:128
buffer_load_dwordx4 a[172:175], v238, s[24:27], s32 offen offset:3072 sc1
v_mfma_f32_16x16x32_bf16 v[24:27], a[228:231], a[92:95], v[24:27]
s_waitcnt lgkmcnt(5)
ds_read_b64_tr_b16 a[250:251], v227 offset:2688
v_mfma_f32_16x16x32_bf16 v[20:23], a[232:235], a[80:83], v[20:23]
s_add_u32 s32, s46, 0
ds_read_b64_tr_b16 a[252:253], v227 offset:10368
v_mfma_f32_16x16x32_bf16 v[20:23], a[236:239], a[88:91], v[20:23]
ds_read_b64_tr_b16 a[254:255], v227 offset:12928
v_mfma_f32_16x16x32_bf16 v[28:31], a[232:235], a[84:87], v[28:31]
ds_read_b64_tr_b16 a[224:225], v226 offset:192
v_mfma_f32_16x16x32_bf16 v[28:31], a[236:239], a[92:95], v[28:31]
s_waitcnt lgkmcnt(5)
ds_read_b64_tr_b16 a[226:227], v226 offset:2752
buffer_load_dwordx4 a[176:179], v238, s[24:27], s32 offen offset:2048 sc1
v_mfma_f32_16x16x32_bf16 v[32:35], a[240:243], a[80:83], v[32:35]
ds_read_b64_tr_b16 a[228:229], v226 offset:10432
v_mfma_f32_16x16x32_bf16 v[32:35], a[244:247], a[88:91], v[32:35]
ds_read_b64_tr_b16 a[230:231], v226 offset:12992
v_mfma_f32_16x16x32_bf16 v[40:43], a[240:243], a[84:87], v[40:43]
ds_read_b64_tr_b16 a[232:233], v227 offset:192
v_mfma_f32_16x16x32_bf16 v[40:43], a[244:247], a[92:95], v[40:43]
s_waitcnt lgkmcnt(5)
ds_read_b64_tr_b16 a[234:235], v227 offset:2752
v_mfma_f32_16x16x32_bf16 v[36:39], a[248:251], a[80:83], v[36:39]
ds_read_b64_tr_b16 a[236:237], v227 offset:10432
buffer_load_dwordx4 a[180:183], v238, s[24:27], s32 offen offset:3072 sc1
v_mfma_f32_16x16x32_bf16 v[36:39], a[252:255], a[88:91], v[36:39]
ds_read_b64_tr_b16 a[238:239], v227 offset:12992
v_mfma_f32_16x16x32_bf16 v[44:47], a[248:251], a[84:87], v[44:47]
s_add_u32 s32, s46, 4096
ds_read_b64_tr_b16 a[240:241], v226 offset:256
v_mfma_f32_16x16x32_bf16 v[44:47], a[252:255], a[92:95], v[44:47]
s_waitcnt lgkmcnt(5)
ds_read_b64_tr_b16 a[242:243], v226 offset:2816
v_mfma_f32_16x16x32_bf16 v[48:51], a[224:227], a[80:83], v[48:51]
ds_read_b64_tr_b16 a[244:245], v226 offset:10496
v_mfma_f32_16x16x32_bf16 v[48:51], a[228:231], a[88:91], v[48:51]
ds_read_b64_tr_b16 a[246:247], v226 offset:13056
buffer_load_dwordx4 a[184:187], v238, s[24:27], s32 offen offset:2048 sc1
v_mfma_f32_16x16x32_bf16 v[56:59], a[224:227], a[84:87], v[56:59]
ds_read_b64_tr_b16 a[248:249], v227 offset:256
v_mfma_f32_16x16x32_bf16 v[56:59], a[228:231], a[92:95], v[56:59]
s_waitcnt lgkmcnt(5)
ds_read_b64_tr_b16 a[250:251], v227 offset:2816
v_mfma_f32_16x16x32_bf16 v[52:55], a[232:235], a[80:83], v[52:55]
ds_read_b64_tr_b16 a[252:253], v227 offset:10496
v_mfma_f32_16x16x32_bf16 v[52:55], a[236:239], a[88:91], v[52:55]
s_waitcnt vmcnt(16)
ds_read_b64_tr_b16 a[254:255], v227 offset:13056
v_mfma_f32_16x16x32_bf16 v[60:63], a[232:235], a[84:87], v[60:63]
s_barrier
ds_read_b64_tr_b16 a[224:225], v226 offset:20480
v_mfma_f32_16x16x32_bf16 v[60:63], a[236:239], a[92:95], v[60:63]
s_waitcnt lgkmcnt(5)
ds_read_b64_tr_b16 a[226:227], v226 offset:23040
buffer_load_dwordx4 a[188:191], v238, s[24:27], s32 offen offset:3072 sc1
v_mfma_f32_16x16x32_bf16 v[64:67], a[240:243], a[80:83], v[64:67]
s_lshr_b32 s40, s76, 2
ds_read_b64_tr_b16 a[228:229], v226 offset:30720
v_mfma_f32_16x16x32_bf16 v[64:67], a[244:247], a[88:91], v[64:67]
ds_read_b64_tr_b16 a[230:231], v226 offset:33280
v_mfma_f32_16x16x32_bf16 v[72:75], a[240:243], a[84:87], v[72:75]
s_add_u32 s32, s44, 8192
ds_read_b64_tr_b16 a[232:233], v227 offset:20480
v_mfma_f32_16x16x32_bf16 v[72:75], a[244:247], a[92:95], v[72:75]
s_waitcnt lgkmcnt(5)
ds_read_b64_tr_b16 a[234:235], v227 offset:23040
v_mfma_f32_16x16x32_bf16 v[68:71], a[248:251], a[80:83], v[68:71]
s_add_u32 s40, s40, s77
ds_read_b64_tr_b16 a[236:237], v227 offset:30720
buffer_load_dwordx4 a[192:195], v238, s[24:27], s32 offen offset:2048 sc1
v_mfma_f32_16x16x32_bf16 v[68:71], a[252:255], a[88:91], v[68:71]
ds_read_b64_tr_b16 a[238:239], v227 offset:33280
v_mfma_f32_16x16x32_bf16 v[76:79], a[248:251], a[84:87], v[76:79]
ds_read_b64_tr_b16 a[240:241], v228 offset:20480
v_mfma_f32_16x16x32_bf16 v[76:79], a[252:255], a[92:95], v[76:79]
s_waitcnt lgkmcnt(5)
ds_read_b64_tr_b16 a[242:243], v228 offset:23040
v_mfma_f32_16x16x32_bf16 v[0:3], a[224:227], a[96:99], v[0:3]
s_and_b32 s40, s40, 0
ds_read_b64_tr_b16 a[244:245], v228 offset:30720
v_mfma_f32_16x16x32_bf16 v[0:3], a[228:231], a[104:107], v[0:3]
ds_read_b64_tr_b16 a[246:247], v228 offset:33280
buffer_load_dwordx4 a[196:199], v238, s[24:27], s32 offen offset:3072 sc1
v_mfma_f32_16x16x32_bf16 v[8:11], a[224:227], a[100:103], v[8:11]
s_add_u32 s32, s44, 12288
ds_read_b64_tr_b16 a[248:249], v229 offset:20480
v_mfma_f32_16x16x32_bf16 v[8:11], a[228:231], a[108:111], v[8:11]
s_waitcnt lgkmcnt(5)
ds_read_b64_tr_b16 a[250:251], v229 offset:23040
v_mfma_f32_16x16x32_bf16 v[4:7], a[232:235], a[96:99], v[4:7]
s_add_u32 s41, s40, 0
ds_read_b64_tr_b16 a[252:253], v229 offset:30720
v_mfma_f32_16x16x32_bf16 v[4:7], a[236:239], a[104:107], v[4:7]
ds_read_b64_tr_b16 a[254:255], v229 offset:33280
v_mfma_f32_16x16x32_bf16 v[12:15], a[232:235], a[100:103], v[12:15]
ds_read_b64_tr_b16 a[224:225], v226 offset:40960
buffer_load_dwordx4 a[200:203], v238, s[24:27], s32 offen offset:2048 sc1
v_mfma_f32_16x16x32_bf16 v[12:15], a[236:239], a[108:111], v[12:15]
s_waitcnt lgkmcnt(5)
ds_read_b64_tr_b16 a[226:227], v226 offset:43520
v_mfma_f32_16x16x32_bf16 v[0:3], a[240:243], a[112:115], v[0:3]
s_sub_u32 s56, s41, 5
s_cselect_b32 s41, s41, s56
ds_read_b64_tr_b16 a[228:229], v226 offset:51200
v_mfma_f32_16x16x32_bf16 v[0:3], a[244:247], a[120:123], v[0:3]
ds_read_b64_tr_b16 a[230:231], v226 offset:53760
v_mfma_f32_16x16x32_bf16 v[8:11], a[240:243], a[116:119], v[8:11]
ds_read_b64_tr_b16 a[232:233], v227 offset:40960
v_mfma_f32_16x16x32_bf16 v[8:11], a[244:247], a[124:127], v[8:11]
s_waitcnt lgkmcnt(5)
ds_read_b64_tr_b16 a[234:235], v227 offset:43520
buffer_load_dwordx4 a[204:207], v238, s[24:27], s32 offen offset:3072 sc1
v_mfma_f32_16x16x32_bf16 v[4:7], a[248:251], a[112:115], v[4:7]
s_mul_i32 s56, s41, 393216
ds_read_b64_tr_b16 a[236:237], v227 offset:51200
v_mfma_f32_16x16x32_bf16 v[4:7], a[252:255], a[120:123], v[4:7]
ds_read_b64_tr_b16 a[238:239], v227 offset:53760
v_mfma_f32_16x16x32_bf16 v[12:15], a[248:251], a[116:119], v[12:15]
s_add_u32 s32, s45, 8192
ds_read_b64_tr_b16 a[240:241], v228 offset:0
v_mfma_f32_16x16x32_bf16 v[12:15], a[252:255], a[124:127], v[12:15]
s_waitcnt vmcnt(18) lgkmcnt(5)
ds_read_b64_tr_b16 a[242:243], v228 offset:2560
v_mfma_f32_16x16x32_bf16 v[0:3], a[224:227], a[128:131], v[0:3]
s_lshl_b32 s41, s41, 12
ds_read_b64_tr_b16 a[244:245], v228 offset:10240
buffer_load_dwordx4 a[208:211], v238, s[24:27], s32 offen offset:2048 sc1
v_mfma_f32_16x16x32_bf16 v[0:3], a[228:231], a[136:139], v[0:3]
s_waitcnt vmcnt(18)
ds_read_b64_tr_b16 a[246:247], v228 offset:12800
v_mfma_f32_16x16x32_bf16 v[8:11], a[224:227], a[132:135], v[8:11]
ds_read_b64_tr_b16 a[248:249], v229 offset:0
v_mfma_f32_16x16x32_bf16 v[8:11], a[228:231], a[140:143], v[8:11]
s_waitcnt lgkmcnt(5)
ds_read_b64_tr_b16 a[250:251], v229 offset:2560
v_mfma_f32_16x16x32_bf16 v[4:7], a[232:235], a[128:131], v[4:7]
s_add_u32 s84, s48, s41
ds_read_b64_tr_b16 a[252:253], v229 offset:10240
v_mfma_f32_16x16x32_bf16 v[4:7], a[236:239], a[136:139], v[4:7]
ds_read_b64_tr_b16 a[254:255], v229 offset:12800
buffer_load_dwordx4 a[212:215], v238, s[24:27], s32 offen offset:3072 sc1
v_mfma_f32_16x16x32_bf16 v[12:15], a[232:235], a[132:135], v[12:15]
s_add_u32 s32, s45, 12288
ds_read_b64_tr_b16 a[224:225], v226 offset:20544
v_mfma_f32_16x16x32_bf16 v[12:15], a[236:239], a[140:143], v[12:15]
s_waitcnt vmcnt(16) lgkmcnt(5)
ds_read_b64_tr_b16 a[226:227], v226 offset:23104
v_mfma_f32_16x16x32_bf16 v[0:3], a[240:243], a[144:147], v[0:3]
s_add_u32 s41, s40, 1
ds_read_b64_tr_b16 a[228:229], v226 offset:30784
v_mfma_f32_16x16x32_bf16 v[0:3], a[244:247], a[152:155], v[0:3]
s_waitcnt vmcnt(15)
ds_read_b64_tr_b16 a[230:231], v226 offset:33344
v_mfma_f32_16x16x32_bf16 v[8:11], a[240:243], a[148:151], v[8:11]
ds_read_b64_tr_b16 a[232:233], v227 offset:20544
buffer_load_dwordx4 a[216:219], v238, s[24:27], s32 offen offset:2048 sc1
v_mfma_f32_16x16x32_bf16 v[8:11], a[244:247], a[156:159], v[8:11]
s_waitcnt lgkmcnt(5)
ds_read_b64_tr_b16 a[234:235], v227 offset:23104
v_mfma_f32_16x16x32_bf16 v[4:7], a[248:251], a[144:147], v[4:7]
s_sub_u32 s57, s41, 5
s_cselect_b32 s41, s41, s57
ds_read_b64_tr_b16 a[236:237], v227 offset:30784
v_mfma_f32_16x16x32_bf16 v[4:7], a[252:255], a[152:155], v[4:7]
ds_read_b64_tr_b16 a[238:239], v227 offset:33344
v_mfma_f32_16x16x32_bf16 v[12:15], a[248:251], a[148:151], v[12:15]
ds_read_b64_tr_b16 a[240:241], v228 offset:20544
v_mfma_f32_16x16x32_bf16 v[12:15], a[252:255], a[156:159], v[12:15]
s_waitcnt lgkmcnt(5)
ds_read_b64_tr_b16 a[242:243], v228 offset:23104
buffer_load_dwordx4 a[220:223], v238, s[24:27], s32 offen offset:3072 sc1
v_mfma_f32_16x16x32_bf16 v[16:19], a[224:227], a[96:99], v[16:19]
s_mul_i32 s57, s41, 393216
ds_read_b64_tr_b16 a[244:245], v228 offset:30784
v_mfma_f32_16x16x32_bf16 v[16:19], a[228:231], a[104:107], v[16:19]
ds_read_b64_tr_b16 a[246:247], v228 offset:33344
v_mfma_f32_16x16x32_bf16 v[24:27], a[224:227], a[100:103], v[24:27]
s_add_u32 s32, s46, 8192
ds_read_b64_tr_b16 a[248:249], v229 offset:20544
v_cvt_pk_bf16_f32 v0, v0, v1
v_mfma_f32_16x16x32_bf16 v[24:27], a[228:231], a[108:111], v[24:27]
s_waitcnt lgkmcnt(5)
ds_read_b64_tr_b16 a[250:251], v229 offset:23104
v_cvt_pk_bf16_f32 v1, v2, v3
v_mfma_f32_16x16x32_bf16 v[20:23], a[232:235], a[96:99], v[20:23]
s_lshl_b32 s41, s41, 12
ds_read_b64_tr_b16 a[252:253], v229 offset:30784
v_cvt_pk_bf16_f32 v2, v4, v5
v_mfma_f32_16x16x32_bf16 v[20:23], a[236:239], a[104:107], v[20:23]
ds_read_b64_tr_b16 a[254:255], v229 offset:33344
v_cvt_pk_bf16_f32 v3, v6, v7
v_mfma_f32_16x16x32_bf16 v[28:31], a[232:235], a[100:103], v[28:31]
s_add_u32 s31, s5, 0
ds_read_b64_tr_b16 a[224:225], v226 offset:41024
v_permlane16_swap_b32 v0, v2
v_mfma_f32_16x16x32_bf16 v[28:31], a[236:239], a[108:111], v[28:31]
s_waitcnt lgkmcnt(5)
ds_read_b64_tr_b16 a[226:227], v226 offset:43584
v_permlane16_swap_b32 v1, v3
v_mfma_f32_16x16x32_bf16 v[16:19], a[240:243], a[112:115], v[16:19]
s_add_u32 s85, s48, s41
ds_read_b64_tr_b16 a[228:229], v226 offset:51264
buffer_store_dwordx4 v[0:3], v237, s[24:27], s31 offen offset:0 sc1
v_mfma_f32_16x16x32_bf16 v[16:19], a[244:247], a[120:123], v[16:19]
ds_read_b64_tr_b16 a[230:231], v226 offset:53824
v_cvt_pk_bf16_f32 v8, v8, v9
v_mfma_f32_16x16x32_bf16 v[24:27], a[240:243], a[116:119], v[24:27]
ds_read_b64_tr_b16 a[232:233], v227 offset:41024
v_cvt_pk_bf16_f32 v9, v10, v11
v_mfma_f32_16x16x32_bf16 v[24:27], a[244:247], a[124:127], v[24:27]
s_waitcnt lgkmcnt(5)
ds_read_b64_tr_b16 a[234:235], v227 offset:43584
v_cvt_pk_bf16_f32 v10, v12, v13
v_mfma_f32_16x16x32_bf16 v[20:23], a[248:251], a[112:115], v[20:23]
s_add_u32 s31, s5, 163840
ds_read_b64_tr_b16 a[236:237], v227 offset:51264
v_cvt_pk_bf16_f32 v11, v14, v15
v_mfma_f32_16x16x32_bf16 v[20:23], a[252:255], a[120:123], v[20:23]
ds_read_b64_tr_b16 a[238:239], v227 offset:53824
v_permlane16_swap_b32 v8, v10
v_mfma_f32_16x16x32_bf16 v[28:31], a[248:251], a[116:119], v[28:31]
s_add_u32 s41, s40, 2
ds_read_b64_tr_b16 a[240:241], v228 offset:64
v_permlane16_swap_b32 v9, v11
v_mfma_f32_16x16x32_bf16 v[28:31], a[252:255], a[124:127], v[28:31]
s_waitcnt lgkmcnt(5)
ds_read_b64_tr_b16 a[242:243], v228 offset:2624
buffer_store_dwordx4 v[8:11], v237, s[24:27], s31 offen offset:0 sc1
v_mfma_f32_16x16x32_bf16 v[16:19], a[224:227], a[128:131], v[16:19]
ds_read_b64_tr_b16 a[244:245], v228 offset:10304
v_mfma_f32_16x16x32_bf16 v[16:19], a[228:231], a[136:139], v[16:19]
ds_read_b64_tr_b16 a[246:247], v228 offset:12864
v_mfma_f32_16x16x32_bf16 v[24:27], a[224:227], a[132:135], v[24:27]
s_sub_u32 s58, s41, 5
s_cselect_b32 s41, s41, s58
ds_read_b64_tr_b16 a[248:249], v229 offset:64
v_mfma_f32_16x16x32_bf16 v[24:27], a[228:231], a[140:143], v[24:27]
s_waitcnt lgkmcnt(5)
ds_read_b64_tr_b16 a[250:251], v229 offset:2624
buffer_load_dwordx4 a[0:3], v238, s[24:27], s32 offen offset:2048 sc1
v_mfma_f32_16x16x32_bf16 v[20:23], a[232:235], a[128:131], v[20:23]
ds_read_b64_tr_b16 a[252:253], v229 offset:10304
v_mfma_f32_16x16x32_bf16 v[20:23], a[236:239], a[136:139], v[20:23]
ds_read_b64_tr_b16 a[254:255], v229 offset:12864
v_mfma_f32_16x16x32_bf16 v[28:31], a[232:235], a[132:135], v[28:31]
s_mul_i32 s58, s41, 393216
ds_read_b64_tr_b16 a[224:225], v226 offset:20608
v_mfma_f32_16x16x32_bf16 v[28:31], a[236:239], a[140:143], v[28:31]
s_waitcnt lgkmcnt(5)
ds_read_b64_tr_b16 a[226:227], v226 offset:23168
v_mfma_f32_16x16x32_bf16 v[16:19], a[240:243], a[144:147], v[16:19]
ds_read_b64_tr_b16 a[228:229], v226 offset:30848
buffer_load_dwordx4 a[4:7], v238, s[24:27], s32 offen offset:3072 sc1
v_mfma_f32_16x16x32_bf16 v[16:19], a[244:247], a[152:155], v[16:19]
ds_read_b64_tr_b16 a[230:231], v226 offset:33408
v_mfma_f32_16x16x32_bf16 v[24:27], a[240:243], a[148:151], v[24:27]
s_lshl_b32 s41, s41, 12
ds_read_b64_tr_b16 a[232:233], v227 offset:20608
v_mfma_f32_16x16x32_bf16 v[24:27], a[244:247], a[156:159], v[24:27]
s_waitcnt lgkmcnt(5)
ds_read_b64_tr_b16 a[234:235], v227 offset:23168
v_mfma_f32_16x16x32_bf16 v[20:23], a[248:251], a[144:147], v[20:23]
s_add_u32 s32, s46, 12288
ds_read_b64_tr_b16 a[236:237], v227 offset:30848
v_mfma_f32_16x16x32_bf16 v[20:23], a[252:255], a[152:155], v[20:23]
ds_read_b64_tr_b16 a[238:239], v227 offset:33408
buffer_load_dwordx4 a[8:11], v238, s[24:27], s32 offen offset:2048 sc1
v_mfma_f32_16x16x32_bf16 v[28:31], a[248:251], a[148:151], v[28:31]
s_add_u32 s86, s48, s41
ds_read_b64_tr_b16 a[240:241], v228 offset:20608
v_mfma_f32_16x16x32_bf16 v[28:31], a[252:255], a[156:159], v[28:31]
s_waitcnt lgkmcnt(5)
ds_read_b64_tr_b16 a[242:243], v228 offset:23168
v_mfma_f32_16x16x32_bf16 v[32:35], a[224:227], a[96:99], v[32:35]
ds_read_b64_tr_b16 a[244:245], v228 offset:30848
v_mfma_f32_16x16x32_bf16 v[32:35], a[228:231], a[104:107], v[32:35]
ds_read_b64_tr_b16 a[246:247], v228 offset:33408
v_mfma_f32_16x16x32_bf16 v[40:43], a[224:227], a[100:103], v[40:43]
s_add_u32 s41, s40, 3
ds_read_b64_tr_b16 a[248:249], v229 offset:20608
v_cvt_pk_bf16_f32 v16, v16, v17
v_mfma_f32_16x16x32_bf16 v[40:43], a[228:231], a[108:111], v[40:43]
s_waitcnt lgkmcnt(5)
ds_read_b64_tr_b16 a[250:251], v229 offset:23168
v_cvt_pk_bf16_f32 v17, v18, v19
v_mfma_f32_16x16x32_bf16 v[36:39], a[232:235], a[96:99], v[36:39]
ds_read_b64_tr_b16 a[252:253], v229 offset:30848
v_cvt_pk_bf16_f32 v18, v20, v21
v_mfma_f32_16x16x32_bf16 v[36:39], a[236:239], a[104:107], v[36:39]
ds_read_b64_tr_b16 a[254:255], v229 offset:33408
v_cvt_pk_bf16_f32 v19, v22, v23
v_mfma_f32_16x16x32_bf16 v[44:47], a[232:235], a[100:103], v[44:47]
s_add_u32 s31, s5, 0
ds_read_b64_tr_b16 a[224:225], v226 offset:41088
v_permlane16_swap_b32 v16, v18
v_mfma_f32_16x16x32_bf16 v[44:47], a[236:239], a[108:111], v[44:47]
s_waitcnt lgkmcnt(5)
ds_read_b64_tr_b16 a[226:227], v226 offset:43648
v_permlane16_swap_b32 v17, v19
v_mfma_f32_16x16x32_bf16 v[32:35], a[240:243], a[112:115], v[32:35]
ds_read_b64_tr_b16 a[228:229], v226 offset:51328
buffer_store_dwordx4 v[16:19], v237, s[24:27], s31 offen offset:256 sc1
v_mfma_f32_16x16x32_bf16 v[32:35], a[244:247], a[120:123], v[32:35]
ds_read_b64_tr_b16 a[230:231], v226 offset:53888
v_cvt_pk_bf16_f32 v24, v24, v25
v_mfma_f32_16x16x32_bf16 v[40:43], a[240:243], a[116:119], v[40:43]
ds_read_b64_tr_b16 a[232:233], v227 offset:41088
v_cvt_pk_bf16_f32 v25, v26, v27
v_mfma_f32_16x16x32_bf16 v[40:43], a[244:247], a[124:127], v[40:43]
s_waitcnt lgkmcnt(5)
ds_read_b64_tr_b16 a[234:235], v227 offset:43648
v_cvt_pk_bf16_f32 v26, v28, v29
v_mfma_f32_16x16x32_bf16 v[36:39], a[248:251], a[112:115], v[36:39]
s_add_u32 s31, s5, 163840
ds_read_b64_tr_b16 a[236:237], v227 offset:51328
v_cvt_pk_bf16_f32 v27, v30, v31
v_mfma_f32_16x16x32_bf16 v[36:39], a[252:255], a[120:123], v[36:39]
ds_read_b64_tr_b16 a[238:239], v227 offset:53888
v_permlane16_swap_b32 v24, v26
v_mfma_f32_16x16x32_bf16 v[44:47], a[248:251], a[116:119], v[44:47]
ds_read_b64_tr_b16 a[240:241], v228 offset:128
v_permlane16_swap_b32 v25, v27
v_mfma_f32_16x16x32_bf16 v[44:47], a[252:255], a[124:127], v[44:47]
s_waitcnt lgkmcnt(5)
ds_read_b64_tr_b16 a[242:243], v228 offset:2688
buffer_store_dwordx4 v[24:27], v237, s[24:27], s31 offen offset:256 sc1
v_mfma_f32_16x16x32_bf16 v[32:35], a[224:227], a[128:131], v[32:35]
s_sub_u32 s59, s41, 5
s_cselect_b32 s41, s41, s59
ds_read_b64_tr_b16 a[244:245], v228 offset:10368
v_mfma_f32_16x16x32_bf16 v[32:35], a[228:231], a[136:139], v[32:35]
ds_read_b64_tr_b16 a[246:247], v228 offset:12928
v_mfma_f32_16x16x32_bf16 v[40:43], a[224:227], a[132:135], v[40:43]
ds_read_b64_tr_b16 a[248:249], v229 offset:128
v_mfma_f32_16x16x32_bf16 v[40:43], a[228:231], a[140:143], v[40:43]
s_waitcnt lgkmcnt(5)
ds_read_b64_tr_b16 a[250:251], v229 offset:2688
buffer_load_dwordx4 a[12:15], v238, s[24:27], s32 offen offset:3072 sc1
v_mfma_f32_16x16x32_bf16 v[36:39], a[232:235], a[128:131], v[36:39]
s_mul_i32 s59, s41, 393216
ds_read_b64_tr_b16 a[252:253], v229 offset:10368
v_mfma_f32_16x16x32_bf16 v[36:39], a[236:239], a[136:139], v[36:39]
ds_read_b64_tr_b16 a[254:255], v229 offset:12928
v_mfma_f32_16x16x32_bf16 v[44:47], a[232:235], a[132:135], v[44:47]
s_add_u32 s32, s44, 16384
ds_read_b64_tr_b16 a[224:225], v226 offset:20672
v_mfma_f32_16x16x32_bf16 v[44:47], a[236:239], a[140:143], v[44:47]
s_waitcnt lgkmcnt(5)
ds_read_b64_tr_b16 a[226:227], v226 offset:23232
v_mfma_f32_16x16x32_bf16 v[32:35], a[240:243], a[144:147], v[32:35]
s_lshl_b32 s41, s41, 12
ds_read_b64_tr_b16 a[228:229], v226 offset:30912
buffer_load_dwordx4 a[16:19], v238, s[24:27], s32 offen offset:2048 sc1
v_mfma_f32_16x16x32_bf16 v[32:35], a[244:247], a[152:155], v[32:35]
ds_read_b64_tr_b16 a[230:231], v226 offset:33472
v_mfma_f32_16x16x32_bf16 v[40:43], a[240:243], a[148:151], v[40:43]
ds_read_b64_tr_b16 a[232:233], v227 offset:20672
v_mfma_f32_16x16x32_bf16 v[40:43], a[244:247], a[156:159], v[40:43]
s_waitcnt lgkmcnt(5)
ds_read_b64_tr_b16 a[234:235], v227 offset:23232
v_mfma_f32_16x16x32_bf16 v[36:39], a[248:251], a[144:147], v[36:39]
s_add_u32 s87, s48, s41
ds_read_b64_tr_b16 a[236:237], v227 offset:30912
v_mfma_f32_16x16x32_bf16 v[36:39], a[252:255], a[152:155], v[36:39]
ds_read_b64_tr_b16 a[238:239], v227 offset:33472
buffer_load_dwordx4 a[20:23], v238, s[24:27], s32 offen offset:3072 sc1
v_mfma_f32_16x16x32_bf16 v[44:47], a[248:251], a[148:151], v[44:47]
s_add_u32 s32, s44, 20480
ds_read_b64_tr_b16 a[240:241], v228 offset:20672
v_mfma_f32_16x16x32_bf16 v[44:47], a[252:255], a[156:159], v[44:47]
s_waitcnt lgkmcnt(5)
ds_read_b64_tr_b16 a[242:243], v228 offset:23232
v_mfma_f32_16x16x32_bf16 v[48:51], a[224:227], a[96:99], v[48:51]
s_add_u32 s41, s40, 4
ds_read_b64_tr_b16 a[244:245], v228 offset:30912
v_mfma_f32_16x16x32_bf16 v[48:51], a[228:231], a[104:107], v[48:51]
ds_read_b64_tr_b16 a[246:247], v228 offset:33472
v_mfma_f32_16x16x32_bf16 v[56:59], a[224:227], a[100:103], v[56:59]
ds_read_b64_tr_b16 a[248:249], v229 offset:20672
v_cvt_pk_bf16_f32 v32, v32, v33
v_mfma_f32_16x16x32_bf16 v[56:59], a[228:231], a[108:111], v[56:59]
s_waitcnt lgkmcnt(5)
ds_read_b64_tr_b16 a[250:251], v229 offset:23232
v_cvt_pk_bf16_f32 v33, v34, v35
v_mfma_f32_16x16x32_bf16 v[52:55], a[232:235], a[96:99], v[52:55]
ds_read_b64_tr_b16 a[252:253], v229 offset:30912
v_cvt_pk_bf16_f32 v34, v36, v37
v_mfma_f32_16x16x32_bf16 v[52:55], a[236:239], a[104:107], v[52:55]
ds_read_b64_tr_b16 a[254:255], v229 offset:33472
v_cvt_pk_bf16_f32 v35, v38, v39
v_mfma_f32_16x16x32_bf16 v[60:63], a[232:235], a[100:103], v[60:63]
s_add_u32 s31, s5, 0
ds_read_b64_tr_b16 a[224:225], v226 offset:41152
v_permlane16_swap_b32 v32, v34
v_mfma_f32_16x16x32_bf16 v[60:63], a[236:239], a[108:111], v[60:63]
s_waitcnt lgkmcnt(5)
ds_read_b64_tr_b16 a[226:227], v226 offset:43712
v_permlane16_swap_b32 v33, v35
v_mfma_f32_16x16x32_bf16 v[48:51], a[240:243], a[112:115], v[48:51]
ds_read_b64_tr_b16 a[228:229], v226 offset:51392
buffer_store_dwordx4 v[32:35], v237, s[24:27], s31 offen offset:512 sc1
v_mfma_f32_16x16x32_bf16 v[48:51], a[244:247], a[120:123], v[48:51]
ds_read_b64_tr_b16 a[230:231], v226 offset:53952
v_cvt_pk_bf16_f32 v40, v40, v41
v_mfma_f32_16x16x32_bf16 v[56:59], a[240:243], a[116:119], v[56:59]
ds_read_b64_tr_b16 a[232:233], v227 offset:41152
v_cvt_pk_bf16_f32 v41, v42, v43
v_mfma_f32_16x16x32_bf16 v[56:59], a[244:247], a[124:127], v[56:59]
s_waitcnt lgkmcnt(5)
ds_read_b64_tr_b16 a[234:235], v227 offset:43712
v_cvt_pk_bf16_f32 v42, v44, v45
v_mfma_f32_16x16x32_bf16 v[52:55], a[248:251], a[112:115], v[52:55]
s_add_u32 s31, s5, 163840
ds_read_b64_tr_b16 a[236:237], v227 offset:51392
v_cvt_pk_bf16_f32 v43, v46, v47
v_mfma_f32_16x16x32_bf16 v[52:55], a[252:255], a[120:123], v[52:55]
ds_read_b64_tr_b16 a[238:239], v227 offset:53952
v_permlane16_swap_b32 v40, v42
v_mfma_f32_16x16x32_bf16 v[60:63], a[248:251], a[116:119], v[60:63]
ds_read_b64_tr_b16 a[240:241], v228 offset:192
v_permlane16_swap_b32 v41, v43
v_mfma_f32_16x16x32_bf16 v[60:63], a[252:255], a[124:127], v[60:63]
s_waitcnt lgkmcnt(5)
ds_read_b64_tr_b16 a[242:243], v228 offset:2752
buffer_store_dwordx4 v[40:43], v237, s[24:27], s31 offen offset:512 sc1
v_mfma_f32_16x16x32_bf16 v[48:51], a[224:227], a[128:131], v[48:51]
s_sub_u32 s89, s41, 5
s_cselect_b32 s41, s41, s89
ds_read_b64_tr_b16 a[244:245], v228 offset:10432
v_mfma_f32_16x16x32_bf16 v[48:51], a[228:231], a[136:139], v[48:51]
ds_read_b64_tr_b16 a[246:247], v228 offset:12992
v_mfma_f32_16x16x32_bf16 v[56:59], a[224:227], a[132:135], v[56:59]
ds_read_b64_tr_b16 a[248:249], v229 offset:192
v_mfma_f32_16x16x32_bf16 v[56:59], a[228:231], a[140:143], v[56:59]
s_waitcnt lgkmcnt(5)
ds_read_b64_tr_b16 a[250:251], v229 offset:2752
buffer_load_dwordx4 a[24:27], v238, s[24:27], s32 offen offset:2048 sc1
v_mfma_f32_16x16x32_bf16 v[52:55], a[232:235], a[128:131], v[52:55]
s_mul_i32 s89, s41, 393216
ds_read_b64_tr_b16 a[252:253], v229 offset:10432
v_mfma_f32_16x16x32_bf16 v[52:55], a[236:239], a[136:139], v[52:55]
ds_read_b64_tr_b16 a[254:255], v229 offset:12992
v_mfma_f32_16x16x32_bf16 v[60:63], a[232:235], a[132:135], v[60:63]
ds_read_b64_tr_b16 a[224:225], v226 offset:20736
v_mfma_f32_16x16x32_bf16 v[60:63], a[236:239], a[140:143], v[60:63]
s_waitcnt lgkmcnt(5)
ds_read_b64_tr_b16 a[226:227], v226 offset:23296
v_mfma_f32_16x16x32_bf16 v[48:51], a[240:243], a[144:147], v[48:51]
s_lshl_b32 s41, s41, 12
ds_read_b64_tr_b16 a[228:229], v226 offset:30976
buffer_load_dwordx4 a[28:31], v238, s[24:27], s32 offen offset:3072 sc1
v_mfma_f32_16x16x32_bf16 v[48:51], a[244:247], a[152:155], v[48:51]
ds_read_b64_tr_b16 a[230:231], v226 offset:33536
v_mfma_f32_16x16x32_bf16 v[56:59], a[240:243], a[148:151], v[56:59]
s_add_u32 s32, s45, 16384
ds_read_b64_tr_b16 a[232:233], v227 offset:20736
v_mfma_f32_16x16x32_bf16 v[56:59], a[244:247], a[156:159], v[56:59]
s_waitcnt lgkmcnt(5)
ds_read_b64_tr_b16 a[234:235], v227 offset:23296
v_mfma_f32_16x16x32_bf16 v[52:55], a[248:251], a[144:147], v[52:55]
s_add_u32 s88, s48, s41
ds_read_b64_tr_b16 a[236:237], v227 offset:30976
v_mfma_f32_16x16x32_bf16 v[52:55], a[252:255], a[152:155], v[52:55]
ds_read_b64_tr_b16 a[238:239], v227 offset:33536
buffer_load_dwordx4 a[32:35], v238, s[24:27], s32 offen offset:2048 sc1
v_mfma_f32_16x16x32_bf16 v[60:63], a[248:251], a[148:151], v[60:63]
ds_read_b64_tr_b16 a[240:241], v228 offset:20736
v_mfma_f32_16x16x32_bf16 v[60:63], a[252:255], a[156:159], v[60:63]
s_waitcnt lgkmcnt(5)
ds_read_b64_tr_b16 a[242:243], v228 offset:23296
v_mfma_f32_16x16x32_bf16 v[64:67], a[224:227], a[96:99], v[64:67]
s_add_u32 s40, s78, s79
ds_read_b64_tr_b16 a[244:245], v228 offset:30976
v_mfma_f32_16x16x32_bf16 v[64:67], a[228:231], a[104:107], v[64:67]
ds_read_b64_tr_b16 a[246:247], v228 offset:33536
v_mfma_f32_16x16x32_bf16 v[72:75], a[224:227], a[100:103], v[72:75]
ds_read_b64_tr_b16 a[248:249], v229 offset:20736
v_cvt_pk_bf16_f32 v48, v48, v49
v_mfma_f32_16x16x32_bf16 v[72:75], a[228:231], a[108:111], v[72:75]
s_waitcnt lgkmcnt(5)
ds_read_b64_tr_b16 a[250:251], v229 offset:23296
v_cvt_pk_bf16_f32 v49, v50, v51
v_mfma_f32_16x16x32_bf16 v[68:71], a[232:235], a[96:99], v[68:71]
s_and_b32 s40, s40, 0
ds_read_b64_tr_b16 a[252:253], v229 offset:30976
v_cvt_pk_bf16_f32 v50, v52, v53
v_mfma_f32_16x16x32_bf16 v[68:71], a[236:239], a[104:107], v[68:71]
ds_read_b64_tr_b16 a[254:255], v229 offset:33536
v_cvt_pk_bf16_f32 v51, v54, v55
v_mfma_f32_16x16x32_bf16 v[76:79], a[232:235], a[100:103], v[76:79]
s_add_u32 s31, s5, 0
ds_read_b64_tr_b16 a[224:225], v226 offset:41216
v_permlane16_swap_b32 v48, v50
v_mfma_f32_16x16x32_bf16 v[76:79], a[236:239], a[108:111], v[76:79]
s_waitcnt lgkmcnt(5)
ds_read_b64_tr_b16 a[226:227], v226 offset:43776
v_permlane16_swap_b32 v49, v51
v_mfma_f32_16x16x32_bf16 v[64:67], a[240:243], a[112:115], v[64:67]
s_add_u32 s41, s40, 0
ds_read_b64_tr_b16 a[228:229], v226 offset:51456
buffer_store_dwordx4 v[48:51], v237, s[24:27], s31 offen offset:768 sc1
v_mfma_f32_16x16x32_bf16 v[64:67], a[244:247], a[120:123], v[64:67]
ds_read_b64_tr_b16 a[230:231], v226 offset:54016
v_cvt_pk_bf16_f32 v56, v56, v57
v_mfma_f32_16x16x32_bf16 v[72:75], a[240:243], a[116:119], v[72:75]
ds_read_b64_tr_b16 a[232:233], v227 offset:41216
v_cvt_pk_bf16_f32 v57, v58, v59
v_mfma_f32_16x16x32_bf16 v[72:75], a[244:247], a[124:127], v[72:75]
s_waitcnt lgkmcnt(5)
ds_read_b64_tr_b16 a[234:235], v227 offset:43776
v_cvt_pk_bf16_f32 v58, v60, v61
v_mfma_f32_16x16x32_bf16 v[68:71], a[248:251], a[112:115], v[68:71]
s_add_u32 s31, s5, 163840
ds_read_b64_tr_b16 a[236:237], v227 offset:51456
v_cvt_pk_bf16_f32 v59, v62, v63
v_mfma_f32_16x16x32_bf16 v[68:71], a[252:255], a[120:123], v[68:71]
ds_read_b64_tr_b16 a[238:239], v227 offset:54016
v_permlane16_swap_b32 v56, v58
v_mfma_f32_16x16x32_bf16 v[76:79], a[248:251], a[116:119], v[76:79]
s_and_b32 s41, s41, 3
ds_read_b64_tr_b16 a[240:241], v228 offset:256
v_permlane16_swap_b32 v57, v59
v_mfma_f32_16x16x32_bf16 v[76:79], a[252:255], a[124:127], v[76:79]
s_waitcnt lgkmcnt(5)
ds_read_b64_tr_b16 a[242:243], v228 offset:2816
buffer_store_dwordx4 v[56:59], v237, s[24:27], s31 offen offset:768 sc1
v_mfma_f32_16x16x32_bf16 v[64:67], a[224:227], a[128:131], v[64:67]
ds_read_b64_tr_b16 a[244:245], v228 offset:10496
v_mfma_f32_16x16x32_bf16 v[64:67], a[228:231], a[136:139], v[64:67]
ds_read_b64_tr_b16 a[246:247], v228 offset:13056
v_mfma_f32_16x16x32_bf16 v[72:75], a[224:227], a[132:135], v[72:75]
s_mul_i32 s52, s41, 12288
ds_read_b64_tr_b16 a[248:249], v229 offset:256
v_mfma_f32_16x16x32_bf16 v[72:75], a[228:231], a[140:143], v[72:75]
s_waitcnt lgkmcnt(5)
ds_read_b64_tr_b16 a[250:251], v229 offset:2816
buffer_load_dwordx4 a[36:39], v238, s[24:27], s32 offen offset:3072 sc1
v_mfma_f32_16x16x32_bf16 v[68:71], a[232:235], a[128:131], v[68:71]
s_add_u32 s32, s45, 20480
ds_read_b64_tr_b16 a[252:253], v229 offset:10496
v_mfma_f32_16x16x32_bf16 v[68:71], a[236:239], a[136:139], v[68:71]
ds_read_b64_tr_b16 a[254:255], v229 offset:13056
v_mfma_f32_16x16x32_bf16 v[76:79], a[232:235], a[132:135], v[76:79]
s_mul_i32 s47, s41, 491520
ds_read_b64_tr_b16 a[224:225], v224 offset:0
v_mfma_f32_16x16x32_bf16 v[76:79], a[236:239], a[140:143], v[76:79]
L_pg14:
s_cbranch_execz L_ret_A
s_waitcnt lgkmcnt(5)
ds_read_b64_tr_b16 a[226:227], v224 offset:2560
v_mfma_f32_16x16x32_bf16 v[64:67], a[240:243], a[144:147], v[64:67]
ds_read_b64_tr_b16 a[228:229], v224 offset:10240
buffer_load_dwordx4 a[40:43], v238, s[24:27], s32 offen offset:2048 sc1
v_mfma_f32_16x16x32_bf16 v[64:67], a[244:247], a[152:155], v[64:67]
ds_read_b64_tr_b16 a[230:231], v224 offset:12800
v_mfma_f32_16x16x32_bf16 v[72:75], a[240:243], a[148:151], v[72:75]
s_add_u32 s41, s40, 1
ds_read_b64_tr_b16 a[232:233], v225 offset:0
v_mfma_f32_16x16x32_bf16 v[72:75], a[244:247], a[156:159], v[72:75]
s_waitcnt lgkmcnt(5)
ds_read_b64_tr_b16 a[234:235], v225 offset:2560
v_mfma_f32_16x16x32_bf16 v[68:71], a[248:251], a[144:147], v[68:71]
ds_read_b64_tr_b16 a[236:237], v225 offset:10240
v_mfma_f32_16x16x32_bf16 v[68:71], a[252:255], a[152:155], v[68:71]
ds_read_b64_tr_b16 a[238:239], v225 offset:12800
buffer_load_dwordx4 a[44:47], v238, s[24:27], s32 offen offset:3072 sc1
v_mfma_f32_16x16x32_bf16 v[76:79], a[248:251], a[148:151], v[76:79]
s_and_b32 s41, s41, 3
ds_read_b64_tr_b16 a[240:241], v224 offset:64
v_mfma_f32_16x16x32_bf16 v[76:79], a[252:255], a[156:159], v[76:79]
s_waitcnt vmcnt(33) lgkmcnt(5)
ds_read_b64_tr_b16 a[242:243], v224 offset:2624
v_mfma_f32_16x16x32_bf16 v[80:83], a[224:227], a[160:163], v[80:83]
s_add_u32 s32, s46, 16384
ds_read_b64_tr_b16 a[244:245], v224 offset:10304
v_mfma_f32_16x16x32_bf16 v[80:83], a[228:231], a[168:171], v[80:83]
s_waitcnt vmcnt(32)
ds_read_b64_tr_b16 a[246:247], v224 offset:12864
v_mfma_f32_16x16x32_bf16 v[88:91], a[224:227], a[164:167], v[88:91]
s_mul_i32 s53, s41, 12288
ds_read_b64_tr_b16 a[248:249], v225 offset:64
v_cvt_pk_bf16_f32 v64, v64, v65
v_mfma_f32_16x16x32_bf16 v[88:91], a[228:231], a[172:175], v[88:91]
s_waitcnt lgkmcnt(5)
ds_read_b64_tr_b16 a[250:251], v225 offset:2624
v_cvt_pk_bf16_f32 v65, v66, v67
v_mfma_f32_16x16x32_bf16 v[84:87], a[232:235], a[160:163], v[84:87]
ds_read_b64_tr_b16 a[252:253], v225 offset:10304
v_cvt_pk_bf16_f32 v66, v68, v69
v_mfma_f32_16x16x32_bf16 v[84:87], a[236:239], a[168:171], v[84:87]
ds_read_b64_tr_b16 a[254:255], v225 offset:12864
v_cvt_pk_bf16_f32 v67, v70, v71
v_mfma_f32_16x16x32_bf16 v[92:95], a[232:235], a[164:167], v[92:95]
s_add_u32 s31, s5, 0
ds_read_b64_tr_b16 a[224:225], v224 offset:128
v_permlane16_swap_b32 v64, v66
v_mfma_f32_16x16x32_bf16 v[92:95], a[236:239], a[172:175], v[92:95]
s_waitcnt lgkmcnt(5)
ds_read_b64_tr_b16 a[226:227], v224 offset:2688
v_permlane16_swap_b32 v65, v67
v_mfma_f32_16x16x32_bf16 v[96:99], a[240:243], a[160:163], v[96:99]
s_mul_i32 s48, s41, 491520
ds_read_b64_tr_b16 a[228:229], v224 offset:10368
buffer_store_dwordx4 v[64:67], v237, s[24:27], s31 offen offset:1024 sc1
v_mfma_f32_16x16x32_bf16 v[96:99], a[244:247], a[168:171], v[96:99]
ds_read_b64_tr_b16 a[230:231], v224 offset:12928
v_cvt_pk_bf16_f32 v72, v72, v73
v_mfma_f32_16x16x32_bf16 v[104:107], a[240:243], a[164:167], v[104:107]
ds_read_b64_tr_b16 a[232:233], v225 offset:128
v_cvt_pk_bf16_f32 v73, v74, v75
v_mfma_f32_16x16x32_bf16 v[104:107], a[244:247], a[172:175], v[104:107]
s_waitcnt lgkmcnt(5)
ds_read_b64_tr_b16 a[234:235], v225 offset:2688
v_cvt_pk_bf16_f32 v74, v76, v77
v_mfma_f32_16x16x32_bf16 v[100:103], a[248:251], a[160:163], v[100:103]
s_add_u32 s31, s5, 163840
ds_read_b64_tr_b16 a[236:237], v225 offset:10368
v_cvt_pk_bf16_f32 v75, v78, v79
v_mfma_f32_16x16x32_bf16 v[100:103], a[252:255], a[168:171], v[100:103]
ds_read_b64_tr_b16 a[238:239], v225 offset:12928
v_permlane16_swap_b32 v72, v74
v_mfma_f32_16x16x32_bf16 v[108:111], a[248:251], a[164:167], v[108:111]
s_add_u32 s41, s40, 2
ds_read_b64_tr_b16 a[240:241], v224 offset:192
v_permlane16_swap_b32 v73, v75
v_mfma_f32_16x16x32_bf16 v[108:111], a[252:255], a[172:175], v[108:111]
s_waitcnt lgkmcnt(5)
ds_read_b64_tr_b16 a[242:243], v224 offset:2752
buffer_store_dwordx4 v[72:75], v237, s[24:27], s31 offen offset:1024 sc1
v_mfma_f32_16x16x32_bf16 v[112:115], a[224:227], a[160:163], v[112:115]
ds_read_b64_tr_b16 a[244:245], v224 offset:10432
v_mfma_f32_16x16x32_bf16 v[112:115], a[228:231], a[168:171], v[112:115]
ds_read_b64_tr_b16 a[246:247], v224 offset:12992
v_mfma_f32_16x16x32_bf16 v[120:123], a[224:227], a[164:167], v[120:123]
s_and_b32 s41, s41, 3
ds_read_b64_tr_b16 a[248:249], v225 offset:192
v_mfma_f32_16x16x32_bf16 v[120:123], a[228:231], a[172:175], v[120:123]
s_waitcnt lgkmcnt(5)
ds_read_b64_tr_b16 a[250:251], v225 offset:2752
buffer_load_dwordx4 a[48:51], v238, s[24:27], s32 offen offset:2048 sc1
v_mfma_f32_16x16x32_bf16 v[116:119], a[232:235], a[160:163], v[116:119]
ds_read_b64_tr_b16 a[252:253], v225 offset:10432
v_mfma_f32_16x16x32_bf16 v[116:119], a[236:239], a[168:171], v[116:119]
ds_read_b64_tr_b16 a[254:255], v225 offset:12992
v_mfma_f32_16x16x32_bf16 v[124:127], a[232:235], a[164:167], v[124:127]
s_mul_i32 s54, s41, 12288
ds_read_b64_tr_b16 a[224:225], v224 offset:256
v_mfma_f32_16x16x32_bf16 v[124:127], a[236:239], a[172:175], v[124:127]
s_waitcnt lgkmcnt(5)
ds_read_b64_tr_b16 a[226:227], v224 offset:2816
v_mfma_f32_16x16x32_bf16 v[128:131], a[240:243], a[160:163], v[128:131]
ds_read_b64_tr_b16 a[228:229], v224 offset:10496
buffer_load_dwordx4 a[52:55], v238, s[24:27], s32 offen offset:3072 sc1
v_mfma_f32_16x16x32_bf16 v[128:131], a[244:247], a[168:171], v[128:131]
ds_read_b64_tr_b16 a[230:231], v224 offset:13056
v_mfma_f32_16x16x32_bf16 v[136:139], a[240:243], a[164:167], v[136:139]
s_mul_i32 s3, s41, 491520
ds_read_b64_tr_b16 a[232:233], v225 offset:256
v_mfma_f32_16x16x32_bf16 v[136:139], a[244:247], a[172:175], v[136:139]
s_waitcnt lgkmcnt(5)
ds_read_b64_tr_b16 a[234:235], v225 offset:2816
v_mfma_f32_16x16x32_bf16 v[132:135], a[248:251], a[160:163], v[132:135]
s_add_u32 s32, s46, 20480
ds_read_b64_tr_b16 a[236:237], v225 offset:10496
v_mfma_f32_16x16x32_bf16 v[132:135], a[252:255], a[168:171], v[132:135]
ds_read_b64_tr_b16 a[238:239], v225 offset:13056
buffer_load_dwordx4 a[56:59], v238, s[24:27], s32 offen offset:2048 sc1
v_mfma_f32_16x16x32_bf16 v[140:143], a[248:251], a[164:167], v[140:143]
s_barrier
ds_read_b64_tr_b16 a[240:241], v224 offset:20480
v_mfma_f32_16x16x32_bf16 v[140:143], a[252:255], a[172:175], v[140:143]
s_waitcnt lgkmcnt(5)
ds_read_b64_tr_b16 a[242:243], v224 offset:23040
v_mfma_f32_16x16x32_bf16 v[144:147], a[224:227], a[160:163], v[144:147]
s_add_u32 s41, s40, 3
ds_read_b64_tr_b16 a[244:245], v224 offset:30720
v_mfma_f32_16x16x32_bf16 v[144:147], a[228:231], a[168:171], v[144:147]
ds_read_b64_tr_b16 a[246:247], v224 offset:33280
v_mfma_f32_16x16x32_bf16 v[152:155], a[224:227], a[164:167], v[152:155]
ds_read_b64_tr_b16 a[248:249], v225 offset:20480
buffer_load_dwordx4 a[60:63], v238, s[24:27], s32 offen offset:3072 sc1
v_mfma_f32_16x16x32_bf16 v[152:155], a[228:231], a[172:175], v[152:155]
s_waitcnt lgkmcnt(5)
ds_read_b64_tr_b16 a[250:251], v225 offset:23040
v_mfma_f32_16x16x32_bf16 v[148:151], a[232:235], a[160:163], v[148:151]
s_and_b32 s41, s41, 3
ds_read_b64_tr_b16 a[252:253], v225 offset:30720
v_mfma_f32_16x16x32_bf16 v[148:151], a[236:239], a[168:171], v[148:151]
ds_read_b64_tr_b16 a[254:255], v225 offset:33280
v_mfma_f32_16x16x32_bf16 v[156:159], a[232:235], a[164:167], v[156:159]
s_add_u32 s91, s91, 29360128
ds_read_b64_tr_b16 a[224:225], v224 offset:20544
v_mfma_f32_16x16x32_bf16 v[156:159], a[236:239], a[172:175], v[156:159]
s_waitcnt vmcnt(35) lgkmcnt(5)
ds_read_b64_tr_b16 a[226:227], v224 offset:23104
buffer_load_dwordx4 v[160:163], v210, s[24:27], s91 offen offset:0 sc1
v_mfma_f32_16x16x32_bf16 v[80:83], a[240:243], a[176:179], v[80:83]
s_mul_i32 s55, s41, 12288
ds_read_b64_tr_b16 a[228:229], v224 offset:30784
v_mfma_f32_16x16x32_bf16 v[80:83], a[244:247], a[184:187], v[80:83]
s_waitcnt vmcnt(35)
ds_read_b64_tr_b16 a[230:231], v224 offset:33344
v_mfma_f32_16x16x32_bf16 v[88:91], a[240:243], a[180:183], v[88:91]
ds_read_b64_tr_b16 a[232:233], v225 offset:20544
v_mfma_f32_16x16x32_bf16 v[88:91], a[244:247], a[188:191], v[88:91]
s_waitcnt lgkmcnt(5)
ds_read_b64_tr_b16 a[234:235], v225 offset:23104
v_mfma_f32_16x16x32_bf16 v[84:87], a[248:251], a[176:179], v[84:87]
s_mul_i32 s4, s41, 491520
ds_read_b64_tr_b16 a[236:237], v225 offset:30784
buffer_load_dword v164, v211, s[24:27], s91 offen offset:2048 sc1
v_mfma_f32_16x16x32_bf16 v[84:87], a[252:255], a[184:187], v[84:87]
ds_read_b64_tr_b16 a[238:239], v225 offset:33344
v_mfma_f32_16x16x32_bf16 v[92:95], a[248:251], a[180:183], v[92:95]
s_add_u32 s91, s91, 40960
ds_read_b64_tr_b16 a[240:241], v224 offset:20608
v_mfma_f32_16x16x32_bf16 v[92:95], a[252:255], a[188:191], v[92:95]
s_waitcnt lgkmcnt(5)
ds_read_b64_tr_b16 a[242:243], v224 offset:23168
v_mfma_f32_16x16x32_bf16 v[96:99], a[224:227], a[176:179], v[96:99]
ds_read_b64_tr_b16 a[244:245], v224 offset:30848
v_mfma_f32_16x16x32_bf16 v[96:99], a[228:231], a[184:187], v[96:99]
ds_read_b64_tr_b16 a[246:247], v224 offset:33408
buffer_load_dwordx4 v[166:169], v210, s[24:27], s91 offen offset:0 sc1
v_mfma_f32_16x16x32_bf16 v[104:107], a[224:227], a[180:183], v[104:107]
ds_read_b64_tr_b16 a[248:249], v225 offset:20608
v_mfma_f32_16x16x32_bf16 v[104:107], a[228:231], a[188:191], v[104:107]
s_waitcnt lgkmcnt(5)
ds_read_b64_tr_b16 a[250:251], v225 offset:23168
v_mfma_f32_16x16x32_bf16 v[100:103], a[232:235], a[176:179], v[100:103]
ds_read_b64_tr_b16 a[252:253], v225 offset:30848
v_mfma_f32_16x16x32_bf16 v[100:103], a[236:239], a[184:187], v[100:103]
ds_read_b64_tr_b16 a[254:255], v225 offset:33408
v_mfma_f32_16x16x32_bf16 v[108:111], a[232:235], a[180:183], v[108:111]
ds_read_b64_tr_b16 a[224:225], v224 offset:20672
buffer_load_dword v165, v211, s[24:27], s91 offen offset:2048 sc1
v_mfma_f32_16x16x32_bf16 v[108:111], a[236:239], a[188:191], v[108:111]
s_waitcnt lgkmcnt(5)
ds_read_b64_tr_b16 a[226:227], v224 offset:23232
v_mfma_f32_16x16x32_bf16 v[112:115], a[240:243], a[176:179], v[112:115]
s_mov_b32 s32, 5120
ds_read_b64_tr_b16 a[228:229], v224 offset:30912
v_mfma_f32_16x16x32_bf16 v[112:115], a[244:247], a[184:187], v[112:115]
ds_read_b64_tr_b16 a[230:231], v224 offset:33472
v_mfma_f32_16x16x32_bf16 v[120:123], a[240:243], a[180:183], v[120:123]
ds_read_b64_tr_b16 a[232:233], v225 offset:20672
v_mfma_f32_16x16x32_bf16 v[120:123], a[244:247], a[188:191], v[120:123]
s_waitcnt lgkmcnt(5)
ds_read_b64_tr_b16 a[234:235], v225 offset:23232
buffer_load_dwordx4 v[170:173], v212, s[24:27], s32 offen offset:0 sc1
v_mfma_f32_16x16x32_bf16 v[116:119], a[248:251], a[176:179], v[116:119]
ds_read_b64_tr_b16 a[236:237], v225 offset:30912
v_mfma_f32_16x16x32_bf16 v[116:119], a[252:255], a[184:187], v[116:119]
ds_read_b64_tr_b16 a[238:239], v225 offset:33472
v_mfma_f32_16x16x32_bf16 v[124:127], a[248:251], a[180:183], v[124:127]
ds_read_b64_tr_b16 a[240:241], v224 offset:20736
v_mfma_f32_16x16x32_bf16 v[124:127], a[252:255], a[188:191], v[124:127]
s_waitcnt lgkmcnt(5)
ds_read_b64_tr_b16 a[242:243], v224 offset:23296
v_mfma_f32_16x16x32_bf16 v[128:131], a[224:227], a[176:179], v[128:131]
ds_read_b64_tr_b16 a[244:245], v224 offset:30976
v_mfma_f32_16x16x32_bf16 v[128:131], a[228:231], a[184:187], v[128:131]
ds_read_b64_tr_b16 a[246:247], v224 offset:33536
v_add_u32_e64 v241, s51, 1
v_mfma_f32_16x16x32_bf16 v[136:139], a[224:227], a[180:183], v[136:139]
ds_read_b64_tr_b16 a[248:249], v225 offset:20736
s_waitcnt vmcnt(9)
buffer_store_dword v241, v240, s[24:27], s6 offen sc1
v_mfma_f32_16x16x32_bf16 v[136:139], a[228:231], a[188:191], v[136:139]
s_waitcnt lgkmcnt(5)
ds_read_b64_tr_b16 a[250:251], v225 offset:23296
v_mfma_f32_16x16x32_bf16 v[132:135], a[232:235], a[176:179], v[132:135]
ds_read_b64_tr_b16 a[252:253], v225 offset:30976
v_mfma_f32_16x16x32_bf16 v[132:135], a[236:239], a[184:187], v[132:135]
ds_read_b64_tr_b16 a[254:255], v225 offset:33536
v_mfma_f32_16x16x32_bf16 v[140:143], a[232:235], a[180:183], v[140:143]
s_barrier
ds_read_b64_tr_b16 a[224:225], v224 offset:40960
v_mfma_f32_16x16x32_bf16 v[140:143], a[236:239], a[188:191], v[140:143]
s_waitcnt lgkmcnt(5)
ds_read_b64_tr_b16 a[226:227], v224 offset:43520
buffer_load_dwordx4 v[174:177], v212, s[24:27], s32 offen offset:16 sc1
v_mfma_f32_16x16x32_bf16 v[144:147], a[240:243], a[176:179], v[144:147]
ds_read_b64_tr_b16 a[228:229], v224 offset:51200
v_mfma_f32_16x16x32_bf16 v[144:147], a[244:247], a[184:187], v[144:147]
ds_read_b64_tr_b16 a[230:231], v224 offset:53760
v_mfma_f32_16x16x32_bf16 v[152:155], a[240:243], a[180:183], v[152:155]
ds_read_b64_tr_b16 a[232:233], v225 offset:40960
v_mfma_f32_16x16x32_bf16 v[152:155], a[244:247], a[188:191], v[152:155]
s_waitcnt lgkmcnt(5)
ds_read_b64_tr_b16 a[234:235], v225 offset:43520
v_mfma_f32_16x16x32_bf16 v[148:151], a[248:251], a[176:179], v[148:151]
ds_read_b64_tr_b16 a[236:237], v225 offset:51200
buffer_load_dwordx2 v[178:179], v213, s[24:27], s32 offen offset:512 sc1
v_mfma_f32_16x16x32_bf16 v[148:151], a[252:255], a[184:187], v[148:151]
ds_read_b64_tr_b16 a[238:239], v225 offset:53760
v_mfma_f32_16x16x32_bf16 v[156:159], a[248:251], a[180:183], v[156:159]
s_mov_b32 s32, 10240
ds_read_b64_tr_b16 a[240:241], v224 offset:41024
v_mfma_f32_16x16x32_bf16 v[156:159], a[252:255], a[188:191], v[156:159]
s_waitcnt lgkmcnt(5)
ds_read_b64_tr_b16 a[242:243], v224 offset:43584
v_mfma_f32_16x16x32_bf16 v[80:83], a[224:227], a[192:195], v[80:83]
ds_read_b64_tr_b16 a[244:245], v224 offset:51264
v_mfma_f32_16x16x32_bf16 v[80:83], a[228:231], a[200:203], v[80:83]
ds_read_b64_tr_b16 a[246:247], v224 offset:53824
buffer_load_dwordx4 v[180:183], v212, s[24:27], s32 offen offset:0 sc1
v_mfma_f32_16x16x32_bf16 v[88:91], a[224:227], a[196:199], v[88:91]
ds_read_b64_tr_b16 a[248:249], v225 offset:41024
v_mfma_f32_16x16x32_bf16 v[88:91], a[228:231], a[204:207], v[88:91]
s_waitcnt lgkmcnt(5)
ds_read_b64_tr_b16 a[250:251], v225 offset:43584
v_mfma_f32_16x16x32_bf16 v[84:87], a[232:235], a[192:195], v[84:87]
ds_read_b64_tr_b16 a[252:253], v225 offset:51264
v_mfma_f32_16x16x32_bf16 v[84:87], a[236:239], a[200:203], v[84:87]
ds_read_b64_tr_b16 a[254:255], v225 offset:53824
v_mfma_f32_16x16x32_bf16 v[92:95], a[232:235], a[196:199], v[92:95]
ds_read_b64_tr_b16 a[224:225], v224 offset:41088
buffer_load_dwordx4 v[184:187], v212, s[24:27], s32 offen offset:16 sc1
v_mfma_f32_16x16x32_bf16 v[92:95], a[236:239], a[204:207], v[92:95]
s_waitcnt lgkmcnt(5)
ds_read_b64_tr_b16 a[226:227], v224 offset:43648
v_mfma_f32_16x16x32_bf16 v[96:99], a[240:243], a[192:195], v[96:99]
ds_read_b64_tr_b16 a[228:229], v224 offset:51328
v_mfma_f32_16x16x32_bf16 v[96:99], a[244:247], a[200:203], v[96:99]
ds_read_b64_tr_b16 a[230:231], v224 offset:53888
v_mfma_f32_16x16x32_bf16 v[104:107], a[240:243], a[196:199], v[104:107]
ds_read_b64_tr_b16 a[232:233], v225 offset:41088
v_mfma_f32_16x16x32_bf16 v[104:107], a[244:247], a[204:207], v[104:107]
s_waitcnt lgkmcnt(5)
ds_read_b64_tr_b16 a[234:235], v225 offset:43648
buffer_load_dwordx2 v[188:189], v213, s[24:27], s32 offen offset:512 sc1
v_mfma_f32_16x16x32_bf16 v[100:103], a[248:251], a[192:195], v[100:103]
s_mov_b32 s32, 7680
ds_read_b64_tr_b16 a[236:237], v225 offset:51328
v_mfma_f32_16x16x32_bf16 v[100:103], a[252:255], a[200:203], v[100:103]
ds_read_b64_tr_b16 a[238:239], v225 offset:53888
v_mfma_f32_16x16x32_bf16 v[108:111], a[248:251], a[196:199], v[108:111]
ds_read_b64_tr_b16 a[240:241], v224 offset:41152
v_mfma_f32_16x16x32_bf16 v[108:111], a[252:255], a[204:207], v[108:111]
s_waitcnt lgkmcnt(5)
ds_read_b64_tr_b16 a[242:243], v224 offset:43712
v_mfma_f32_16x16x32_bf16 v[112:115], a[224:227], a[192:195], v[112:115]
ds_read_b64_tr_b16 a[244:245], v224 offset:51392
buffer_load_dwordx4 v[190:193], v212, s[24:27], s32 offen offset:0 sc1
v_mfma_f32_16x16x32_bf16 v[112:115], a[228:231], a[200:203], v[112:115]
ds_read_b64_tr_b16 a[246:247], v224 offset:53952
v_mfma_f32_16x16x32_bf16 v[120:123], a[224:227], a[196:199], v[120:123]
ds_read_b64_tr_b16 a[248:249], v225 offset:41152
v_mfma_f32_16x16x32_bf16 v[120:123], a[228:231], a[204:207], v[120:123]
s_waitcnt lgkmcnt(5)
ds_read_b64_tr_b16 a[250:251], v225 offset:43712
v_mfma_f32_16x16x32_bf16 v[116:119], a[232:235], a[192:195], v[116:119]
ds_read_b64_tr_b16 a[252:253], v225 offset:51392
v_mfma_f32_16x16x32_bf16 v[116:119], a[236:239], a[200:203], v[116:119]
ds_read_b64_tr_b16 a[254:255], v225 offset:53952
buffer_load_dwordx4 v[194:197], v212, s[24:27], s32 offen offset:16 sc1
v_mfma_f32_16x16x32_bf16 v[124:127], a[232:235], a[196:199], v[124:127]
ds_read_b64_tr_b16 a[224:225], v224 offset:41216
v_mfma_f32_16x16x32_bf16 v[124:127], a[236:239], a[204:207], v[124:127]
s_waitcnt lgkmcnt(5)
ds_read_b64_tr_b16 a[226:227], v224 offset:43776
v_mfma_f32_16x16x32_bf16 v[128:131], a[240:243], a[192:195], v[128:131]
ds_read_b64_tr_b16 a[228:229], v224 offset:51456
v_mfma_f32_16x16x32_bf16 v[128:131], a[244:247], a[200:203], v[128:131]
ds_read_b64_tr_b16 a[230:231], v224 offset:54016
v_mfma_f32_16x16x32_bf16 v[136:139], a[240:243], a[196:199], v[136:139]
ds_read_b64_tr_b16 a[232:233], v225 offset:41216
buffer_load_dwordx2 v[198:199], v213, s[24:27], s32 offen offset:512 sc1
v_mfma_f32_16x16x32_bf16 v[136:139], a[244:247], a[204:207], v[136:139]
s_waitcnt lgkmcnt(5)
ds_read_b64_tr_b16 a[234:235], v225 offset:43776
v_mfma_f32_16x16x32_bf16 v[132:135], a[248:251], a[192:195], v[132:135]
s_add_u32 m0, s28, 0
ds_read_b64_tr_b16 a[236:237], v225 offset:51456
v_mfma_f32_16x16x32_bf16 v[132:135], a[252:255], a[200:203], v[132:135]
ds_read_b64_tr_b16 a[238:239], v225 offset:54016
v_mfma_f32_16x16x32_bf16 v[140:143], a[248:251], a[196:199], v[140:143]
s_barrier
ds_read_b64_tr_b16 a[240:241], v226 offset:0
v_mfma_f32_16x16x32_bf16 v[140:143], a[252:255], a[204:207], v[140:143]
s_waitcnt lgkmcnt(5)
ds_read_b64_tr_b16 a[242:243], v226 offset:2560
v_mfma_f32_16x16x32_bf16 v[144:147], a[224:227], a[192:195], v[144:147]
s_add_u32 s30, s56, 0
ds_read_b64_tr_b16 a[244:245], v226 offset:10240
v_mfma_f32_16x16x32_bf16 v[144:147], a[228:231], a[200:203], v[144:147]
ds_read_b64_tr_b16 a[246:247], v226 offset:12800
buffer_load_dwordx4 v243, s[8:11], s30 offen offset:0 lds
v_mfma_f32_16x16x32_bf16 v[152:155], a[224:227], a[196:199], v[152:155]
ds_read_b64_tr_b16 a[248:249], v227 offset:0
v_mfma_f32_16x16x32_bf16 v[152:155], a[228:231], a[204:207], v[152:155]
s_waitcnt lgkmcnt(5)
ds_read_b64_tr_b16 a[250:251], v227 offset:2560
v_mfma_f32_16x16x32_bf16 v[148:151], a[232:235], a[192:195], v[148:151]
ds_read_b64_tr_b16 a[252:253], v227 offset:10240
v_mfma_f32_16x16x32_bf16 v[148:151], a[236:239], a[200:203], v[148:151]
ds_read_b64_tr_b16 a[254:255], v227 offset:12800
v_mfma_f32_16x16x32_bf16 v[156:159], a[232:235], a[196:199], v[156:159]
ds_read_b64_tr_b16 a[224:225], v226 offset:64
buffer_load_dwordx4 v244, s[8:11], s30 offen offset:1024 lds
v_mfma_f32_16x16x32_bf16 v[156:159], a[236:239], a[204:207], v[156:159]
s_waitcnt lgkmcnt(5)
ds_read_b64_tr_b16 a[226:227], v226 offset:2624
v_mfma_f32_16x16x32_bf16 v[80:83], a[240:243], a[208:211], v[80:83]
ds_read_b64_tr_b16 a[228:229], v226 offset:10304
v_mfma_f32_16x16x32_bf16 v[80:83], a[244:247], a[216:219], v[80:83]
ds_read_b64_tr_b16 a[230:231], v226 offset:12864
v_mfma_f32_16x16x32_bf16 v[88:91], a[240:243], a[212:215], v[88:91]
ds_read_b64_tr_b16 a[232:233], v227 offset:64
v_mfma_f32_16x16x32_bf16 v[88:91], a[244:247], a[220:223], v[88:91]
s_waitcnt lgkmcnt(5)
ds_read_b64_tr_b16 a[234:235], v227 offset:2624
v_mfma_f32_16x16x32_bf16 v[84:87], a[248:251], a[208:211], v[84:87]
ds_read_b64_tr_b16 a[236:237], v227 offset:10304
v_mfma_f32_16x16x32_bf16 v[84:87], a[252:255], a[216:219], v[84:87]
ds_read_b64_tr_b16 a[238:239], v227 offset:12864
buffer_load_dword v239, v236, s[24:27], 0 offen sc1
v_mfma_f32_16x16x32_bf16 v[92:95], a[248:251], a[212:215], v[92:95]
ds_read_b64_tr_b16 a[240:241], v226 offset:128
v_mfma_f32_16x16x32_bf16 v[92:95], a[252:255], a[220:223], v[92:95]
s_waitcnt lgkmcnt(5)
ds_read_b64_tr_b16 a[242:243], v226 offset:2688
v_mfma_f32_16x16x32_bf16 v[96:99], a[224:227], a[208:211], v[96:99]
ds_read_b64_tr_b16 a[244:245], v226 offset:10368
v_mfma_f32_16x16x32_bf16 v[96:99], a[228:231], a[216:219], v[96:99]
ds_read_b64_tr_b16 a[246:247], v226 offset:12928
buffer_load_dwordx4 v245, s[8:11], s30 offen offset:2048 lds
v_mfma_f32_16x16x32_bf16 v[104:107], a[224:227], a[212:215], v[104:107]
s_add_u32 m0, s28, 12288
ds_read_b64_tr_b16 a[248:249], v227 offset:128
v_mfma_f32_16x16x32_bf16 v[104:107], a[228:231], a[220:223], v[104:107]
s_waitcnt lgkmcnt(5)
ds_read_b64_tr_b16 a[250:251], v227 offset:2688
v_mfma_f32_16x16x32_bf16 v[100:103], a[232:235], a[208:211], v[100:103]
s_add_u32 s30, s56, 196608
ds_read_b64_tr_b16 a[252:253], v227 offset:10368
v_mfma_f32_16x16x32_bf16 v[100:103], a[236:239], a[216:219], v[100:103]
ds_read_b64_tr_b16 a[254:255], v227 offset:12928
v_mfma_f32_16x16x32_bf16 v[108:111], a[232:235], a[212:215], v[108:111]
ds_read_b64_tr_b16 a[224:225], v226 offset:192
buffer_load_dwordx4 v243, s[8:11], s30 offen offset:0 lds
v_mfma_f32_16x16x32_bf16 v[108:111], a[236:239], a[220:223], v[108:111]
s_waitcnt lgkmcnt(5)
ds_read_b64_tr_b16 a[226:227], v226 offset:2752
v_mfma_f32_16x16x32_bf16 v[112:115], a[240:243], a[208:211], v[112:115]
ds_read_b64_tr_b16 a[228:229], v226 offset:10432
v_mfma_f32_16x16x32_bf16 v[112:115], a[244:247], a[216:219], v[112:115]
ds_read_b64_tr_b16 a[230:231], v226 offset:12992
v_mfma_f32_16x16x32_bf16 v[120:123], a[240:243], a[212:215], v[120:123]
ds_read_b64_tr_b16 a[232:233], v227 offset:192
v_mfma_f32_16x16x32_bf16 v[120:123], a[244:247], a[220:223], v[120:123]
s_waitcnt lgkmcnt(5)
ds_read_b64_tr_b16 a[234:235], v227 offset:2752
buffer_load_dwordx4 v244, s[8:11], s30 offen offset:1024 lds
v_mfma_f32_16x16x32_bf16 v[116:119], a[248:251], a[208:211], v[116:119]
ds_read_b64_tr_b16 a[236:237], v227 offset:10432
v_mfma_f32_16x16x32_bf16 v[116:119], a[252:255], a[216:219], v[116:119]
ds_read_b64_tr_b16 a[238:239], v227 offset:12992
v_mfma_f32_16x16x32_bf16 v[124:127], a[248:251], a[212:215], v[124:127]
ds_read_b64_tr_b16 a[240:241], v226 offset:256
v_mfma_f32_16x16x32_bf16 v[124:127], a[252:255], a[220:223], v[124:127]
s_waitcnt lgkmcnt(5)
ds_read_b64_tr_b16 a[242:243], v226 offset:2816
v_mfma_f32_16x16x32_bf16 v[128:131], a[224:227], a[208:211], v[128:131]
ds_read_b64_tr_b16 a[244:245], v226 offset:10496
buffer_load_dwordx4 v245, s[8:11], s30 offen offset:2048 lds
v_mfma_f32_16x16x32_bf16 v[128:131], a[228:231], a[216:219], v[128:131]
ds_read_b64_tr_b16 a[246:247], v226 offset:13056
v_mfma_f32_16x16x32_bf16 v[136:139], a[224:227], a[212:215], v[136:139]
s_add_u32 m0, s28, 24576
ds_read_b64_tr_b16 a[248:249], v227 offset:256
v_mfma_f32_16x16x32_bf16 v[136:139], a[228:231], a[220:223], v[136:139]
s_waitcnt lgkmcnt(5)
ds_read_b64_tr_b16 a[250:251], v227 offset:2816
v_mfma_f32_16x16x32_bf16 v[132:135], a[232:235], a[208:211], v[132:135]
s_add_u32 s30, s57, 0
ds_read_b64_tr_b16 a[252:253], v227 offset:10496
v_mfma_f32_16x16x32_bf16 v[132:135], a[236:239], a[216:219], v[132:135]
ds_read_b64_tr_b16 a[254:255], v227 offset:13056
buffer_load_dwordx4 v243, s[8:11], s30 offen offset:0 lds
v_mfma_f32_16x16x32_bf16 v[140:143], a[232:235], a[212:215], v[140:143]
s_barrier
ds_read_b64_tr_b16 a[224:225], v226 offset:20480
v_mfma_f32_16x16x32_bf16 v[140:143], a[236:239], a[220:223], v[140:143]
s_waitcnt lgkmcnt(5)
ds_read_b64_tr_b16 a[226:227], v226 offset:23040
v_mfma_f32_16x16x32_bf16 v[144:147], a[240:243], a[208:211], v[144:147]
ds_read_b64_tr_b16 a[228:229], v226 offset:30720
v_mfma_f32_16x16x32_bf16 v[144:147], a[244:247], a[216:219], v[144:147]
ds_read_b64_tr_b16 a[230:231], v226 offset:33280
v_mfma_f32_16x16x32_bf16 v[152:155], a[240:243], a[212:215], v[152:155]
ds_read_b64_tr_b16 a[232:233], v227 offset:20480
buffer_load_dwordx4 v244, s[8:11], s30 offen offset:1024 lds
v_mfma_f32_16x16x32_bf16 v[152:155], a[244:247], a[220:223], v[152:155]
s_waitcnt lgkmcnt(5)
ds_read_b64_tr_b16 a[234:235], v227 offset:23040
v_mfma_f32_16x16x32_bf16 v[148:151], a[248:251], a[208:211], v[148:151]
ds_read_b64_tr_b16 a[236:237], v227 offset:30720
v_mfma_f32_16x16x32_bf16 v[148:151], a[252:255], a[216:219], v[148:151]
ds_read_b64_tr_b16 a[238:239], v227 offset:33280
v_mfma_f32_16x16x32_bf16 v[156:159], a[248:251], a[212:215], v[156:159]
ds_read_b64_tr_b16 a[240:241], v226 offset:20544
s_waitcnt vmcnt(6)
v_subrev_u32 v239, s51, v239
v_mfma_f32_16x16x32_bf16 v[156:159], a[252:255], a[220:223], v[156:159]
s_waitcnt lgkmcnt(5)
ds_read_b64_tr_b16 a[242:243], v226 offset:23104
buffer_load_dwordx4 v245, s[8:11], s30 offen offset:2048 lds
v_mfma_f32_16x16x32_bf16 v[80:83], a[224:227], a[0:3], v[80:83]
ds_read_b64_tr_b16 a[244:245], v226 offset:30784
v_cmp_lt_u32 vcc, 1, v239
v_mfma_f32_16x16x32_bf16 v[80:83], a[228:231], a[8:11], v[80:83]
ds_read_b64_tr_b16 a[246:247], v226 offset:33344
v_mfma_f32_16x16x32_bf16 v[88:91], a[224:227], a[4:7], v[88:91]
s_barrier
ds_read_b64_tr_b16 a[248:249], v227 offset:20544
v_mfma_f32_16x16x32_bf16 v[88:91], a[228:231], a[12:15], v[88:91]
s_waitcnt lgkmcnt(5)
ds_read_b64_tr_b16 a[250:251], v227 offset:23104
s_cbranch_vccnz L_slow_pa
L_back_pa:
v_mfma_f32_16x16x32_bf16 v[84:87], a[232:235], a[0:3], v[84:87]
s_add_u32 s39, s92, 0
ds_read_b64_tr_b16 a[252:253], v227 offset:30784
v_mfma_f32_16x16x32_bf16 v[84:87], a[236:239], a[8:11], v[84:87]
ds_read_b64_tr_b16 a[254:255], v227 offset:33344
buffer_load_dwordx4 v[0:3], v238, s[24:27], s39 offen offset:0 sc1
v_mfma_f32_16x16x32_bf16 v[92:95], a[232:235], a[4:7], v[92:95]
ds_read_b64_tr_b16 a[224:225], v226 offset:20608
v_mfma_f32_16x16x32_bf16 v[92:95], a[236:239], a[12:15], v[92:95]
s_waitcnt lgkmcnt(5)
ds_read_b64_tr_b16 a[226:227], v226 offset:23168
v_mfma_f32_16x16x32_bf16 v[96:99], a[240:243], a[0:3], v[96:99]
ds_read_b64_tr_b16 a[228:229], v226 offset:30848
v_mfma_f32_16x16x32_bf16 v[96:99], a[244:247], a[8:11], v[96:99]
ds_read_b64_tr_b16 a[230:231], v226 offset:33408
buffer_load_dword v32, v251, s[24:27], s39 offen offset:1024 sc1
v_mfma_f32_16x16x32_bf16 v[104:107], a[240:243], a[4:7], v[104:107]
ds_read_b64_tr_b16 a[232:233], v227 offset:20608
v_mfma_f32_16x16x32_bf16 v[104:107], a[244:247], a[12:15], v[104:107]
s_waitcnt lgkmcnt(5)
ds_read_b64_tr_b16 a[234:235], v227 offset:23168
v_mfma_f32_16x16x32_bf16 v[100:103], a[248:251], a[0:3], v[100:103]
ds_read_b64_tr_b16 a[236:237], v227 offset:30848
v_mfma_f32_16x16x32_bf16 v[100:103], a[252:255], a[8:11], v[100:103]
ds_read_b64_tr_b16 a[238:239], v227 offset:33408
buffer_load_dwordx4 v[4:7], v238, s[24:27], s39 offen offset:1280 sc1
v_mfma_f32_16x16x32_bf16 v[108:111], a[248:251], a[4:7], v[108:111]
ds_read_b64_tr_b16 a[240:241], v226 offset:20672
v_mfma_f32_16x16x32_bf16 v[108:111], a[252:255], a[12:15], v[108:111]
s_waitcnt lgkmcnt(5)
ds_read_b64_tr_b16 a[242:243], v226 offset:23232
v_mfma_f32_16x16x32_bf16 v[112:115], a[224:227], a[0:3], v[112:115]
ds_read_b64_tr_b16 a[244:245], v226 offset:30912
v_mfma_f32_16x16x32_bf16 v[112:115], a[228:231], a[8:11], v[112:115]
ds_read_b64_tr_b16 a[246:247], v226 offset:33472
buffer_load_dword v33, v251, s[24:27], s39 offen offset:2304 sc1
v_mfma_f32_16x16x32_bf16 v[120:123], a[224:227], a[4:7], v[120:123]
s_add_u32 s39, s92, 2560
ds_read_b64_tr_b16 a[248:249], v227 offset:20672
v_mfma_f32_16x16x32_bf16 v[120:123], a[228:231], a[12:15], v[120:123]
s_waitcnt lgkmcnt(5)
ds_read_b64_tr_b16 a[250:251], v227 offset:23232
v_mfma_f32_16x16x32_bf16 v[116:119], a[232:235], a[0:3], v[116:119]
ds_read_b64_tr_b16 a[252:253], v227 offset:30912
v_mfma_f32_16x16x32_bf16 v[116:119], a[236:239], a[8:11], v[116:119]
ds_read_b64_tr_b16 a[254:255], v227 offset:33472
buffer_load_dwordx4 v[8:11], v238, s[24:27], s39 offen offset:0 sc1
v_mfma_f32_16x16x32_bf16 v[124:127], a[232:235], a[4:7], v[124:127]
ds_read_b64_tr_b16 a[224:225], v226 offset:20736
v_mfma_f32_16x16x32_bf16 v[124:127], a[236:239], a[12:15], v[124:127]
s_waitcnt lgkmcnt(5)
ds_read_b64_tr_b16 a[226:227], v226 offset:23296
v_mfma_f32_16x16x32_bf16 v[128:131], a[240:243], a[0:3], v[128:131]
ds_read_b64_tr_b16 a[228:229], v226 offset:30976
v_mfma_f32_16x16x32_bf16 v[128:131], a[244:247], a[8:11], v[128:131]
ds_read_b64_tr_b16 a[230:231], v226 offset:33536
buffer_load_dword v34, v251, s[24:27], s39 offen offset:1024 sc1
v_mfma_f32_16x16x32_bf16 v[136:139], a[240:243], a[4:7], v[136:139]
ds_read_b64_tr_b16 a[232:233], v227 offset:20736
v_mfma_f32_16x16x32_bf16 v[136:139], a[244:247], a[12:15], v[136:139]
s_waitcnt lgkmcnt(5)
ds_read_b64_tr_b16 a[234:235], v227 offset:23296
v_mfma_f32_16x16x32_bf16 v[132:135], a[248:251], a[0:3], v[132:135]
ds_read_b64_tr_b16 a[236:237], v227 offset:30976
v_mfma_f32_16x16x32_bf16 v[132:135], a[252:255], a[8:11], v[132:135]
ds_read_b64_tr_b16 a[238:239], v227 offset:33536
buffer_load_dwordx4 v[12:15], v238, s[24:27], s39 offen offset:1280 sc1
v_mfma_f32_16x16x32_bf16 v[140:143], a[248:251], a[4:7], v[140:143]
s_barrier
ds_read_b64_tr_b16 a[240:241], v228 offset:20480
v_mfma_f32_16x16x32_bf16 v[140:143], a[252:255], a[12:15], v[140:143]
s_waitcnt lgkmcnt(5)
ds_read_b64_tr_b16 a[242:243], v228 offset:23040
v_mfma_f32_16x16x32_bf16 v[144:147], a[224:227], a[0:3], v[144:147]
ds_read_b64_tr_b16 a[244:245], v228 offset:30720
v_mfma_f32_16x16x32_bf16 v[144:147], a[228:231], a[8:11], v[144:147]
L_pg15:
s_cbranch_execz L_ret_A
ds_read_b64_tr_b16 a[246:247], v228 offset:33280
buffer_load_dword v35, v251, s[24:27], s39 offen offset:2304 sc1
v_mfma_f32_16x16x32_bf16 v[152:155], a[224:227], a[4:7], v[152:155]
s_add_u32 s39, s92, 5120
ds_read_b64_tr_b16 a[248:249], v229 offset:20480
v_mfma_f32_16x16x32_bf16 v[152:155], a[228:231], a[12:15], v[152:155]
s_waitcnt lgkmcnt(5)
ds_read_b64_tr_b16 a[250:251], v229 offset:23040
v_mfma_f32_16x16x32_bf16 v[148:151], a[232:235], a[0:3], v[148:151]
ds_read_b64_tr_b16 a[252:253], v229 offset:30720
v_mfma_f32_16x16x32_bf16 v[148:151], a[236:239], a[8:11], v[148:151]
ds_read_b64_tr_b16 a[254:255], v229 offset:33280
buffer_load_dwordx4 v[16:19], v238, s[24:27], s39 offen offset:0 sc1
v_mfma_f32_16x16x32_bf16 v[156:159], a[232:235], a[4:7], v[156:159]
ds_read_b64_tr_b16 a[224:225], v226 offset:40960
v_mfma_f32_16x16x32_bf16 v[156:159], a[236:239], a[12:15], v[156:159]
s_waitcnt lgkmcnt(5)
ds_read_b64_tr_b16 a[226:227], v226 offset:43520
v_mfma_f32_16x16x32_bf16 v[80:83], a[240:243], a[16:19], v[80:83]
ds_read_b64_tr_b16 a[228:229], v226 offset:51200
v_mfma_f32_16x16x32_bf16 v[80:83], a[244:247], a[24:27], v[80:83]
ds_read_b64_tr_b16 a[230:231], v226 offset:53760
buffer_load_dword v36, v251, s[24:27], s39 offen offset:1024 sc1
v_mfma_f32_16x16x32_bf16 v[88:91], a[240:243], a[20:23], v[88:91]
ds_read_b64_tr_b16 a[232:233], v227 offset:40960
v_mfma_f32_16x16x32_bf16 v[88:91], a[244:247], a[28:31], v[88:91]
s_waitcnt lgkmcnt(5)
ds_read_b64_tr_b16 a[234:235], v227 offset:43520
v_mfma_f32_16x16x32_bf16 v[84:87], a[248:251], a[16:19], v[84:87]
ds_read_b64_tr_b16 a[236:237], v227 offset:51200
v_mfma_f32_16x16x32_bf16 v[84:87], a[252:255], a[24:27], v[84:87]
ds_read_b64_tr_b16 a[238:239], v227 offset:53760
buffer_load_dwordx4 v[20:23], v238, s[24:27], s39 offen offset:1280 sc1
v_mfma_f32_16x16x32_bf16 v[92:95], a[248:251], a[20:23], v[92:95]
ds_read_b64_tr_b16 a[240:241], v228 offset:0
v_mfma_f32_16x16x32_bf16 v[92:95], a[252:255], a[28:31], v[92:95]
s_waitcnt lgkmcnt(5)
ds_read_b64_tr_b16 a[242:243], v228 offset:2560
v_mfma_f32_16x16x32_bf16 v[80:83], a[224:227], a[32:35], v[80:83]
ds_read_b64_tr_b16 a[244:245], v228 offset:10240
v_mfma_f32_16x16x32_bf16 v[80:83], a[228:231], a[40:43], v[80:83]
ds_read_b64_tr_b16 a[246:247], v228 offset:12800
buffer_load_dword v37, v251, s[24:27], s39 offen offset:2304 sc1
v_mfma_f32_16x16x32_bf16 v[88:91], a[224:227], a[36:39], v[88:91]
s_add_u32 s39, s92, 7680
ds_read_b64_tr_b16 a[248:249], v229 offset:0
v_mfma_f32_16x16x32_bf16 v[88:91], a[228:231], a[44:47], v[88:91]
s_waitcnt lgkmcnt(5)
ds_read_b64_tr_b16 a[250:251], v229 offset:2560
v_mfma_f32_16x16x32_bf16 v[84:87], a[232:235], a[32:35], v[84:87]
ds_read_b64_tr_b16 a[252:253], v229 offset:10240
v_mfma_f32_16x16x32_bf16 v[84:87], a[236:239], a[40:43], v[84:87]
ds_read_b64_tr_b16 a[254:255], v229 offset:12800
buffer_load_dwordx4 v[24:27], v238, s[24:27], s39 offen offset:0 sc1
v_mfma_f32_16x16x32_bf16 v[92:95], a[232:235], a[36:39], v[92:95]
ds_read_b64_tr_b16 a[224:225], v228 offset:20544
v_mfma_f32_16x16x32_bf16 v[92:95], a[236:239], a[44:47], v[92:95]
s_waitcnt lgkmcnt(5)
ds_read_b64_tr_b16 a[226:227], v228 offset:23104
v_mfma_f32_16x16x32_bf16 v[80:83], a[240:243], a[48:51], v[80:83]
ds_read_b64_tr_b16 a[228:229], v228 offset:30784
v_mfma_f32_16x16x32_bf16 v[80:83], a[244:247], a[56:59], v[80:83]
ds_read_b64_tr_b16 a[230:231], v228 offset:33344
buffer_load_dword v38, v251, s[24:27], s39 offen offset:1024 sc1
v_mfma_f32_16x16x32_bf16 v[88:91], a[240:243], a[52:55], v[88:91]
ds_read_b64_tr_b16 a[232:233], v229 offset:20544
v_mfma_f32_16x16x32_bf16 v[88:91], a[244:247], a[60:63], v[88:91]
s_waitcnt lgkmcnt(5)
ds_read_b64_tr_b16 a[234:235], v229 offset:23104
v_mfma_f32_16x16x32_bf16 v[84:87], a[248:251], a[48:51], v[84:87]
ds_read_b64_tr_b16 a[236:237], v229 offset:30784
v_mfma_f32_16x16x32_bf16 v[84:87], a[252:255], a[56:59], v[84:87]
ds_read_b64_tr_b16 a[238:239], v229 offset:33344
buffer_load_dwordx4 v[28:31], v238, s[24:27], s39 offen offset:1280 sc1
v_mfma_f32_16x16x32_bf16 v[92:95], a[248:251], a[52:55], v[92:95]
ds_read_b64_tr_b16 a[240:241], v226 offset:41024
v_mfma_f32_16x16x32_bf16 v[92:95], a[252:255], a[60:63], v[92:95]
s_waitcnt lgkmcnt(5)
ds_read_b64_tr_b16 a[242:243], v226 offset:43584
v_mfma_f32_16x16x32_bf16 v[96:99], a[224:227], a[16:19], v[96:99]
ds_read_b64_tr_b16 a[244:245], v226 offset:51264
v_mfma_f32_16x16x32_bf16 v[96:99], a[228:231], a[24:27], v[96:99]
ds_read_b64_tr_b16 a[246:247], v226 offset:53824
buffer_load_dword v39, v251, s[24:27], s39 offen offset:2304 sc1
v_mfma_f32_16x16x32_bf16 v[104:107], a[224:227], a[20:23], v[104:107]
ds_read_b64_tr_b16 a[248:249], v227 offset:41024
v_cvt_pk_bf16_f32 v80, v80, v81
v_mfma_f32_16x16x32_bf16 v[104:107], a[228:231], a[28:31], v[104:107]
s_waitcnt lgkmcnt(5)
ds_read_b64_tr_b16 a[250:251], v227 offset:43584
v_cvt_pk_bf16_f32 v81, v82, v83
v_mfma_f32_16x16x32_bf16 v[100:103], a[232:235], a[16:19], v[100:103]
ds_read_b64_tr_b16 a[252:253], v227 offset:51264
v_cvt_pk_bf16_f32 v82, v84, v85
v_mfma_f32_16x16x32_bf16 v[100:103], a[236:239], a[24:27], v[100:103]
ds_read_b64_tr_b16 a[254:255], v227 offset:53824
v_cvt_pk_bf16_f32 v83, v86, v87
v_mfma_f32_16x16x32_bf16 v[108:111], a[232:235], a[20:23], v[108:111]
s_add_u32 s31, s5, 10485760
ds_read_b64_tr_b16 a[224:225], v228 offset:64
v_permlane16_swap_b32 v80, v82
v_mfma_f32_16x16x32_bf16 v[108:111], a[236:239], a[28:31], v[108:111]
s_waitcnt lgkmcnt(5)
ds_read_b64_tr_b16 a[226:227], v228 offset:2624
v_permlane16_swap_b32 v81, v83
v_mfma_f32_16x16x32_bf16 v[96:99], a[240:243], a[32:35], v[96:99]
ds_read_b64_tr_b16 a[228:229], v228 offset:10304
buffer_store_dwordx4 v[80:83], v237, s[24:27], s31 offen offset:0 sc1
v_mfma_f32_16x16x32_bf16 v[96:99], a[244:247], a[40:43], v[96:99]
ds_read_b64_tr_b16 a[230:231], v228 offset:12864
v_cvt_pk_bf16_f32 v88, v88, v89
v_mfma_f32_16x16x32_bf16 v[104:107], a[240:243], a[36:39], v[104:107]
ds_read_b64_tr_b16 a[232:233], v229 offset:64
v_cvt_pk_bf16_f32 v89, v90, v91
v_mfma_f32_16x16x32_bf16 v[104:107], a[244:247], a[44:47], v[104:107]
s_waitcnt lgkmcnt(5)
ds_read_b64_tr_b16 a[234:235], v229 offset:2624
v_cvt_pk_bf16_f32 v90, v92, v93
v_mfma_f32_16x16x32_bf16 v[100:103], a[248:251], a[32:35], v[100:103]
s_add_u32 s31, s5, 10649600
ds_read_b64_tr_b16 a[236:237], v229 offset:10304
v_cvt_pk_bf16_f32 v91, v94, v95
v_mfma_f32_16x16x32_bf16 v[100:103], a[252:255], a[40:43], v[100:103]
ds_read_b64_tr_b16 a[238:239], v229 offset:12864
v_permlane16_swap_b32 v88, v90
v_mfma_f32_16x16x32_bf16 v[108:111], a[248:251], a[36:39], v[108:111]
ds_read_b64_tr_b16 a[240:241], v228 offset:20608
v_permlane16_swap_b32 v89, v91
v_mfma_f32_16x16x32_bf16 v[108:111], a[252:255], a[44:47], v[108:111]
s_waitcnt lgkmcnt(5)
ds_read_b64_tr_b16 a[242:243], v228 offset:23168
buffer_store_dwordx4 v[88:91], v237, s[24:27], s31 offen offset:0 sc1
v_mfma_f32_16x16x32_bf16 v[96:99], a[224:227], a[48:51], v[96:99]
ds_read_b64_tr_b16 a[244:245], v228 offset:30848
v_mfma_f32_16x16x32_bf16 v[96:99], a[228:231], a[56:59], v[96:99]
ds_read_b64_tr_b16 a[246:247], v228 offset:33408
v_mfma_f32_16x16x32_bf16 v[104:107], a[224:227], a[52:55], v[104:107]
ds_read_b64_tr_b16 a[248:249], v229 offset:20608
v_mfma_f32_16x16x32_bf16 v[104:107], a[228:231], a[60:63], v[104:107]
s_waitcnt lgkmcnt(5)
ds_read_b64_tr_b16 a[250:251], v229 offset:23168
v_mfma_f32_16x16x32_bf16 v[100:103], a[232:235], a[48:51], v[100:103]
ds_read_b64_tr_b16 a[252:253], v229 offset:30848
v_mfma_f32_16x16x32_bf16 v[100:103], a[236:239], a[56:59], v[100:103]
ds_read_b64_tr_b16 a[254:255], v229 offset:33408
v_mfma_f32_16x16x32_bf16 v[108:111], a[232:235], a[52:55], v[108:111]
ds_read_b64_tr_b16 a[224:225], v226 offset:41088
v_mfma_f32_16x16x32_bf16 v[108:111], a[236:239], a[60:63], v[108:111]
s_waitcnt lgkmcnt(5)
ds_read_b64_tr_b16 a[226:227], v226 offset:43648
v_mfma_f32_16x16x32_bf16 v[112:115], a[240:243], a[16:19], v[112:115]
ds_read_b64_tr_b16 a[228:229], v226 offset:51328
v_mfma_f32_16x16x32_bf16 v[112:115], a[244:247], a[24:27], v[112:115]
ds_read_b64_tr_b16 a[230:231], v226 offset:53888
v_mfma_f32_16x16x32_bf16 v[120:123], a[240:243], a[20:23], v[120:123]
ds_read_b64_tr_b16 a[232:233], v227 offset:41088
v_cvt_pk_bf16_f32 v96, v96, v97
v_mfma_f32_16x16x32_bf16 v[120:123], a[244:247], a[28:31], v[120:123]
s_waitcnt lgkmcnt(5)
ds_read_b64_tr_b16 a[234:235], v227 offset:43648
v_cvt_pk_bf16_f32 v97, v98, v99
v_mfma_f32_16x16x32_bf16 v[116:119], a[248:251], a[16:19], v[116:119]
ds_read_b64_tr_b16 a[236:237], v227 offset:51328
v_cvt_pk_bf16_f32 v98, v100, v101
v_mfma_f32_16x16x32_bf16 v[116:119], a[252:255], a[24:27], v[116:119]
ds_read_b64_tr_b16 a[238:239], v227 offset:53888
v_cvt_pk_bf16_f32 v99, v102, v103
v_mfma_f32_16x16x32_bf16 v[124:127], a[248:251], a[20:23], v[124:127]
s_add_u32 s31, s5, 10485760
ds_read_b64_tr_b16 a[240:241], v228 offset:128
v_permlane16_swap_b32 v96, v98
v_mfma_f32_16x16x32_bf16 v[124:127], a[252:255], a[28:31], v[124:127]
s_waitcnt lgkmcnt(5)
ds_read_b64_tr_b16 a[242:243], v228 offset:2688
v_permlane16_swap_b32 v97, v99
v_mfma_f32_16x16x32_bf16 v[112:115], a[224:227], a[32:35], v[112:115]
ds_read_b64_tr_b16 a[244:245], v228 offset:10368
buffer_store_dwordx4 v[96:99], v237, s[24:27], s31 offen offset:256 sc1
v_mfma_f32_16x16x32_bf16 v[112:115], a[228:231], a[40:43], v[112:115]
ds_read_b64_tr_b16 a[246:247], v228 offset:12928
v_cvt_pk_bf16_f32 v104, v104, v105
v_mfma_f32_16x16x32_bf16 v[120:123], a[224:227], a[36:39], v[120:123]
ds_read_b64_tr_b16 a[248:249], v229 offset:128
v_cvt_pk_bf16_f32 v105, v106, v107
v_mfma_f32_16x16x32_bf16 v[120:123], a[228:231], a[44:47], v[120:123]
s_waitcnt lgkmcnt(5)
ds_read_b64_tr_b16 a[250:251], v229 offset:2688
v_cvt_pk_bf16_f32 v106, v108, v109
v_mfma_f32_16x16x32_bf16 v[116:119], a[232:235], a[32:35], v[116:119]
s_add_u32 s31, s5, 10649600
ds_read_b64_tr_b16 a[252:253], v229 offset:10368
v_cvt_pk_bf16_f32 v107, v110, v111
v_mfma_f32_16x16x32_bf16 v[116:119], a[236:239], a[40:43], v[116:119]
ds_read_b64_tr_b16 a[254:255], v229 offset:12928
v_permlane16_swap_b32 v104, v106
v_mfma_f32_16x16x32_bf16 v[124:127], a[232:235], a[36:39], v[124:127]
ds_read_b64_tr_b16 a[224:225], v228 offset:20672
v_permlane16_swap_b32 v105, v107
v_mfma_f32_16x16x32_bf16 v[124:127], a[236:239], a[44:47], v[124:127]
s_waitcnt lgkmcnt(5)
ds_read_b64_tr_b16 a[226:227], v228 offset:23232
buffer_store_dwordx4 v[104:107], v237, s[24:27], s31 offen offset:256 sc1
v_mfma_f32_16x16x32_bf16 v[112:115], a[240:243], a[48:51], v[112:115]
ds_read_b64_tr_b16 a[228:229], v228 offset:30912
v_mfma_f32_16x16x32_bf16 v[112:115], a[244:247], a[56:59], v[112:115]
ds_read_b64_tr_b16 a[230:231], v228 offset:33472
v_mfma_f32_16x16x32_bf16 v[120:123], a[240:243], a[52:55], v[120:123]
ds_read_b64_tr_b16 a[232:233], v229 offset:20672
v_mfma_f32_16x16x32_bf16 v[120:123], a[244:247], a[60:63], v[120:123]
s_waitcnt lgkmcnt(5)
ds_read_b64_tr_b16 a[234:235], v229 offset:23232
v_mfma_f32_16x16x32_bf16 v[116:119], a[248:251], a[48:51], v[116:119]
ds_read_b64_tr_b16 a[236:237], v229 offset:30912
v_mfma_f32_16x16x32_bf16 v[116:119], a[252:255], a[56:59], v[116:119]
ds_read_b64_tr_b16 a[238:239], v229 offset:33472
v_mfma_f32_16x16x32_bf16 v[124:127], a[248:251], a[52:55], v[124:127]
ds_read_b64_tr_b16 a[240:241], v226 offset:41152
v_mfma_f32_16x16x32_bf16 v[124:127], a[252:255], a[60:63], v[124:127]
s_waitcnt lgkmcnt(5)
ds_read_b64_tr_b16 a[242:243], v226 offset:43712
v_mfma_f32_16x16x32_bf16 v[128:131], a[224:227], a[16:19], v[128:131]
ds_read_b64_tr_b16 a[244:245], v226 offset:51392
v_mfma_f32_16x16x32_bf16 v[128:131], a[228:231], a[24:27], v[128:131]
ds_read_b64_tr_b16 a[246:247], v226 offset:53952
v_mfma_f32_16x16x32_bf16 v[136:139], a[224:227], a[20:23], v[136:139]
ds_read_b64_tr_b16 a[248:249], v227 offset:41152
v_cvt_pk_bf16_f32 v112, v112, v113
v_mfma_f32_16x16x32_bf16 v[136:139], a[228:231], a[28:31], v[136:139]
s_waitcnt lgkmcnt(5)
ds_read_b64_tr_b16 a[250:251], v227 offset:43712
v_cvt_pk_bf16_f32 v113, v114, v115
v_mfma_f32_16x16x32_bf16 v[132:135], a[232:235], a[16:19], v[132:135]
ds_read_b64_tr_b16 a[252:253], v227 offset:51392
v_cvt_pk_bf16_f32 v114, v116, v117
v_mfma_f32_16x16x32_bf16 v[132:135], a[236:239], a[24:27], v[132:135]
ds_read_b64_tr_b16 a[254:255], v227 offset:53952
v_cvt_pk_bf16_f32 v115, v118, v119
v_mfma_f32_16x16x32_bf16 v[140:143], a[232:235], a[20:23], v[140:143]
s_add_u32 s31, s5, 10485760
ds_read_b64_tr_b16 a[224:225], v228 offset:192
v_permlane16_swap_b32 v112, v114
v_mfma_f32_16x16x32_bf16 v[140:143], a[236:239], a[28:31], v[140:143]
s_waitcnt lgkmcnt(5)
ds_read_b64_tr_b16 a[226:227], v228 offset:2752
v_permlane16_swap_b32 v113, v115
v_mfma_f32_16x16x32_bf16 v[128:131], a[240:243], a[32:35], v[128:131]
ds_read_b64_tr_b16 a[228:229], v228 offset:10432
buffer_store_dwordx4 v[112:115], v237, s[24:27], s31 offen offset:512 sc1
v_mfma_f32_16x16x32_bf16 v[128:131], a[244:247], a[40:43], v[128:131]
ds_read_b64_tr_b16 a[230:231], v228 offset:12992
v_cvt_pk_bf16_f32 v120, v120, v121
v_mfma_f32_16x16x32_bf16 v[136:139], a[240:243], a[36:39], v[136:139]
ds_read_b64_tr_b16 a[232:233], v229 offset:192
v_cvt_pk_bf16_f32 v121, v122, v123
v_mfma_f32_16x16x32_bf16 v[136:139], a[244:247], a[44:47], v[136:139]
s_waitcnt lgkmcnt(5)
ds_read_b64_tr_b16 a[234:235], v229 offset:2752
v_cvt_pk_bf16_f32 v122, v124, v125
v_mfma_f32_16x16x32_bf16 v[132:135], a[248:251], a[32:35], v[132:135]
s_add_u32 s31, s5, 10649600
ds_read_b64_tr_b16 a[236:237], v229 offset:10432
v_cvt_pk_bf16_f32 v123, v126, v127
v_mfma_f32_16x16x32_bf16 v[132:135], a[252:255], a[40:43], v[132:135]
ds_read_b64_tr_b16 a[238:239], v229 offset:12992
v_permlane16_swap_b32 v120, v122
v_mfma_f32_16x16x32_bf16 v[140:143], a[248:251], a[36:39], v[140:143]
ds_read_b64_tr_b16 a[240:241], v228 offset:20736
v_permlane16_swap_b32 v121, v123
v_mfma_f32_16x16x32_bf16 v[140:143], a[252:255], a[44:47], v[140:143]
s_waitcnt lgkmcnt(5)
ds_read_b64_tr_b16 a[242:243], v228 offset:23296
buffer_store_dwordx4 v[120:123], v237, s[24:27], s31 offen offset:512 sc1
v_mfma_f32_16x16x32_bf16 v[128:131], a[224:227], a[48:51], v[128:131]
ds_read_b64_tr_b16 a[244:245], v228 offset:30976
v_mfma_f32_16x16x32_bf16 v[128:131], a[228:231], a[56:59], v[128:131]
ds_read_b64_tr_b16 a[246:247], v228 offset:33536
v_mfma_f32_16x16x32_bf16 v[136:139], a[224:227], a[52:55], v[136:139]
ds_read_b64_tr_b16 a[248:249], v229 offset:20736
v_mfma_f32_16x16x32_bf16 v[136:139], a[228:231], a[60:63], v[136:139]
s_waitcnt lgkmcnt(5)
ds_read_b64_tr_b16 a[250:251], v229 offset:23296
v_mfma_f32_16x16x32_bf16 v[132:135], a[232:235], a[48:51], v[132:135]
ds_read_b64_tr_b16 a[252:253], v229 offset:30976
v_mfma_f32_16x16x32_bf16 v[132:135], a[236:239], a[56:59], v[132:135]
ds_read_b64_tr_b16 a[254:255], v229 offset:33536
v_mfma_f32_16x16x32_bf16 v[140:143], a[232:235], a[52:55], v[140:143]
ds_read_b64_tr_b16 a[224:225], v226 offset:41216
v_mfma_f32_16x16x32_bf16 v[140:143], a[236:239], a[60:63], v[140:143]
s_waitcnt lgkmcnt(5)
ds_read_b64_tr_b16 a[226:227], v226 offset:43776
v_mfma_f32_16x16x32_bf16 v[144:147], a[240:243], a[16:19], v[144:147]
ds_read_b64_tr_b16 a[228:229], v226 offset:51456
v_mfma_f32_16x16x32_bf16 v[144:147], a[244:247], a[24:27], v[144:147]
ds_read_b64_tr_b16 a[230:231], v226 offset:54016
v_mfma_f32_16x16x32_bf16 v[152:155], a[240:243], a[20:23], v[152:155]
ds_read_b64_tr_b16 a[232:233], v227 offset:41216
v_cvt_pk_bf16_f32 v128, v128, v129
v_mfma_f32_16x16x32_bf16 v[152:155], a[244:247], a[28:31], v[152:155]
s_waitcnt lgkmcnt(5)
ds_read_b64_tr_b16 a[234:235], v227 offset:43776
v_cvt_pk_bf16_f32 v129, v130, v131
v_mfma_f32_16x16x32_bf16 v[148:151], a[248:251], a[16:19], v[148:151]
ds_read_b64_tr_b16 a[236:237], v227 offset:51456
v_cvt_pk_bf16_f32 v130, v132, v133
v_mfma_f32_16x16x32_bf16 v[148:151], a[252:255], a[24:27], v[148:151]
ds_read_b64_tr_b16 a[238:239], v227 offset:54016
v_cvt_pk_bf16_f32 v131, v134, v135
v_mfma_f32_16x16x32_bf16 v[156:159], a[248:251], a[20:23], v[156:159]
s_add_u32 s31, s5, 10485760
ds_read_b64_tr_b16 a[240:241], v228 offset:256
v_permlane16_swap_b32 v128, v130
v_mfma_f32_16x16x32_bf16 v[156:159], a[252:255], a[28:31], v[156:159]
s_waitcnt lgkmcnt(5)
ds_read_b64_tr_b16 a[242:243], v228 offset:2816
v_permlane16_swap_b32 v129, v131
v_mfma_f32_16x16x32_bf16 v[144:147], a[224:227], a[32:35], v[144:147]
ds_read_b64_tr_b16 a[244:245], v228 offset:10496
buffer_store_dwordx4 v[128:131], v237, s[24:27], s31 offen offset:768 sc1
v_mfma_f32_16x16x32_bf16 v[144:147], a[228:231], a[40:43], v[144:147]
ds_read_b64_tr_b16 a[246:247], v228 offset:13056
v_cvt_pk_bf16_f32 v136, v136, v137
v_mfma_f32_16x16x32_bf16 v[152:155], a[224:227], a[36:39], v[152:155]
ds_read_b64_tr_b16 a[248:249], v229 offset:256
v_cvt_pk_bf16_f32 v137, v138, v139
v_mfma_f32_16x16x32_bf16 v[152:155], a[228:231], a[44:47], v[152:155]
s_waitcnt lgkmcnt(5)
ds_read_b64_tr_b16 a[250:251], v229 offset:2816
v_cvt_pk_bf16_f32 v138, v140, v141
v_mfma_f32_16x16x32_bf16 v[148:151], a[232:235], a[32:35], v[148:151]
ds_read_b64_tr_b16 a[252:253], v229 offset:10496
v_cvt_pk_bf16_f32 v139, v142, v143
v_mfma_f32_16x16x32_bf16 v[148:151], a[236:239], a[40:43], v[148:151]
s_waitcnt vmcnt(29)
ds_read_b64_tr_b16 a[254:255], v229 offset:13056
v_permlane16_swap_b32 v136, v138
v_mfma_f32_16x16x32_bf16 v[156:159], a[232:235], a[36:39], v[156:159]
s_barrier
ds_read_b64_tr_b16 a[224:225], v230 offset:0
v_mfma_f32_16x16x32_bf16 v[156:159], a[236:239], a[44:47], v[156:159]
s_waitcnt lgkmcnt(5)
ds_read_b64_tr_b16 a[226:227], v230 offset:768
v_permlane16_swap_b32 v137, v139
v_mfma_f32_16x16x32_bf16 v[144:147], a[240:243], a[48:51], v[144:147]
s_add_u32 s31, s5, 10649600
ds_read_b64_tr_b16 a[228:229], v230 offset:6144
v_mfma_f32_16x16x32_bf16 v[144:147], a[244:247], a[56:59], v[144:147]
ds_read_b64_tr_b16 a[230:231], v230 offset:6912
buffer_store_dwordx4 v[136:139], v237, s[24:27], s31 offen offset:768 sc1
v_mfma_f32_16x16x32_bf16 v[152:155], a[240:243], a[52:55], v[152:155]
ds_read_b64_tr_b16 a[232:233], v230 offset:32
v_mfma_f32_16x16x32_bf16 v[152:155], a[244:247], a[60:63], v[152:155]
s_waitcnt lgkmcnt(5)
ds_read_b64_tr_b16 a[234:235], v230 offset:800
v_mfma_f32_16x16x32_bf16 v[148:151], a[248:251], a[48:51], v[148:151]
ds_read_b64_tr_b16 a[236:237], v230 offset:6176
v_mfma_f32_16x16x32_bf16 v[148:151], a[252:255], a[56:59], v[148:151]
ds_read_b64_tr_b16 a[238:239], v230 offset:6944
v_mfma_f32_16x16x32_bf16 v[156:159], a[248:251], a[52:55], v[156:159]
ds_read_b64_tr_b16 a[240:241], v230 offset:64
v_mfma_f32_16x16x32_bf16 v[156:159], a[252:255], a[60:63], v[156:159]
ds_read_b64_tr_b16 a[242:243], v230 offset:832
v_lshlrev_b32 v200, 16, v160
v_and_b32 v201, 0xffff0000, v160
v_lshlrev_b32 v202, 16, v161
v_and_b32 v203, 0xffff0000, v161
v_cvt_pk_bf16_f32 v144, v144, v145
v_cvt_pk_bf16_f32 v145, v146, v147
v_cvt_pk_bf16_f32 v146, v148, v149
v_cvt_pk_bf16_f32 v147, v150, v151
v_cvt_pk_bf16_f32 v152, v152, v153
v_cvt_pk_bf16_f32 v153, v154, v155
v_cvt_pk_bf16_f32 v154, v156, v157
v_cvt_pk_bf16_f32 v155, v158, v159
v_permlane16_swap_b32 v144, v146
v_permlane16_swap_b32 v145, v147
v_permlane16_swap_b32 v152, v154
v_permlane16_swap_b32 v153, v155
s_add_u32 s31, s5, 10485760
buffer_store_dwordx4 v[144:147], v237, s[24:27], s31 offen offset:1024 sc1
s_add_u32 s31, s5, 10649600
buffer_store_dwordx4 v[152:155], v237, s[24:27], s31 offen offset:1024 sc1
v_lshlrev_b32 v204, 16, v162
v_and_b32 v205, 0xffff0000, v162
v_lshlrev_b32 v206, 16, v163
v_and_b32 v207, 0xffff0000, v163
v_lshlrev_b32 v208, 16, v164
v_and_b32 v209, 0xffff0000, v164
s_waitcnt vmcnt(25)
v_lshlrev_b32 v40, 16, v0
v_and_b32 v0, 0xffff0000, v0
v_lshlrev_b32 v41, 16, v1
v_and_b32 v1, 0xffff0000, v1
v_lshlrev_b32 v42, 16, v2
v_and_b32 v2, 0xffff0000, v2
v_lshlrev_b32 v43, 16, v3
v_and_b32 v3, 0xffff0000, v3
s_waitcnt vmcnt(24)
v_lshlrev_b32 v72, 16, v32
v_and_b32 v32, 0xffff0000, v32
s_waitcnt vmcnt(23)
v_lshlrev_b32 v44, 16, v4
v_and_b32 v4, 0xffff0000, v4
v_lshlrev_b32 v45, 16, v5
v_and_b32 v5, 0xffff0000, v5
v_lshlrev_b32 v46, 16, v6
v_and_b32 v6, 0xffff0000, v6
v_lshlrev_b32 v47, 16, v7
v_and_b32 v7, 0xffff0000, v7
s_waitcnt vmcnt(22)
v_lshlrev_b32 v73, 16, v33
v_and_b32 v33, 0xffff0000, v33
s_waitcnt vmcnt(21)
v_lshlrev_b32 v48, 16, v8
v_and_b32 v8, 0xffff0000, v8
v_lshlrev_b32 v49, 16, v9
v_and_b32 v9, 0xffff0000, v9
v_lshlrev_b32 v50, 16, v10
v_and_b32 v10, 0xffff0000, v10
v_lshlrev_b32 v51, 16, v11
v_and_b32 v11, 0xffff0000, v11
s_waitcnt vmcnt(20)
v_lshlrev_b32 v74, 16, v34
v_and_b32 v34, 0xffff0000, v34
s_waitcnt vmcnt(19)
v_lshlrev_b32 v52, 16, v12
v_and_b32 v12, 0xffff0000, v12
v_lshlrev_b32 v53, 16, v13
v_and_b32 v13, 0xffff0000, v13
v_lshlrev_b32 v54, 16, v14
v_and_b32 v14, 0xffff0000, v14
v_lshlrev_b32 v55, 16, v15
v_and_b32 v15, 0xffff0000, v15
s_waitcnt vmcnt(18)
v_lshlrev_b32 v75, 16, v35
v_and_b32 v35, 0xffff0000, v35
s_waitcnt vmcnt(17)
v_lshlrev_b32 v56, 16, v16
v_and_b32 v16, 0xffff0000, v16
v_lshlrev_b32 v57, 16, v17
v_and_b32 v17, 0xffff0000, v17
v_lshlrev_b32 v58, 16, v18
v_and_b32 v18, 0xffff0000, v18
v_lshlrev_b32 v59, 16, v19
v_and_b32 v19, 0xffff0000, v19
s_waitcnt vmcnt(16)
v_lshlrev_b32 v76, 16, v36
v_and_b32 v36, 0xffff0000, v36
s_waitcnt vmcnt(15)
v_lshlrev_b32 v60, 16, v20
v_and_b32 v20, 0xffff0000, v20
v_lshlrev_b32 v61, 16, v21
v_and_b32 v21, 0xffff0000, v21
v_lshlrev_b32 v62, 16, v22
v_and_b32 v22, 0xffff0000, v22
v_lshlrev_b32 v63, 16, v23
v_and_b32 v23, 0xffff0000, v23
s_waitcnt vmcnt(14)
v_lshlrev_b32 v77, 16, v37
v_and_b32 v37, 0xffff0000, v37
s_waitcnt vmcnt(13)
v_lshlrev_b32 v64, 16, v24
v_and_b32 v24, 0xffff0000, v24
v_lshlrev_b32 v65, 16, v25
v_and_b32 v25, 0xffff0000, v25
v_lshlrev_b32 v66, 16, v26
v_and_b32 v26, 0xffff0000, v26
v_lshlrev_b32 v67, 16, v27
v_and_b32 v27, 0xffff0000, v27
s_waitcnt vmcnt(12)
v_lshlrev_b32 v78, 16, v38
v_and_b32 v38, 0xffff0000, v38
s_waitcnt vmcnt(11)
v_lshlrev_b32 v68, 16, v28
v_and_b32 v28, 0xffff0000, v28
v_lshlrev_b32 v69, 16, v29
v_and_b32 v29, 0xffff0000, v29
v_lshlrev_b32 v70, 16, v30
v_and_b32 v30, 0xffff0000, v30
v_lshlrev_b32 v71, 16, v31
v_and_b32 v31, 0xffff0000, v31
s_waitcnt vmcnt(10)
v_lshlrev_b32 v79, 16, v39
v_and_b32 v39, 0xffff0000, v39
v_pk_add_f32 v[40:41], v[40:41], v[44:45]
v_pk_add_f32 v[42:43], v[42:43], v[46:47]
v_pk_add_f32 v[0:1], v[0:1], v[4:5]
v_pk_add_f32 v[2:3], v[2:3], v[6:7]
v_pk_add_f32 v[40:41], v[40:41], v[48:49]
v_pk_add_f32 v[42:43], v[42:43], v[50:51]
v_pk_add_f32 v[0:1], v[0:1], v[8:9]
v_pk_add_f32 v[2:3], v[2:3], v[10:11]
v_pk_add_f32 v[40:41], v[40:41], v[52:53]
v_pk_add_f32 v[42:43], v[42:43], v[54:55]
v_pk_add_f32 v[0:1], v[0:1], v[12:13]
v_pk_add_f32 v[2:3], v[2:3], v[14:15]
v_pk_add_f32 v[72:73], v[72:73], v[74:75]
v_pk_add_f32 v[32:33], v[32:33], v[34:35]
v_pk_add_f32 v[40:41], v[40:41], v[56:57]
v_pk_add_f32 v[42:43], v[42:43], v[58:59]
v_pk_add_f32 v[0:1], v[0:1], v[16:17]
v_pk_add_f32 v[2:3], v[2:3], v[18:19]
v_pk_add_f32 v[40:41], v[40:41], v[60:61]
v_pk_add_f32 v[42:43], v[42:43], v[62:63]
v_pk_add_f32 v[0:1], v[0:1], v[20:21]
v_pk_add_f32 v[2:3], v[2:3], v[22:23]
v_pk_add_f32 v[72:73], v[72:73], v[76:77]
v_pk_add_f32 v[32:33], v[32:33], v[36:37]
v_pk_add_f32 v[40:41], v[40:41], v[64:65]
v_pk_add_f32 v[42:43], v[42:43], v[66:67]
v_pk_add_f32 v[0:1], v[0:1], v[24:25]
v_pk_add_f32 v[2:3], v[2:3], v[26:27]
v_pk_add_f32 v[40:41], v[40:41], v[68:69]
v_pk_add_f32 v[42:43], v[42:43], v[70:71]
v_pk_add_f32 v[0:1], v[0:1], v[28:29]
v_pk_add_f32 v[2:3], v[2:3], v[30:31]
v_pk_add_f32 v[72:73], v[72:73], v[78:79]
v_pk_add_f32 v[32:33], v[32:33], v[38:39]
v_add_f32 v72, v72, v73
v_add_f32 v32, v32, v33
v_fmac_f32 v200, v170, v40
v_fmac_f32 v201, v171, v0
v_fmac_f32 v202, v172, v41
v_fmac_f32 v203, v173, v1
v_fmac_f32 v204, v174, v42
v_fmac_f32 v205, v175, v2
v_fmac_f32 v206, v176, v43
v_fmac_f32 v207, v177, v3
v_fmac_f32 v208, v178, v72
v_fmac_f32 v209, v179, v32
v_mov_b32 v241, s51
s_waitcnt vmcnt(0)
buffer_store_dword v241, v240, s[24:27], s6 offen sc1
s_add_u32 s37, s7, 58720256
s_add_u32 s38, s37, 4096
v_cvt_pk_bf16_f32 v48, v200, v201
v_cvt_pk_bf16_f32 v49, v202, v203
v_cvt_pk_bf16_f32 v50, v204, v205
v_cvt_pk_bf16_f32 v51, v206, v207
v_cvt_pk_bf16_f32 v52, v208, v209
buffer_store_dwordx4 v[48:51], v250, s[24:27], s37 offen sc1
buffer_store_dword v52, v252, s[24:27], s38 offen sc1
s_add_u32 m0, s28, 36864
s_add_u32 s30, s57, 196608
buffer_load_dwordx4 v243, s[8:11], s30 offen offset:0 lds
buffer_load_dwordx4 v244, s[8:11], s30 offen offset:1024 lds
buffer_load_dwordx4 v245, s[8:11], s30 offen offset:2048 lds
s_add_u32 m0, s28, 49152
s_add_u32 s30, s58, 0
buffer_load_dwordx4 v243, s[8:11], s30 offen offset:0 lds
buffer_load_dwordx4 v244, s[8:11], s30 offen offset:1024 lds
buffer_load_dwordx4 v245, s[8:11], s30 offen offset:2048 lds
s_add_u32 m0, s28, 61440
s_add_u32 s30, s58, 196608
buffer_load_dwordx4 v243, s[8:11], s30 offen offset:0 lds
buffer_load_dwordx4 v244, s[8:11], s30 offen offset:1024 lds
buffer_load_dwordx4 v245, s[8:11], s30 offen offset:2048 lds
v_pk_add_f32 v[8:9], v[200:201], v[202:203]
v_pk_add_f32 v[10:11], v[204:205], v[206:207]
v_pk_add_f32 v[8:9], v[8:9], v[208:209]
v_pk_add_f32 v[8:9], v[8:9], v[10:11]
v_add_f32 v8, v8, v9
s_nop 1
v_add_f32_dpp v8, v8, v8 row_ror:4 row_mask:0xf bank_mask:0xf
s_nop 1
v_add_f32_dpp v8, v8, v8 row_ror:8 row_mask:0xf bank_mask:0xf
v_mov_b32 v9, v8
s_nop 1
v_permlane16_swap_b32 v8, v9
v_add_f32 v8, v8, v9
v_mov_b32 v9, v8
s_nop 1
v_permlane32_swap_b32 v8, v9
v_add_f32 v8, v8, v9
v_mul_f32 v18, 0x3bcccccd, v8
v_mul_f32 v12, 0xbbcccccd, v8
v_mov_b32 v13, v12
v_pk_add_f32 v[200:201], v[200:201], v[12:13]
v_pk_add_f32 v[202:203], v[202:203], v[12:13]
v_pk_add_f32 v[204:205], v[204:205], v[12:13]
v_pk_add_f32 v[206:207], v[206:207], v[12:13]
v_pk_add_f32 v[208:209], v[208:209], v[12:13]
v_pk_mul_f32 v[8:9], v[200:201], v[200:201]
L_pg16:
s_cbranch_execz L_pg20
v_pk_mul_f32 v[10:11], v[202:203], v[202:203]
v_pk_fma_f32 v[8:9], v[204:205], v[204:205], v[8:9]
v_pk_fma_f32 v[10:11], v[206:207], v[206:207], v[10:11]
v_pk_fma_f32 v[8:9], v[208:209], v[208:209], v[8:9]
v_pk_add_f32 v[8:9], v[8:9], v[10:11]
v_add_f32 v19, v8, v9
s_nop 1
v_add_f32_dpp v19, v19, v19 row_ror:4 row_mask:0xf bank_mask:0xf
s_nop 1
v_add_f32_dpp v19, v19, v19 row_ror:8 row_mask:0xf bank_mask:0xf
v_mov_b32 v9, v19
s_nop 1
v_permlane16_swap_b32 v19, v9
v_add_f32 v19, v19, v9
v_mov_b32 v9, v19
s_nop 1
v_permlane32_swap_b32 v19, v9
v_add_f32 v19, v19, v9
ds_write_b64 v253, v[18:19] offset:0
s_waitcnt lgkmcnt(0)
s_barrier
ds_read_b128 v[20:23], v254 offset:0
ds_read_b128 v[24:27], v254 offset:16
s_waitcnt lgkmcnt(1)
v_add_f32 v8, v20, v22
s_waitcnt lgkmcnt(0)
v_add_f32 v9, v24, v26
v_add_f32 v8, v8, v9
v_mul_f32 v8, 0x3e800000, v8
v_sub_f32 v20, v20, v8
v_sub_f32 v22, v22, v8
v_sub_f32 v24, v24, v8
v_sub_f32 v26, v26, v8
v_mul_f32 v10, v20, v20
v_fmac_f32 v10, v22, v22
v_fmac_f32 v10, v24, v24
v_fmac_f32 v10, v26, v26
v_add_f32 v21, v21, v23
v_add_f32 v25, v25, v27
v_add_f32 v21, v21, v25
v_mov_b32 v14, 0x3727c5ac
v_fmac_f32 v14, 0x3acccccd, v21
v_fmac_f32 v14, 0x3e800000, v10
v_rsq_f32 v14, v14
v_sub_f32 v12, v18, v8
v_mul_f32 v12, v12, v14
v_mov_b32 v15, v14
v_mov_b32 v13, v12
v_pk_fma_f32 v[200:201], v[200:201], v[14:15], v[12:13]
v_pk_fma_f32 v[202:203], v[202:203], v[14:15], v[12:13]
v_pk_fma_f32 v[204:205], v[204:205], v[14:15], v[12:13]
v_pk_fma_f32 v[206:207], v[206:207], v[14:15], v[12:13]
v_pk_fma_f32 v[208:209], v[208:209], v[14:15], v[12:13]
v_pk_fma_f32 v[200:201], v[200:201], v[180:181], v[190:191]
v_pk_fma_f32 v[202:203], v[202:203], v[182:183], v[192:193]
v_pk_fma_f32 v[204:205], v[204:205], v[184:185], v[194:195]
v_pk_fma_f32 v[206:207], v[206:207], v[186:187], v[196:197]
v_pk_fma_f32 v[208:209], v[208:209], v[188:189], v[198:199]
s_add_u32 s37, s7, 54525952
s_add_u32 s38, s37, 4096
v_cvt_pk_bf16_f32 v56, v200, v201
v_cvt_pk_bf16_f32 v57, v202, v203
v_cvt_pk_bf16_f32 v58, v204, v205
v_cvt_pk_bf16_f32 v59, v206, v207
v_cvt_pk_bf16_f32 v60, v208, v209
buffer_store_dwordx4 v[56:59], v250, s[24:27], s37 offen sc1
buffer_store_dword v60, v252, s[24:27], s38 offen sc1
buffer_load_dword v239, v236, s[24:27], 0 offen sc1
v_lshlrev_b32 v200, 16, v166
v_and_b32 v201, 0xffff0000, v166
v_lshlrev_b32 v202, 16, v167
v_and_b32 v203, 0xffff0000, v167
v_lshlrev_b32 v204, 16, v168
v_and_b32 v205, 0xffff0000, v168
v_lshlrev_b32 v206, 16, v169
v_and_b32 v207, 0xffff0000, v169
v_lshlrev_b32 v208, 16, v165
v_and_b32 v209, 0xffff0000, v165
v_add_u32_e64 v241, s51, 1
s_mov_b64 exec, 0
s_cmp_eq_u32 s36, 0
s_cbranch_scc1 L_pg16
s_cmp_eq_u32 s36, 1
s_cbranch_scc1 L_pg17
s_cmp_eq_u32 s36, 2
s_cbranch_scc1 L_pg18
s_cmp_eq_u32 s36, 3
s_cbranch_scc1 L_pg19
L_ret_B:
s_mov_b64 exec, -1
s_waitcnt vmcnt(0)
v_cmp_eq_u32 vcc, s51, v239
s_nop 3
s_and_b32 s82, vcc_lo, 0xff
s_barrier
buffer_store_dword v241, v240, s[24:27], s49 offen sc1
s_bitcmp1_b32 s82, 0
s_cbranch_scc0 L_pia_0
s_add_u32 s39, s92, 10485760
buffer_load_dwordx4 v[80:83], v238, s[24:27], s39 offen sc1
buffer_load_dword v112, v251, s[24:27], s39 offen offset:1024 sc1
L_pia_0:
s_bitcmp1_b32 s82, 1
s_cbranch_scc0 L_pia_1
s_add_u32 s39, s92, 10487040
buffer_load_dwordx4 v[84:87], v238, s[24:27], s39 offen sc1
buffer_load_dword v113, v251, s[24:27], s39 offen offset:1024 sc1
L_pia_1:
s_bitcmp1_b32 s82, 2
s_cbranch_scc0 L_pia_2
s_add_u32 s39, s92, 10488320
buffer_load_dwordx4 v[88:91], v238, s[24:27], s39 offen sc1
buffer_load_dword v114, v251, s[24:27], s39 offen offset:1024 sc1
L_pia_2:
s_bitcmp1_b32 s82, 3
s_cbranch_scc0 L_pia_3
s_add_u32 s39, s92, 10489600
buffer_load_dwordx4 v[92:95], v238, s[24:27], s39 offen sc1
buffer_load_dword v115, v251, s[24:27], s39 offen offset:1024 sc1
L_pia_3:
s_bitcmp1_b32 s82, 4
s_cbranch_scc0 L_pia_4
s_add_u32 s39, s92, 10490880
buffer_load_dwordx4 v[96:99], v238, s[24:27], s39 offen sc1
buffer_load_dword v116, v251, s[24:27], s39 offen offset:1024 sc1
L_pia_4:
s_bitcmp1_b32 s82, 5
s_cbranch_scc0 L_pia_5
s_add_u32 s39, s92, 10492160
buffer_load_dwordx4 v[100:103], v238, s[24:27], s39 offen sc1
buffer_load_dword v117, v251, s[24:27], s39 offen offset:1024 sc1
L_pia_5:
s_bitcmp1_b32 s82, 6
s_cbranch_scc0 L_pia_6
s_add_u32 s39, s92, 10493440
buffer_load_dwordx4 v[104:107], v238, s[24:27], s39 offen sc1
buffer_load_dword v118, v251, s[24:27], s39 offen offset:1024 sc1
L_pia_6:
s_bitcmp1_b32 s82, 7
s_cbranch_scc0 L_pia_7
s_add_u32 s39, s92, 10494720
buffer_load_dwordx4 v[108:111], v238, s[24:27], s39 offen sc1
buffer_load_dword v119, v251, s[24:27], s39 offen offset:1024 sc1
L_pia_7:
s_mov_b32 s81, s82
s_mov_b32 s83, s82
s_add_u32 m0, s28, 73728
s_add_u32 s30, s59, 0
buffer_load_dwordx4 v243, s[8:11], s30 offen offset:0 lds
buffer_load_dwordx4 v244, s[8:11], s30 offen offset:1024 lds
buffer_load_dwordx4 v245, s[8:11], s30 offen offset:2048 lds
buffer_load_dword v220, v255, s[24:27], 0 offen sc1
buffer_load_dword v239, v236, s[24:27], 0 offen sc1
v_lshrrev_b32 v159, 8, v238
v_bfe_u32 v156, v238, 6, 2
v_lshl_add_u32 v157, v159, 3, v156
v_lshlrev_b32 v157, 7, v157
v_bfe_u32 v158, v238, 4, 2
v_lshl_add_u32 v157, v158, 3, v157
v_add_u32 v157, s29, v157
v_lshrrev_b32 v156, 1, v156
v_and_b32 v158, 1, v159
v_lshl_add_u32 v156, v158, 1, v156
v_xor_b32 v156, s36, v156
v_xor_b32 v210, 0, v156
v_lshl_add_u32 v210, v210, 5, v157
v_add_u32 v214, 65536, v210
v_add_u32 v218, 131072, v210
v_xor_b32 v211, 1, v156
v_lshl_add_u32 v211, v211, 5, v157
v_add_u32 v215, 65536, v211
v_add_u32 v219, 131072, v211
v_xor_b32 v212, 2, v156
v_lshl_add_u32 v212, v212, 5, v157
v_add_u32 v216, 65536, v212
v_add_u32 v227, 131072, v212
v_xor_b32 v213, 3, v156
v_lshl_add_u32 v213, v213, 5, v157
v_add_u32 v217, 65536, v213
v_add_u32 v228, 131072, v213
s_mov_b32 s37, 0x40000
s_mov_b32 s6, 0
L_ploop:
s_waitcnt vmcnt(0)
L_plast:
v_cmp_eq_u32 vcc, s51, v239
s_nop 3
s_andn2_b32 s82, vcc_lo, s81
s_and_b32 s82, s82, 0xff
s_cbranch_scc0 L_pnone
s_bitcmp1_b32 s82, 0
s_cbranch_scc0 L_pib_0
s_add_u32 s39, s92, 10485760
buffer_load_dwordx4 v[80:83], v238, s[24:27], s39 offen sc1
buffer_load_dword v112, v251, s[24:27], s39 offen offset:1024 sc1
L_pib_0:
s_bitcmp1_b32 s82, 1
s_cbranch_scc0 L_pib_1
s_add_u32 s39, s92, 10487040
buffer_load_dwordx4 v[84:87], v238, s[24:27], s39 offen sc1
buffer_load_dword v113, v251, s[24:27], s39 offen offset:1024 sc1
L_pib_1:
s_bitcmp1_b32 s82, 2
s_cbranch_scc0 L_pib_2
s_add_u32 s39, s92, 10488320
buffer_load_dwordx4 v[88:91], v238, s[24:27], s39 offen sc1
buffer_load_dword v114, v251, s[24:27], s39 offen offset:1024 sc1
L_pib_2:
s_bitcmp1_b32 s82, 3
s_cbranch_scc0 L_pib_3
s_add_u32 s39, s92, 10489600
buffer_load_dwordx4 v[92:95], v238, s[24:27], s39 offen sc1
buffer_load_dword v115, v251, s[24:27], s39 offen offset:1024 sc1
L_pib_3:
s_bitcmp1_b32 s82, 4
s_cbranch_scc0 L_pib_4
s_add_u32 s39, s92, 10490880
buffer_load_dwordx4 v[96:99], v238, s[24:27], s39 offen sc1
buffer_load_dword v116, v251, s[24:27], s39 offen offset:1024 sc1
L_pib_4:
s_bitcmp1_b32 s82, 5
s_cbranch_scc0 L_pib_5
s_add_u32 s39, s92, 10492160
buffer_load_dwordx4 v[100:103], v238, s[24:27], s39 offen sc1
buffer_load_dword v117, v251, s[24:27], s39 offen offset:1024 sc1
L_pib_5:
s_bitcmp1_b32 s82, 6
s_cbranch_scc0 L_pib_6
s_add_u32 s39, s92, 10493440
buffer_load_dwordx4 v[104:107], v238, s[24:27], s39 offen sc1
buffer_load_dword v118, v251, s[24:27], s39 offen offset:1024 sc1
L_pib_6:
s_bitcmp1_b32 s82, 7
s_cbranch_scc0 L_pib_7
s_add_u32 s39, s92, 10494720
buffer_load_dwordx4 v[108:111], v238, s[24:27], s39 offen sc1
buffer_load_dword v119, v251, s[24:27], s39 offen offset:1024 sc1
L_pib_7:
buffer_load_dword v220, v255, s[24:27], 0 offen sc1
s_or_b32 s81, s81, s82
L_pnone:
s_cmp_eq_u32 s81, 0xff
s_cbranch_scc1 L_pnopoll
s_or_b32 s38, s82, s83
s_cbranch_scc1 L_pnosleep
s_sleep 1
L_pnosleep:
s_xor_b32 exec_lo, s81, 0xff
s_mov_b32 exec_hi, 0
buffer_load_dword v239, v236, s[24:27], 0 offen sc1
s_mov_b64 exec, -1
s_sub_u32 s37, s37, 1
s_cselect_b32 s81, 0xff, s81
s_branch L_pgo
L_pnopoll:
s_cmp_lg_u32 s6, 0
s_cbranch_scc1 L_pgo
s_mov_b32 s6, 1
s_add_u32 m0, s28, 86016
s_add_u32 s30, s59, 196608
buffer_load_dwordx4 v243, s[8:11], s30 offen offset:0 lds
buffer_load_dwordx4 v244, s[8:11], s30 offen offset:1024 lds
buffer_load_dwordx4 v245, s[8:11], s30 offen offset:2048 lds
s_add_u32 m0, s28, 98304
s_add_u32 s30, s89, 0
buffer_load_dwordx4 v243, s[8:11], s30 offen offset:0 lds
buffer_load_dwordx4 v244, s[8:11], s30 offen offset:1024 lds
buffer_load_dwordx4 v245, s[8:11], s30 offen offset:2048 lds
L_pgo:
s_cmp_eq_u32 s83, 0
s_cbranch_scc1 L_punp
s_bitcmp1_b32 s83, 0
s_cbranch_scc0 L_pu_0
v_lshlrev_b32 v120, 16, v80
v_and_b32 v80, 0xffff0000, v80
v_lshlrev_b32 v121, 16, v81
v_and_b32 v81, 0xffff0000, v81
v_lshlrev_b32 v122, 16, v82
v_and_b32 v82, 0xffff0000, v82
v_lshlrev_b32 v123, 16, v83
v_and_b32 v83, 0xffff0000, v83
v_lshlrev_b32 v152, 16, v112
v_and_b32 v112, 0xffff0000, v112
L_pu_0:
s_bitcmp1_b32 s83, 1
s_cbranch_scc0 L_pu_1
v_lshlrev_b32 v124, 16, v84
v_and_b32 v84, 0xffff0000, v84
v_lshlrev_b32 v125, 16, v85
v_and_b32 v85, 0xffff0000, v85
v_lshlrev_b32 v126, 16, v86
v_and_b32 v86, 0xffff0000, v86
v_lshlrev_b32 v127, 16, v87
v_and_b32 v87, 0xffff0000, v87
v_lshlrev_b32 v153, 16, v113
v_and_b32 v113, 0xffff0000, v113
L_pu_1:
s_bitcmp1_b32 s83, 2
s_cbranch_scc0 L_pu_2
v_lshlrev_b32 v128, 16, v88
v_and_b32 v88, 0xffff0000, v88
v_lshlrev_b32 v129, 16, v89
v_and_b32 v89, 0xffff0000, v89
v_lshlrev_b32 v130, 16, v90
v_and_b32 v90, 0xffff0000, v90
v_lshlrev_b32 v131, 16, v91
v_and_b32 v91, 0xffff0000, v91
v_lshlrev_b32 v154, 16, v114
v_and_b32 v114, 0xffff0000, v114
L_pu_2:
s_bitcmp1_b32 s83, 3
s_cbranch_scc0 L_pu_3
v_lshlrev_b32 v132, 16, v92
v_and_b32 v92, 0xffff0000, v92
v_lshlrev_b32 v133, 16, v93
v_and_b32 v93, 0xffff0000, v93
v_lshlrev_b32 v134, 16, v94
v_and_b32 v94, 0xffff0000, v94
v_lshlrev_b32 v135, 16, v95
v_and_b32 v95, 0xffff0000, v95
v_lshlrev_b32 v155, 16, v115
v_and_b32 v115, 0xffff0000, v115
L_pu_3:
s_bitcmp1_b32 s83, 4
s_cbranch_scc0 L_pu_4
v_lshlrev_b32 v136, 16, v96
v_and_b32 v96, 0xffff0000, v96
v_lshlrev_b32 v137, 16, v97
v_and_b32 v97, 0xffff0000, v97
v_lshlrev_b32 v138, 16, v98
v_and_b32 v98, 0xffff0000, v98
v_lshlrev_b32 v139, 16, v99
v_and_b32 v99, 0xffff0000, v99
v_lshlrev_b32 v156, 16, v116
v_and_b32 v116, 0xffff0000, v116
L_pu_4:
s_bitcmp1_b32 s83, 5
s_cbranch_scc0 L_pu_5
v_lshlrev_b32 v140, 16, v100
v_and_b32 v100, 0xffff0000, v100
v_lshlrev_b32 v141, 16, v101
v_and_b32 v101, 0xffff0000, v101
v_lshlrev_b32 v142, 16, v102
v_and_b32 v102, 0xffff0000, v102
v_lshlrev_b32 v143, 16, v103
v_and_b32 v103, 0xffff0000, v103
v_lshlrev_b32 v157, 16, v117
v_and_b32 v117, 0xffff0000, v117
L_pu_5:
s_bitcmp1_b32 s83, 6
s_cbranch_scc0 L_pu_6
v_lshlrev_b32 v144, 16, v104
v_and_b32 v104, 0xffff0000, v104
v_lshlrev_b32 v145, 16, v105
v_and_b32 v105, 0xffff0000, v105
v_lshlrev_b32 v146, 16, v106
v_and_b32 v106, 0xffff0000, v106
v_lshlrev_b32 v147, 16, v107
v_and_b32 v107, 0xffff0000, v107
v_lshlrev_b32 v158, 16, v118
v_and_b32 v118, 0xffff0000, v118
L_pu_6:
s_bitcmp1_b32 s83, 7
s_cbranch_scc0 L_pu_7
v_lshlrev_b32 v148, 16, v108
v_and_b32 v108, 0xffff0000, v108
v_lshlrev_b32 v149, 16, v109
v_and_b32 v109, 0xffff0000, v109
v_lshlrev_b32 v150, 16, v110
v_and_b32 v110, 0xffff0000, v110
v_lshlrev_b32 v151, 16, v111
v_and_b32 v111, 0xffff0000, v111
v_lshlrev_b32 v159, 16, v119
v_and_b32 v119, 0xffff0000, v119
L_pu_7:
L_punp:
s_mov_b32 s83, s82
s_cmp_eq_u32 s6, 0
s_cbranch_scc1 L_ploop
s_cmp_lg_u32 s82, 0
s_waitcnt vmcnt(6)
s_cbranch_scc1 L_plast
v_mov_b32 v239, v220
v_subrev_u32 v239, s51, v239
v_cmp_lt_u32 vcc, 1, v239
s_nop 4
s_cbranch_vccnz L_slow_ha
L_back_ha:
buffer_load_dwordx4 a[112:115], v246, s[24:27], s84 offen offset:0 sc1
buffer_load_dwordx4 a[116:119], v247, s[24:27], s84 offen offset:0 sc1
buffer_load_dwordx4 a[120:123], v246, s[24:27], s84 offen offset:1024 sc1
buffer_load_dwordx4 a[124:127], v247, s[24:27], s84 offen offset:1024 sc1
buffer_load_dwordx4 a[128:131], v246, s[24:27], s84 offen offset:2048 sc1
buffer_load_dwordx4 a[132:135], v247, s[24:27], s84 offen offset:2048 sc1
buffer_load_dwordx4 a[144:147], v246, s[24:27], s84 offen offset:3072 sc1
buffer_load_dwordx4 a[148:151], v247, s[24:27], s84 offen offset:3072 sc1
s_add_u32 s84, s84, 40960
v_pk_add_f32 v[120:121], v[120:121], v[124:125]
v_pk_add_f32 v[122:123], v[122:123], v[126:127]
v_pk_add_f32 v[80:81], v[80:81], v[84:85]
v_pk_add_f32 v[82:83], v[82:83], v[86:87]
v_pk_add_f32 v[120:121], v[120:121], v[128:129]
v_pk_add_f32 v[122:123], v[122:123], v[130:131]
v_pk_add_f32 v[80:81], v[80:81], v[88:89]
v_pk_add_f32 v[82:83], v[82:83], v[90:91]
v_pk_add_f32 v[120:121], v[120:121], v[132:133]
v_pk_add_f32 v[122:123], v[122:123], v[134:135]
v_pk_add_f32 v[80:81], v[80:81], v[92:93]
v_pk_add_f32 v[82:83], v[82:83], v[94:95]
v_pk_add_f32 v[152:153], v[152:153], v[154:155]
v_pk_add_f32 v[112:113], v[112:113], v[114:115]
v_pk_add_f32 v[120:121], v[120:121], v[136:137]
v_pk_add_f32 v[122:123], v[122:123], v[138:139]
v_pk_add_f32 v[80:81], v[80:81], v[96:97]
v_pk_add_f32 v[82:83], v[82:83], v[98:99]
v_pk_add_f32 v[120:121], v[120:121], v[140:141]
v_pk_add_f32 v[122:123], v[122:123], v[142:143]
v_pk_add_f32 v[80:81], v[80:81], v[100:101]
v_pk_add_f32 v[82:83], v[82:83], v[102:103]
v_pk_add_f32 v[152:153], v[152:153], v[156:157]
v_pk_add_f32 v[112:113], v[112:113], v[116:117]
v_pk_add_f32 v[120:121], v[120:121], v[144:145]
v_pk_add_f32 v[122:123], v[122:123], v[146:147]
v_pk_add_f32 v[80:81], v[80:81], v[104:105]
v_pk_add_f32 v[82:83], v[82:83], v[106:107]
v_pk_add_f32 v[120:121], v[120:121], v[148:149]
v_pk_add_f32 v[122:123], v[122:123], v[150:151]
v_pk_add_f32 v[80:81], v[80:81], v[108:109]
v_pk_add_f32 v[82:83], v[82:83], v[110:111]
v_pk_add_f32 v[152:153], v[152:153], v[158:159]
v_pk_add_f32 v[112:113], v[112:113], v[118:119]
v_add_f32 v152, v152, v153
v_add_f32 v112, v112, v113
v_fmac_f32 v200, v170, v120
v_fmac_f32 v201, v171, v80
v_fmac_f32 v202, v172, v121
v_fmac_f32 v203, v173, v81
v_fmac_f32 v204, v174, v122
v_fmac_f32 v205, v175, v82
v_fmac_f32 v206, v176, v123
v_fmac_f32 v207, v177, v83
v_fmac_f32 v208, v178, v152
v_fmac_f32 v209, v179, v112
s_add_u32 s37, s7, 58761216
s_add_u32 s38, s37, 4096
v_cvt_pk_bf16_f32 v128, v200, v201
v_cvt_pk_bf16_f32 v129, v202, v203
v_cvt_pk_bf16_f32 v130, v204, v205
v_cvt_pk_bf16_f32 v131, v206, v207
v_cvt_pk_bf16_f32 v132, v208, v209
buffer_store_dwordx4 v[128:131], v250, s[24:27], s37 offen sc1
buffer_store_dword v132, v252, s[24:27], s38 offen sc1
v_pk_add_f32 v[88:89], v[200:201], v[202:203]
v_pk_add_f32 v[90:91], v[204:205], v[206:207]
v_pk_add_f32 v[88:89], v[88:89], v[208:209]
v_pk_add_f32 v[88:89], v[88:89], v[90:91]
v_add_f32 v88, v88, v89
s_nop 1
v_add_f32_dpp v88, v88, v88 row_ror:4 row_mask:0xf bank_mask:0xf
s_nop 1
v_add_f32_dpp v88, v88, v88 row_ror:8 row_mask:0xf bank_mask:0xf
v_mov_b32 v89, v88
s_nop 1
v_permlane16_swap_b32 v88, v89
v_add_f32 v88, v88, v89
v_mov_b32 v89, v88
s_nop 1
v_permlane32_swap_b32 v88, v89
v_add_f32 v88, v88, v89
v_mul_f32 v98, 0x3bcccccd, v88
v_mul_f32 v92, 0xbbcccccd, v88
v_mov_b32 v93, v92
v_pk_add_f32 v[200:201], v[200:201], v[92:93]
v_pk_add_f32 v[202:203], v[202:203], v[92:93]
v_pk_add_f32 v[204:205], v[204:205], v[92:93]
v_pk_add_f32 v[206:207], v[206:207], v[92:93]
v_pk_add_f32 v[208:209], v[208:209], v[92:93]
v_pk_mul_f32 v[88:89], v[200:201], v[200:201]
v_pk_mul_f32 v[90:91], v[202:203], v[202:203]
v_pk_fma_f32 v[88:89], v[204:205], v[204:205], v[88:89]
v_pk_fma_f32 v[90:91], v[206:207], v[206:207], v[90:91]
v_pk_fma_f32 v[88:89], v[208:209], v[208:209], v[88:89]
v_pk_add_f32 v[88:89], v[88:89], v[90:91]
v_add_f32 v99, v88, v89
s_nop 1
v_add_f32_dpp v99, v99, v99 row_ror:4 row_mask:0xf bank_mask:0xf
s_nop 1
v_add_f32_dpp v99, v99, v99 row_ror:8 row_mask:0xf bank_mask:0xf
v_mov_b32 v89, v99
s_nop 1
v_permlane16_swap_b32 v99, v89
v_add_f32 v99, v99, v89
v_mov_b32 v89, v99
s_nop 1
v_permlane32_swap_b32 v99, v89
v_add_f32 v99, v99, v89
ds_write_b64 v253, v[98:99] offset:41216
buffer_load_dwordx4 a[160:163], v246, s[24:27], s85 offen offset:0 sc1
buffer_load_dwordx4 a[164:167], v247, s[24:27], s85 offen offset:0 sc1
buffer_load_dwordx4 a[176:179], v246, s[24:27], s85 offen offset:1024 sc1
buffer_load_dwordx4 a[180:183], v247, s[24:27], s85 offen offset:1024 sc1
buffer_load_dwordx4 a[192:195], v246, s[24:27], s85 offen offset:2048 sc1
buffer_load_dwordx4 a[196:199], v247, s[24:27], s85 offen offset:2048 sc1
buffer_load_dwordx4 a[208:211], v246, s[24:27], s85 offen offset:3072 sc1
buffer_load_dwordx4 a[212:215], v247, s[24:27], s85 offen offset:3072 sc1
s_add_u32 s85, s85, 40960
s_waitcnt lgkmcnt(0)
s_barrier
ds_read_b128 v[100:103], v254 offset:41216
ds_read_b128 v[104:107], v254 offset:41232
s_waitcnt lgkmcnt(1)
v_add_f32 v88, v100, v102
s_waitcnt lgkmcnt(0)
v_add_f32 v89, v104, v106
v_add_f32 v88, v88, v89
v_mul_f32 v88, 0x3e800000, v88
v_sub_f32 v100, v100, v88
v_sub_f32 v102, v102, v88
v_sub_f32 v104, v104, v88
v_sub_f32 v106, v106, v88
v_mul_f32 v90, v100, v100
v_fmac_f32 v90, v102, v102
v_fmac_f32 v90, v104, v104
v_fmac_f32 v90, v106, v106
v_add_f32 v101, v101, v103
v_add_f32 v105, v105, v107
v_add_f32 v101, v101, v105
v_mov_b32 v94, 0x3727c5ac
v_fmac_f32 v94, 0x3acccccd, v101
v_fmac_f32 v94, 0x3e800000, v90
v_rsq_f32 v94, v94
v_sub_f32 v92, v98, v88
v_mul_f32 v92, v92, v94
v_mov_b32 v95, v94
v_mov_b32 v93, v92
v_pk_fma_f32 v[200:201], v[200:201], v[94:95], v[92:93]
v_pk_fma_f32 v[202:203], v[202:203], v[94:95], v[92:93]
v_pk_fma_f32 v[204:205], v[204:205], v[94:95], v[92:93]
v_pk_fma_f32 v[206:207], v[206:207], v[94:95], v[92:93]
v_pk_fma_f32 v[208:209], v[208:209], v[94:95], v[92:93]
v_pk_fma_f32 v[200:201], v[200:201], v[180:181], v[190:191]
v_pk_fma_f32 v[202:203], v[202:203], v[182:183], v[192:193]
v_pk_fma_f32 v[204:205], v[204:205], v[184:185], v[194:195]
v_pk_fma_f32 v[206:207], v[206:207], v[186:187], v[196:197]
v_pk_fma_f32 v[208:209], v[208:209], v[188:189], v[198:199]
s_add_u32 m0, s28, 110592
s_add_u32 s30, s89, 196608
buffer_load_dwordx4 v243, s[8:11], s30 offen offset:0 lds
buffer_load_dwordx4 v244, s[8:11], s30 offen offset:1024 lds
buffer_load_dwordx4 v245, s[8:11], s30 offen offset:2048 lds
s_add_u32 s37, s7, 54566912
s_add_u32 s38, s37, 4096
v_cvt_pk_bf16_f32 v136, v200, v201
v_cvt_pk_bf16_f32 v137, v202, v203
v_cvt_pk_bf16_f32 v138, v204, v205
v_cvt_pk_bf16_f32 v139, v206, v207
v_cvt_pk_bf16_f32 v140, v208, v209
buffer_store_dwordx4 v[136:139], v250, s[24:27], s37 offen sc1
buffer_store_dword v140, v252, s[24:27], s38 offen sc1
s_waitcnt vmcnt(21)
v_mfma_f32_16x16x32_bf16 v[0:3], a[224:227], a[112:115], 0
ds_read_b64_tr_b16 a[244:245], v230 offset:6208
buffer_load_dwordx4 a[0:3], v246, s[24:27], s86 offen offset:0 sc1
v_mfma_f32_16x16x32_bf16 v[4:7], a[224:227], a[116:119], 0
ds_read_b64_tr_b16 a[246:247], v230 offset:6976
v_mfma_f32_16x16x32_bf16 v[8:11], a[228:231], a[112:115], 0
ds_read_b64_tr_b16 a[248:249], v230 offset:3072
v_mfma_f32_16x16x32_bf16 v[12:15], a[228:231], a[116:119], 0
ds_read_b64_tr_b16 a[250:251], v230 offset:3840
v_mfma_f32_16x16x32_bf16 v[16:19], a[232:235], a[112:115], 0
ds_read_b64_tr_b16 a[252:253], v230 offset:9216
buffer_load_dwordx4 a[4:7], v247, s[24:27], s86 offen offset:0 sc1
v_mfma_f32_16x16x32_bf16 v[20:23], a[232:235], a[116:119], 0
ds_read_b64_tr_b16 a[254:255], v230 offset:9984
v_mfma_f32_16x16x32_bf16 v[24:27], a[236:239], a[112:115], 0
ds_read_b64_tr_b16 a[224:225], v230 offset:3104
v_mfma_f32_16x16x32_bf16 v[28:31], a[236:239], a[116:119], 0
ds_read_b64_tr_b16 a[226:227], v230 offset:3872
v_mfma_f32_16x16x32_bf16 v[32:35], a[240:243], a[112:115], 0
s_barrier
ds_read_b64_tr_b16 a[228:229], v230 offset:9248
v_mfma_f32_16x16x32_bf16 v[36:39], a[240:243], a[116:119], 0
s_waitcnt lgkmcnt(7)
ds_read_b64_tr_b16 a[230:231], v230 offset:10016
buffer_load_dwordx4 a[8:11], v246, s[24:27], s86 offen offset:1024 sc1
v_mfma_f32_16x16x32_bf16 v[40:43], a[244:247], a[112:115], 0
s_mul_i32 s81, s78, 3
ds_read_b64_tr_b16 a[232:233], v230 offset:3136
v_add_u32 v229, s29, v238
v_mfma_f32_16x16x32_bf16 v[44:47], a[244:247], a[116:119], 0
s_waitcnt vmcnt(22) lgkmcnt(7)
ds_read_b64_tr_b16 a[234:235], v230 offset:3904
v_mfma_f32_16x16x32_bf16 v[0:3], a[248:251], a[120:123], v[0:3]
ds_read_b64_tr_b16 a[236:237], v230 offset:9280
v_add_u32 v229, 0, v229
v_mfma_f32_16x16x32_bf16 v[4:7], a[248:251], a[124:127], v[4:7]
s_waitcnt lgkmcnt(7)
ds_read_b64_tr_b16 a[238:239], v230 offset:10048
buffer_load_dwordx4 a[12:15], v247, s[24:27], s86 offen offset:1024 sc1
v_mfma_f32_16x16x32_bf16 v[8:11], a[252:255], a[120:123], v[8:11]
s_lshr_b32 s82, s36, 1
ds_read_b64_tr_b16 a[240:241], v230 offset:12288
v_xor_b32 v231, 4096, v229
v_mfma_f32_16x16x32_bf16 v[12:15], a[252:255], a[124:127], v[12:15]
s_waitcnt lgkmcnt(7)
ds_read_b64_tr_b16 a[242:243], v230 offset:13056
v_mfma_f32_16x16x32_bf16 v[16:19], a[224:227], a[120:123], v[16:19]
ds_read_b64_tr_b16 a[244:245], v230 offset:18432
v_xor_b32 v232, 8192, v229
v_mfma_f32_16x16x32_bf16 v[20:23], a[224:227], a[124:127], v[20:23]
s_waitcnt lgkmcnt(7)
ds_read_b64_tr_b16 a[246:247], v230 offset:19200
buffer_load_dwordx4 a[16:19], v246, s[24:27], s86 offen offset:2048 sc1
v_mfma_f32_16x16x32_bf16 v[24:27], a[228:231], a[120:123], v[24:27]
s_lshl_b32 s82, s82, 1
ds_read_b64_tr_b16 a[248:249], v230 offset:12320
v_xor_b32 v233, 12288, v229
v_mfma_f32_16x16x32_bf16 v[28:31], a[228:231], a[124:127], v[28:31]
s_waitcnt lgkmcnt(7)
ds_read_b64_tr_b16 a[250:251], v230 offset:13088
v_mfma_f32_16x16x32_bf16 v[32:35], a[232:235], a[120:123], v[32:35]
ds_read_b64_tr_b16 a[252:253], v230 offset:18464
v_bfe_u32 v156, v238, 6, 2
v_mfma_f32_16x16x32_bf16 v[36:39], a[232:235], a[124:127], v[36:39]
s_waitcnt lgkmcnt(7)
ds_read_b64_tr_b16 a[254:255], v230 offset:19232
buffer_load_dwordx4 a[20:23], v247, s[24:27], s86 offen offset:2048 sc1
v_mfma_f32_16x16x32_bf16 v[40:43], a[236:239], a[120:123], v[40:43]
s_add_u32 s45, s81, s82
ds_read_b64_tr_b16 a[224:225], v230 offset:12352
v_and_b32 v158, 0x30, v238
v_mfma_f32_16x16x32_bf16 v[44:47], a[236:239], a[124:127], v[44:47]
s_waitcnt vmcnt(23) lgkmcnt(7)
ds_read_b64_tr_b16 a[226:227], v230 offset:13120
v_mfma_f32_16x16x32_bf16 v[0:3], a[240:243], a[128:131], v[0:3]
s_add_u32 m0, s29, 131072
ds_read_b64_tr_b16 a[228:229], v230 offset:18496
v_lshl_add_u32 v251, v156, 8, v158
v_mfma_f32_16x16x32_bf16 v[4:7], a[240:243], a[132:135], v[4:7]
s_waitcnt lgkmcnt(7)
ds_read_b64_tr_b16 a[230:231], v230 offset:19264
v_mfma_f32_16x16x32_bf16 v[8:11], a[244:247], a[128:131], v[8:11]
s_lshr_b32 s45, s45, 3
ds_read_b64_tr_b16 a[232:233], v230 offset:15360
v_bfe_u32 v158, v238, 8, 1
v_mfma_f32_16x16x32_bf16 v[12:15], a[244:247], a[132:135], v[12:15]
s_waitcnt lgkmcnt(7)
ds_read_b64_tr_b16 a[234:235], v230 offset:16128
v_mfma_f32_16x16x32_bf16 v[16:19], a[248:251], a[128:131], v[16:19]
s_add_u32 s30, s47, 0
ds_read_b64_tr_b16 a[236:237], v230 offset:21504
v_lshrrev_b32 v159, 9, v238
v_mfma_f32_16x16x32_bf16 v[20:23], a[248:251], a[132:135], v[20:23]
s_waitcnt lgkmcnt(7)
ds_read_b64_tr_b16 a[238:239], v230 offset:22272
buffer_load_dwordx4 v248, s[12:15], s30 offen offset:0 lds
v_mfma_f32_16x16x32_bf16 v[24:27], a[252:255], a[128:131], v[24:27]
s_min_u32 s45, s45, 7
ds_read_b64_tr_b16 a[240:241], v230 offset:15392
v_lshlrev_b32 v237, 5, v159
v_mfma_f32_16x16x32_bf16 v[28:31], a[252:255], a[132:135], v[28:31]
s_waitcnt lgkmcnt(7)
ds_read_b64_tr_b16 a[242:243], v230 offset:16160
v_mfma_f32_16x16x32_bf16 v[32:35], a[224:227], a[128:131], v[32:35]
ds_read_b64_tr_b16 a[244:245], v230 offset:21536
v_lshl_add_u32 v251, v159, 6, v251
v_mfma_f32_16x16x32_bf16 v[36:39], a[224:227], a[132:135], v[36:39]
s_waitcnt lgkmcnt(7)
ds_read_b64_tr_b16 a[246:247], v230 offset:22304
buffer_load_dwordx4 v249, s[12:15], s30 offen offset:1024 lds
v_mfma_f32_16x16x32_bf16 v[40:43], a[228:231], a[128:131], v[40:43]
s_lshl_b32 s45, s45, 1
ds_read_b64_tr_b16 a[248:249], v230 offset:15424
v_bfe_u32 v156, v238, 4, 4
v_mfma_f32_16x16x32_bf16 v[44:47], a[228:231], a[132:135], v[44:47]
s_waitcnt vmcnt(23) lgkmcnt(7)
ds_read_b64_tr_b16 a[250:251], v230 offset:16192
v_mfma_f32_16x16x32_bf16 v[0:3], a[232:235], a[144:147], v[0:3]
s_add_u32 m0, s29, 133120
ds_read_b64_tr_b16 a[252:253], v230 offset:21568
v_mul_u32_u24 v156, 1280, v156
v_mfma_f32_16x16x32_bf16 v[4:7], a[232:235], a[148:151], v[4:7]
L_pg17:
s_cbranch_execz L_pg21
s_waitcnt lgkmcnt(7)
ds_read_b64_tr_b16 a[254:255], v230 offset:22336
v_mfma_f32_16x16x32_bf16 v[8:11], a[236:239], a[144:147], v[8:11]
s_and_b32 s82, s36, 1
ds_read_b64_tr_b16 a[224:225], v230 offset:24576
v_lshl_add_u32 v235, v159, 4, v156
v_mfma_f32_16x16x32_bf16 v[12:15], a[236:239], a[148:151], v[12:15]
s_waitcnt lgkmcnt(7)
ds_read_b64_tr_b16 a[226:227], v230 offset:25344
v_mfma_f32_16x16x32_bf16 v[16:19], a[240:243], a[144:147], v[16:19]
s_add_u32 s30, s47, 20480
ds_read_b64_tr_b16 a[228:229], v230 offset:30720
v_and_b32 v236, 0xf0, v238
v_mfma_f32_16x16x32_bf16 v[20:23], a[240:243], a[148:151], v[20:23]
s_waitcnt lgkmcnt(7)
ds_read_b64_tr_b16 a[230:231], v230 offset:31488
buffer_load_dwordx4 v248, s[12:15], s30 offen offset:0 lds
v_mfma_f32_16x16x32_bf16 v[24:27], a[244:247], a[144:147], v[24:27]
s_add_u32 s45, s45, s82
ds_read_b64_tr_b16 a[232:233], v230 offset:24608
v_mfma_f32_16x16x32_bf16 v[28:31], a[244:247], a[148:151], v[28:31]
s_waitcnt lgkmcnt(7)
ds_read_b64_tr_b16 a[234:235], v230 offset:25376
v_mfma_f32_16x16x32_bf16 v[32:35], a[248:251], a[144:147], v[32:35]
ds_read_b64_tr_b16 a[236:237], v230 offset:30752
v_mfma_f32_16x16x32_bf16 v[36:39], a[248:251], a[148:151], v[36:39]
s_waitcnt lgkmcnt(7)
ds_read_b64_tr_b16 a[238:239], v230 offset:31520
buffer_load_dwordx4 v249, s[12:15], s30 offen offset:1024 lds
v_mfma_f32_16x16x32_bf16 v[40:43], a[252:255], a[144:147], v[40:43]
s_lshl_b32 s45, s45, 11
ds_read_b64_tr_b16 a[240:241], v230 offset:24640
v_mfma_f32_16x16x32_bf16 v[44:47], a[252:255], a[148:151], v[44:47]
s_waitcnt vmcnt(21) lgkmcnt(7)
ds_read_b64_tr_b16 a[242:243], v230 offset:25408
v_add_u32_e64 v241, s51, 0
v_mfma_f32_16x16x32_bf16 v[0:3], a[224:227], a[160:163], v[0:3]
s_add_u32 m0, s29, 147456
ds_read_b64_tr_b16 a[244:245], v230 offset:30784
s_waitcnt vmcnt(10)
s_barrier
buffer_store_dword v241, v240, s[24:27], s49 offen sc1
v_mfma_f32_16x16x32_bf16 v[4:7], a[224:227], a[164:167], v[4:7]
s_waitcnt lgkmcnt(7)
ds_read_b64_tr_b16 a[246:247], v230 offset:31552
v_mfma_f32_16x16x32_bf16 v[8:11], a[228:231], a[160:163], v[8:11]
s_add_u32 s45, s45, 3407872
ds_read_b64_tr_b16 a[248:249], v230 offset:27648
v_mfma_f32_16x16x32_bf16 v[12:15], a[228:231], a[164:167], v[12:15]
s_waitcnt lgkmcnt(7)
ds_read_b64_tr_b16 a[250:251], v230 offset:28416
v_mfma_f32_16x16x32_bf16 v[16:19], a[232:235], a[160:163], v[16:19]
s_add_u32 s30, s47, 163840
ds_read_b64_tr_b16 a[252:253], v230 offset:33792
v_mfma_f32_16x16x32_bf16 v[20:23], a[232:235], a[164:167], v[20:23]
s_waitcnt lgkmcnt(7)
ds_read_b64_tr_b16 a[254:255], v230 offset:34560
buffer_load_dwordx4 v248, s[12:15], s30 offen offset:0 lds
v_mfma_f32_16x16x32_bf16 v[24:27], a[236:239], a[160:163], v[24:27]
s_and_b32 s82, s81, 1
ds_read_b64_tr_b16 a[224:225], v230 offset:27680
v_mfma_f32_16x16x32_bf16 v[28:31], a[236:239], a[164:167], v[28:31]
s_waitcnt lgkmcnt(7)
ds_read_b64_tr_b16 a[226:227], v230 offset:28448
v_mfma_f32_16x16x32_bf16 v[32:35], a[240:243], a[160:163], v[32:35]
ds_read_b64_tr_b16 a[228:229], v230 offset:33824
v_mfma_f32_16x16x32_bf16 v[36:39], a[240:243], a[164:167], v[36:39]
s_waitcnt lgkmcnt(7)
ds_read_b64_tr_b16 a[230:231], v230 offset:34592
buffer_load_dwordx4 v249, s[12:15], s30 offen offset:1024 lds
v_mfma_f32_16x16x32_bf16 v[40:43], a[244:247], a[160:163], v[40:43]
s_lshl_b32 s42, s81, 1
ds_read_b64_tr_b16 a[232:233], v230 offset:27712
v_mfma_f32_16x16x32_bf16 v[44:47], a[244:247], a[164:167], v[44:47]
s_waitcnt lgkmcnt(7)
ds_read_b64_tr_b16 a[234:235], v230 offset:28480
v_mfma_f32_16x16x32_bf16 v[0:3], a[248:251], a[176:179], v[0:3]
s_add_u32 m0, s29, 149504
ds_read_b64_tr_b16 a[236:237], v230 offset:33856
v_mfma_f32_16x16x32_bf16 v[4:7], a[248:251], a[180:183], v[4:7]
s_waitcnt lgkmcnt(7)
ds_read_b64_tr_b16 a[238:239], v230 offset:34624
v_mfma_f32_16x16x32_bf16 v[8:11], a[252:255], a[176:179], v[8:11]
s_sub_u32 s42, s42, s82
ds_read_b64_tr_b16 a[240:241], v230 offset:36864
v_mfma_f32_16x16x32_bf16 v[12:15], a[252:255], a[180:183], v[12:15]
s_waitcnt lgkmcnt(7)
ds_read_b64_tr_b16 a[242:243], v230 offset:37632
v_mfma_f32_16x16x32_bf16 v[16:19], a[224:227], a[176:179], v[16:19]
s_add_u32 s30, s47, 184320
ds_read_b64_tr_b16 a[244:245], v230 offset:43008
v_mfma_f32_16x16x32_bf16 v[20:23], a[224:227], a[180:183], v[20:23]
s_waitcnt lgkmcnt(7)
ds_read_b64_tr_b16 a[246:247], v230 offset:43776
buffer_load_dwordx4 v248, s[12:15], s30 offen offset:0 lds
v_mfma_f32_16x16x32_bf16 v[24:27], a[228:231], a[176:179], v[24:27]
s_lshl_b32 s82, s82, 1
ds_read_b64_tr_b16 a[248:249], v230 offset:36896
v_mfma_f32_16x16x32_bf16 v[28:31], a[228:231], a[180:183], v[28:31]
s_waitcnt lgkmcnt(7)
ds_read_b64_tr_b16 a[250:251], v230 offset:37664
v_mfma_f32_16x16x32_bf16 v[32:35], a[232:235], a[176:179], v[32:35]
ds_read_b64_tr_b16 a[252:253], v230 offset:43040
v_mfma_f32_16x16x32_bf16 v[36:39], a[232:235], a[180:183], v[36:39]
s_waitcnt lgkmcnt(7)
ds_read_b64_tr_b16 a[254:255], v230 offset:43808
buffer_load_dwordx4 v249, s[12:15], s30 offen offset:1024 lds
v_mfma_f32_16x16x32_bf16 v[40:43], a[236:239], a[176:179], v[40:43]
s_add_u32 s82, s82, 1
ds_read_b64_tr_b16 a[224:225], v230 offset:36928
v_mfma_f32_16x16x32_bf16 v[44:47], a[236:239], a[180:183], v[44:47]
s_waitcnt lgkmcnt(7)
ds_read_b64_tr_b16 a[226:227], v230 offset:37696
v_mfma_f32_16x16x32_bf16 v[0:3], a[240:243], a[192:195], v[0:3]
ds_read_b64_tr_b16 a[228:229], v230 offset:43072
v_mfma_f32_16x16x32_bf16 v[4:7], a[240:243], a[196:199], v[4:7]
s_waitcnt lgkmcnt(7)
ds_read_b64_tr_b16 a[230:231], v230 offset:43840
buffer_load_dwordx4 a[24:27], v246, s[24:27], s86 offen offset:3072 sc1
v_mfma_f32_16x16x32_bf16 v[8:11], a[244:247], a[192:195], v[8:11]
s_add_u32 s43, s42, s82
ds_read_b64_tr_b16 a[232:233], v230 offset:39936
v_mfma_f32_16x16x32_bf16 v[12:15], a[244:247], a[196:199], v[12:15]
s_waitcnt lgkmcnt(7)
ds_read_b64_tr_b16 a[234:235], v230 offset:40704
v_mfma_f32_16x16x32_bf16 v[16:19], a[248:251], a[192:195], v[16:19]
ds_read_b64_tr_b16 a[236:237], v230 offset:46080
v_mfma_f32_16x16x32_bf16 v[20:23], a[248:251], a[196:199], v[20:23]
s_waitcnt lgkmcnt(7)
ds_read_b64_tr_b16 a[238:239], v230 offset:46848
buffer_load_dwordx4 a[28:31], v247, s[24:27], s86 offen offset:3072 sc1
v_mfma_f32_16x16x32_bf16 v[24:27], a[252:255], a[192:195], v[24:27]
s_add_u32 s44, s42, 4
ds_read_b64_tr_b16 a[240:241], v230 offset:39968
v_mfma_f32_16x16x32_bf16 v[28:31], a[252:255], a[196:199], v[28:31]
s_waitcnt lgkmcnt(7)
ds_read_b64_tr_b16 a[242:243], v230 offset:40736
v_mfma_f32_16x16x32_bf16 v[32:35], a[224:227], a[192:195], v[32:35]
s_add_u32 s86, s86, 40960
ds_read_b64_tr_b16 a[244:245], v230 offset:46112
v_mfma_f32_16x16x32_bf16 v[36:39], a[224:227], a[196:199], v[36:39]
s_waitcnt lgkmcnt(7)
ds_read_b64_tr_b16 a[246:247], v230 offset:46880
buffer_load_dwordx4 a[32:35], v246, s[24:27], s87 offen offset:0 sc1
v_mfma_f32_16x16x32_bf16 v[40:43], a[228:231], a[192:195], v[40:43]
s_mul_i32 s46, s82, 20480
ds_read_b64_tr_b16 a[248:249], v230 offset:40000
v_mfma_f32_16x16x32_bf16 v[44:47], a[228:231], a[196:199], v[44:47]
s_waitcnt lgkmcnt(7)
ds_read_b64_tr_b16 a[250:251], v230 offset:40768
v_mfma_f32_16x16x32_bf16 v[0:3], a[232:235], a[208:211], v[0:3]
ds_read_b64_tr_b16 a[252:253], v230 offset:46144
v_mfma_f32_16x16x32_bf16 v[4:7], a[232:235], a[212:215], v[4:7]
s_waitcnt lgkmcnt(7)
ds_read_b64_tr_b16 a[254:255], v230 offset:46912
buffer_load_dwordx4 a[36:39], v247, s[24:27], s87 offen offset:0 sc1
v_mfma_f32_16x16x32_bf16 v[8:11], a[236:239], a[208:211], v[8:11]
s_mul_i32 s92, s42, 20480
ds_read_b64_tr_b16 a[224:225], v230 offset:49152
v_mfma_f32_16x16x32_bf16 v[12:15], a[236:239], a[212:215], v[12:15]
s_waitcnt lgkmcnt(7)
ds_read_b64_tr_b16 a[226:227], v230 offset:49920
v_mfma_f32_16x16x32_bf16 v[16:19], a[240:243], a[208:211], v[16:19]
ds_read_b64_tr_b16 a[228:229], v230 offset:55296
v_mfma_f32_16x16x32_bf16 v[20:23], a[240:243], a[212:215], v[20:23]
s_waitcnt lgkmcnt(7)
ds_read_b64_tr_b16 a[230:231], v230 offset:56064
buffer_load_dwordx4 a[40:43], v246, s[24:27], s87 offen offset:1024 sc1
v_mfma_f32_16x16x32_bf16 v[24:27], a[244:247], a[208:211], v[24:27]
s_lshl_b32 s81, s79, 2
ds_read_b64_tr_b16 a[232:233], v230 offset:49184
s_waitcnt vmcnt(10)
v_mfma_f32_16x16x32_bf16 v[28:31], a[244:247], a[212:215], v[28:31]
s_waitcnt lgkmcnt(7)
ds_read_b64_tr_b16 a[234:235], v230 offset:49952
v_mfma_f32_16x16x32_bf16 v[32:35], a[248:251], a[208:211], v[32:35]
ds_read_b64_tr_b16 a[236:237], v230 offset:55328
ds_read_b64_tr_b16 v[160:161], v218 offset:0
v_mfma_f32_16x16x32_bf16 v[36:39], a[248:251], a[212:215], v[36:39]
s_waitcnt lgkmcnt(8)
ds_read_b64_tr_b16 a[238:239], v230 offset:56096
buffer_load_dwordx4 a[44:47], v247, s[24:27], s87 offen offset:1024 sc1
v_mfma_f32_16x16x32_bf16 v[40:43], a[252:255], a[208:211], v[40:43]
s_add_u32 s81, s81, s36
ds_read_b64_tr_b16 a[240:241], v230 offset:49216
ds_read_b64_tr_b16 v[162:163], v218 offset:512
v_mfma_f32_16x16x32_bf16 v[44:47], a[252:255], a[212:215], v[44:47]
s_waitcnt lgkmcnt(9)
ds_read_b64_tr_b16 a[242:243], v230 offset:49984
v_mfma_f32_16x16x32_bf16 v[0:3], a[224:227], a[0:3], v[0:3]
ds_read_b64_tr_b16 a[244:245], v230 offset:55360
ds_read_b64_tr_b16 v[164:165], v219 offset:0
v_mfma_f32_16x16x32_bf16 v[4:7], a[224:227], a[4:7], v[4:7]
s_waitcnt lgkmcnt(10)
ds_read_b64_tr_b16 a[246:247], v230 offset:56128
buffer_load_dwordx4 a[48:51], v246, s[24:27], s87 offen offset:2048 sc1
v_mfma_f32_16x16x32_bf16 v[8:11], a[228:231], a[0:3], v[8:11]
s_lshl_b32 s90, s81, 6
ds_read_b64_tr_b16 a[248:249], v230 offset:52224
ds_read_b64_tr_b16 v[166:167], v219 offset:512
v_mfma_f32_16x16x32_bf16 v[12:15], a[228:231], a[4:7], v[12:15]
s_waitcnt lgkmcnt(11)
ds_read_b64_tr_b16 a[250:251], v230 offset:52992
v_mfma_f32_16x16x32_bf16 v[16:19], a[232:235], a[0:3], v[16:19]
ds_read_b64_tr_b16 a[252:253], v230 offset:58368
buffer_load_dword v239, v255, s[24:27], 0 offen sc1
v_mfma_f32_16x16x32_bf16 v[20:23], a[232:235], a[4:7], v[20:23]
s_waitcnt lgkmcnt(10)
ds_read_b64_tr_b16 a[254:255], v230 offset:59136
ds_read_b64_tr_b16 v[168:169], v227 offset:0
v_mfma_f32_16x16x32_bf16 v[24:27], a[236:239], a[0:3], v[24:27]
s_add_u32 s90, s90, 12800
ds_read_b64_tr_b16 a[224:225], v230 offset:52256
buffer_load_dwordx4 a[52:55], v247, s[24:27], s87 offen offset:2048 sc1
v_mfma_f32_16x16x32_bf16 v[28:31], a[236:239], a[4:7], v[28:31]
s_waitcnt lgkmcnt(10)
ds_read_b64_tr_b16 a[226:227], v230 offset:53024
ds_read_b64_tr_b16 v[170:171], v227 offset:512
v_mfma_f32_16x16x32_bf16 v[32:35], a[240:243], a[0:3], v[32:35]
ds_read_b64_tr_b16 a[228:229], v230 offset:58400
v_mfma_f32_16x16x32_bf16 v[36:39], a[240:243], a[4:7], v[36:39]
s_waitcnt lgkmcnt(10)
ds_read_b64_tr_b16 a[230:231], v230 offset:59168
ds_read_b64_tr_b16 v[172:173], v228 offset:0
v_mfma_f32_16x16x32_bf16 v[40:43], a[244:247], a[0:3], v[40:43]
s_lshr_b32 s82, s81, 1
ds_read_b64_tr_b16 a[232:233], v230 offset:52288
buffer_load_dwordx4 a[56:59], v246, s[24:27], s87 offen offset:3072 sc1
v_mfma_f32_16x16x32_bf16 v[44:47], a[244:247], a[4:7], v[44:47]
s_waitcnt lgkmcnt(10)
ds_read_b64_tr_b16 a[234:235], v230 offset:53056
ds_read_b64_tr_b16 v[174:175], v228 offset:512
v_mfma_f32_16x16x32_bf16 v[0:3], a[248:251], a[8:11], v[0:3]
ds_read_b64_tr_b16 a[236:237], v230 offset:58432
v_mfma_f32_16x16x32_bf16 v[4:7], a[248:251], a[12:15], v[4:7]
s_waitcnt lgkmcnt(11)
ds_read_b64_tr_b16 a[238:239], v230 offset:59200
v_mfma_f32_16x16x32_bf16 v[8:11], a[252:255], a[8:11], v[8:11]
s_lshl_b32 s82, s82, 10
ds_read_b64_tr_b16 a[240:241], v223 offset:0
buffer_load_dwordx4 a[60:63], v247, s[24:27], s87 offen offset:3072 sc1
v_mfma_f32_16x16x32_bf16 v[12:15], a[252:255], a[12:15], v[12:15]
s_waitcnt lgkmcnt(10)
ds_read_b64_tr_b16 a[242:243], v223 offset:768
v_mfma_f32_16x16x32_bf16 v[16:19], a[224:227], a[8:11], v[16:19]
s_add_u32 s87, s87, 40960
ds_read_b64_tr_b16 a[244:245], v223 offset:6144
v_mfma_f32_16x16x32_bf16 v[20:23], a[224:227], a[12:15], v[20:23]
s_waitcnt lgkmcnt(9)
ds_read_b64_tr_b16 a[246:247], v223 offset:6912
v_mfma_f32_16x16x32_bf16 v[24:27], a[228:231], a[8:11], v[24:27]
s_add_u32 s91, s92, s82
ds_read_b64_tr_b16 a[248:249], v223 offset:32
s_waitcnt vmcnt(11)
v_mfma_f32_16x16x32_bf16 v[28:31], a[228:231], a[12:15], v[28:31]
s_waitcnt lgkmcnt(8)
ds_read_b64_tr_b16 a[250:251], v223 offset:800
buffer_load_dwordx4 a[64:67], v246, s[24:27], s88 offen offset:0 sc1
v_mfma_f32_16x16x32_bf16 v[32:35], a[232:235], a[8:11], v[32:35]
ds_read_b64_tr_b16 a[252:253], v223 offset:6176
ds_read_b64_tr_b16 v[176:177], v218 offset:16384
v_mfma_f32_16x16x32_bf16 v[36:39], a[232:235], a[12:15], v[36:39]
s_waitcnt lgkmcnt(8)
ds_read_b64_tr_b16 a[254:255], v223 offset:6944
v_mfma_f32_16x16x32_bf16 v[40:43], a[236:239], a[8:11], v[40:43]
s_and_b32 s82, s81, 1
ds_read_b64_tr_b16 a[224:225], v223 offset:64
ds_read_b64_tr_b16 v[178:179], v218 offset:16896
v_mfma_f32_16x16x32_bf16 v[44:47], a[236:239], a[12:15], v[44:47]
s_waitcnt lgkmcnt(9)
ds_read_b64_tr_b16 a[226:227], v223 offset:832
buffer_load_dwordx4 a[68:71], v247, s[24:27], s88 offen offset:0 sc1
v_mfma_f32_16x16x32_bf16 v[0:3], a[240:243], a[16:19], v[0:3]
ds_read_b64_tr_b16 a[228:229], v223 offset:6208
ds_read_b64_tr_b16 v[180:181], v219 offset:16384
v_mfma_f32_16x16x32_bf16 v[4:7], a[240:243], a[20:23], v[4:7]
s_waitcnt lgkmcnt(10)
ds_read_b64_tr_b16 a[230:231], v223 offset:6976
v_mfma_f32_16x16x32_bf16 v[8:11], a[244:247], a[16:19], v[8:11]
s_lshl_b32 s82, s82, 7
ds_read_b64_tr_b16 a[232:233], v223 offset:3072
ds_read_b64_tr_b16 v[182:183], v219 offset:16896
v_mfma_f32_16x16x32_bf16 v[12:15], a[244:247], a[20:23], v[12:15]
s_waitcnt lgkmcnt(11)
ds_read_b64_tr_b16 a[234:235], v223 offset:3840
buffer_load_dwordx4 a[72:75], v246, s[24:27], s88 offen offset:1024 sc1
v_mfma_f32_16x16x32_bf16 v[16:19], a[248:251], a[16:19], v[16:19]
ds_read_b64_tr_b16 a[236:237], v223 offset:9216
ds_read_b64_tr_b16 v[184:185], v227 offset:16384
v_mfma_f32_16x16x32_bf16 v[20:23], a[248:251], a[20:23], v[20:23]
s_waitcnt lgkmcnt(11)
ds_read_b64_tr_b16 a[238:239], v223 offset:9984
v_mfma_f32_16x16x32_bf16 v[24:27], a[252:255], a[16:19], v[24:27]
s_add_u32 s91, s91, s82
ds_read_b64_tr_b16 a[240:241], v223 offset:3104
ds_read_b64_tr_b16 v[186:187], v227 offset:16896
v_mfma_f32_16x16x32_bf16 v[28:31], a[252:255], a[20:23], v[28:31]
s_waitcnt lgkmcnt(11)
ds_read_b64_tr_b16 a[242:243], v223 offset:3872
buffer_load_dwordx4 a[76:79], v247, s[24:27], s88 offen offset:1024 sc1
v_mfma_f32_16x16x32_bf16 v[32:35], a[224:227], a[16:19], v[32:35]
ds_read_b64_tr_b16 a[244:245], v223 offset:9248
ds_read_b64_tr_b16 v[188:189], v228 offset:16384
v_mfma_f32_16x16x32_bf16 v[36:39], a[224:227], a[20:23], v[36:39]
s_waitcnt lgkmcnt(11)
ds_read_b64_tr_b16 a[246:247], v223 offset:10016
v_mfma_f32_16x16x32_bf16 v[40:43], a[228:231], a[16:19], v[40:43]
s_add_u32 s91, s91, 58720256
ds_read_b64_tr_b16 a[248:249], v223 offset:3136
ds_read_b64_tr_b16 v[190:191], v228 offset:16896
v_mfma_f32_16x16x32_bf16 v[44:47], a[228:231], a[20:23], v[44:47]
s_waitcnt vmcnt(13) lgkmcnt(11)
ds_read_b64_tr_b16 a[250:251], v223 offset:3904
buffer_load_dwordx4 a[80:83], v246, s[24:27], s88 offen offset:2048 sc1
v_mfma_f32_16x16x32_bf16 v[0:3], a[232:235], a[24:27], v[0:3]
ds_read_b64_tr_b16 a[252:253], v223 offset:9280
v_mfma_f32_16x16x32_bf16 v[4:7], a[232:235], a[28:31], v[4:7]
s_waitcnt lgkmcnt(10)
ds_read_b64_tr_b16 a[254:255], v223 offset:10048
v_mfma_f32_16x16x32_bf16 v[8:11], a[236:239], a[24:27], v[8:11]
s_add_u32 s41, s91, 81920
ds_read_b64_tr_b16 a[224:225], v223 offset:12288
v_mfma_f32_16x16x32_bf16 v[12:15], a[236:239], a[28:31], v[12:15]
s_waitcnt lgkmcnt(9)
ds_read_b64_tr_b16 a[226:227], v223 offset:13056
buffer_load_dwordx4 a[84:87], v247, s[24:27], s88 offen offset:2048 sc1
v_mfma_f32_16x16x32_bf16 v[16:19], a[240:243], a[24:27], v[16:19]
ds_read_b64_tr_b16 a[228:229], v223 offset:18432
v_mfma_f32_16x16x32_bf16 v[20:23], a[240:243], a[28:31], v[20:23]
s_waitcnt lgkmcnt(8)
ds_read_b64_tr_b16 a[230:231], v223 offset:19200
v_mfma_f32_16x16x32_bf16 v[24:27], a[244:247], a[24:27], v[24:27]
s_lshl_b32 s81, s81, 5
ds_read_b64_tr_b16 a[232:233], v223 offset:12320
v_mfma_f32_16x16x32_bf16 v[28:31], a[244:247], a[28:31], v[28:31]
s_waitcnt lgkmcnt(7)
ds_read_b64_tr_b16 a[234:235], v223 offset:13088
buffer_load_dwordx4 a[88:91], v246, s[24:27], s88 offen offset:3072 sc1
v_mfma_f32_16x16x32_bf16 v[32:35], a[248:251], a[24:27], v[32:35]
ds_read_b64_tr_b16 a[236:237], v223 offset:18464
s_waitcnt vmcnt(10)
v_cmp_ne_u32 vcc, s51, v239
v_mfma_f32_16x16x32_bf16 v[36:39], a[248:251], a[28:31], v[36:39]
s_waitcnt lgkmcnt(7)
ds_read_b64_tr_b16 a[238:239], v223 offset:19232
v_mfma_f32_16x16x32_bf16 v[40:43], a[252:255], a[24:27], v[40:43]
s_add_u32 s92, s92, s81
ds_read_b64_tr_b16 a[240:241], v223 offset:12352
v_mfma_f32_16x16x32_bf16 v[44:47], a[252:255], a[28:31], v[44:47]
s_waitcnt lgkmcnt(7)
ds_read_b64_tr_b16 a[242:243], v223 offset:13120
buffer_load_dwordx4 a[92:95], v247, s[24:27], s88 offen offset:3072 sc1
s_cbranch_vccnz L_slow_hb
L_back_hb:
v_mfma_f32_16x16x32_bf16 v[0:3], a[224:227], a[32:35], v[0:3]
s_add_u32 s88, s88, 40960
ds_read_b64_tr_b16 a[244:245], v223 offset:18496
v_mfma_f32_16x16x32_bf16 v[4:7], a[224:227], a[36:39], v[4:7]
s_waitcnt lgkmcnt(7)
ds_read_b64_tr_b16 a[246:247], v223 offset:19264
v_mfma_f32_16x16x32_bf16 v[8:11], a[228:231], a[32:35], v[8:11]
s_add_u32 s40, s92, 81920
ds_read_b64_tr_b16 a[248:249], v223 offset:15360
v_mfma_f32_16x16x32_bf16 v[12:15], a[228:231], a[36:39], v[12:15]
s_waitcnt lgkmcnt(7)
ds_read_b64_tr_b16 a[250:251], v223 offset:16128
buffer_load_dwordx4 a[112:115], v246, s[24:27], s84 offen offset:0 sc1
v_mfma_f32_16x16x32_bf16 v[16:19], a[232:235], a[32:35], v[16:19]
ds_read_b64_tr_b16 a[252:253], v223 offset:21504
v_mfma_f32_16x16x32_bf16 v[20:23], a[232:235], a[36:39], v[20:23]
s_waitcnt lgkmcnt(7)
ds_read_b64_tr_b16 a[254:255], v223 offset:22272
v_mfma_f32_16x16x32_bf16 v[24:27], a[236:239], a[32:35], v[24:27]
s_lshl_b32 s81, s36, 10
ds_read_b64_tr_b16 a[224:225], v223 offset:15392
v_mfma_f32_16x16x32_bf16 v[28:31], a[236:239], a[36:39], v[28:31]
s_waitcnt lgkmcnt(7)
ds_read_b64_tr_b16 a[226:227], v223 offset:16160
buffer_load_dwordx4 a[116:119], v247, s[24:27], s84 offen offset:0 sc1
v_mfma_f32_16x16x32_bf16 v[32:35], a[240:243], a[32:35], v[32:35]
ds_read_b64_tr_b16 a[228:229], v223 offset:21536
v_mfma_f32_16x16x32_bf16 v[36:39], a[240:243], a[36:39], v[36:39]
s_waitcnt lgkmcnt(7)
ds_read_b64_tr_b16 a[230:231], v223 offset:22304
v_mfma_f32_16x16x32_bf16 v[40:43], a[244:247], a[32:35], v[40:43]
s_mul_i32 s42, s42, 49152
ds_read_b64_tr_b16 a[232:233], v223 offset:15424
v_mfma_f32_16x16x32_bf16 v[44:47], a[244:247], a[36:39], v[44:47]
s_waitcnt lgkmcnt(7)
ds_read_b64_tr_b16 a[234:235], v223 offset:16192
buffer_load_dwordx4 a[120:123], v246, s[24:27], s84 offen offset:1024 sc1
v_mfma_f32_16x16x32_bf16 v[0:3], a[248:251], a[40:43], v[0:3]
ds_read_b64_tr_b16 a[236:237], v223 offset:21568
v_mfma_f32_16x16x32_bf16 v[4:7], a[248:251], a[44:47], v[4:7]
s_waitcnt lgkmcnt(7)
ds_read_b64_tr_b16 a[238:239], v223 offset:22336
v_mfma_f32_16x16x32_bf16 v[8:11], a[252:255], a[40:43], v[8:11]
s_add_u32 s42, s42, s81
ds_read_b64_tr_b16 a[240:241], v223 offset:24576
v_mfma_f32_16x16x32_bf16 v[12:15], a[252:255], a[44:47], v[12:15]
s_waitcnt lgkmcnt(7)
ds_read_b64_tr_b16 a[242:243], v223 offset:25344
buffer_load_dwordx4 a[124:127], v247, s[24:27], s84 offen offset:1024 sc1
v_mfma_f32_16x16x32_bf16 v[16:19], a[224:227], a[40:43], v[16:19]
ds_read_b64_tr_b16 a[244:245], v223 offset:30720
v_mfma_f32_16x16x32_bf16 v[20:23], a[224:227], a[44:47], v[20:23]
s_waitcnt lgkmcnt(7)
ds_read_b64_tr_b16 a[246:247], v223 offset:31488
v_mfma_f32_16x16x32_bf16 v[24:27], a[228:231], a[40:43], v[24:27]
s_mul_i32 s43, s43, 49152
ds_read_b64_tr_b16 a[248:249], v223 offset:24608
v_mfma_f32_16x16x32_bf16 v[28:31], a[228:231], a[44:47], v[28:31]
s_waitcnt lgkmcnt(7)
ds_read_b64_tr_b16 a[250:251], v223 offset:25376
buffer_load_dwordx4 a[128:131], v246, s[24:27], s84 offen offset:2048 sc1
v_mfma_f32_16x16x32_bf16 v[32:35], a[232:235], a[40:43], v[32:35]
ds_read_b64_tr_b16 a[252:253], v223 offset:30752
v_mfma_f32_16x16x32_bf16 v[36:39], a[232:235], a[44:47], v[36:39]
s_waitcnt lgkmcnt(7)
ds_read_b64_tr_b16 a[254:255], v223 offset:31520
v_mfma_f32_16x16x32_bf16 v[40:43], a[236:239], a[40:43], v[40:43]
s_add_u32 s43, s43, s81
ds_read_b64_tr_b16 a[224:225], v223 offset:24640
v_mfma_f32_16x16x32_bf16 v[44:47], a[236:239], a[44:47], v[44:47]
s_waitcnt vmcnt(15) lgkmcnt(7)
ds_read_b64_tr_b16 a[226:227], v223 offset:25408
buffer_load_dwordx4 a[132:135], v247, s[24:27], s84 offen offset:2048 sc1
v_mfma_f32_16x16x32_bf16 v[0:3], a[240:243], a[48:51], v[0:3]
ds_read_b64_tr_b16 a[228:229], v223 offset:30784
v_mfma_f32_16x16x32_bf16 v[4:7], a[240:243], a[52:55], v[4:7]
s_waitcnt lgkmcnt(7)
ds_read_b64_tr_b16 a[230:231], v223 offset:31552
v_mfma_f32_16x16x32_bf16 v[8:11], a[244:247], a[48:51], v[8:11]
s_mul_i32 s44, s44, 49152
ds_read_b64_tr_b16 a[232:233], v223 offset:27648
v_mfma_f32_16x16x32_bf16 v[12:15], a[244:247], a[52:55], v[12:15]
s_waitcnt lgkmcnt(7)
ds_read_b64_tr_b16 a[234:235], v223 offset:28416
buffer_load_dwordx4 a[144:147], v246, s[24:27], s84 offen offset:3072 sc1
v_mfma_f32_16x16x32_bf16 v[16:19], a[248:251], a[48:51], v[16:19]
ds_read_b64_tr_b16 a[236:237], v223 offset:33792
v_mfma_f32_16x16x32_bf16 v[20:23], a[248:251], a[52:55], v[20:23]
s_waitcnt lgkmcnt(7)
ds_read_b64_tr_b16 a[238:239], v223 offset:34560
v_mfma_f32_16x16x32_bf16 v[24:27], a[252:255], a[48:51], v[24:27]
s_add_u32 s44, s44, s81
ds_read_b64_tr_b16 a[240:241], v223 offset:27680
v_mfma_f32_16x16x32_bf16 v[28:31], a[252:255], a[52:55], v[28:31]
s_waitcnt lgkmcnt(7)
ds_read_b64_tr_b16 a[242:243], v223 offset:28448
buffer_load_dwordx4 a[148:151], v247, s[24:27], s84 offen offset:3072 sc1
v_mfma_f32_16x16x32_bf16 v[32:35], a[224:227], a[48:51], v[32:35]
ds_read_b64_tr_b16 a[244:245], v223 offset:33824
v_mfma_f32_16x16x32_bf16 v[36:39], a[224:227], a[52:55], v[36:39]
s_waitcnt lgkmcnt(7)
ds_read_b64_tr_b16 a[246:247], v223 offset:34592
v_lshl_add_u32 v236, v236, 3, s45
v_mfma_f32_16x16x32_bf16 v[40:43], a[228:231], a[48:51], v[40:43]
ds_read_b64_tr_b16 a[248:249], v223 offset:27712
v_mfma_f32_16x16x32_bf16 v[44:47], a[228:231], a[52:55], v[44:47]
s_waitcnt vmcnt(16) lgkmcnt(7)
ds_read_b64_tr_b16 a[250:251], v223 offset:28480
buffer_load_dwordx4 a[160:163], v246, s[24:27], s85 offen offset:0 sc1
v_mfma_f32_16x16x32_bf16 v[0:3], a[232:235], a[56:59], v[0:3]
ds_read_b64_tr_b16 a[252:253], v223 offset:33856
v_add_u32 v224, s42, v238
v_mfma_f32_16x16x32_bf16 v[4:7], a[232:235], a[60:63], v[4:7]
s_waitcnt lgkmcnt(7)
ds_read_b64_tr_b16 a[254:255], v223 offset:34624
v_mfma_f32_16x16x32_bf16 v[8:11], a[236:239], a[56:59], v[8:11]
ds_read_b64_tr_b16 a[224:225], v223 offset:36864
v_add_u32 v225, s43, v238
v_mfma_f32_16x16x32_bf16 v[12:15], a[236:239], a[60:63], v[12:15]
s_waitcnt lgkmcnt(7)
ds_read_b64_tr_b16 a[226:227], v223 offset:37632
buffer_load_dwordx4 a[164:167], v247, s[24:27], s85 offen offset:0 sc1
v_mfma_f32_16x16x32_bf16 v[16:19], a[240:243], a[56:59], v[16:19]
ds_read_b64_tr_b16 a[228:229], v223 offset:43008
v_add_u32 v226, s44, v238
v_mfma_f32_16x16x32_bf16 v[20:23], a[240:243], a[60:63], v[20:23]
s_waitcnt lgkmcnt(7)
ds_read_b64_tr_b16 a[230:231], v223 offset:43776
v_mfma_f32_16x16x32_bf16 v[24:27], a[244:247], a[56:59], v[24:27]
ds_read_b64_tr_b16 a[232:233], v223 offset:36896
v_mul_u32_u24 v156, s46, v158
v_mfma_f32_16x16x32_bf16 v[28:31], a[244:247], a[60:63], v[28:31]
s_waitcnt lgkmcnt(7)
ds_read_b64_tr_b16 a[234:235], v223 offset:37664
buffer_load_dwordx4 a[176:179], v246, s[24:27], s85 offen offset:1024 sc1
v_mfma_f32_16x16x32_bf16 v[32:35], a[248:251], a[56:59], v[32:35]
ds_read_b64_tr_b16 a[236:237], v223 offset:43040
v_mul_u32_u24 v157, 40960, v158
v_mfma_f32_16x16x32_bf16 v[36:39], a[248:251], a[60:63], v[36:39]
s_waitcnt lgkmcnt(7)
ds_read_b64_tr_b16 a[238:239], v223 offset:43808
v_mfma_f32_16x16x32_bf16 v[40:43], a[252:255], a[56:59], v[40:43]
ds_read_b64_tr_b16 a[240:241], v223 offset:36928
v_add_u32 v250, v251, v156
v_mfma_f32_16x16x32_bf16 v[44:47], a[252:255], a[60:63], v[44:47]
s_waitcnt vmcnt(17) lgkmcnt(7)
ds_read_b64_tr_b16 a[242:243], v223 offset:37696
buffer_load_dwordx4 a[180:183], v247, s[24:27], s85 offen offset:1024 sc1
v_mfma_f32_16x16x32_bf16 v[0:3], a[224:227], a[64:67], v[0:3]
ds_read_b64_tr_b16 a[244:245], v223 offset:43072
v_add_u32 v234, v235, v156
v_mfma_f32_16x16x32_bf16 v[4:7], a[224:227], a[68:71], v[4:7]
s_waitcnt lgkmcnt(7)
ds_read_b64_tr_b16 a[246:247], v223 offset:43840
v_mfma_f32_16x16x32_bf16 v[8:11], a[228:231], a[64:67], v[8:11]
ds_read_b64_tr_b16 a[248:249], v223 offset:39936
v_add_u32 v251, v251, v157
v_mfma_f32_16x16x32_bf16 v[12:15], a[228:231], a[68:71], v[12:15]
s_waitcnt lgkmcnt(7)
ds_read_b64_tr_b16 a[250:251], v223 offset:40704
buffer_load_dwordx4 a[192:195], v246, s[24:27], s85 offen offset:2048 sc1
v_mfma_f32_16x16x32_bf16 v[16:19], a[232:235], a[64:67], v[16:19]
ds_read_b64_tr_b16 a[252:253], v223 offset:46080
v_add_u32 v235, v235, v157
v_mfma_f32_16x16x32_bf16 v[20:23], a[232:235], a[68:71], v[20:23]
s_waitcnt lgkmcnt(7)
ds_read_b64_tr_b16 a[254:255], v223 offset:46848
v_mfma_f32_16x16x32_bf16 v[24:27], a[236:239], a[64:67], v[24:27]
ds_read_b64_tr_b16 a[224:225], v223 offset:39968
v_mfma_f32_16x16x32_bf16 v[28:31], a[236:239], a[68:71], v[28:31]
s_waitcnt lgkmcnt(7)
ds_read_b64_tr_b16 a[226:227], v223 offset:40736
buffer_load_dwordx4 a[196:199], v247, s[24:27], s85 offen offset:2048 sc1
v_mfma_f32_16x16x32_bf16 v[32:35], a[240:243], a[64:67], v[32:35]
ds_read_b64_tr_b16 a[228:229], v223 offset:46112
v_mfma_f32_16x16x32_bf16 v[36:39], a[240:243], a[68:71], v[36:39]
s_waitcnt lgkmcnt(7)
ds_read_b64_tr_b16 a[230:231], v223 offset:46880
v_mfma_f32_16x16x32_bf16 v[40:43], a[244:247], a[64:67], v[40:43]
ds_read_b64_tr_b16 a[232:233], v223 offset:40000
v_mfma_f32_16x16x32_bf16 v[44:47], a[244:247], a[68:71], v[44:47]
s_waitcnt vmcnt(18) lgkmcnt(7)
ds_read_b64_tr_b16 a[234:235], v223 offset:40768
buffer_load_dwordx4 a[208:211], v246, s[24:27], s85 offen offset:3072 sc1
v_mfma_f32_16x16x32_bf16 v[0:3], a[248:251], a[72:75], v[0:3]
ds_read_b64_tr_b16 a[236:237], v223 offset:46144
v_mfma_f32_16x16x32_bf16 v[4:7], a[248:251], a[76:79], v[4:7]
s_waitcnt lgkmcnt(7)
ds_read_b64_tr_b16 a[238:239], v223 offset:46912
v_mfma_f32_16x16x32_bf16 v[8:11], a[252:255], a[72:75], v[8:11]
ds_read_b64_tr_b16 a[240:241], v223 offset:49152
v_mfma_f32_16x16x32_bf16 v[12:15], a[252:255], a[76:79], v[12:15]
s_waitcnt lgkmcnt(7)
ds_read_b64_tr_b16 a[242:243], v223 offset:49920
buffer_load_dwordx4 a[212:215], v247, s[24:27], s85 offen offset:3072 sc1
v_mfma_f32_16x16x32_bf16 v[16:19], a[224:227], a[72:75], v[16:19]
ds_read_b64_tr_b16 a[244:245], v223 offset:55296
v_mfma_f32_16x16x32_bf16 v[20:23], a[224:227], a[76:79], v[20:23]
s_waitcnt lgkmcnt(7)
ds_read_b64_tr_b16 a[246:247], v223 offset:56064
v_mfma_f32_16x16x32_bf16 v[24:27], a[228:231], a[72:75], v[24:27]
ds_read_b64_tr_b16 a[248:249], v223 offset:49184
v_mfma_f32_16x16x32_bf16 v[28:31], a[228:231], a[76:79], v[28:31]
s_waitcnt lgkmcnt(7)
ds_read_b64_tr_b16 a[250:251], v223 offset:49952
buffer_load_dwordx4 a[0:3], v246, s[24:27], s86 offen offset:0 sc1
v_mfma_f32_16x16x32_bf16 v[32:35], a[232:235], a[72:75], v[32:35]
ds_read_b64_tr_b16 a[252:253], v223 offset:55328
v_mfma_f32_16x16x32_bf16 v[36:39], a[232:235], a[76:79], v[36:39]
s_waitcnt lgkmcnt(7)
ds_read_b64_tr_b16 a[254:255], v223 offset:56096
v_mfma_f32_16x16x32_bf16 v[40:43], a[236:239], a[72:75], v[40:43]
ds_read_b64_tr_b16 a[224:225], v223 offset:49216
v_mfma_f32_16x16x32_bf16 v[44:47], a[236:239], a[76:79], v[44:47]
s_waitcnt vmcnt(19) lgkmcnt(7)
ds_read_b64_tr_b16 a[226:227], v223 offset:49984
buffer_load_dwordx4 a[4:7], v247, s[24:27], s86 offen offset:0 sc1
v_mfma_f32_16x16x32_bf16 v[0:3], a[240:243], a[80:83], v[0:3]
ds_read_b64_tr_b16 a[228:229], v223 offset:55360
v_mfma_f32_16x16x32_bf16 v[4:7], a[240:243], a[84:87], v[4:7]
s_waitcnt lgkmcnt(7)
ds_read_b64_tr_b16 a[230:231], v223 offset:56128
v_mfma_f32_16x16x32_bf16 v[8:11], a[244:247], a[80:83], v[8:11]
L_pg18:
s_cbranch_execz L_ret_B
ds_read_b64_tr_b16 a[232:233], v223 offset:52224
v_mfma_f32_16x16x32_bf16 v[12:15], a[244:247], a[84:87], v[12:15]
s_waitcnt lgkmcnt(7)
ds_read_b64_tr_b16 a[234:235], v223 offset:52992
buffer_load_dwordx4 a[8:11], v246, s[24:27], s86 offen offset:1024 sc1
v_mfma_f32_16x16x32_bf16 v[16:19], a[248:251], a[80:83], v[16:19]
ds_read_b64_tr_b16 a[236:237], v223 offset:58368
v_mfma_f32_16x16x32_bf16 v[20:23], a[248:251], a[84:87], v[20:23]
s_waitcnt lgkmcnt(7)
ds_read_b64_tr_b16 a[238:239], v223 offset:59136
v_mfma_f32_16x16x32_bf16 v[24:27], a[252:255], a[80:83], v[24:27]
ds_read_b64_tr_b16 a[240:241], v223 offset:52256
v_mfma_f32_16x16x32_bf16 v[28:31], a[252:255], a[84:87], v[28:31]
s_waitcnt lgkmcnt(7)
ds_read_b64_tr_b16 a[242:243], v223 offset:53024
buffer_load_dwordx4 a[12:15], v247, s[24:27], s86 offen offset:1024 sc1
v_mfma_f32_16x16x32_bf16 v[32:35], a[224:227], a[80:83], v[32:35]
ds_read_b64_tr_b16 a[244:245], v223 offset:58400
v_mfma_f32_16x16x32_bf16 v[36:39], a[224:227], a[84:87], v[36:39]
s_waitcnt lgkmcnt(7)
ds_read_b64_tr_b16 a[246:247], v223 offset:59168
v_mfma_f32_16x16x32_bf16 v[40:43], a[228:231], a[80:83], v[40:43]
ds_read_b64_tr_b16 a[248:249], v223 offset:52288
v_mfma_f32_16x16x32_bf16 v[44:47], a[228:231], a[84:87], v[44:47]
s_waitcnt vmcnt(20) lgkmcnt(7)
ds_read_b64_tr_b16 a[250:251], v223 offset:53056
buffer_load_dwordx4 a[16:19], v246, s[24:27], s86 offen offset:2048 sc1
v_mfma_f32_16x16x32_bf16 v[0:3], a[232:235], a[88:91], v[0:3]
ds_read_b64_tr_b16 a[252:253], v223 offset:58432
v_mfma_f32_16x16x32_bf16 v[4:7], a[232:235], a[92:95], v[4:7]
s_waitcnt lgkmcnt(7)
ds_read_b64_tr_b16 a[254:255], v223 offset:59200
v_mfma_f32_16x16x32_bf16 v[8:11], a[236:239], a[88:91], v[8:11]
ds_read_b64_tr_b16 a[224:225], v230 offset:0
v_mfma_f32_16x16x32_bf16 v[12:15], a[236:239], a[92:95], v[12:15]
s_waitcnt lgkmcnt(7)
ds_read_b64_tr_b16 a[226:227], v230 offset:768
buffer_load_dwordx4 a[20:23], v247, s[24:27], s86 offen offset:2048 sc1
v_mfma_f32_16x16x32_bf16 v[16:19], a[240:243], a[88:91], v[16:19]
ds_read_b64_tr_b16 a[228:229], v230 offset:6144
v_mfma_f32_16x16x32_bf16 v[20:23], a[240:243], a[92:95], v[20:23]
s_waitcnt lgkmcnt(7)
ds_read_b64_tr_b16 a[230:231], v230 offset:6912
v_mfma_f32_16x16x32_bf16 v[24:27], a[244:247], a[88:91], v[24:27]
ds_read_b64_tr_b16 a[232:233], v230 offset:32
v_mfma_f32_16x16x32_bf16 v[28:31], a[244:247], a[92:95], v[28:31]
s_waitcnt lgkmcnt(7)
ds_read_b64_tr_b16 a[234:235], v230 offset:800
buffer_load_dwordx4 a[24:27], v246, s[24:27], s86 offen offset:3072 sc1
v_mfma_f32_16x16x32_bf16 v[32:35], a[248:251], a[88:91], v[32:35]
ds_read_b64_tr_b16 a[236:237], v230 offset:6176
v_mfma_f32_16x16x32_bf16 v[36:39], a[248:251], a[92:95], v[36:39]
s_waitcnt lgkmcnt(7)
ds_read_b64_tr_b16 a[238:239], v230 offset:6944
v_mfma_f32_16x16x32_bf16 v[40:43], a[252:255], a[88:91], v[40:43]
ds_read_b64_tr_b16 a[240:241], v230 offset:64
v_mfma_f32_16x16x32_bf16 v[44:47], a[252:255], a[92:95], v[44:47]
s_waitcnt vmcnt(21) lgkmcnt(7)
ds_read_b64_tr_b16 a[242:243], v230 offset:832
buffer_load_dwordx4 a[28:31], v247, s[24:27], s86 offen offset:3072 sc1
v_mov_b32 v128, 0xc0135761
v_mov_b32 v129, 0xc0135761
v_mov_b32 v130, 0xbdd2d3e8
v_mov_b32 v131, 0xbdd2d3e8
v_mov_b32 v132, 0x3f800000
v_mov_b32 v133, 0x3f800000
s_add_u32 s37, s80, 49152
s_add_u32 s38, s80, 0
v_pk_mul_f32 v[136:137], v[0:1], v[0:1]
v_pk_mul_f32 v[138:139], v[2:3], v[2:3]
v_pk_mul_f32 v[140:141], v[16:17], v[16:17]
v_pk_mul_f32 v[142:143], v[18:19], v[18:19]
v_pk_fma_f32 v[136:137], v[136:137], v[130:131], v[128:129]
v_pk_fma_f32 v[138:139], v[138:139], v[130:131], v[128:129]
v_pk_fma_f32 v[140:141], v[140:141], v[130:131], v[128:129]
v_pk_fma_f32 v[142:143], v[142:143], v[130:131], v[128:129]
v_pk_mul_f32 v[136:137], v[136:137], v[0:1]
v_pk_mul_f32 v[138:139], v[138:139], v[2:3]
v_pk_mul_f32 v[140:141], v[140:141], v[16:17]
v_pk_mul_f32 v[142:143], v[142:143], v[18:19]
v_exp_f32 v136, v136
v_exp_f32 v137, v137
v_exp_f32 v138, v138
v_exp_f32 v139, v139
v_exp_f32 v140, v140
v_exp_f32 v141, v141
v_exp_f32 v142, v142
v_exp_f32 v143, v143
v_pk_mul_f32 v[0:1], v[0:1], v[8:9]
v_pk_mul_f32 v[2:3], v[2:3], v[10:11]
v_pk_mul_f32 v[16:17], v[16:17], v[24:25]
v_pk_mul_f32 v[18:19], v[18:19], v[26:27]
v_pk_add_f32 v[136:137], v[136:137], v[132:133]
v_pk_add_f32 v[138:139], v[138:139], v[132:133]
v_pk_add_f32 v[140:141], v[140:141], v[132:133]
v_pk_add_f32 v[142:143], v[142:143], v[132:133]
v_rcp_f32 v136, v136
v_rcp_f32 v137, v137
v_rcp_f32 v138, v138
v_rcp_f32 v139, v139
v_rcp_f32 v140, v140
v_rcp_f32 v141, v141
v_rcp_f32 v142, v142
v_rcp_f32 v143, v143
v_pk_mul_f32 v[0:1], v[0:1], v[136:137]
v_pk_mul_f32 v[2:3], v[2:3], v[138:139]
v_pk_mul_f32 v[16:17], v[16:17], v[140:141]
v_pk_mul_f32 v[18:19], v[18:19], v[142:143]
v_cvt_pk_bf16_f32 v144, v0, v1
v_cvt_pk_bf16_f32 v145, v2, v3
v_cvt_pk_bf16_f32 v146, v16, v17
v_cvt_pk_bf16_f32 v147, v18, v19
s_nop 0
v_permlane16_swap_b32 v144, v146
v_permlane16_swap_b32 v145, v147
buffer_store_dwordx4 v[144:147], v242, s[24:27], s38 offen sc1
v_pk_mul_f32 v[136:137], v[4:5], v[4:5]
v_pk_mul_f32 v[138:139], v[6:7], v[6:7]
v_pk_mul_f32 v[140:141], v[20:21], v[20:21]
v_pk_mul_f32 v[142:143], v[22:23], v[22:23]
v_pk_fma_f32 v[136:137], v[136:137], v[130:131], v[128:129]
v_pk_fma_f32 v[138:139], v[138:139], v[130:131], v[128:129]
v_pk_fma_f32 v[140:141], v[140:141], v[130:131], v[128:129]
v_pk_fma_f32 v[142:143], v[142:143], v[130:131], v[128:129]
v_pk_mul_f32 v[136:137], v[136:137], v[4:5]
v_pk_mul_f32 v[138:139], v[138:139], v[6:7]
v_pk_mul_f32 v[140:141], v[140:141], v[20:21]
v_pk_mul_f32 v[142:143], v[142:143], v[22:23]
v_exp_f32 v136, v136
v_exp_f32 v137, v137
v_exp_f32 v138, v138
v_exp_f32 v139, v139
v_exp_f32 v140, v140
v_exp_f32 v141, v141
v_exp_f32 v142, v142
v_exp_f32 v143, v143
v_pk_mul_f32 v[4:5], v[4:5], v[12:13]
v_pk_mul_f32 v[6:7], v[6:7], v[14:15]
v_pk_mul_f32 v[20:21], v[20:21], v[28:29]
v_pk_mul_f32 v[22:23], v[22:23], v[30:31]
v_pk_add_f32 v[136:137], v[136:137], v[132:133]
v_pk_add_f32 v[138:139], v[138:139], v[132:133]
v_pk_add_f32 v[140:141], v[140:141], v[132:133]
v_pk_add_f32 v[142:143], v[142:143], v[132:133]
v_rcp_f32 v136, v136
v_rcp_f32 v137, v137
v_rcp_f32 v138, v138
v_rcp_f32 v139, v139
v_rcp_f32 v140, v140
v_rcp_f32 v141, v141
v_rcp_f32 v142, v142
v_rcp_f32 v143, v143
v_pk_mul_f32 v[4:5], v[4:5], v[136:137]
v_pk_mul_f32 v[6:7], v[6:7], v[138:139]
v_pk_mul_f32 v[20:21], v[20:21], v[140:141]
v_pk_mul_f32 v[22:23], v[22:23], v[142:143]
v_cvt_pk_bf16_f32 v148, v4, v5
v_cvt_pk_bf16_f32 v149, v6, v7
v_cvt_pk_bf16_f32 v150, v20, v21
v_cvt_pk_bf16_f32 v151, v22, v23
s_nop 0
v_permlane16_swap_b32 v148, v150
v_permlane16_swap_b32 v149, v151
buffer_store_dwordx4 v[148:151], v242, s[24:27], s37 offen sc1
v_pk_mul_f32 v[136:137], v[32:33], v[32:33]
v_pk_mul_f32 v[138:139], v[34:35], v[34:35]
v_pk_mul_f32 v[140:141], v[36:37], v[36:37]
v_pk_mul_f32 v[142:143], v[38:39], v[38:39]
v_pk_fma_f32 v[136:137], v[136:137], v[130:131], v[128:129]
v_pk_fma_f32 v[138:139], v[138:139], v[130:131], v[128:129]
v_pk_fma_f32 v[140:141], v[140:141], v[130:131], v[128:129]
v_pk_fma_f32 v[142:143], v[142:143], v[130:131], v[128:129]
v_pk_mul_f32 v[136:137], v[136:137], v[32:33]
v_pk_mul_f32 v[138:139], v[138:139], v[34:35]
v_pk_mul_f32 v[140:141], v[140:141], v[36:37]
v_pk_mul_f32 v[142:143], v[142:143], v[38:39]
v_exp_f32 v136, v136
v_exp_f32 v137, v137
v_exp_f32 v138, v138
v_exp_f32 v139, v139
v_exp_f32 v140, v140
v_exp_f32 v141, v141
v_exp_f32 v142, v142
v_exp_f32 v143, v143
v_pk_mul_f32 v[32:33], v[32:33], v[40:41]
v_pk_mul_f32 v[34:35], v[34:35], v[42:43]
v_pk_mul_f32 v[36:37], v[36:37], v[44:45]
v_pk_mul_f32 v[38:39], v[38:39], v[46:47]
v_pk_add_f32 v[136:137], v[136:137], v[132:133]
v_pk_add_f32 v[138:139], v[138:139], v[132:133]
v_pk_add_f32 v[140:141], v[140:141], v[132:133]
v_pk_add_f32 v[142:143], v[142:143], v[132:133]
v_rcp_f32 v136, v136
v_rcp_f32 v137, v137
v_rcp_f32 v138, v138
v_rcp_f32 v139, v139
v_rcp_f32 v140, v140
v_rcp_f32 v141, v141
v_rcp_f32 v142, v142
v_rcp_f32 v143, v143
v_pk_mul_f32 v[32:33], v[32:33], v[136:137]
v_pk_mul_f32 v[34:35], v[34:35], v[138:139]
v_pk_mul_f32 v[36:37], v[36:37], v[140:141]
v_pk_mul_f32 v[38:39], v[38:39], v[142:143]
v_cvt_pk_bf16_f32 v152, v32, v33
v_cvt_pk_bf16_f32 v153, v34, v35
v_cvt_pk_bf16_f32 v154, v36, v37
v_cvt_pk_bf16_f32 v155, v38, v39
s_nop 0
v_permlane16_swap_b32 v152, v154
v_permlane16_swap_b32 v153, v155
buffer_store_dwordx4 v[152:155], v221, s[24:27], s38 offen offset:1024 sc1
v_mfma_f32_16x16x32_bf16 v[48:51], a[224:227], a[112:115], 0
ds_read_b64_tr_b16 a[244:245], v230 offset:6208
v_mfma_f32_16x16x32_bf16 v[52:55], a[224:227], a[116:119], 0
s_waitcnt lgkmcnt(7)
ds_read_b64_tr_b16 a[246:247], v230 offset:6976
v_mfma_f32_16x16x32_bf16 v[56:59], a[228:231], a[112:115], 0
ds_read_b64_tr_b16 a[248:249], v230 offset:3072
v_mfma_f32_16x16x32_bf16 v[60:63], a[228:231], a[116:119], 0
s_waitcnt lgkmcnt(7)
ds_read_b64_tr_b16 a[250:251], v230 offset:3840
buffer_load_dwordx4 a[32:35], v246, s[24:27], s87 offen offset:0 sc1
v_mfma_f32_16x16x32_bf16 v[64:67], a[232:235], a[112:115], 0
ds_read_b64_tr_b16 a[252:253], v230 offset:9216
v_mfma_f32_16x16x32_bf16 v[68:71], a[232:235], a[116:119], 0
s_waitcnt lgkmcnt(7)
ds_read_b64_tr_b16 a[254:255], v230 offset:9984
v_mfma_f32_16x16x32_bf16 v[72:75], a[236:239], a[112:115], 0
ds_read_b64_tr_b16 a[224:225], v230 offset:3104
v_mfma_f32_16x16x32_bf16 v[76:79], a[236:239], a[116:119], 0
s_waitcnt lgkmcnt(7)
ds_read_b64_tr_b16 a[226:227], v230 offset:3872
buffer_load_dwordx4 a[36:39], v247, s[24:27], s87 offen offset:0 sc1
v_mfma_f32_16x16x32_bf16 v[80:83], a[240:243], a[112:115], 0
ds_read_b64_tr_b16 a[228:229], v230 offset:9248
v_mfma_f32_16x16x32_bf16 v[84:87], a[240:243], a[116:119], 0
s_waitcnt lgkmcnt(7)
ds_read_b64_tr_b16 a[230:231], v230 offset:10016
v_mfma_f32_16x16x32_bf16 v[88:91], a[244:247], a[112:115], 0
ds_read_b64_tr_b16 a[232:233], v230 offset:3136
v_mfma_f32_16x16x32_bf16 v[92:95], a[244:247], a[116:119], 0
s_waitcnt vmcnt(25) lgkmcnt(7)
ds_read_b64_tr_b16 a[234:235], v230 offset:3904
buffer_load_dwordx4 a[40:43], v246, s[24:27], s87 offen offset:1024 sc1
v_mfma_f32_16x16x32_bf16 v[48:51], a[248:251], a[120:123], v[48:51]
ds_read_b64_tr_b16 a[236:237], v230 offset:9280
v_mfma_f32_16x16x32_bf16 v[52:55], a[248:251], a[124:127], v[52:55]
s_waitcnt lgkmcnt(7)
ds_read_b64_tr_b16 a[238:239], v230 offset:10048
v_mfma_f32_16x16x32_bf16 v[56:59], a[252:255], a[120:123], v[56:59]
ds_read_b64_tr_b16 a[240:241], v230 offset:12288
v_mfma_f32_16x16x32_bf16 v[60:63], a[252:255], a[124:127], v[60:63]
s_waitcnt lgkmcnt(7)
ds_read_b64_tr_b16 a[242:243], v230 offset:13056
buffer_load_dwordx4 a[44:47], v247, s[24:27], s87 offen offset:1024 sc1
v_mfma_f32_16x16x32_bf16 v[64:67], a[224:227], a[120:123], v[64:67]
ds_read_b64_tr_b16 a[244:245], v230 offset:18432
v_mfma_f32_16x16x32_bf16 v[68:71], a[224:227], a[124:127], v[68:71]
s_waitcnt lgkmcnt(7)
ds_read_b64_tr_b16 a[246:247], v230 offset:19200
v_mfma_f32_16x16x32_bf16 v[72:75], a[228:231], a[120:123], v[72:75]
ds_read_b64_tr_b16 a[248:249], v230 offset:12320
v_mfma_f32_16x16x32_bf16 v[76:79], a[228:231], a[124:127], v[76:79]
s_waitcnt lgkmcnt(7)
ds_read_b64_tr_b16 a[250:251], v230 offset:13088
buffer_load_dwordx4 a[48:51], v246, s[24:27], s87 offen offset:2048 sc1
v_mfma_f32_16x16x32_bf16 v[80:83], a[232:235], a[120:123], v[80:83]
ds_read_b64_tr_b16 a[252:253], v230 offset:18464
v_mfma_f32_16x16x32_bf16 v[84:87], a[232:235], a[124:127], v[84:87]
s_waitcnt lgkmcnt(7)
ds_read_b64_tr_b16 a[254:255], v230 offset:19232
v_mfma_f32_16x16x32_bf16 v[88:91], a[236:239], a[120:123], v[88:91]
ds_read_b64_tr_b16 a[224:225], v230 offset:12352
v_mfma_f32_16x16x32_bf16 v[92:95], a[236:239], a[124:127], v[92:95]
s_waitcnt vmcnt(26) lgkmcnt(7)
ds_read_b64_tr_b16 a[226:227], v230 offset:13120
buffer_load_dwordx4 a[52:55], v247, s[24:27], s87 offen offset:2048 sc1
v_mfma_f32_16x16x32_bf16 v[48:51], a[240:243], a[128:131], v[48:51]
ds_read_b64_tr_b16 a[228:229], v230 offset:18496
v_mfma_f32_16x16x32_bf16 v[52:55], a[240:243], a[132:135], v[52:55]
s_waitcnt lgkmcnt(7)
ds_read_b64_tr_b16 a[230:231], v230 offset:19264
v_mfma_f32_16x16x32_bf16 v[56:59], a[244:247], a[128:131], v[56:59]
ds_read_b64_tr_b16 a[232:233], v230 offset:15360
v_mfma_f32_16x16x32_bf16 v[60:63], a[244:247], a[132:135], v[60:63]
s_waitcnt lgkmcnt(7)
ds_read_b64_tr_b16 a[234:235], v230 offset:16128
buffer_load_dwordx4 a[56:59], v246, s[24:27], s87 offen offset:3072 sc1
v_mfma_f32_16x16x32_bf16 v[64:67], a[248:251], a[128:131], v[64:67]
ds_read_b64_tr_b16 a[236:237], v230 offset:21504
v_mfma_f32_16x16x32_bf16 v[68:71], a[248:251], a[132:135], v[68:71]
s_waitcnt lgkmcnt(7)
ds_read_b64_tr_b16 a[238:239], v230 offset:22272
v_mfma_f32_16x16x32_bf16 v[72:75], a[252:255], a[128:131], v[72:75]
ds_read_b64_tr_b16 a[240:241], v230 offset:15392
v_mfma_f32_16x16x32_bf16 v[76:79], a[252:255], a[132:135], v[76:79]
s_waitcnt lgkmcnt(7)
ds_read_b64_tr_b16 a[242:243], v230 offset:16160
buffer_load_dwordx4 a[60:63], v247, s[24:27], s87 offen offset:3072 sc1
v_mfma_f32_16x16x32_bf16 v[80:83], a[224:227], a[128:131], v[80:83]
ds_read_b64_tr_b16 a[244:245], v230 offset:21536
v_mfma_f32_16x16x32_bf16 v[84:87], a[224:227], a[132:135], v[84:87]
s_waitcnt lgkmcnt(7)
ds_read_b64_tr_b16 a[246:247], v230 offset:22304
v_add_u32_e64 v241, s51, 1
v_mfma_f32_16x16x32_bf16 v[88:91], a[228:231], a[128:131], v[88:91]
ds_read_b64_tr_b16 a[248:249], v230 offset:15424
s_waitcnt vmcnt(8)
s_barrier
buffer_store_dword v241, v240, s[24:27], s50 offen sc1
v_mfma_f32_16x16x32_bf16 v[92:95], a[228:231], a[132:135], v[92:95]
s_waitcnt lgkmcnt(7)
ds_read_b64_tr_b16 a[250:251], v230 offset:16192
buffer_load_dwordx4 a[64:67], v246, s[24:27], s88 offen offset:0 sc1
v_mfma_f32_16x16x32_bf16 v[48:51], a[232:235], a[144:147], v[48:51]
ds_read_b64_tr_b16 a[252:253], v230 offset:21568
v_mfma_f32_16x16x32_bf16 v[52:55], a[232:235], a[148:151], v[52:55]
s_waitcnt lgkmcnt(7)
ds_read_b64_tr_b16 a[254:255], v230 offset:22336
v_mfma_f32_16x16x32_bf16 v[56:59], a[236:239], a[144:147], v[56:59]
ds_read_b64_tr_b16 a[224:225], v230 offset:24576
v_mfma_f32_16x16x32_bf16 v[60:63], a[236:239], a[148:151], v[60:63]
s_waitcnt lgkmcnt(7)
ds_read_b64_tr_b16 a[226:227], v230 offset:25344
buffer_load_dwordx4 a[68:71], v247, s[24:27], s88 offen offset:0 sc1
v_mfma_f32_16x16x32_bf16 v[64:67], a[240:243], a[144:147], v[64:67]
ds_read_b64_tr_b16 a[228:229], v230 offset:30720
v_mfma_f32_16x16x32_bf16 v[68:71], a[240:243], a[148:151], v[68:71]
s_waitcnt lgkmcnt(7)
ds_read_b64_tr_b16 a[230:231], v230 offset:31488
v_mfma_f32_16x16x32_bf16 v[72:75], a[244:247], a[144:147], v[72:75]
ds_read_b64_tr_b16 a[232:233], v230 offset:24608
v_mfma_f32_16x16x32_bf16 v[76:79], a[244:247], a[148:151], v[76:79]
s_waitcnt lgkmcnt(7)
ds_read_b64_tr_b16 a[234:235], v230 offset:25376
buffer_load_dwordx4 a[72:75], v246, s[24:27], s88 offen offset:1024 sc1
v_mfma_f32_16x16x32_bf16 v[80:83], a[248:251], a[144:147], v[80:83]
ds_read_b64_tr_b16 a[236:237], v230 offset:30752
v_mfma_f32_16x16x32_bf16 v[84:87], a[248:251], a[148:151], v[84:87]
s_waitcnt lgkmcnt(7)
ds_read_b64_tr_b16 a[238:239], v230 offset:31520
v_mfma_f32_16x16x32_bf16 v[88:91], a[252:255], a[144:147], v[88:91]
ds_read_b64_tr_b16 a[240:241], v230 offset:24640
v_mfma_f32_16x16x32_bf16 v[92:95], a[252:255], a[148:151], v[92:95]
s_waitcnt lgkmcnt(7)
ds_read_b64_tr_b16 a[242:243], v230 offset:25408
buffer_load_dwordx4 a[76:79], v247, s[24:27], s88 offen offset:1024 sc1
v_mfma_f32_16x16x32_bf16 v[48:51], a[224:227], a[160:163], v[48:51]
ds_read_b64_tr_b16 a[244:245], v230 offset:30784
v_mfma_f32_16x16x32_bf16 v[52:55], a[224:227], a[164:167], v[52:55]
s_waitcnt lgkmcnt(7)
ds_read_b64_tr_b16 a[246:247], v230 offset:31552
v_mfma_f32_16x16x32_bf16 v[56:59], a[228:231], a[160:163], v[56:59]
ds_read_b64_tr_b16 a[248:249], v230 offset:27648
v_mfma_f32_16x16x32_bf16 v[60:63], a[228:231], a[164:167], v[60:63]
s_waitcnt lgkmcnt(7)
ds_read_b64_tr_b16 a[250:251], v230 offset:28416
buffer_load_dwordx4 a[80:83], v246, s[24:27], s88 offen offset:2048 sc1
v_mfma_f32_16x16x32_bf16 v[64:67], a[232:235], a[160:163], v[64:67]
ds_read_b64_tr_b16 a[252:253], v230 offset:33792
v_mfma_f32_16x16x32_bf16 v[68:71], a[232:235], a[164:167], v[68:71]
s_waitcnt lgkmcnt(7)
ds_read_b64_tr_b16 a[254:255], v230 offset:34560
v_mfma_f32_16x16x32_bf16 v[72:75], a[236:239], a[160:163], v[72:75]
ds_read_b64_tr_b16 a[224:225], v230 offset:27680
v_mfma_f32_16x16x32_bf16 v[76:79], a[236:239], a[164:167], v[76:79]
s_waitcnt lgkmcnt(7)
ds_read_b64_tr_b16 a[226:227], v230 offset:28448
buffer_load_dwordx4 a[84:87], v247, s[24:27], s88 offen offset:2048 sc1
v_mfma_f32_16x16x32_bf16 v[80:83], a[240:243], a[160:163], v[80:83]
ds_read_b64_tr_b16 a[228:229], v230 offset:33824
v_mfma_f32_16x16x32_bf16 v[84:87], a[240:243], a[164:167], v[84:87]
s_waitcnt lgkmcnt(7)
ds_read_b64_tr_b16 a[230:231], v230 offset:34592
v_mfma_f32_16x16x32_bf16 v[88:91], a[244:247], a[160:163], v[88:91]
ds_read_b64_tr_b16 a[232:233], v230 offset:27712
v_mfma_f32_16x16x32_bf16 v[92:95], a[244:247], a[164:167], v[92:95]
s_waitcnt lgkmcnt(7)
ds_read_b64_tr_b16 a[234:235], v230 offset:28480
buffer_load_dwordx4 a[88:91], v246, s[24:27], s88 offen offset:3072 sc1
v_mfma_f32_16x16x32_bf16 v[48:51], a[248:251], a[176:179], v[48:51]
ds_read_b64_tr_b16 a[236:237], v230 offset:33856
v_mfma_f32_16x16x32_bf16 v[52:55], a[248:251], a[180:183], v[52:55]
s_waitcnt lgkmcnt(7)
ds_read_b64_tr_b16 a[238:239], v230 offset:34624
v_mfma_f32_16x16x32_bf16 v[56:59], a[252:255], a[176:179], v[56:59]
ds_read_b64_tr_b16 a[240:241], v230 offset:36864
v_mfma_f32_16x16x32_bf16 v[60:63], a[252:255], a[180:183], v[60:63]
s_waitcnt lgkmcnt(7)
ds_read_b64_tr_b16 a[242:243], v230 offset:37632
buffer_load_dwordx4 a[92:95], v247, s[24:27], s88 offen offset:3072 sc1
v_mfma_f32_16x16x32_bf16 v[64:67], a[224:227], a[176:179], v[64:67]
s_add_u32 m0, s29, 131072
ds_read_b64_tr_b16 a[244:245], v230 offset:43008
v_mfma_f32_16x16x32_bf16 v[68:71], a[224:227], a[180:183], v[68:71]
s_waitcnt lgkmcnt(7)
ds_read_b64_tr_b16 a[246:247], v230 offset:43776
v_mfma_f32_16x16x32_bf16 v[72:75], a[228:231], a[176:179], v[72:75]
s_add_u32 s30, s4, 163840
ds_read_b64_tr_b16 a[248:249], v230 offset:36896
v_mfma_f32_16x16x32_bf16 v[76:79], a[228:231], a[180:183], v[76:79]
s_waitcnt lgkmcnt(7)
ds_read_b64_tr_b16 a[250:251], v230 offset:37664
buffer_load_dwordx4 v248, s[12:15], s30 offen offset:0 lds
v_mfma_f32_16x16x32_bf16 v[80:83], a[232:235], a[176:179], v[80:83]
ds_read_b64_tr_b16 a[252:253], v230 offset:43040
v_mfma_f32_16x16x32_bf16 v[84:87], a[232:235], a[180:183], v[84:87]
s_waitcnt lgkmcnt(7)
ds_read_b64_tr_b16 a[254:255], v230 offset:43808
v_mfma_f32_16x16x32_bf16 v[88:91], a[236:239], a[176:179], v[88:91]
ds_read_b64_tr_b16 a[224:225], v230 offset:36928
v_mfma_f32_16x16x32_bf16 v[92:95], a[236:239], a[180:183], v[92:95]
s_waitcnt lgkmcnt(7)
ds_read_b64_tr_b16 a[226:227], v230 offset:37696
buffer_load_dwordx4 v249, s[12:15], s30 offen offset:1024 lds
v_mfma_f32_16x16x32_bf16 v[48:51], a[240:243], a[192:195], v[48:51]
s_add_u32 m0, s29, 133120
ds_read_b64_tr_b16 a[228:229], v230 offset:43072
v_mfma_f32_16x16x32_bf16 v[52:55], a[240:243], a[196:199], v[52:55]
s_waitcnt lgkmcnt(7)
ds_read_b64_tr_b16 a[230:231], v230 offset:43840
v_mfma_f32_16x16x32_bf16 v[56:59], a[244:247], a[192:195], v[56:59]
s_add_u32 s30, s4, 184320
ds_read_b64_tr_b16 a[232:233], v230 offset:39936
v_mfma_f32_16x16x32_bf16 v[60:63], a[244:247], a[196:199], v[60:63]
s_waitcnt lgkmcnt(7)
ds_read_b64_tr_b16 a[234:235], v230 offset:40704
buffer_load_dwordx4 v248, s[12:15], s30 offen offset:0 lds
v_mfma_f32_16x16x32_bf16 v[64:67], a[248:251], a[192:195], v[64:67]
ds_read_b64_tr_b16 a[236:237], v230 offset:46080
v_mfma_f32_16x16x32_bf16 v[68:71], a[248:251], a[196:199], v[68:71]
s_waitcnt lgkmcnt(7)
ds_read_b64_tr_b16 a[238:239], v230 offset:46848
v_mfma_f32_16x16x32_bf16 v[72:75], a[252:255], a[192:195], v[72:75]
ds_read_b64_tr_b16 a[240:241], v230 offset:39968
v_mfma_f32_16x16x32_bf16 v[76:79], a[252:255], a[196:199], v[76:79]
s_waitcnt lgkmcnt(7)
ds_read_b64_tr_b16 a[242:243], v230 offset:40736
buffer_load_dwordx4 v249, s[12:15], s30 offen offset:1024 lds
v_mfma_f32_16x16x32_bf16 v[80:83], a[224:227], a[192:195], v[80:83]
s_add_u32 m0, s29, 147456
ds_read_b64_tr_b16 a[244:245], v230 offset:46112
v_mfma_f32_16x16x32_bf16 v[84:87], a[224:227], a[196:199], v[84:87]
s_waitcnt lgkmcnt(7)
ds_read_b64_tr_b16 a[246:247], v230 offset:46880
v_mfma_f32_16x16x32_bf16 v[88:91], a[228:231], a[192:195], v[88:91]
s_add_u32 s30, s4, 327680
ds_read_b64_tr_b16 a[248:249], v230 offset:40000
v_mfma_f32_16x16x32_bf16 v[92:95], a[228:231], a[196:199], v[92:95]
s_waitcnt lgkmcnt(7)
ds_read_b64_tr_b16 a[250:251], v230 offset:40768
buffer_load_dwordx4 v248, s[12:15], s30 offen offset:0 lds
v_mfma_f32_16x16x32_bf16 v[48:51], a[232:235], a[208:211], v[48:51]
ds_read_b64_tr_b16 a[252:253], v230 offset:46144
v_mfma_f32_16x16x32_bf16 v[52:55], a[232:235], a[212:215], v[52:55]
s_waitcnt lgkmcnt(7)
ds_read_b64_tr_b16 a[254:255], v230 offset:46912
v_mfma_f32_16x16x32_bf16 v[56:59], a[236:239], a[208:211], v[56:59]
ds_read_b64_tr_b16 a[224:225], v230 offset:49152
v_mfma_f32_16x16x32_bf16 v[60:63], a[236:239], a[212:215], v[60:63]
s_waitcnt lgkmcnt(7)
ds_read_b64_tr_b16 a[226:227], v230 offset:49920
buffer_load_dwordx4 v249, s[12:15], s30 offen offset:1024 lds
v_mfma_f32_16x16x32_bf16 v[64:67], a[240:243], a[208:211], v[64:67]
s_add_u32 m0, s29, 149504
ds_read_b64_tr_b16 a[228:229], v230 offset:55296
v_mfma_f32_16x16x32_bf16 v[68:71], a[240:243], a[212:215], v[68:71]
s_waitcnt lgkmcnt(7)
ds_read_b64_tr_b16 a[230:231], v230 offset:56064
v_mfma_f32_16x16x32_bf16 v[72:75], a[244:247], a[208:211], v[72:75]
s_add_u32 s30, s4, 348160
ds_read_b64_tr_b16 a[232:233], v230 offset:49184
v_mfma_f32_16x16x32_bf16 v[76:79], a[244:247], a[212:215], v[76:79]
s_waitcnt lgkmcnt(7)
ds_read_b64_tr_b16 a[234:235], v230 offset:49952
buffer_load_dwordx4 v248, s[12:15], s30 offen offset:0 lds
v_mfma_f32_16x16x32_bf16 v[80:83], a[248:251], a[208:211], v[80:83]
ds_read_b64_tr_b16 a[236:237], v230 offset:55328
v_mfma_f32_16x16x32_bf16 v[84:87], a[248:251], a[212:215], v[84:87]
s_waitcnt lgkmcnt(7)
ds_read_b64_tr_b16 a[238:239], v230 offset:56096
v_mfma_f32_16x16x32_bf16 v[88:91], a[252:255], a[208:211], v[88:91]
s_barrier
ds_read_b64_tr_b16 a[240:241], v230 offset:49216
v_mfma_f32_16x16x32_bf16 v[92:95], a[252:255], a[212:215], v[92:95]
s_waitcnt lgkmcnt(7)
ds_read_b64_tr_b16 a[242:243], v230 offset:49984
buffer_load_dwordx4 v249, s[12:15], s30 offen offset:1024 lds
v_mfma_f32_16x16x32_bf16 v[48:51], a[224:227], a[0:3], v[48:51]
s_add_u32 m0, s29, 0
ds_read_b64_tr_b16 a[244:245], v230 offset:55360
v_mfma_f32_16x16x32_bf16 v[52:55], a[224:227], a[4:7], v[52:55]
s_waitcnt lgkmcnt(7)
ds_read_b64_tr_b16 a[246:247], v230 offset:56128
v_mfma_f32_16x16x32_bf16 v[56:59], a[228:231], a[0:3], v[56:59]
s_add_u32 s30, s47, 327680
ds_read_b64_tr_b16 a[248:249], v230 offset:52224
v_mfma_f32_16x16x32_bf16 v[60:63], a[228:231], a[4:7], v[60:63]
s_waitcnt lgkmcnt(7)
ds_read_b64_tr_b16 a[250:251], v230 offset:52992
buffer_load_dwordx4 v248, s[12:15], s30 offen offset:0 lds
v_mfma_f32_16x16x32_bf16 v[64:67], a[232:235], a[0:3], v[64:67]
ds_read_b64_tr_b16 a[252:253], v230 offset:58368
v_mfma_f32_16x16x32_bf16 v[68:71], a[232:235], a[4:7], v[68:71]
s_waitcnt lgkmcnt(7)
ds_read_b64_tr_b16 a[254:255], v230 offset:59136
v_mfma_f32_16x16x32_bf16 v[72:75], a[236:239], a[0:3], v[72:75]
ds_read_b64_tr_b16 a[224:225], v230 offset:52256
v_mfma_f32_16x16x32_bf16 v[76:79], a[236:239], a[4:7], v[76:79]
s_waitcnt lgkmcnt(7)
ds_read_b64_tr_b16 a[226:227], v230 offset:53024
buffer_load_dwordx4 v249, s[12:15], s30 offen offset:1024 lds
v_mfma_f32_16x16x32_bf16 v[80:83], a[240:243], a[0:3], v[80:83]
s_add_u32 m0, s29, 2048
ds_read_b64_tr_b16 a[228:229], v230 offset:58400
v_mfma_f32_16x16x32_bf16 v[84:87], a[240:243], a[4:7], v[84:87]
s_waitcnt lgkmcnt(7)
ds_read_b64_tr_b16 a[230:231], v230 offset:59168
v_mfma_f32_16x16x32_bf16 v[88:91], a[244:247], a[0:3], v[88:91]
s_add_u32 s30, s47, 348160
ds_read_b64_tr_b16 a[232:233], v230 offset:52288
v_mfma_f32_16x16x32_bf16 v[92:95], a[244:247], a[4:7], v[92:95]
s_waitcnt lgkmcnt(7)
ds_read_b64_tr_b16 a[234:235], v230 offset:53056
buffer_load_dwordx4 v248, s[12:15], s30 offen offset:0 lds
v_mfma_f32_16x16x32_bf16 v[48:51], a[248:251], a[8:11], v[48:51]
ds_read_b64_tr_b16 a[236:237], v230 offset:58432
v_mfma_f32_16x16x32_bf16 v[52:55], a[248:251], a[12:15], v[52:55]
s_waitcnt lgkmcnt(7)
ds_read_b64_tr_b16 a[238:239], v230 offset:59200
v_mfma_f32_16x16x32_bf16 v[56:59], a[252:255], a[8:11], v[56:59]
ds_read_b64_tr_b16 a[240:241], v223 offset:0
v_mfma_f32_16x16x32_bf16 v[60:63], a[252:255], a[12:15], v[60:63]
s_waitcnt lgkmcnt(7)
ds_read_b64_tr_b16 a[242:243], v223 offset:768
buffer_load_dwordx4 v249, s[12:15], s30 offen offset:1024 lds
v_mfma_f32_16x16x32_bf16 v[64:67], a[224:227], a[8:11], v[64:67]
s_add_u32 m0, s29, 16384
ds_read_b64_tr_b16 a[244:245], v223 offset:6144
v_mfma_f32_16x16x32_bf16 v[68:71], a[224:227], a[12:15], v[68:71]
s_waitcnt lgkmcnt(7)
ds_read_b64_tr_b16 a[246:247], v223 offset:6912
v_mfma_f32_16x16x32_bf16 v[72:75], a[228:231], a[8:11], v[72:75]
s_add_u32 s30, s48, 0
ds_read_b64_tr_b16 a[248:249], v223 offset:32
v_mfma_f32_16x16x32_bf16 v[76:79], a[228:231], a[12:15], v[76:79]
s_waitcnt lgkmcnt(7)
ds_read_b64_tr_b16 a[250:251], v223 offset:800
buffer_load_dwordx4 v248, s[12:15], s30 offen offset:0 lds
v_mfma_f32_16x16x32_bf16 v[80:83], a[232:235], a[8:11], v[80:83]
ds_read_b64_tr_b16 a[252:253], v223 offset:6176
v_mfma_f32_16x16x32_bf16 v[84:87], a[232:235], a[12:15], v[84:87]
s_waitcnt lgkmcnt(7)
ds_read_b64_tr_b16 a[254:255], v223 offset:6944
v_mfma_f32_16x16x32_bf16 v[88:91], a[236:239], a[8:11], v[88:91]
ds_read_b64_tr_b16 a[224:225], v223 offset:64
v_mfma_f32_16x16x32_bf16 v[92:95], a[236:239], a[12:15], v[92:95]
s_waitcnt lgkmcnt(7)
ds_read_b64_tr_b16 a[226:227], v223 offset:832
buffer_load_dwordx4 v249, s[12:15], s30 offen offset:1024 lds
v_mfma_f32_16x16x32_bf16 v[48:51], a[240:243], a[16:19], v[48:51]
s_add_u32 m0, s29, 18432
ds_read_b64_tr_b16 a[228:229], v223 offset:6208
v_mfma_f32_16x16x32_bf16 v[52:55], a[240:243], a[20:23], v[52:55]
s_waitcnt lgkmcnt(7)
ds_read_b64_tr_b16 a[230:231], v223 offset:6976
v_mfma_f32_16x16x32_bf16 v[56:59], a[244:247], a[16:19], v[56:59]
s_add_u32 s30, s48, 20480
ds_read_b64_tr_b16 a[232:233], v223 offset:3072
v_mfma_f32_16x16x32_bf16 v[60:63], a[244:247], a[20:23], v[60:63]
s_waitcnt lgkmcnt(7)
ds_read_b64_tr_b16 a[234:235], v223 offset:3840
buffer_load_dwordx4 v248, s[12:15], s30 offen offset:0 lds
v_mfma_f32_16x16x32_bf16 v[64:67], a[248:251], a[16:19], v[64:67]
ds_read_b64_tr_b16 a[236:237], v223 offset:9216
v_mfma_f32_16x16x32_bf16 v[68:71], a[248:251], a[20:23], v[68:71]
s_waitcnt lgkmcnt(7)
ds_read_b64_tr_b16 a[238:239], v223 offset:9984
v_mfma_f32_16x16x32_bf16 v[72:75], a[252:255], a[16:19], v[72:75]
ds_read_b64_tr_b16 a[240:241], v223 offset:3104
v_mfma_f32_16x16x32_bf16 v[76:79], a[252:255], a[20:23], v[76:79]
L_pg19:
s_cbranch_execz L_ret_B
s_waitcnt lgkmcnt(7)
ds_read_b64_tr_b16 a[242:243], v223 offset:3872
buffer_load_dwordx4 v249, s[12:15], s30 offen offset:1024 lds
v_mfma_f32_16x16x32_bf16 v[80:83], a[224:227], a[16:19], v[80:83]
s_add_u32 m0, s29, 32768
ds_read_b64_tr_b16 a[244:245], v223 offset:9248
v_mfma_f32_16x16x32_bf16 v[84:87], a[224:227], a[20:23], v[84:87]
s_waitcnt lgkmcnt(7)
ds_read_b64_tr_b16 a[246:247], v223 offset:10016
v_mfma_f32_16x16x32_bf16 v[88:91], a[228:231], a[16:19], v[88:91]
s_add_u32 s30, s48, 163840
ds_read_b64_tr_b16 a[248:249], v223 offset:3136
v_mfma_f32_16x16x32_bf16 v[92:95], a[228:231], a[20:23], v[92:95]
s_waitcnt lgkmcnt(7)
ds_read_b64_tr_b16 a[250:251], v223 offset:3904
buffer_load_dwordx4 v248, s[12:15], s30 offen offset:0 lds
v_mfma_f32_16x16x32_bf16 v[48:51], a[232:235], a[24:27], v[48:51]
ds_read_b64_tr_b16 a[252:253], v223 offset:9280
v_mfma_f32_16x16x32_bf16 v[52:55], a[232:235], a[28:31], v[52:55]
s_waitcnt lgkmcnt(7)
ds_read_b64_tr_b16 a[254:255], v223 offset:10048
v_mfma_f32_16x16x32_bf16 v[56:59], a[236:239], a[24:27], v[56:59]
ds_read_b64_tr_b16 a[224:225], v223 offset:12288
v_mfma_f32_16x16x32_bf16 v[60:63], a[236:239], a[28:31], v[60:63]
s_waitcnt lgkmcnt(7)
ds_read_b64_tr_b16 a[226:227], v223 offset:13056
buffer_load_dword v239, v236, s[24:27], 0 offen sc1
v_mfma_f32_16x16x32_bf16 v[64:67], a[240:243], a[24:27], v[64:67]
ds_read_b64_tr_b16 a[228:229], v223 offset:18432
buffer_load_dwordx4 v249, s[12:15], s30 offen offset:1024 lds
v_mfma_f32_16x16x32_bf16 v[68:71], a[240:243], a[28:31], v[68:71]
s_waitcnt lgkmcnt(7)
ds_read_b64_tr_b16 a[230:231], v223 offset:19200
v_mfma_f32_16x16x32_bf16 v[72:75], a[244:247], a[24:27], v[72:75]
s_add_u32 m0, s29, 34816
ds_read_b64_tr_b16 a[232:233], v223 offset:12320
v_mfma_f32_16x16x32_bf16 v[76:79], a[244:247], a[28:31], v[76:79]
s_waitcnt lgkmcnt(7)
ds_read_b64_tr_b16 a[234:235], v223 offset:13088
v_mfma_f32_16x16x32_bf16 v[80:83], a[248:251], a[24:27], v[80:83]
s_add_u32 s30, s48, 184320
ds_read_b64_tr_b16 a[236:237], v223 offset:18464
v_mfma_f32_16x16x32_bf16 v[84:87], a[248:251], a[28:31], v[84:87]
s_waitcnt lgkmcnt(7)
ds_read_b64_tr_b16 a[238:239], v223 offset:19232
buffer_load_dwordx4 v248, s[12:15], s30 offen offset:0 lds
v_mfma_f32_16x16x32_bf16 v[88:91], a[252:255], a[24:27], v[88:91]
s_barrier
ds_read_b64_tr_b16 a[240:241], v223 offset:12352
v_mfma_f32_16x16x32_bf16 v[92:95], a[252:255], a[28:31], v[92:95]
s_waitcnt vmcnt(35) lgkmcnt(7)
ds_read_b64_tr_b16 a[242:243], v223 offset:13120
v_mfma_f32_16x16x32_bf16 v[48:51], a[224:227], a[32:35], v[48:51]
ds_read_b64_tr_b16 a[244:245], v223 offset:18496
v_mfma_f32_16x16x32_bf16 v[52:55], a[224:227], a[36:39], v[52:55]
s_waitcnt lgkmcnt(7)
ds_read_b64_tr_b16 a[246:247], v223 offset:19264
buffer_load_dwordx4 v249, s[12:15], s30 offen offset:1024 lds
v_mfma_f32_16x16x32_bf16 v[56:59], a[228:231], a[32:35], v[56:59]
s_add_u32 m0, s29, 49152
ds_read_b64_tr_b16 a[248:249], v223 offset:15360
v_mfma_f32_16x16x32_bf16 v[60:63], a[228:231], a[36:39], v[60:63]
s_waitcnt lgkmcnt(7)
ds_read_b64_tr_b16 a[250:251], v223 offset:16128
v_mfma_f32_16x16x32_bf16 v[64:67], a[232:235], a[32:35], v[64:67]
s_add_u32 s30, s48, 327680
ds_read_b64_tr_b16 a[252:253], v223 offset:21504
v_mfma_f32_16x16x32_bf16 v[68:71], a[232:235], a[36:39], v[68:71]
s_waitcnt lgkmcnt(7)
ds_read_b64_tr_b16 a[254:255], v223 offset:22272
buffer_load_dwordx4 v248, s[12:15], s30 offen offset:0 lds
v_mfma_f32_16x16x32_bf16 v[72:75], a[236:239], a[32:35], v[72:75]
ds_read_b64_tr_b16 a[224:225], v223 offset:15392
v_mfma_f32_16x16x32_bf16 v[76:79], a[236:239], a[36:39], v[76:79]
s_waitcnt lgkmcnt(7)
ds_read_b64_tr_b16 a[226:227], v223 offset:16160
v_mfma_f32_16x16x32_bf16 v[80:83], a[240:243], a[32:35], v[80:83]
ds_read_b64_tr_b16 a[228:229], v223 offset:21536
v_mfma_f32_16x16x32_bf16 v[84:87], a[240:243], a[36:39], v[84:87]
s_waitcnt lgkmcnt(7)
ds_read_b64_tr_b16 a[230:231], v223 offset:22304
buffer_load_dwordx4 v249, s[12:15], s30 offen offset:1024 lds
v_mfma_f32_16x16x32_bf16 v[88:91], a[244:247], a[32:35], v[88:91]
s_add_u32 m0, s29, 51200
ds_read_b64_tr_b16 a[232:233], v223 offset:15424
v_mfma_f32_16x16x32_bf16 v[92:95], a[244:247], a[36:39], v[92:95]
s_waitcnt vmcnt(36) lgkmcnt(7)
ds_read_b64_tr_b16 a[234:235], v223 offset:16192
v_mfma_f32_16x16x32_bf16 v[48:51], a[248:251], a[40:43], v[48:51]
s_add_u32 s30, s48, 348160
ds_read_b64_tr_b16 a[236:237], v223 offset:21568
v_mfma_f32_16x16x32_bf16 v[52:55], a[248:251], a[44:47], v[52:55]
s_waitcnt lgkmcnt(7)
ds_read_b64_tr_b16 a[238:239], v223 offset:22336
buffer_load_dwordx4 v248, s[12:15], s30 offen offset:0 lds
v_mfma_f32_16x16x32_bf16 v[56:59], a[252:255], a[40:43], v[56:59]
ds_read_b64_tr_b16 a[240:241], v223 offset:24576
v_mfma_f32_16x16x32_bf16 v[60:63], a[252:255], a[44:47], v[60:63]
s_waitcnt lgkmcnt(7)
ds_read_b64_tr_b16 a[242:243], v223 offset:25344
v_mfma_f32_16x16x32_bf16 v[64:67], a[224:227], a[40:43], v[64:67]
ds_read_b64_tr_b16 a[244:245], v223 offset:30720
v_mfma_f32_16x16x32_bf16 v[68:71], a[224:227], a[44:47], v[68:71]
s_waitcnt lgkmcnt(7)
ds_read_b64_tr_b16 a[246:247], v223 offset:31488
buffer_load_dwordx4 v249, s[12:15], s30 offen offset:1024 lds
v_mfma_f32_16x16x32_bf16 v[72:75], a[228:231], a[40:43], v[72:75]
ds_read_b64_tr_b16 a[248:249], v223 offset:24608
v_mfma_f32_16x16x32_bf16 v[76:79], a[228:231], a[44:47], v[76:79]
s_waitcnt lgkmcnt(7)
ds_read_b64_tr_b16 a[250:251], v223 offset:25376
v_mfma_f32_16x16x32_bf16 v[80:83], a[232:235], a[40:43], v[80:83]
ds_read_b64_tr_b16 a[252:253], v223 offset:30752
v_mfma_f32_16x16x32_bf16 v[84:87], a[232:235], a[44:47], v[84:87]
s_waitcnt lgkmcnt(7)
ds_read_b64_tr_b16 a[254:255], v223 offset:31520
v_mfma_f32_16x16x32_bf16 v[88:91], a[236:239], a[40:43], v[88:91]
ds_read_b64_tr_b16 a[224:225], v223 offset:24640
v_mfma_f32_16x16x32_bf16 v[92:95], a[236:239], a[44:47], v[92:95]
s_waitcnt vmcnt(36) lgkmcnt(7)
ds_read_b64_tr_b16 a[226:227], v223 offset:25408
v_mfma_f32_16x16x32_bf16 v[48:51], a[240:243], a[48:51], v[48:51]
ds_read_b64_tr_b16 a[228:229], v223 offset:30784
v_mfma_f32_16x16x32_bf16 v[52:55], a[240:243], a[52:55], v[52:55]
s_waitcnt lgkmcnt(7)
ds_read_b64_tr_b16 a[230:231], v223 offset:31552
v_mfma_f32_16x16x32_bf16 v[56:59], a[244:247], a[48:51], v[56:59]
ds_read_b64_tr_b16 a[232:233], v223 offset:27648
v_mfma_f32_16x16x32_bf16 v[60:63], a[244:247], a[52:55], v[60:63]
s_waitcnt lgkmcnt(7)
ds_read_b64_tr_b16 a[234:235], v223 offset:28416
v_mfma_f32_16x16x32_bf16 v[64:67], a[248:251], a[48:51], v[64:67]
ds_read_b64_tr_b16 a[236:237], v223 offset:33792
v_mfma_f32_16x16x32_bf16 v[68:71], a[248:251], a[52:55], v[68:71]
s_waitcnt lgkmcnt(7)
ds_read_b64_tr_b16 a[238:239], v223 offset:34560
s_waitcnt vmcnt(7)
v_subrev_u32 v239, s51, v239
v_mfma_f32_16x16x32_bf16 v[72:75], a[252:255], a[48:51], v[72:75]
ds_read_b64_tr_b16 a[240:241], v223 offset:27680
v_mfma_f32_16x16x32_bf16 v[76:79], a[252:255], a[52:55], v[76:79]
s_waitcnt lgkmcnt(7)
ds_read_b64_tr_b16 a[242:243], v223 offset:28448
v_cmp_lt_u32 vcc, 1, v239
v_mfma_f32_16x16x32_bf16 v[80:83], a[224:227], a[48:51], v[80:83]
ds_read_b64_tr_b16 a[244:245], v223 offset:33824
v_mfma_f32_16x16x32_bf16 v[84:87], a[224:227], a[52:55], v[84:87]
s_waitcnt lgkmcnt(7)
ds_read_b64_tr_b16 a[246:247], v223 offset:34592
v_mfma_f32_16x16x32_bf16 v[88:91], a[228:231], a[48:51], v[88:91]
ds_read_b64_tr_b16 a[248:249], v223 offset:27712
s_cbranch_vccnz L_slow_aa
L_back_aa:
v_mfma_f32_16x16x32_bf16 v[92:95], a[228:231], a[52:55], v[92:95]
s_waitcnt lgkmcnt(7)
ds_read_b64_tr_b16 a[250:251], v223 offset:28480
v_mfma_f32_16x16x32_bf16 v[48:51], a[232:235], a[56:59], v[48:51]
s_barrier
ds_read_b64_tr_b16 a[252:253], v223 offset:33856
v_mfma_f32_16x16x32_bf16 v[52:55], a[232:235], a[60:63], v[52:55]
s_waitcnt lgkmcnt(7)
ds_read_b64_tr_b16 a[254:255], v223 offset:34624
v_mfma_f32_16x16x32_bf16 v[56:59], a[236:239], a[56:59], v[56:59]
s_add_u32 m0, s29, 65536
ds_read_b64_tr_b16 a[224:225], v223 offset:36864
v_mfma_f32_16x16x32_bf16 v[60:63], a[236:239], a[60:63], v[60:63]
s_waitcnt lgkmcnt(7)
ds_read_b64_tr_b16 a[226:227], v223 offset:37632
v_mfma_f32_16x16x32_bf16 v[64:67], a[240:243], a[56:59], v[64:67]
s_add_u32 s30, s3, 0
ds_read_b64_tr_b16 a[228:229], v223 offset:43008
v_mfma_f32_16x16x32_bf16 v[68:71], a[240:243], a[60:63], v[68:71]
s_waitcnt lgkmcnt(7)
ds_read_b64_tr_b16 a[230:231], v223 offset:43776
buffer_load_dwordx4 v248, s[12:15], s30 offen offset:0 lds
v_mfma_f32_16x16x32_bf16 v[72:75], a[244:247], a[56:59], v[72:75]
ds_read_b64_tr_b16 a[232:233], v223 offset:36896
v_mfma_f32_16x16x32_bf16 v[76:79], a[244:247], a[60:63], v[76:79]
s_waitcnt lgkmcnt(7)
ds_read_b64_tr_b16 a[234:235], v223 offset:37664
v_mfma_f32_16x16x32_bf16 v[80:83], a[248:251], a[56:59], v[80:83]
ds_read_b64_tr_b16 a[236:237], v223 offset:43040
buffer_load_dwordx4 v249, s[12:15], s30 offen offset:1024 lds
v_mfma_f32_16x16x32_bf16 v[84:87], a[248:251], a[60:63], v[84:87]
s_waitcnt lgkmcnt(7)
ds_read_b64_tr_b16 a[238:239], v223 offset:43808
v_mfma_f32_16x16x32_bf16 v[88:91], a[252:255], a[56:59], v[88:91]
s_barrier
ds_read_b64_tr_b16 a[240:241], v223 offset:36928
v_mfma_f32_16x16x32_bf16 v[92:95], a[252:255], a[60:63], v[92:95]
s_waitcnt lgkmcnt(7)
ds_read_b64_tr_b16 a[242:243], v223 offset:37696
v_mfma_f32_16x16x32_bf16 v[48:51], a[224:227], a[64:67], v[48:51]
s_add_u32 s32, s52, 62914560
ds_read_b64_tr_b16 a[244:245], v223 offset:43072
v_mfma_f32_16x16x32_bf16 v[52:55], a[224:227], a[68:71], v[52:55]
s_waitcnt lgkmcnt(7)
ds_read_b64_tr_b16 a[246:247], v223 offset:43840
buffer_load_dwordx4 a[96:99], v224, s[24:27], s32 offen sc1
v_mfma_f32_16x16x32_bf16 v[56:59], a[228:231], a[64:67], v[56:59]
ds_read_b64_tr_b16 a[248:249], v223 offset:39936
v_mfma_f32_16x16x32_bf16 v[60:63], a[228:231], a[68:71], v[60:63]
s_waitcnt lgkmcnt(7)
ds_read_b64_tr_b16 a[250:251], v223 offset:40704
v_mfma_f32_16x16x32_bf16 v[64:67], a[232:235], a[64:67], v[64:67]
ds_read_b64_tr_b16 a[252:253], v223 offset:46080
buffer_load_dwordx4 a[100:103], v225, s[24:27], s32 offen sc1
v_mfma_f32_16x16x32_bf16 v[68:71], a[232:235], a[68:71], v[68:71]
s_waitcnt lgkmcnt(7)
ds_read_b64_tr_b16 a[254:255], v223 offset:46848
v_mfma_f32_16x16x32_bf16 v[72:75], a[236:239], a[64:67], v[72:75]
ds_read_b64_tr_b16 a[224:225], v223 offset:39968
v_mfma_f32_16x16x32_bf16 v[76:79], a[236:239], a[68:71], v[76:79]
s_waitcnt lgkmcnt(7)
ds_read_b64_tr_b16 a[226:227], v223 offset:40736
buffer_load_dwordx4 a[104:107], v226, s[24:27], s32 offen sc1
v_mfma_f32_16x16x32_bf16 v[80:83], a[240:243], a[64:67], v[80:83]
s_add_u32 s32, s52, 62918656
ds_read_b64_tr_b16 a[228:229], v223 offset:46112
v_mfma_f32_16x16x32_bf16 v[84:87], a[240:243], a[68:71], v[84:87]
s_waitcnt lgkmcnt(7)
ds_read_b64_tr_b16 a[230:231], v223 offset:46880
v_mfma_f32_16x16x32_bf16 v[88:91], a[244:247], a[64:67], v[88:91]
ds_read_b64_tr_b16 a[232:233], v223 offset:40000
buffer_load_dwordx4 a[108:111], v224, s[24:27], s32 offen sc1
v_mfma_f32_16x16x32_bf16 v[92:95], a[244:247], a[68:71], v[92:95]
s_waitcnt lgkmcnt(7)
ds_read_b64_tr_b16 a[234:235], v223 offset:40768
v_mfma_f32_16x16x32_bf16 v[48:51], a[248:251], a[72:75], v[48:51]
ds_read_b64_tr_b16 a[236:237], v223 offset:46144
v_mfma_f32_16x16x32_bf16 v[52:55], a[248:251], a[76:79], v[52:55]
s_waitcnt lgkmcnt(7)
ds_read_b64_tr_b16 a[238:239], v223 offset:46912
buffer_load_dwordx4 a[136:139], v225, s[24:27], s32 offen sc1
v_mfma_f32_16x16x32_bf16 v[56:59], a[252:255], a[72:75], v[56:59]
ds_read_b64_tr_b16 a[240:241], v223 offset:49152
v_mfma_f32_16x16x32_bf16 v[60:63], a[252:255], a[76:79], v[60:63]
s_waitcnt lgkmcnt(7)
ds_read_b64_tr_b16 a[242:243], v223 offset:49920
v_mfma_f32_16x16x32_bf16 v[64:67], a[224:227], a[72:75], v[64:67]
ds_read_b64_tr_b16 a[244:245], v223 offset:55296
buffer_load_dwordx4 a[140:143], v226, s[24:27], s32 offen sc1
v_mfma_f32_16x16x32_bf16 v[68:71], a[224:227], a[76:79], v[68:71]
s_waitcnt lgkmcnt(7)
ds_read_b64_tr_b16 a[246:247], v223 offset:56064
v_mfma_f32_16x16x32_bf16 v[72:75], a[228:231], a[72:75], v[72:75]
s_add_u32 s32, s52, 62922752
ds_read_b64_tr_b16 a[248:249], v223 offset:49184
v_mfma_f32_16x16x32_bf16 v[76:79], a[228:231], a[76:79], v[76:79]
s_waitcnt lgkmcnt(7)
ds_read_b64_tr_b16 a[250:251], v223 offset:49952
buffer_load_dwordx4 a[152:155], v224, s[24:27], s32 offen sc1
v_mfma_f32_16x16x32_bf16 v[80:83], a[232:235], a[72:75], v[80:83]
ds_read_b64_tr_b16 a[252:253], v223 offset:55328
v_mfma_f32_16x16x32_bf16 v[84:87], a[232:235], a[76:79], v[84:87]
s_waitcnt lgkmcnt(7)
ds_read_b64_tr_b16 a[254:255], v223 offset:56096
v_mfma_f32_16x16x32_bf16 v[88:91], a[236:239], a[72:75], v[88:91]
ds_read_b64_tr_b16 a[224:225], v223 offset:49216
buffer_load_dwordx4 a[156:159], v225, s[24:27], s32 offen sc1
v_mfma_f32_16x16x32_bf16 v[92:95], a[236:239], a[76:79], v[92:95]
s_waitcnt lgkmcnt(7)
ds_read_b64_tr_b16 a[226:227], v223 offset:49984
v_mfma_f32_16x16x32_bf16 v[48:51], a[240:243], a[80:83], v[48:51]
ds_read_b64_tr_b16 a[228:229], v223 offset:55360
v_mfma_f32_16x16x32_bf16 v[52:55], a[240:243], a[84:87], v[52:55]
s_waitcnt lgkmcnt(7)
ds_read_b64_tr_b16 a[230:231], v223 offset:56128
buffer_load_dwordx4 a[168:171], v226, s[24:27], s32 offen sc1
v_mfma_f32_16x16x32_bf16 v[56:59], a[244:247], a[80:83], v[56:59]
s_add_u32 m0, s29, 67584
ds_read_b64_tr_b16 a[232:233], v223 offset:52224
v_mfma_f32_16x16x32_bf16 v[60:63], a[244:247], a[84:87], v[60:63]
s_waitcnt lgkmcnt(7)
ds_read_b64_tr_b16 a[234:235], v223 offset:52992
v_mfma_f32_16x16x32_bf16 v[64:67], a[248:251], a[80:83], v[64:67]
s_add_u32 s30, s3, 20480
ds_read_b64_tr_b16 a[236:237], v223 offset:58368
v_mfma_f32_16x16x32_bf16 v[68:71], a[248:251], a[84:87], v[68:71]
s_waitcnt lgkmcnt(7)
ds_read_b64_tr_b16 a[238:239], v223 offset:59136
buffer_load_dwordx4 v248, s[12:15], s30 offen offset:0 lds
v_mfma_f32_16x16x32_bf16 v[72:75], a[252:255], a[80:83], v[72:75]
ds_read_b64_tr_b16 a[240:241], v223 offset:52256
v_mfma_f32_16x16x32_bf16 v[76:79], a[252:255], a[84:87], v[76:79]
s_waitcnt lgkmcnt(7)
ds_read_b64_tr_b16 a[242:243], v223 offset:53024
v_mfma_f32_16x16x32_bf16 v[80:83], a[224:227], a[80:83], v[80:83]
ds_read_b64_tr_b16 a[244:245], v223 offset:58400
buffer_load_dwordx4 v249, s[12:15], s30 offen offset:1024 lds
v_mfma_f32_16x16x32_bf16 v[84:87], a[224:227], a[84:87], v[84:87]
s_waitcnt lgkmcnt(7)
ds_read_b64_tr_b16 a[246:247], v223 offset:59168
v_mfma_f32_16x16x32_bf16 v[88:91], a[228:231], a[80:83], v[88:91]
s_add_u32 m0, s29, 81920
ds_read_b64_tr_b16 a[248:249], v223 offset:52288
v_mfma_f32_16x16x32_bf16 v[92:95], a[228:231], a[84:87], v[92:95]
s_waitcnt lgkmcnt(7)
ds_read_b64_tr_b16 a[250:251], v223 offset:53056
v_mfma_f32_16x16x32_bf16 v[48:51], a[232:235], a[88:91], v[48:51]
s_add_u32 s30, s3, 163840
ds_read_b64_tr_b16 a[252:253], v223 offset:58432
v_mfma_f32_16x16x32_bf16 v[52:55], a[232:235], a[92:95], v[52:55]
s_waitcnt lgkmcnt(7)
ds_read_b64_tr_b16 a[254:255], v223 offset:59200
buffer_load_dwordx4 v248, s[12:15], s30 offen offset:0 lds
v_mfma_f32_16x16x32_bf16 v[56:59], a[236:239], a[88:91], v[56:59]
v_mfma_f32_16x16x32_bf16 v[60:63], a[236:239], a[92:95], v[60:63]
s_waitcnt lgkmcnt(6)
v_mfma_f32_16x16x32_bf16 v[64:67], a[240:243], a[88:91], v[64:67]
buffer_load_dwordx4 v249, s[12:15], s30 offen offset:1024 lds
v_mfma_f32_16x16x32_bf16 v[68:71], a[240:243], a[92:95], v[68:71]
s_waitcnt lgkmcnt(4)
v_mfma_f32_16x16x32_bf16 v[72:75], a[244:247], a[88:91], v[72:75]
v_mfma_f32_16x16x32_bf16 v[76:79], a[244:247], a[92:95], v[76:79]
s_waitcnt lgkmcnt(2)
v_mfma_f32_16x16x32_bf16 v[80:83], a[248:251], a[88:91], v[80:83]
v_mfma_f32_16x16x32_bf16 v[84:87], a[248:251], a[92:95], v[84:87]
s_waitcnt lgkmcnt(0)
v_mfma_f32_16x16x32_bf16 v[88:91], a[252:255], a[88:91], v[88:91]
v_mfma_f32_16x16x32_bf16 v[92:95], a[252:255], a[92:95], v[92:95]
s_barrier
s_add_u32 s37, s80, 147456
s_add_u32 s38, s80, 98304
s_add_u32 s32, s53, 62914560
buffer_load_dwordx4 a[172:175], v224, s[24:27], s32 offen sc1
buffer_load_dwordx4 a[184:187], v225, s[24:27], s32 offen sc1
buffer_load_dwordx4 a[188:191], v226, s[24:27], s32 offen sc1
s_add_u32 s32, s53, 62918656
buffer_load_dwordx4 a[200:203], v224, s[24:27], s32 offen sc1
buffer_load_dwordx4 a[204:207], v225, s[24:27], s32 offen sc1
buffer_load_dwordx4 a[216:219], v226, s[24:27], s32 offen sc1
v_pk_mul_f32 v[136:137], v[48:49], v[48:49]
v_pk_mul_f32 v[138:139], v[50:51], v[50:51]
v_pk_mul_f32 v[140:141], v[64:65], v[64:65]
v_pk_mul_f32 v[142:143], v[66:67], v[66:67]
v_pk_fma_f32 v[136:137], v[136:137], v[130:131], v[128:129]
v_pk_fma_f32 v[138:139], v[138:139], v[130:131], v[128:129]
v_pk_fma_f32 v[140:141], v[140:141], v[130:131], v[128:129]
v_pk_fma_f32 v[142:143], v[142:143], v[130:131], v[128:129]
v_pk_mul_f32 v[136:137], v[136:137], v[48:49]
v_pk_mul_f32 v[138:139], v[138:139], v[50:51]
v_pk_mul_f32 v[140:141], v[140:141], v[64:65]
v_pk_mul_f32 v[142:143], v[142:143], v[66:67]
v_exp_f32 v136, v136
v_exp_f32 v137, v137
v_exp_f32 v138, v138
v_exp_f32 v139, v139
v_exp_f32 v140, v140
v_exp_f32 v141, v141
v_exp_f32 v142, v142
v_exp_f32 v143, v143
v_pk_mul_f32 v[48:49], v[48:49], v[56:57]
v_pk_mul_f32 v[50:51], v[50:51], v[58:59]
v_pk_mul_f32 v[64:65], v[64:65], v[72:73]
v_pk_mul_f32 v[66:67], v[66:67], v[74:75]
v_pk_add_f32 v[136:137], v[136:137], v[132:133]
v_pk_add_f32 v[138:139], v[138:139], v[132:133]
v_pk_add_f32 v[140:141], v[140:141], v[132:133]
v_pk_add_f32 v[142:143], v[142:143], v[132:133]
v_rcp_f32 v136, v136
v_rcp_f32 v137, v137
v_rcp_f32 v138, v138
v_rcp_f32 v139, v139
v_rcp_f32 v140, v140
v_rcp_f32 v141, v141
v_rcp_f32 v142, v142
v_rcp_f32 v143, v143
v_pk_mul_f32 v[48:49], v[48:49], v[136:137]
v_pk_mul_f32 v[50:51], v[50:51], v[138:139]
v_pk_mul_f32 v[64:65], v[64:65], v[140:141]
v_pk_mul_f32 v[66:67], v[66:67], v[142:143]
v_cvt_pk_bf16_f32 v144, v48, v49
v_cvt_pk_bf16_f32 v145, v50, v51
v_cvt_pk_bf16_f32 v146, v64, v65
v_cvt_pk_bf16_f32 v147, v66, v67
s_nop 0
v_permlane16_swap_b32 v144, v146
v_permlane16_swap_b32 v145, v147
buffer_store_dwordx4 v[144:147], v242, s[24:27], s38 offen sc1
s_add_u32 s32, s53, 62922752
buffer_load_dwordx4 a[220:223], v224, s[24:27], s32 offen sc1
buffer_load_dwordx4 a[112:115], v225, s[24:27], s32 offen sc1
buffer_load_dwordx4 a[116:119], v226, s[24:27], s32 offen sc1
v_pk_mul_f32 v[136:137], v[52:53], v[52:53]
v_pk_mul_f32 v[138:139], v[54:55], v[54:55]
v_pk_mul_f32 v[140:141], v[68:69], v[68:69]
v_pk_mul_f32 v[142:143], v[70:71], v[70:71]
v_pk_fma_f32 v[136:137], v[136:137], v[130:131], v[128:129]
v_pk_fma_f32 v[138:139], v[138:139], v[130:131], v[128:129]
v_pk_fma_f32 v[140:141], v[140:141], v[130:131], v[128:129]
v_pk_fma_f32 v[142:143], v[142:143], v[130:131], v[128:129]
v_pk_mul_f32 v[136:137], v[136:137], v[52:53]
v_pk_mul_f32 v[138:139], v[138:139], v[54:55]
v_pk_mul_f32 v[140:141], v[140:141], v[68:69]
v_pk_mul_f32 v[142:143], v[142:143], v[70:71]
v_exp_f32 v136, v136
v_exp_f32 v137, v137
v_exp_f32 v138, v138
v_exp_f32 v139, v139
v_exp_f32 v140, v140
v_exp_f32 v141, v141
v_exp_f32 v142, v142
v_exp_f32 v143, v143
v_pk_mul_f32 v[52:53], v[52:53], v[60:61]
v_pk_mul_f32 v[54:55], v[54:55], v[62:63]
v_pk_mul_f32 v[68:69], v[68:69], v[76:77]
v_pk_mul_f32 v[70:71], v[70:71], v[78:79]
v_pk_add_f32 v[136:137], v[136:137], v[132:133]
v_pk_add_f32 v[138:139], v[138:139], v[132:133]
v_pk_add_f32 v[140:141], v[140:141], v[132:133]
v_pk_add_f32 v[142:143], v[142:143], v[132:133]
v_rcp_f32 v136, v136
v_rcp_f32 v137, v137
v_rcp_f32 v138, v138
v_rcp_f32 v139, v139
v_rcp_f32 v140, v140
v_rcp_f32 v141, v141
v_rcp_f32 v142, v142
v_rcp_f32 v143, v143
v_pk_mul_f32 v[52:53], v[52:53], v[136:137]
v_pk_mul_f32 v[54:55], v[54:55], v[138:139]
v_pk_mul_f32 v[68:69], v[68:69], v[140:141]
v_pk_mul_f32 v[70:71], v[70:71], v[142:143]
v_cvt_pk_bf16_f32 v148, v52, v53
v_cvt_pk_bf16_f32 v149, v54, v55
v_cvt_pk_bf16_f32 v150, v68, v69
v_cvt_pk_bf16_f32 v151, v70, v71
s_nop 0
v_permlane16_swap_b32 v148, v150
v_permlane16_swap_b32 v149, v151
buffer_store_dwordx4 v[148:151], v242, s[24:27], s37 offen sc1
s_add_u32 s32, s54, 62914560
buffer_load_dwordx4 a[120:123], v224, s[24:27], s32 offen sc1
buffer_load_dwordx4 a[124:127], v225, s[24:27], s32 offen sc1
buffer_load_dwordx4 a[128:131], v226, s[24:27], s32 offen sc1
v_pk_mul_f32 v[136:137], v[80:81], v[80:81]
v_pk_mul_f32 v[138:139], v[82:83], v[82:83]
v_pk_mul_f32 v[140:141], v[84:85], v[84:85]
v_pk_mul_f32 v[142:143], v[86:87], v[86:87]
v_pk_fma_f32 v[136:137], v[136:137], v[130:131], v[128:129]
v_pk_fma_f32 v[138:139], v[138:139], v[130:131], v[128:129]
v_pk_fma_f32 v[140:141], v[140:141], v[130:131], v[128:129]
v_pk_fma_f32 v[142:143], v[142:143], v[130:131], v[128:129]
v_pk_mul_f32 v[136:137], v[136:137], v[80:81]
v_pk_mul_f32 v[138:139], v[138:139], v[82:83]
v_pk_mul_f32 v[140:141], v[140:141], v[84:85]
v_pk_mul_f32 v[142:143], v[142:143], v[86:87]
v_exp_f32 v136, v136
v_exp_f32 v137, v137
v_exp_f32 v138, v138
v_exp_f32 v139, v139
v_exp_f32 v140, v140
v_exp_f32 v141, v141
v_exp_f32 v142, v142
v_exp_f32 v143, v143
v_pk_mul_f32 v[80:81], v[80:81], v[88:89]
v_pk_mul_f32 v[82:83], v[82:83], v[90:91]
v_pk_mul_f32 v[84:85], v[84:85], v[92:93]
v_pk_mul_f32 v[86:87], v[86:87], v[94:95]
v_pk_add_f32 v[136:137], v[136:137], v[132:133]
v_pk_add_f32 v[138:139], v[138:139], v[132:133]
v_pk_add_f32 v[140:141], v[140:141], v[132:133]
v_pk_add_f32 v[142:143], v[142:143], v[132:133]
v_rcp_f32 v136, v136
v_rcp_f32 v137, v137
v_rcp_f32 v138, v138
v_rcp_f32 v139, v139
v_rcp_f32 v140, v140
v_rcp_f32 v141, v141
v_rcp_f32 v142, v142
v_rcp_f32 v143, v143
v_pk_mul_f32 v[80:81], v[80:81], v[136:137]
v_pk_mul_f32 v[82:83], v[82:83], v[138:139]
v_pk_mul_f32 v[84:85], v[84:85], v[140:141]
v_pk_mul_f32 v[86:87], v[86:87], v[142:143]
v_cvt_pk_bf16_f32 v152, v80, v81
v_cvt_pk_bf16_f32 v153, v82, v83
v_cvt_pk_bf16_f32 v154, v84, v85
v_cvt_pk_bf16_f32 v155, v86, v87
s_nop 0
v_permlane16_swap_b32 v152, v154
v_permlane16_swap_b32 v153, v155
buffer_store_dwordx4 v[152:155], v221, s[24:27], s38 offen offset:1024 sc1
s_cmp_ge_u32 s78, 22
s_cbranch_scc1 L_idle7
s_waitcnt vmcnt(25)
v_mfma_f32_16x16x32_bf16 v[0:3], v[160:163], a[96:99], 0
s_add_u32 m0, s29, 83968
v_mfma_f32_16x16x32_bf16 v[4:7], v[160:163], a[100:103], 0
s_add_u32 s30, s3, 184320
v_mfma_f32_16x16x32_bf16 v[8:11], v[160:163], a[104:107], 0
buffer_load_dwordx4 v248, s[12:15], s30 offen offset:0 lds
v_mfma_f32_16x16x32_bf16 v[12:15], v[164:167], a[96:99], 0
v_mfma_f32_16x16x32_bf16 v[16:19], v[164:167], a[100:103], 0
v_mfma_f32_16x16x32_bf16 v[20:23], v[164:167], a[104:107], 0
buffer_load_dwordx4 v249, s[12:15], s30 offen offset:1024 lds
v_mfma_f32_16x16x32_bf16 v[24:27], v[168:171], a[96:99], 0
s_add_u32 m0, s29, 98304
v_mfma_f32_16x16x32_bf16 v[28:31], v[168:171], a[100:103], 0
s_add_u32 s30, s3, 327680
v_mfma_f32_16x16x32_bf16 v[32:35], v[168:171], a[104:107], 0
buffer_load_dwordx4 v248, s[12:15], s30 offen offset:0 lds
v_mfma_f32_16x16x32_bf16 v[36:39], v[172:175], a[96:99], 0
ds_read_b64_tr_b16 v[192:193], v210 offset:0
v_mfma_f32_16x16x32_bf16 v[40:43], v[172:175], a[100:103], 0
ds_read_b64_tr_b16 v[194:195], v210 offset:512
v_mfma_f32_16x16x32_bf16 v[44:47], v[172:175], a[104:107], 0
s_waitcnt vmcnt(25)
buffer_load_dwordx4 v249, s[12:15], s30 offen offset:1024 lds
v_mfma_f32_16x16x32_bf16 v[0:3], v[176:179], a[108:111], v[0:3]
s_add_u32 m0, s29, 100352
ds_read_b64_tr_b16 v[196:197], v211 offset:0
v_mfma_f32_16x16x32_bf16 v[4:7], v[176:179], a[136:139], v[4:7]
s_add_u32 s30, s3, 348160
ds_read_b64_tr_b16 v[198:199], v211 offset:512
v_mfma_f32_16x16x32_bf16 v[8:11], v[176:179], a[140:143], v[8:11]
buffer_load_dwordx4 v248, s[12:15], s30 offen offset:0 lds
v_mfma_f32_16x16x32_bf16 v[12:15], v[180:183], a[108:111], v[12:15]
ds_read_b64_tr_b16 v[200:201], v212 offset:0
v_mfma_f32_16x16x32_bf16 v[16:19], v[180:183], a[136:139], v[16:19]
ds_read_b64_tr_b16 v[202:203], v212 offset:512
v_mfma_f32_16x16x32_bf16 v[20:23], v[180:183], a[140:143], v[20:23]
buffer_load_dwordx4 v249, s[12:15], s30 offen offset:1024 lds
v_mfma_f32_16x16x32_bf16 v[24:27], v[184:187], a[108:111], v[24:27]
s_add_u32 s32, s54, 62918656
ds_read_b64_tr_b16 v[204:205], v213 offset:0
v_mfma_f32_16x16x32_bf16 v[28:31], v[184:187], a[136:139], v[28:31]
ds_read_b64_tr_b16 v[206:207], v213 offset:512
v_mfma_f32_16x16x32_bf16 v[32:35], v[184:187], a[140:143], v[32:35]
buffer_load_dwordx4 a[132:135], v224, s[24:27], s32 offen sc1
v_mfma_f32_16x16x32_bf16 v[36:39], v[188:191], a[108:111], v[36:39]
ds_read_b64_tr_b16 v[96:97], v210 offset:16384
v_mfma_f32_16x16x32_bf16 v[40:43], v[188:191], a[136:139], v[40:43]
ds_read_b64_tr_b16 v[98:99], v210 offset:16896
v_mfma_f32_16x16x32_bf16 v[44:47], v[188:191], a[140:143], v[44:47]
s_waitcnt vmcnt(26) lgkmcnt(8)
buffer_load_dwordx4 a[144:147], v225, s[24:27], s32 offen sc1
v_mfma_f32_16x16x32_bf16 v[0:3], v[192:195], a[152:155], v[0:3]
ds_read_b64_tr_b16 v[100:101], v211 offset:16384
v_mfma_f32_16x16x32_bf16 v[4:7], v[192:195], a[156:159], v[4:7]
ds_read_b64_tr_b16 v[102:103], v211 offset:16896
v_mfma_f32_16x16x32_bf16 v[8:11], v[192:195], a[168:171], v[8:11]
s_waitcnt lgkmcnt(8)
buffer_load_dwordx4 a[148:151], v226, s[24:27], s32 offen sc1
v_mfma_f32_16x16x32_bf16 v[12:15], v[196:199], a[152:155], v[12:15]
s_add_u32 m0, s29, 114688
ds_read_b64_tr_b16 v[104:105], v212 offset:16384
v_mfma_f32_16x16x32_bf16 v[16:19], v[196:199], a[156:159], v[16:19]
s_add_u32 s30, s4, 0
ds_read_b64_tr_b16 v[106:107], v212 offset:16896
v_mfma_f32_16x16x32_bf16 v[20:23], v[196:199], a[168:171], v[20:23]
s_waitcnt lgkmcnt(8)
buffer_load_dwordx4 v248, s[12:15], s30 offen offset:0 lds
v_add_u32_e64 v241, s51, 0
v_mfma_f32_16x16x32_bf16 v[24:27], v[200:203], a[152:155], v[24:27]
ds_read_b64_tr_b16 v[108:109], v213 offset:16384
s_waitcnt vmcnt(10)
s_barrier
buffer_store_dword v241, v240, s[24:27], s50 offen sc1
v_mfma_f32_16x16x32_bf16 v[28:31], v[200:203], a[156:159], v[28:31]
ds_read_b64_tr_b16 v[110:111], v213 offset:16896
v_mfma_f32_16x16x32_bf16 v[32:35], v[200:203], a[168:171], v[32:35]
s_waitcnt lgkmcnt(8)
buffer_load_dwordx4 v249, s[12:15], s30 offen offset:1024 lds
v_mfma_f32_16x16x32_bf16 v[36:39], v[204:207], a[152:155], v[36:39]
s_add_u32 m0, s29, 116736
ds_read_b64_tr_b16 v[112:113], v210 offset:32768
v_mfma_f32_16x16x32_bf16 v[40:43], v[204:207], a[156:159], v[40:43]
s_add_u32 s30, s4, 20480
ds_read_b64_tr_b16 v[114:115], v210 offset:33280
v_mfma_f32_16x16x32_bf16 v[44:47], v[204:207], a[168:171], v[44:47]
s_waitcnt lgkmcnt(8)
buffer_load_dwordx4 v248, s[12:15], s30 offen offset:0 lds
v_mfma_f32_16x16x32_bf16 v[0:3], v[96:99], a[172:175], v[0:3]
ds_read_b64_tr_b16 v[116:117], v211 offset:32768
v_mfma_f32_16x16x32_bf16 v[4:7], v[96:99], a[184:187], v[4:7]
ds_read_b64_tr_b16 v[118:119], v211 offset:33280
v_mfma_f32_16x16x32_bf16 v[8:11], v[96:99], a[188:191], v[8:11]
L_pg20:
s_cbranch_execz L_ret_B
s_waitcnt lgkmcnt(8)
buffer_load_dwordx4 v249, s[12:15], s30 offen offset:1024 lds
v_mfma_f32_16x16x32_bf16 v[12:15], v[100:103], a[172:175], v[12:15]
s_add_u32 s32, s54, 62922752
ds_read_b64_tr_b16 v[120:121], v212 offset:32768
v_mfma_f32_16x16x32_bf16 v[16:19], v[100:103], a[184:187], v[16:19]
ds_read_b64_tr_b16 v[122:123], v212 offset:33280
v_mfma_f32_16x16x32_bf16 v[20:23], v[100:103], a[188:191], v[20:23]
s_waitcnt lgkmcnt(8)
buffer_load_dwordx4 a[160:163], v224, s[24:27], s32 offen sc1
v_mfma_f32_16x16x32_bf16 v[24:27], v[104:107], a[172:175], v[24:27]
ds_read_b64_tr_b16 v[124:125], v213 offset:32768
v_mfma_f32_16x16x32_bf16 v[28:31], v[104:107], a[184:187], v[28:31]
ds_read_b64_tr_b16 v[126:127], v213 offset:33280
v_mfma_f32_16x16x32_bf16 v[32:35], v[104:107], a[188:191], v[32:35]
s_waitcnt lgkmcnt(8)
buffer_load_dwordx4 a[164:167], v225, s[24:27], s32 offen sc1
v_mfma_f32_16x16x32_bf16 v[36:39], v[108:111], a[172:175], v[36:39]
ds_read_b64_tr_b16 a[240:241], v210 offset:49152
v_mfma_f32_16x16x32_bf16 v[40:43], v[108:111], a[184:187], v[40:43]
ds_read_b64_tr_b16 a[242:243], v210 offset:49664
v_mfma_f32_16x16x32_bf16 v[44:47], v[108:111], a[188:191], v[44:47]
s_waitcnt lgkmcnt(8)
buffer_load_dwordx4 a[176:179], v226, s[24:27], s32 offen sc1
v_mfma_f32_16x16x32_bf16 v[0:3], v[112:115], a[200:203], v[0:3]
s_add_u32 s32, s55, 62914560
ds_read_b64_tr_b16 a[244:245], v211 offset:49152
v_mfma_f32_16x16x32_bf16 v[4:7], v[112:115], a[204:207], v[4:7]
ds_read_b64_tr_b16 a[246:247], v211 offset:49664
v_mfma_f32_16x16x32_bf16 v[8:11], v[112:115], a[216:219], v[8:11]
s_waitcnt lgkmcnt(8)
buffer_load_dwordx4 a[180:183], v224, s[24:27], s32 offen sc1
v_mfma_f32_16x16x32_bf16 v[12:15], v[116:119], a[200:203], v[12:15]
ds_read_b64_tr_b16 a[248:249], v212 offset:49152
v_mfma_f32_16x16x32_bf16 v[16:19], v[116:119], a[204:207], v[16:19]
ds_read_b64_tr_b16 a[250:251], v212 offset:49664
v_mfma_f32_16x16x32_bf16 v[20:23], v[116:119], a[216:219], v[20:23]
s_waitcnt lgkmcnt(8)
buffer_load_dwordx4 a[192:195], v225, s[24:27], s32 offen sc1
v_mfma_f32_16x16x32_bf16 v[24:27], v[120:123], a[200:203], v[24:27]
ds_read_b64_tr_b16 a[252:253], v213 offset:49152
v_mfma_f32_16x16x32_bf16 v[28:31], v[120:123], a[204:207], v[28:31]
ds_read_b64_tr_b16 a[254:255], v213 offset:49664
v_mfma_f32_16x16x32_bf16 v[32:35], v[120:123], a[216:219], v[32:35]
s_waitcnt lgkmcnt(8)
buffer_load_dwordx4 a[196:199], v226, s[24:27], s32 offen sc1
v_mfma_f32_16x16x32_bf16 v[36:39], v[124:127], a[200:203], v[36:39]
s_add_u32 s32, s55, 62918656
ds_read_b64_tr_b16 a[224:225], v214 offset:0
v_mfma_f32_16x16x32_bf16 v[40:43], v[124:127], a[204:207], v[40:43]
ds_read_b64_tr_b16 a[226:227], v214 offset:512
v_mfma_f32_16x16x32_bf16 v[44:47], v[124:127], a[216:219], v[44:47]
s_waitcnt lgkmcnt(8)
buffer_load_dwordx4 a[208:211], v224, s[24:27], s32 offen sc1
v_mfma_f32_16x16x32_bf16 v[0:3], a[240:243], a[220:223], v[0:3]
ds_read_b64_tr_b16 a[228:229], v215 offset:0
v_mfma_f32_16x16x32_bf16 v[4:7], a[240:243], a[112:115], v[4:7]
ds_read_b64_tr_b16 a[230:231], v215 offset:512
v_mfma_f32_16x16x32_bf16 v[8:11], a[240:243], a[116:119], v[8:11]
s_waitcnt lgkmcnt(8)
buffer_load_dwordx4 a[212:215], v225, s[24:27], s32 offen sc1
v_mfma_f32_16x16x32_bf16 v[12:15], a[244:247], a[220:223], v[12:15]
ds_read_b64_tr_b16 a[232:233], v216 offset:0
v_mfma_f32_16x16x32_bf16 v[16:19], a[244:247], a[112:115], v[16:19]
ds_read_b64_tr_b16 a[234:235], v216 offset:512
v_mfma_f32_16x16x32_bf16 v[20:23], a[244:247], a[116:119], v[20:23]
s_waitcnt lgkmcnt(8)
buffer_load_dwordx4 a[0:3], v226, s[24:27], s32 offen sc1
v_mfma_f32_16x16x32_bf16 v[24:27], a[248:251], a[220:223], v[24:27]
s_add_u32 s32, s55, 62922752
ds_read_b64_tr_b16 a[236:237], v217 offset:0
v_mfma_f32_16x16x32_bf16 v[28:31], a[248:251], a[112:115], v[28:31]
ds_read_b64_tr_b16 a[238:239], v217 offset:512
v_mfma_f32_16x16x32_bf16 v[32:35], a[248:251], a[116:119], v[32:35]
s_waitcnt vmcnt(21) lgkmcnt(8)
buffer_load_dwordx4 a[4:7], v224, s[24:27], s32 offen sc1
v_mfma_f32_16x16x32_bf16 v[36:39], a[252:255], a[220:223], v[36:39]
ds_read_b64_tr_b16 a[240:241], v214 offset:16384
v_mfma_f32_16x16x32_bf16 v[40:43], a[252:255], a[112:115], v[40:43]
ds_read_b64_tr_b16 a[242:243], v214 offset:16896
buffer_load_dword v239, v236, s[24:27], 0 offen sc1
v_mfma_f32_16x16x32_bf16 v[44:47], a[252:255], a[116:119], v[44:47]
s_waitcnt lgkmcnt(8)
buffer_load_dwordx4 a[8:11], v225, s[24:27], s32 offen sc1
v_mfma_f32_16x16x32_bf16 v[0:3], a[224:227], a[120:123], v[0:3]
ds_read_b64_tr_b16 a[244:245], v215 offset:16384
v_mfma_f32_16x16x32_bf16 v[4:7], a[224:227], a[124:127], v[4:7]
ds_read_b64_tr_b16 a[246:247], v215 offset:16896
v_mfma_f32_16x16x32_bf16 v[8:11], a[224:227], a[128:131], v[8:11]
s_waitcnt lgkmcnt(8)
buffer_load_dwordx4 a[12:15], v226, s[24:27], s32 offen sc1
v_mfma_f32_16x16x32_bf16 v[12:15], a[228:231], a[120:123], v[12:15]
ds_read_b64_tr_b16 a[248:249], v216 offset:16384
v_mfma_f32_16x16x32_bf16 v[16:19], a[228:231], a[124:127], v[16:19]
ds_read_b64_tr_b16 a[250:251], v216 offset:16896
v_mfma_f32_16x16x32_bf16 v[20:23], a[228:231], a[128:131], v[20:23]
s_waitcnt lgkmcnt(8)
buffer_load_dwordx4 v[128:131], v250, s[24:27], s91 offen offset:0 sc1
v_mfma_f32_16x16x32_bf16 v[24:27], a[232:235], a[120:123], v[24:27]
ds_read_b64_tr_b16 a[252:253], v217 offset:16384
v_mfma_f32_16x16x32_bf16 v[28:31], a[232:235], a[124:127], v[28:31]
ds_read_b64_tr_b16 a[254:255], v217 offset:16896
v_mfma_f32_16x16x32_bf16 v[32:35], a[232:235], a[128:131], v[32:35]
s_waitcnt vmcnt(22) lgkmcnt(8)
buffer_load_dwordx4 v[140:143], v237, s[24:27], s90 offen offset:0 sc1
v_mfma_f32_16x16x32_bf16 v[36:39], a[236:239], a[120:123], v[36:39]
ds_read_b64_tr_b16 a[224:225], v214 offset:32768
v_mfma_f32_16x16x32_bf16 v[40:43], a[236:239], a[124:127], v[40:43]
ds_read_b64_tr_b16 a[226:227], v214 offset:33280
v_mfma_f32_16x16x32_bf16 v[44:47], a[236:239], a[128:131], v[44:47]
s_waitcnt vmcnt(20) lgkmcnt(8)
buffer_load_dwordx4 v[144:147], v237, s[24:27], s90 offen offset:16 sc1
v_mfma_f32_16x16x32_bf16 v[0:3], a[240:243], a[132:135], v[0:3]
s_add_u32 s91, s91, 40960
ds_read_b64_tr_b16 a[228:229], v215 offset:32768
v_mfma_f32_16x16x32_bf16 v[4:7], a[240:243], a[144:147], v[4:7]
ds_read_b64_tr_b16 a[230:231], v215 offset:33280
v_mfma_f32_16x16x32_bf16 v[8:11], a[240:243], a[148:151], v[8:11]
s_waitcnt lgkmcnt(8)
buffer_load_dwordx4 v[132:135], v250, s[24:27], s91 offen offset:0 sc1
v_mfma_f32_16x16x32_bf16 v[12:15], a[244:247], a[132:135], v[12:15]
ds_read_b64_tr_b16 a[232:233], v216 offset:32768
v_mfma_f32_16x16x32_bf16 v[16:19], a[244:247], a[144:147], v[16:19]
ds_read_b64_tr_b16 a[234:235], v216 offset:33280
v_mfma_f32_16x16x32_bf16 v[20:23], a[244:247], a[148:151], v[20:23]
s_waitcnt lgkmcnt(8)
buffer_load_dwordx4 v[136:139], v251, s[24:27], s41 offen offset:0 sc1
v_mfma_f32_16x16x32_bf16 v[24:27], a[248:251], a[132:135], v[24:27]
ds_read_b64_tr_b16 a[236:237], v217 offset:32768
v_mfma_f32_16x16x32_bf16 v[28:31], a[248:251], a[144:147], v[28:31]
ds_read_b64_tr_b16 a[238:239], v217 offset:33280
v_mfma_f32_16x16x32_bf16 v[32:35], a[248:251], a[148:151], v[32:35]
s_waitcnt vmcnt(18) lgkmcnt(8)
v_mfma_f32_16x16x32_bf16 v[36:39], a[252:255], a[132:135], v[36:39]
ds_read_b64_tr_b16 a[240:241], v214 offset:49152
v_mfma_f32_16x16x32_bf16 v[40:43], a[252:255], a[144:147], v[40:43]
ds_read_b64_tr_b16 a[242:243], v214 offset:49664
v_mfma_f32_16x16x32_bf16 v[44:47], a[252:255], a[148:151], v[44:47]
s_waitcnt vmcnt(15) lgkmcnt(8)
v_mfma_f32_16x16x32_bf16 v[0:3], a[224:227], a[160:163], v[0:3]
ds_read_b64_tr_b16 a[244:245], v215 offset:49152
v_mfma_f32_16x16x32_bf16 v[4:7], a[224:227], a[164:167], v[4:7]
ds_read_b64_tr_b16 a[246:247], v215 offset:49664
v_mfma_f32_16x16x32_bf16 v[8:11], a[224:227], a[176:179], v[8:11]
s_waitcnt lgkmcnt(8)
v_mfma_f32_16x16x32_bf16 v[12:15], a[228:231], a[160:163], v[12:15]
ds_read_b64_tr_b16 a[248:249], v216 offset:49152
v_mfma_f32_16x16x32_bf16 v[16:19], a[228:231], a[164:167], v[16:19]
ds_read_b64_tr_b16 a[250:251], v216 offset:49664
v_mfma_f32_16x16x32_bf16 v[20:23], a[228:231], a[176:179], v[20:23]
s_waitcnt lgkmcnt(8)
v_mfma_f32_16x16x32_bf16 v[24:27], a[232:235], a[160:163], v[24:27]
ds_read_b64_tr_b16 a[252:253], v217 offset:49152
v_mfma_f32_16x16x32_bf16 v[28:31], a[232:235], a[164:167], v[28:31]
ds_read_b64_tr_b16 a[254:255], v217 offset:49664
v_mfma_f32_16x16x32_bf16 v[32:35], a[232:235], a[176:179], v[32:35]
s_waitcnt lgkmcnt(8)
s_waitcnt vmcnt(7)
v_cmp_ne_u32 vcc, s51, v239
v_mfma_f32_16x16x32_bf16 v[36:39], a[236:239], a[160:163], v[36:39]
ds_read_b64_tr_b16 a[224:225], v218 offset:0
v_mfma_f32_16x16x32_bf16 v[40:43], a[236:239], a[164:167], v[40:43]
ds_read_b64_tr_b16 a[226:227], v218 offset:512
v_mfma_f32_16x16x32_bf16 v[44:47], a[236:239], a[176:179], v[44:47]
s_waitcnt lgkmcnt(8)
s_cbranch_vccnz L_slow_ab
L_back_ab:
v_mfma_f32_16x16x32_bf16 v[0:3], a[240:243], a[180:183], v[0:3]
s_barrier
ds_read_b64_tr_b16 a[228:229], v219 offset:0
v_mfma_f32_16x16x32_bf16 v[4:7], a[240:243], a[192:195], v[4:7]
s_add_u32 s32, s52, 63012864
ds_read_b64_tr_b16 a[230:231], v219 offset:512
v_mfma_f32_16x16x32_bf16 v[8:11], a[240:243], a[196:199], v[8:11]
s_waitcnt lgkmcnt(8)
buffer_load_dwordx4 a[16:19], v224, s[24:27], s32 offen sc1
v_mfma_f32_16x16x32_bf16 v[12:15], a[244:247], a[180:183], v[12:15]
ds_read_b64_tr_b16 a[232:233], v227 offset:0
v_mfma_f32_16x16x32_bf16 v[16:19], a[244:247], a[192:195], v[16:19]
ds_read_b64_tr_b16 a[234:235], v227 offset:512
v_mfma_f32_16x16x32_bf16 v[20:23], a[244:247], a[196:199], v[20:23]
s_waitcnt lgkmcnt(8)
buffer_load_dwordx4 a[20:23], v225, s[24:27], s32 offen sc1
v_mfma_f32_16x16x32_bf16 v[24:27], a[248:251], a[180:183], v[24:27]
ds_read_b64_tr_b16 a[236:237], v228 offset:0
v_mfma_f32_16x16x32_bf16 v[28:31], a[248:251], a[192:195], v[28:31]
ds_read_b64_tr_b16 a[238:239], v228 offset:512
v_mfma_f32_16x16x32_bf16 v[32:35], a[248:251], a[196:199], v[32:35]
s_waitcnt lgkmcnt(8)
buffer_load_dwordx4 a[24:27], v226, s[24:27], s32 offen sc1
v_mfma_f32_16x16x32_bf16 v[36:39], a[252:255], a[180:183], v[36:39]
s_add_u32 s32, s52, 63016960
ds_read_b64_tr_b16 a[240:241], v218 offset:16384
v_mfma_f32_16x16x32_bf16 v[40:43], a[252:255], a[192:195], v[40:43]
ds_read_b64_tr_b16 a[242:243], v218 offset:16896
v_mfma_f32_16x16x32_bf16 v[44:47], a[252:255], a[196:199], v[44:47]
s_waitcnt lgkmcnt(8)
buffer_load_dwordx4 a[28:31], v224, s[24:27], s32 offen sc1
v_mfma_f32_16x16x32_bf16 v[0:3], a[224:227], a[208:211], v[0:3]
ds_read_b64_tr_b16 a[244:245], v219 offset:16384
v_mfma_f32_16x16x32_bf16 v[4:7], a[224:227], a[212:215], v[4:7]
ds_read_b64_tr_b16 a[246:247], v219 offset:16896
v_mfma_f32_16x16x32_bf16 v[8:11], a[224:227], a[0:3], v[8:11]
s_waitcnt lgkmcnt(8)
buffer_load_dwordx4 a[32:35], v225, s[24:27], s32 offen sc1
v_mfma_f32_16x16x32_bf16 v[12:15], a[228:231], a[208:211], v[12:15]
ds_read_b64_tr_b16 a[248:249], v227 offset:16384
v_mfma_f32_16x16x32_bf16 v[16:19], a[228:231], a[212:215], v[16:19]
ds_read_b64_tr_b16 a[250:251], v227 offset:16896
v_mfma_f32_16x16x32_bf16 v[20:23], a[228:231], a[0:3], v[20:23]
s_waitcnt lgkmcnt(8)
buffer_load_dwordx4 a[36:39], v226, s[24:27], s32 offen sc1
v_mfma_f32_16x16x32_bf16 v[24:27], a[232:235], a[208:211], v[24:27]
s_add_u32 s32, s54, 63012864
ds_read_b64_tr_b16 a[252:253], v228 offset:16384
v_mfma_f32_16x16x32_bf16 v[28:31], a[232:235], a[212:215], v[28:31]
ds_read_b64_tr_b16 a[254:255], v228 offset:16896
v_mfma_f32_16x16x32_bf16 v[32:35], a[232:235], a[0:3], v[32:35]
s_waitcnt lgkmcnt(8)
buffer_load_dwordx4 a[88:91], v224, s[24:27], s32 offen sc1
v_mfma_f32_16x16x32_bf16 v[36:39], a[236:239], a[208:211], v[36:39]
v_mfma_f32_16x16x32_bf16 v[40:43], a[236:239], a[212:215], v[40:43]
v_mfma_f32_16x16x32_bf16 v[44:47], a[236:239], a[0:3], v[44:47]
s_waitcnt vmcnt(12) lgkmcnt(6)
buffer_load_dwordx4 a[92:95], v225, s[24:27], s32 offen sc1
v_mfma_f32_16x16x32_bf16 v[0:3], a[240:243], a[4:7], v[0:3]
v_mfma_f32_16x16x32_bf16 v[4:7], a[240:243], a[8:11], v[4:7]
v_mfma_f32_16x16x32_bf16 v[8:11], a[240:243], a[12:15], v[8:11]
s_waitcnt lgkmcnt(4)
buffer_load_dwordx4 a[96:99], v226, s[24:27], s32 offen sc1
v_mfma_f32_16x16x32_bf16 v[12:15], a[244:247], a[4:7], v[12:15]
s_add_u32 s32, s54, 63016960
v_mfma_f32_16x16x32_bf16 v[16:19], a[244:247], a[8:11], v[16:19]
v_mfma_f32_16x16x32_bf16 v[20:23], a[244:247], a[12:15], v[20:23]
s_waitcnt lgkmcnt(2)
buffer_load_dwordx4 a[100:103], v224, s[24:27], s32 offen sc1
v_mfma_f32_16x16x32_bf16 v[24:27], a[248:251], a[4:7], v[24:27]
v_mfma_f32_16x16x32_bf16 v[28:31], a[248:251], a[8:11], v[28:31]
v_mfma_f32_16x16x32_bf16 v[32:35], a[248:251], a[12:15], v[32:35]
s_waitcnt lgkmcnt(0)
buffer_load_dwordx4 a[104:107], v225, s[24:27], s32 offen sc1
v_mfma_f32_16x16x32_bf16 v[36:39], a[252:255], a[4:7], v[36:39]
v_mfma_f32_16x16x32_bf16 v[40:43], a[252:255], a[8:11], v[40:43]
v_mfma_f32_16x16x32_bf16 v[44:47], a[252:255], a[12:15], v[44:47]
buffer_load_dwordx4 a[108:111], v226, s[24:27], s32 offen sc1
s_waitcnt vmcnt(16)
v_lshlrev_b32 v64, 16, v128
v_and_b32 v65, 0xffff0000, v128
v_lshlrev_b32 v66, 16, v129
v_and_b32 v67, 0xffff0000, v129
v_lshlrev_b32 v68, 16, v130
v_and_b32 v69, 0xffff0000, v130
v_lshlrev_b32 v70, 16, v131
v_and_b32 v71, 0xffff0000, v131
ds_write_b128 v229, v[12:15] offset:0
ds_write_b128 v229, v[16:19] offset:1024
ds_write_b128 v229, v[20:23] offset:2048
ds_write_b128 v229, v[24:27] offset:16384
ds_write_b128 v229, v[28:31] offset:17408
ds_write_b128 v229, v[32:35] offset:18432
ds_write_b128 v229, v[36:39] offset:32768
ds_write_b128 v229, v[40:43] offset:33792
ds_write_b128 v229, v[44:47] offset:34816
s_add_u32 s32, s52, 63021056
buffer_load_dwordx4 a[40:43], v224, s[24:27], s32 offen sc1
buffer_load_dwordx4 a[44:47], v225, s[24:27], s32 offen sc1
buffer_load_dwordx4 a[48:51], v226, s[24:27], s32 offen sc1
s_add_u32 s32, s53, 63012864
buffer_load_dwordx4 a[52:55], v224, s[24:27], s32 offen sc1
buffer_load_dwordx4 a[56:59], v225, s[24:27], s32 offen sc1
buffer_load_dwordx4 a[60:63], v226, s[24:27], s32 offen sc1
s_waitcnt lgkmcnt(0)
s_barrier
ds_read_b128 v[12:15], v231 offset:0
ds_read_b128 v[24:27], v232 offset:16384
ds_read_b128 v[36:39], v233 offset:32768
ds_read_b128 v[16:19], v231 offset:1024
ds_read_b128 v[28:31], v232 offset:17408
ds_read_b128 v[40:43], v233 offset:33792
ds_read_b128 v[20:23], v231 offset:2048
ds_read_b128 v[32:35], v232 offset:18432
ds_read_b128 v[44:47], v233 offset:34816
s_add_u32 s32, s53, 63016960
buffer_load_dwordx4 a[64:67], v224, s[24:27], s32 offen sc1
buffer_load_dwordx4 a[68:71], v225, s[24:27], s32 offen sc1
buffer_load_dwordx4 a[72:75], v226, s[24:27], s32 offen sc1
s_add_u32 s32, s53, 63021056
buffer_load_dwordx4 a[76:79], v224, s[24:27], s32 offen sc1
buffer_load_dwordx4 a[80:83], v225, s[24:27], s32 offen sc1
buffer_load_dwordx4 a[84:87], v226, s[24:27], s32 offen sc1
v_add_u32 v229, 49152, v229
v_add_u32 v231, 49152, v231
v_add_u32 v232, 49152, v232
v_add_u32 v233, 49152, v233
s_waitcnt lgkmcnt(8)
v_pk_add_f32 v[0:1], v[0:1], v[12:13]
v_pk_add_f32 v[2:3], v[2:3], v[14:15]
s_waitcnt lgkmcnt(6)
v_pk_add_f32 v[24:25], v[24:25], v[36:37]
v_pk_add_f32 v[26:27], v[26:27], v[38:39]
v_pk_add_f32 v[0:1], v[0:1], v[24:25]
v_pk_add_f32 v[2:3], v[2:3], v[26:27]
s_waitcnt lgkmcnt(5)
v_pk_add_f32 v[4:5], v[4:5], v[16:17]
v_pk_add_f32 v[6:7], v[6:7], v[18:19]
s_waitcnt lgkmcnt(3)
v_pk_add_f32 v[28:29], v[28:29], v[40:41]
v_pk_add_f32 v[30:31], v[30:31], v[42:43]
v_pk_add_f32 v[4:5], v[4:5], v[28:29]
v_pk_add_f32 v[6:7], v[6:7], v[30:31]
s_nop 0
v_permlane16_swap_b32 v0, v4
v_permlane16_swap_b32 v1, v5
v_permlane16_swap_b32 v2, v6
v_permlane16_swap_b32 v3, v7
s_waitcnt vmcnt(27)
v_pk_fma_f32 v[64:65], v[140:141], v[0:1], v[64:65]
v_pk_fma_f32 v[66:67], v[142:143], v[2:3], v[66:67]
s_waitcnt vmcnt(26)
v_pk_fma_f32 v[68:69], v[144:145], v[4:5], v[68:69]
v_pk_fma_f32 v[70:71], v[146:147], v[6:7], v[70:71]
v_cvt_pk_bf16_f32 v64, v64, v65
v_cvt_pk_bf16_f32 v65, v66, v67
v_cvt_pk_bf16_f32 v66, v68, v69
v_cvt_pk_bf16_f32 v67, v70, v71
buffer_store_dwordx4 v[64:67], v234, s[16:19], s92 offen
s_waitcnt lgkmcnt(2)
v_pk_add_f32 v[8:9], v[8:9], v[20:21]
v_pk_add_f32 v[10:11], v[10:11], v[22:23]
s_waitcnt lgkmcnt(0)
v_pk_add_f32 v[32:33], v[32:33], v[44:45]
v_pk_add_f32 v[34:35], v[34:35], v[46:47]
v_pk_add_f32 v[8:9], v[8:9], v[32:33]
v_pk_add_f32 v[10:11], v[10:11], v[34:35]
s_add_u32 s92, s92, 40960
s_waitcnt vmcnt(22)
v_mfma_f32_16x16x32_bf16 v[48:51], v[160:163], a[16:19], 0
s_add_u32 s32, s54, 63021056
v_mfma_f32_16x16x32_bf16 v[52:55], v[160:163], a[20:23], 0
v_mfma_f32_16x16x32_bf16 v[56:59], v[160:163], a[24:27], 0
buffer_load_dwordx4 a[136:139], v224, s[24:27], s32 offen sc1
v_mfma_f32_16x16x32_bf16 v[12:15], v[164:167], a[16:19], 0
v_mfma_f32_16x16x32_bf16 v[16:19], v[164:167], a[20:23], 0
v_mfma_f32_16x16x32_bf16 v[20:23], v[164:167], a[24:27], 0
buffer_load_dwordx4 a[140:143], v225, s[24:27], s32 offen sc1
v_mfma_f32_16x16x32_bf16 v[24:27], v[168:171], a[16:19], 0
v_mfma_f32_16x16x32_bf16 v[28:31], v[168:171], a[20:23], 0
v_mfma_f32_16x16x32_bf16 v[32:35], v[168:171], a[24:27], 0
buffer_load_dwordx4 a[152:155], v226, s[24:27], s32 offen sc1
v_mfma_f32_16x16x32_bf16 v[36:39], v[172:175], a[16:19], 0
s_add_u32 s32, s55, 63012864
v_mfma_f32_16x16x32_bf16 v[40:43], v[172:175], a[20:23], 0
v_mfma_f32_16x16x32_bf16 v[44:47], v[172:175], a[24:27], 0
s_waitcnt vmcnt(22)
buffer_load_dwordx4 a[156:159], v224, s[24:27], s32 offen sc1
v_mfma_f32_16x16x32_bf16 v[48:51], v[176:179], a[28:31], v[48:51]
v_mfma_f32_16x16x32_bf16 v[52:55], v[176:179], a[32:35], v[52:55]
v_mfma_f32_16x16x32_bf16 v[56:59], v[176:179], a[36:39], v[56:59]
buffer_load_dwordx4 a[168:171], v225, s[24:27], s32 offen sc1
v_mfma_f32_16x16x32_bf16 v[12:15], v[180:183], a[28:31], v[12:15]
v_mfma_f32_16x16x32_bf16 v[16:19], v[180:183], a[32:35], v[16:19]
v_mfma_f32_16x16x32_bf16 v[20:23], v[180:183], a[36:39], v[20:23]
buffer_load_dwordx4 a[172:175], v226, s[24:27], s32 offen sc1
v_mfma_f32_16x16x32_bf16 v[24:27], v[184:187], a[28:31], v[24:27]
s_add_u32 s32, s55, 63016960
v_mfma_f32_16x16x32_bf16 v[28:31], v[184:187], a[32:35], v[28:31]
v_mfma_f32_16x16x32_bf16 v[32:35], v[184:187], a[36:39], v[32:35]
buffer_load_dwordx4 a[184:187], v224, s[24:27], s32 offen sc1
v_mfma_f32_16x16x32_bf16 v[36:39], v[188:191], a[28:31], v[36:39]
v_mfma_f32_16x16x32_bf16 v[40:43], v[188:191], a[32:35], v[40:43]
v_mfma_f32_16x16x32_bf16 v[44:47], v[188:191], a[36:39], v[44:47]
s_waitcnt vmcnt(17)
buffer_load_dwordx4 a[188:191], v225, s[24:27], s32 offen sc1
v_mfma_f32_16x16x32_bf16 v[48:51], v[192:195], a[40:43], v[48:51]
v_mfma_f32_16x16x32_bf16 v[52:55], v[192:195], a[44:47], v[52:55]
v_mfma_f32_16x16x32_bf16 v[56:59], v[192:195], a[48:51], v[56:59]
buffer_load_dwordx4 a[200:203], v226, s[24:27], s32 offen sc1
v_mfma_f32_16x16x32_bf16 v[12:15], v[196:199], a[40:43], v[12:15]
s_add_u32 s32, s55, 63021056
v_mfma_f32_16x16x32_bf16 v[16:19], v[196:199], a[44:47], v[16:19]
v_mfma_f32_16x16x32_bf16 v[20:23], v[196:199], a[48:51], v[20:23]
buffer_load_dwordx4 a[204:207], v224, s[24:27], s32 offen sc1
v_mfma_f32_16x16x32_bf16 v[24:27], v[200:203], a[40:43], v[24:27]
v_mfma_f32_16x16x32_bf16 v[28:31], v[200:203], a[44:47], v[28:31]
v_mfma_f32_16x16x32_bf16 v[32:35], v[200:203], a[48:51], v[32:35]
buffer_load_dwordx4 a[216:219], v225, s[24:27], s32 offen sc1
v_mfma_f32_16x16x32_bf16 v[36:39], v[204:207], a[40:43], v[36:39]
v_mfma_f32_16x16x32_bf16 v[40:43], v[204:207], a[44:47], v[40:43]
v_mfma_f32_16x16x32_bf16 v[44:47], v[204:207], a[48:51], v[44:47]
s_waitcnt vmcnt(18)
buffer_load_dwordx4 a[112:115], v226, s[24:27], s32 offen sc1
v_mfma_f32_16x16x32_bf16 v[48:51], v[96:99], a[52:55], v[48:51]
v_mfma_f32_16x16x32_bf16 v[52:55], v[96:99], a[56:59], v[52:55]
v_mfma_f32_16x16x32_bf16 v[56:59], v[96:99], a[60:63], v[56:59]
v_mfma_f32_16x16x32_bf16 v[12:15], v[100:103], a[52:55], v[12:15]
v_mfma_f32_16x16x32_bf16 v[16:19], v[100:103], a[56:59], v[16:19]
v_mfma_f32_16x16x32_bf16 v[20:23], v[100:103], a[60:63], v[20:23]
v_mfma_f32_16x16x32_bf16 v[24:27], v[104:107], a[52:55], v[24:27]
v_mfma_f32_16x16x32_bf16 v[28:31], v[104:107], a[56:59], v[28:31]
v_mfma_f32_16x16x32_bf16 v[32:35], v[104:107], a[60:63], v[32:35]
v_mfma_f32_16x16x32_bf16 v[36:39], v[108:111], a[52:55], v[36:39]
ds_read_b64_tr_b16 a[240:241], v210 offset:49152
v_mfma_f32_16x16x32_bf16 v[40:43], v[108:111], a[56:59], v[40:43]
ds_read_b64_tr_b16 a[242:243], v210 offset:49664
v_mfma_f32_16x16x32_bf16 v[44:47], v[108:111], a[60:63], v[44:47]
s_waitcnt vmcnt(16)
v_mfma_f32_16x16x32_bf16 v[48:51], v[112:115], a[64:67], v[48:51]
ds_read_b64_tr_b16 a[244:245], v211 offset:49152
v_mfma_f32_16x16x32_bf16 v[52:55], v[112:115], a[68:71], v[52:55]
ds_read_b64_tr_b16 a[246:247], v211 offset:49664
v_mfma_f32_16x16x32_bf16 v[56:59], v[112:115], a[72:75], v[56:59]
v_mfma_f32_16x16x32_bf16 v[12:15], v[116:119], a[64:67], v[12:15]
ds_read_b64_tr_b16 a[248:249], v212 offset:49152
v_mfma_f32_16x16x32_bf16 v[16:19], v[116:119], a[68:71], v[16:19]
ds_read_b64_tr_b16 a[250:251], v212 offset:49664
v_mfma_f32_16x16x32_bf16 v[20:23], v[116:119], a[72:75], v[20:23]
v_mfma_f32_16x16x32_bf16 v[24:27], v[120:123], a[64:67], v[24:27]
ds_read_b64_tr_b16 a[252:253], v213 offset:49152
v_mfma_f32_16x16x32_bf16 v[28:31], v[120:123], a[68:71], v[28:31]
ds_read_b64_tr_b16 a[254:255], v213 offset:49664
v_mfma_f32_16x16x32_bf16 v[32:35], v[120:123], a[72:75], v[32:35]
v_mfma_f32_16x16x32_bf16 v[36:39], v[124:127], a[64:67], v[36:39]
ds_read_b64_tr_b16 a[224:225], v214 offset:0
v_mfma_f32_16x16x32_bf16 v[40:43], v[124:127], a[68:71], v[40:43]
ds_read_b64_tr_b16 a[226:227], v214 offset:512
v_mfma_f32_16x16x32_bf16 v[44:47], v[124:127], a[72:75], v[44:47]
s_waitcnt vmcnt(13) lgkmcnt(8)
v_mfma_f32_16x16x32_bf16 v[48:51], a[240:243], a[76:79], v[48:51]
ds_read_b64_tr_b16 a[228:229], v215 offset:0
v_mfma_f32_16x16x32_bf16 v[52:55], a[240:243], a[80:83], v[52:55]
ds_read_b64_tr_b16 a[230:231], v215 offset:512
v_mfma_f32_16x16x32_bf16 v[56:59], a[240:243], a[84:87], v[56:59]
s_waitcnt lgkmcnt(8)
v_mfma_f32_16x16x32_bf16 v[12:15], a[244:247], a[76:79], v[12:15]
ds_read_b64_tr_b16 a[232:233], v216 offset:0
v_mfma_f32_16x16x32_bf16 v[16:19], a[244:247], a[80:83], v[16:19]
ds_read_b64_tr_b16 a[234:235], v216 offset:512
v_mfma_f32_16x16x32_bf16 v[20:23], a[244:247], a[84:87], v[20:23]
s_waitcnt lgkmcnt(8)
v_mfma_f32_16x16x32_bf16 v[24:27], a[248:251], a[76:79], v[24:27]
ds_read_b64_tr_b16 a[236:237], v217 offset:0
v_mfma_f32_16x16x32_bf16 v[28:31], a[248:251], a[80:83], v[28:31]
ds_read_b64_tr_b16 a[238:239], v217 offset:512
v_mfma_f32_16x16x32_bf16 v[32:35], a[248:251], a[84:87], v[32:35]
s_waitcnt lgkmcnt(8)
v_mfma_f32_16x16x32_bf16 v[36:39], a[252:255], a[76:79], v[36:39]
ds_read_b64_tr_b16 a[240:241], v214 offset:16384
v_mfma_f32_16x16x32_bf16 v[40:43], a[252:255], a[80:83], v[40:43]
ds_read_b64_tr_b16 a[242:243], v214 offset:16896
v_mfma_f32_16x16x32_bf16 v[44:47], a[252:255], a[84:87], v[44:47]
s_waitcnt lgkmcnt(8)
v_mfma_f32_16x16x32_bf16 v[48:51], a[224:227], a[88:91], v[48:51]
ds_read_b64_tr_b16 a[244:245], v215 offset:16384
v_mfma_f32_16x16x32_bf16 v[52:55], a[224:227], a[92:95], v[52:55]
ds_read_b64_tr_b16 a[246:247], v215 offset:16896
v_mfma_f32_16x16x32_bf16 v[56:59], a[224:227], a[96:99], v[56:59]
s_waitcnt lgkmcnt(8)
v_mfma_f32_16x16x32_bf16 v[12:15], a[228:231], a[88:91], v[12:15]
ds_read_b64_tr_b16 a[248:249], v216 offset:16384
v_mfma_f32_16x16x32_bf16 v[16:19], a[228:231], a[92:95], v[16:19]
ds_read_b64_tr_b16 a[250:251], v216 offset:16896
v_mfma_f32_16x16x32_bf16 v[20:23], a[228:231], a[96:99], v[20:23]
s_waitcnt lgkmcnt(8)
v_mfma_f32_16x16x32_bf16 v[24:27], a[232:235], a[88:91], v[24:27]
ds_read_b64_tr_b16 a[252:253], v217 offset:16384
v_mfma_f32_16x16x32_bf16 v[28:31], a[232:235], a[92:95], v[28:31]
ds_read_b64_tr_b16 a[254:255], v217 offset:16896
v_mfma_f32_16x16x32_bf16 v[32:35], a[232:235], a[96:99], v[32:35]
s_waitcnt lgkmcnt(8)
v_mfma_f32_16x16x32_bf16 v[36:39], a[236:239], a[88:91], v[36:39]
ds_read_b64_tr_b16 a[224:225], v214 offset:32768
v_mfma_f32_16x16x32_bf16 v[40:43], a[236:239], a[92:95], v[40:43]
ds_read_b64_tr_b16 a[226:227], v214 offset:33280
v_mfma_f32_16x16x32_bf16 v[44:47], a[236:239], a[96:99], v[44:47]
s_waitcnt lgkmcnt(8)
v_mfma_f32_16x16x32_bf16 v[48:51], a[240:243], a[100:103], v[48:51]
ds_read_b64_tr_b16 a[228:229], v215 offset:32768
v_mfma_f32_16x16x32_bf16 v[52:55], a[240:243], a[104:107], v[52:55]
ds_read_b64_tr_b16 a[230:231], v215 offset:33280
v_mfma_f32_16x16x32_bf16 v[56:59], a[240:243], a[108:111], v[56:59]
s_waitcnt lgkmcnt(8)
v_mfma_f32_16x16x32_bf16 v[12:15], a[244:247], a[100:103], v[12:15]
ds_read_b64_tr_b16 a[232:233], v216 offset:32768
v_mfma_f32_16x16x32_bf16 v[16:19], a[244:247], a[104:107], v[16:19]
ds_read_b64_tr_b16 a[234:235], v216 offset:33280
v_mfma_f32_16x16x32_bf16 v[20:23], a[244:247], a[108:111], v[20:23]
s_waitcnt lgkmcnt(8)
v_mfma_f32_16x16x32_bf16 v[24:27], a[248:251], a[100:103], v[24:27]
ds_read_b64_tr_b16 a[236:237], v217 offset:32768
v_mfma_f32_16x16x32_bf16 v[28:31], a[248:251], a[104:107], v[28:31]
ds_read_b64_tr_b16 a[238:239], v217 offset:33280
v_mfma_f32_16x16x32_bf16 v[32:35], a[248:251], a[108:111], v[32:35]
s_waitcnt lgkmcnt(8)
v_mfma_f32_16x16x32_bf16 v[36:39], a[252:255], a[100:103], v[36:39]
ds_read_b64_tr_b16 a[240:241], v214 offset:49152
v_mfma_f32_16x16x32_bf16 v[40:43], a[252:255], a[104:107], v[40:43]
ds_read_b64_tr_b16 a[242:243], v214 offset:49664
v_mfma_f32_16x16x32_bf16 v[44:47], a[252:255], a[108:111], v[44:47]
s_waitcnt vmcnt(9) lgkmcnt(8)
v_mfma_f32_16x16x32_bf16 v[48:51], a[224:227], a[136:139], v[48:51]
ds_read_b64_tr_b16 a[244:245], v215 offset:49152
v_mfma_f32_16x16x32_bf16 v[52:55], a[224:227], a[140:143], v[52:55]
ds_read_b64_tr_b16 a[246:247], v215 offset:49664
v_mfma_f32_16x16x32_bf16 v[56:59], a[224:227], a[152:155], v[56:59]
s_waitcnt lgkmcnt(8)
v_mfma_f32_16x16x32_bf16 v[12:15], a[228:231], a[136:139], v[12:15]
ds_read_b64_tr_b16 a[248:249], v216 offset:49152
v_mfma_f32_16x16x32_bf16 v[16:19], a[228:231], a[140:143], v[16:19]
ds_read_b64_tr_b16 a[250:251], v216 offset:49664
v_mfma_f32_16x16x32_bf16 v[20:23], a[228:231], a[152:155], v[20:23]
s_waitcnt lgkmcnt(8)
v_mfma_f32_16x16x32_bf16 v[24:27], a[232:235], a[136:139], v[24:27]
ds_read_b64_tr_b16 a[252:253], v217 offset:49152
v_mfma_f32_16x16x32_bf16 v[28:31], a[232:235], a[140:143], v[28:31]
ds_read_b64_tr_b16 a[254:255], v217 offset:49664
v_mfma_f32_16x16x32_bf16 v[32:35], a[232:235], a[152:155], v[32:35]
s_waitcnt lgkmcnt(8)
v_mfma_f32_16x16x32_bf16 v[36:39], a[236:239], a[136:139], v[36:39]
ds_read_b64_tr_b16 a[224:225], v218 offset:0
v_mfma_f32_16x16x32_bf16 v[40:43], a[236:239], a[140:143], v[40:43]
ds_read_b64_tr_b16 a[226:227], v218 offset:512
v_mfma_f32_16x16x32_bf16 v[44:47], a[236:239], a[152:155], v[44:47]
s_waitcnt vmcnt(6) lgkmcnt(8)
v_mfma_f32_16x16x32_bf16 v[48:51], a[240:243], a[156:159], v[48:51]
ds_read_b64_tr_b16 a[228:229], v219 offset:0
v_mfma_f32_16x16x32_bf16 v[52:55], a[240:243], a[168:171], v[52:55]
ds_read_b64_tr_b16 a[230:231], v219 offset:512
v_mfma_f32_16x16x32_bf16 v[56:59], a[240:243], a[172:175], v[56:59]
s_waitcnt lgkmcnt(8)
v_mfma_f32_16x16x32_bf16 v[12:15], a[244:247], a[156:159], v[12:15]
ds_read_b64_tr_b16 a[232:233], v227 offset:0
v_mfma_f32_16x16x32_bf16 v[16:19], a[244:247], a[168:171], v[16:19]
ds_read_b64_tr_b16 a[234:235], v227 offset:512
v_mfma_f32_16x16x32_bf16 v[20:23], a[244:247], a[172:175], v[20:23]
s_waitcnt lgkmcnt(8)
v_mfma_f32_16x16x32_bf16 v[24:27], a[248:251], a[156:159], v[24:27]
ds_read_b64_tr_b16 a[236:237], v228 offset:0
v_mfma_f32_16x16x32_bf16 v[28:31], a[248:251], a[168:171], v[28:31]
ds_read_b64_tr_b16 a[238:239], v228 offset:512
v_mfma_f32_16x16x32_bf16 v[32:35], a[248:251], a[172:175], v[32:35]
s_waitcnt lgkmcnt(8)
v_mfma_f32_16x16x32_bf16 v[36:39], a[252:255], a[156:159], v[36:39]
ds_read_b64_tr_b16 a[240:241], v218 offset:16384
v_mfma_f32_16x16x32_bf16 v[40:43], a[252:255], a[168:171], v[40:43]
ds_read_b64_tr_b16 a[242:243], v218 offset:16896
v_mfma_f32_16x16x32_bf16 v[44:47], a[252:255], a[172:175], v[44:47]
s_waitcnt vmcnt(3) lgkmcnt(8)
v_mfma_f32_16x16x32_bf16 v[48:51], a[224:227], a[184:187], v[48:51]
ds_read_b64_tr_b16 a[244:245], v219 offset:16384
v_mfma_f32_16x16x32_bf16 v[52:55], a[224:227], a[188:191], v[52:55]
ds_read_b64_tr_b16 a[246:247], v219 offset:16896
v_mfma_f32_16x16x32_bf16 v[56:59], a[224:227], a[200:203], v[56:59]
s_waitcnt lgkmcnt(8)
v_mfma_f32_16x16x32_bf16 v[12:15], a[228:231], a[184:187], v[12:15]
ds_read_b64_tr_b16 a[248:249], v227 offset:16384
v_mfma_f32_16x16x32_bf16 v[16:19], a[228:231], a[188:191], v[16:19]
L_pg21:
s_cbranch_execz L_ret_B
ds_read_b64_tr_b16 a[250:251], v227 offset:16896
v_mfma_f32_16x16x32_bf16 v[20:23], a[228:231], a[200:203], v[20:23]
s_waitcnt lgkmcnt(8)
v_mfma_f32_16x16x32_bf16 v[24:27], a[232:235], a[184:187], v[24:27]
ds_read_b64_tr_b16 a[252:253], v228 offset:16384
v_mfma_f32_16x16x32_bf16 v[28:31], a[232:235], a[188:191], v[28:31]
ds_read_b64_tr_b16 a[254:255], v228 offset:16896
v_mfma_f32_16x16x32_bf16 v[32:35], a[232:235], a[200:203], v[32:35]
s_waitcnt lgkmcnt(8)
v_mfma_f32_16x16x32_bf16 v[36:39], a[236:239], a[184:187], v[36:39]
v_mfma_f32_16x16x32_bf16 v[40:43], a[236:239], a[188:191], v[40:43]
v_mfma_f32_16x16x32_bf16 v[44:47], a[236:239], a[200:203], v[44:47]
s_waitcnt vmcnt(0) lgkmcnt(6)
v_mfma_f32_16x16x32_bf16 v[48:51], a[240:243], a[204:207], v[48:51]
v_mfma_f32_16x16x32_bf16 v[52:55], a[240:243], a[216:219], v[52:55]
v_mfma_f32_16x16x32_bf16 v[56:59], a[240:243], a[112:115], v[56:59]
s_waitcnt lgkmcnt(4)
v_mfma_f32_16x16x32_bf16 v[12:15], a[244:247], a[204:207], v[12:15]
v_mfma_f32_16x16x32_bf16 v[16:19], a[244:247], a[216:219], v[16:19]
v_mfma_f32_16x16x32_bf16 v[20:23], a[244:247], a[112:115], v[20:23]
s_waitcnt lgkmcnt(2)
v_mfma_f32_16x16x32_bf16 v[24:27], a[248:251], a[204:207], v[24:27]
v_mfma_f32_16x16x32_bf16 v[28:31], a[248:251], a[216:219], v[28:31]
v_mfma_f32_16x16x32_bf16 v[32:35], a[248:251], a[112:115], v[32:35]
s_waitcnt lgkmcnt(0)
v_mfma_f32_16x16x32_bf16 v[36:39], a[252:255], a[204:207], v[36:39]
v_mfma_f32_16x16x32_bf16 v[40:43], a[252:255], a[216:219], v[40:43]
v_mfma_f32_16x16x32_bf16 v[44:47], a[252:255], a[112:115], v[44:47]
v_lshlrev_b32 v64, 16, v132
v_and_b32 v65, 0xffff0000, v132
v_lshlrev_b32 v66, 16, v133
v_and_b32 v67, 0xffff0000, v133
v_lshlrev_b32 v68, 16, v134
v_and_b32 v69, 0xffff0000, v134
v_lshlrev_b32 v70, 16, v135
v_and_b32 v71, 0xffff0000, v135
ds_write_b128 v229, v[12:15] offset:0
ds_write_b128 v229, v[16:19] offset:1024
ds_write_b128 v229, v[20:23] offset:2048
ds_write_b128 v229, v[24:27] offset:16384
ds_write_b128 v229, v[28:31] offset:17408
ds_write_b128 v229, v[32:35] offset:18432
ds_write_b128 v229, v[36:39] offset:32768
ds_write_b128 v229, v[40:43] offset:33792
ds_write_b128 v229, v[44:47] offset:34816
v_lshlrev_b32 v72, 16, v136
v_and_b32 v73, 0xffff0000, v136
v_lshlrev_b32 v74, 16, v137
v_and_b32 v75, 0xffff0000, v137
v_lshlrev_b32 v76, 16, v138
v_and_b32 v77, 0xffff0000, v138
v_lshlrev_b32 v78, 16, v139
v_and_b32 v79, 0xffff0000, v139
s_waitcnt lgkmcnt(0)
s_barrier
ds_read_b128 v[12:15], v231 offset:0
ds_read_b128 v[24:27], v232 offset:16384
ds_read_b128 v[36:39], v233 offset:32768
ds_read_b128 v[16:19], v231 offset:1024
ds_read_b128 v[28:31], v232 offset:17408
ds_read_b128 v[40:43], v233 offset:33792
ds_read_b128 v[20:23], v231 offset:2048
ds_read_b128 v[32:35], v232 offset:18432
ds_read_b128 v[44:47], v233 offset:34816
s_waitcnt lgkmcnt(8)
v_pk_add_f32 v[48:49], v[48:49], v[12:13]
v_pk_add_f32 v[50:51], v[50:51], v[14:15]
s_waitcnt lgkmcnt(6)
v_pk_add_f32 v[24:25], v[24:25], v[36:37]
v_pk_add_f32 v[26:27], v[26:27], v[38:39]
v_pk_add_f32 v[48:49], v[48:49], v[24:25]
v_pk_add_f32 v[50:51], v[50:51], v[26:27]
s_waitcnt lgkmcnt(5)
v_pk_add_f32 v[52:53], v[52:53], v[16:17]
v_pk_add_f32 v[54:55], v[54:55], v[18:19]
s_waitcnt lgkmcnt(3)
v_pk_add_f32 v[28:29], v[28:29], v[40:41]
v_pk_add_f32 v[30:31], v[30:31], v[42:43]
v_pk_add_f32 v[52:53], v[52:53], v[28:29]
v_pk_add_f32 v[54:55], v[54:55], v[30:31]
s_nop 0
v_permlane16_swap_b32 v48, v52
v_permlane16_swap_b32 v49, v53
v_permlane16_swap_b32 v50, v54
v_permlane16_swap_b32 v51, v55
v_pk_fma_f32 v[64:65], v[140:141], v[48:49], v[64:65]
v_pk_fma_f32 v[66:67], v[142:143], v[50:51], v[66:67]
v_pk_fma_f32 v[68:69], v[144:145], v[52:53], v[68:69]
v_pk_fma_f32 v[70:71], v[146:147], v[54:55], v[70:71]
v_cvt_pk_bf16_f32 v64, v64, v65
v_cvt_pk_bf16_f32 v65, v66, v67
v_cvt_pk_bf16_f32 v66, v68, v69
v_cvt_pk_bf16_f32 v67, v70, v71
buffer_store_dwordx4 v[64:67], v234, s[16:19], s92 offen
s_waitcnt lgkmcnt(2)
v_pk_add_f32 v[56:57], v[56:57], v[20:21]
v_pk_add_f32 v[58:59], v[58:59], v[22:23]
s_waitcnt lgkmcnt(0)
v_pk_add_f32 v[32:33], v[32:33], v[44:45]
v_pk_add_f32 v[34:35], v[34:35], v[46:47]
v_pk_add_f32 v[56:57], v[56:57], v[32:33]
v_pk_add_f32 v[58:59], v[58:59], v[34:35]
s_nop 0
v_permlane16_swap_b32 v8, v56
v_permlane16_swap_b32 v9, v57
v_permlane16_swap_b32 v10, v58
v_permlane16_swap_b32 v11, v59
v_pk_fma_f32 v[72:73], v[140:141], v[8:9], v[72:73]
v_pk_fma_f32 v[74:75], v[142:143], v[10:11], v[74:75]
v_pk_fma_f32 v[76:77], v[144:145], v[56:57], v[76:77]
v_pk_fma_f32 v[78:79], v[146:147], v[58:59], v[78:79]
v_cvt_pk_bf16_f32 v72, v72, v73
v_cvt_pk_bf16_f32 v73, v74, v75
v_cvt_pk_bf16_f32 v74, v76, v77
v_cvt_pk_bf16_f32 v75, v78, v79
buffer_store_dwordx4 v[72:75], v235, s[16:19], s40 offen
L_tail_fin:
L_main_end:
s_endpgm
L_idle7:
v_mov_b32 v241, s51
s_waitcnt vmcnt(0) lgkmcnt(0)
s_barrier
buffer_store_dword v241, v240, s[24:27], s50 offen sc1
s_branch L_tail_fin
L_slow_o1:
s_mov_b32 s37, 0x40000
L_poll_o1:
buffer_load_dword v239, v236, s[24:27], 0 offen sc1
s_waitcnt vmcnt(0)
v_subrev_u32 v239, s51, v239
v_cmp_lt_u32 vcc, 2, v239
s_nop 4
s_cbranch_vccz L_back_o1
s_sleep 4
s_sub_u32 s37, s37, 1
s_cbranch_scc0 L_poll_o1
s_branch L_back_o1
L_slow_o2:
s_mov_b32 s37, 0x40000
L_poll_o2:
buffer_load_dword v239, v236, s[24:27], 0 offen sc1
s_waitcnt vmcnt(0)
v_subrev_u32 v239, s51, v239
v_cmp_lt_u32 vcc, 1, v239
s_nop 4
s_cbranch_vccz L_back_o2
s_sleep 4
s_sub_u32 s37, s37, 1
s_cbranch_scc0 L_poll_o2
s_branch L_back_o2
L_slow_o3:
s_mov_b32 s37, 0x40000
L_poll_o3:
buffer_load_dword v239, v236, s[24:27], 0 offen sc1
s_waitcnt vmcnt(0)
v_cmp_ne_u32 vcc, s51, v239
s_nop 4
s_cbranch_vccz L_back_o3
s_sleep 4
s_sub_u32 s37, s37, 1
s_cbranch_scc0 L_poll_o3
s_branch L_back_o3
L_slow_pa:
s_mov_b32 s37, 0x40000
L_poll_pa:
buffer_load_dword v239, v236, s[24:27], 0 offen sc1
s_waitcnt vmcnt(0)
v_subrev_u32 v239, s51, v239
v_cmp_lt_u32 vcc, 1, v239
s_nop 4
s_cbranch_vccz L_back_pa
s_sleep 1
s_sub_u32 s37, s37, 1
s_cbranch_scc0 L_poll_pa
s_branch L_back_pa
L_slow_hb:
s_mov_b32 s37, 0x40000
L_poll_hb:
buffer_load_dword v239, v255, s[24:27], 0 offen sc1
s_waitcnt vmcnt(0)
v_cmp_ne_u32 vcc, s51, v239
s_nop 4
s_cbranch_vccz L_back_hb
s_sleep 4
s_sub_u32 s37, s37, 1
s_cbranch_scc0 L_poll_hb
s_branch L_back_hb
L_slow_aa:
s_mov_b32 s37, 0x40000
L_poll_aa:
buffer_load_dword v239, v236, s[24:27], 0 offen sc1
s_waitcnt vmcnt(0)
v_subrev_u32 v239, s51, v239
v_cmp_lt_u32 vcc, 1, v239
s_nop 4
s_cbranch_vccz L_back_aa
s_sleep 4
s_sub_u32 s37, s37, 1
s_cbranch_scc0 L_poll_aa
s_branch L_back_aa
L_slow_ab:
s_mov_b32 s37, 0x40000
L_poll_ab:
buffer_load_dword v239, v236, s[24:27], 0 offen sc1
s_waitcnt vmcnt(0)
v_cmp_ne_u32 vcc, s51, v239
s_nop 4
s_cbranch_vccz L_back_ab
s_sleep 4
s_sub_u32 s37, s37, 1
s_cbranch_scc0 L_poll_ab
s_branch L_back_ab
L_slow_m:
s_mov_b32 s37, 0x40000
L_poll_m:
buffer_load_dword v239, v220, s[24:27], 0 offen sc1
s_waitcnt vmcnt(0)
v_subrev_u32 v239, s51, v239
v_cmp_lt_u32 vcc, 2, v239
s_nop 4
s_cbranch_vccz L_back_m
s_sleep 4
s_sub_u32 s37, s37, 1
s_cbranch_scc0 L_poll_m
s_branch L_back_m
L_slow_ha:
s_mov_b32 s37, 0x40000
L_poll_ha:
buffer_load_dword v239, v255, s[24:27], 0 offen sc1
s_waitcnt vmcnt(0)
v_subrev_u32 v239, s51, v239
v_cmp_lt_u32 vcc, 1, v239
s_nop 4
s_cbranch_vccz L_back_ha
s_sleep 4
s_sub_u32 s37, s37, 1
s_cbranch_scc0 L_poll_ha
s_branch L_back_ha
L_att_redo:
s_waitcnt vmcnt(0) lgkmcnt(0)
s_nop 15
s_barrier
s_mov_b32 s35, -1
v_mov_b32 v192, 0xff800000
v_mov_b32 v196, 0xff800000
v_mov_b32 v200, 0xff800000
v_mov_b32 v204, 0xff800000
v_bfe_u32 v248, v238, 8, 1
v_lshrrev_b32 v245, 9, v238
v_lshl_add_u32 v248, v248, 1, v245
v_bfe_u32 v245, v238, 4, 4
v_mul_u32_u24 v245, 384, v245
v_lshl_add_u32 v245, v248, 4, v245
v_add_u32 v248, 6144, v245
s_mov_b32 s48, 184320
v_add_u32 v228, 4294930432, v228
v_add_u32 v229, 4294930432, v229
v_xor_b32 v230, 64, v230
v_xor_b32 v223, 64, v223
s_add_u32 m0, s28, 77824
s_mov_b32 s30, 12288
buffer_load_dwordx4 v234, s[12:15], s30 offen offset:0 nt lds
buffer_load_dwordx4 v235, s[12:15], s30 offen offset:1024 nt lds
buffer_load_dwordx4 v236, s[12:15], s30 offen offset:2048 nt lds
s_add_u32 m0, s28, 90112
s_mov_b32 s30, 24576
buffer_load_dwordx4 v234, s[12:15], s30 offen offset:0 nt lds
buffer_load_dwordx4 v235, s[12:15], s30 offen offset:1024 nt lds
buffer_load_dwordx4 v236, s[12:15], s30 offen offset:2048 nt lds
s_add_u32 m0, s28, 102400
s_mov_b32 s30, 36864
buffer_load_dwordx4 v234, s[12:15], s30 offen offset:0 nt lds
buffer_load_dwordx4 v235, s[12:15], s30 offen offset:1024 nt lds
buffer_load_dwordx4 v236, s[12:15], s30 offen offset:2048 nt lds
s_add_u32 m0, s28, 114688
s_mov_b32 s30, 49152
buffer_load_dwordx4 v234, s[12:15], s30 offen offset:0 nt lds
buffer_load_dwordx4 v235, s[12:15], s30 offen offset:1024 nt lds
buffer_load_dwordx4 v236, s[12:15], s30 offen offset:2048 nt lds
s_add_u32 m0, s28, 126976
s_mov_b32 s30, 61440
buffer_load_dwordx4 v234, s[12:15], s30 offen offset:0 nt lds
buffer_load_dwordx4 v235, s[12:15], s30 offen offset:1024 nt lds
buffer_load_dwordx4 v236, s[12:15], s30 offen offset:2048 nt lds
s_add_u32 m0, s28, 139264
s_mov_b32 s30, 73728
buffer_load_dwordx4 v234, s[12:15], s30 offen offset:0 nt lds
buffer_load_dwordx4 v235, s[12:15], s30 offen offset:1024 nt lds
L_att_redo_loop:
buffer_load_dwordx4 v[0:3], v245, s[12:15], s48 offen offset:0
buffer_load_dwordx4 v[4:7], v248, s[12:15], s48 offen offset:0
buffer_load_dwordx4 v[8:11], v245, s[12:15], s48 offen offset:64
buffer_load_dwordx4 v[12:15], v248, s[12:15], s48 offen offset:64
buffer_load_dwordx4 v[16:19], v245, s[12:15], s48 offen offset:128
buffer_load_dwordx4 v[20:23], v248, s[12:15], s48 offen offset:128
buffer_load_dwordx4 v[24:27], v245, s[12:15], s48 offen offset:192
buffer_load_dwordx4 v[28:31], v248, s[12:15], s48 offen offset:192
buffer_load_dwordx4 v[32:35], v245, s[12:15], s48 offen offset:256
buffer_load_dwordx4 v[36:39], v248, s[12:15], s48 offen offset:256
buffer_load_dwordx4 v[40:43], v245, s[12:15], s48 offen offset:320
buffer_load_dwordx4 v[44:47], v248, s[12:15], s48 offen offset:320
s_waitcnt vmcnt(0)
v_mfma_f32_16x16x32_bf16 v[128:131], v[0:3], a[128:131], 0
v_mfma_f32_16x16x32_bf16 v[136:139], v[0:3], a[132:135], 0
v_mfma_f32_16x16x32_bf16 v[144:147], v[0:3], a[136:139], 0
v_mfma_f32_16x16x32_bf16 v[152:155], v[0:3], a[140:143], 0
v_mfma_f32_16x16x32_bf16 v[132:135], v[4:7], a[128:131], 0
v_mfma_f32_16x16x32_bf16 v[140:143], v[4:7], a[132:135], 0
v_mfma_f32_16x16x32_bf16 v[148:151], v[4:7], a[136:139], 0
v_mfma_f32_16x16x32_bf16 v[156:159], v[4:7], a[140:143], 0
v_mfma_f32_16x16x32_bf16 v[128:131], v[8:11], a[144:147], v[128:131]
v_mfma_f32_16x16x32_bf16 v[136:139], v[8:11], a[148:151], v[136:139]
v_mfma_f32_16x16x32_bf16 v[144:147], v[8:11], a[152:155], v[144:147]
v_mfma_f32_16x16x32_bf16 v[152:155], v[8:11], a[156:159], v[152:155]
v_mfma_f32_16x16x32_bf16 v[132:135], v[12:15], a[144:147], v[132:135]
v_mfma_f32_16x16x32_bf16 v[140:143], v[12:15], a[148:151], v[140:143]
v_mfma_f32_16x16x32_bf16 v[148:151], v[12:15], a[152:155], v[148:151]
v_mfma_f32_16x16x32_bf16 v[156:159], v[12:15], a[156:159], v[156:159]
v_mfma_f32_16x16x32_bf16 v[128:131], v[16:19], a[160:163], v[128:131]
v_mfma_f32_16x16x32_bf16 v[136:139], v[16:19], a[164:167], v[136:139]
v_mfma_f32_16x16x32_bf16 v[144:147], v[16:19], a[168:171], v[144:147]
v_mfma_f32_16x16x32_bf16 v[152:155], v[16:19], a[172:175], v[152:155]
v_mfma_f32_16x16x32_bf16 v[132:135], v[20:23], a[160:163], v[132:135]
v_mfma_f32_16x16x32_bf16 v[140:143], v[20:23], a[164:167], v[140:143]
v_mfma_f32_16x16x32_bf16 v[148:151], v[20:23], a[168:171], v[148:151]
v_mfma_f32_16x16x32_bf16 v[156:159], v[20:23], a[172:175], v[156:159]
v_mfma_f32_16x16x32_bf16 v[128:131], v[24:27], a[176:179], v[128:131]
v_mfma_f32_16x16x32_bf16 v[136:139], v[24:27], a[180:183], v[136:139]
v_mfma_f32_16x16x32_bf16 v[144:147], v[24:27], a[184:187], v[144:147]
v_mfma_f32_16x16x32_bf16 v[152:155], v[24:27], a[188:191], v[152:155]
v_mfma_f32_16x16x32_bf16 v[132:135], v[28:31], a[176:179], v[132:135]
v_mfma_f32_16x16x32_bf16 v[140:143], v[28:31], a[180:183], v[140:143]
v_mfma_f32_16x16x32_bf16 v[148:151], v[28:31], a[184:187], v[148:151]
v_mfma_f32_16x16x32_bf16 v[156:159], v[28:31], a[188:191], v[156:159]
v_mfma_f32_16x16x32_bf16 v[128:131], v[32:35], a[192:195], v[128:131]
v_mfma_f32_16x16x32_bf16 v[136:139], v[32:35], a[196:199], v[136:139]
v_mfma_f32_16x16x32_bf16 v[144:147], v[32:35], a[200:203], v[144:147]
v_mfma_f32_16x16x32_bf16 v[152:155], v[32:35], a[204:207], v[152:155]
v_mfma_f32_16x16x32_bf16 v[132:135], v[36:39], a[192:195], v[132:135]
v_mfma_f32_16x16x32_bf16 v[140:143], v[36:39], a[196:199], v[140:143]
v_mfma_f32_16x16x32_bf16 v[148:151], v[36:39], a[200:203], v[148:151]
v_mfma_f32_16x16x32_bf16 v[156:159], v[36:39], a[204:207], v[156:159]
v_mfma_f32_16x16x32_bf16 v[128:131], v[40:43], a[208:211], v[128:131]
v_mfma_f32_16x16x32_bf16 v[136:139], v[40:43], a[212:215], v[136:139]
v_mfma_f32_16x16x32_bf16 v[144:147], v[40:43], a[216:219], v[144:147]
v_mfma_f32_16x16x32_bf16 v[152:155], v[40:43], a[220:223], v[152:155]
v_mfma_f32_16x16x32_bf16 v[132:135], v[44:47], a[208:211], v[132:135]
v_mfma_f32_16x16x32_bf16 v[140:143], v[44:47], a[212:215], v[140:143]
v_mfma_f32_16x16x32_bf16 v[148:151], v[44:47], a[216:219], v[148:151]
v_mfma_f32_16x16x32_bf16 v[156:159], v[44:47], a[220:223], v[156:159]
s_nop 15
v_max3_f32 v192, v192, v128, v129
v_max3_f32 v192, v192, v130, v131
v_max3_f32 v192, v192, v132, v133
v_max3_f32 v192, v192, v134, v135
v_max3_f32 v196, v196, v136, v137
v_max3_f32 v196, v196, v138, v139
v_max3_f32 v196, v196, v140, v141
v_max3_f32 v196, v196, v142, v143
v_max3_f32 v200, v200, v144, v145
v_max3_f32 v200, v200, v146, v147
v_max3_f32 v200, v200, v148, v149
v_max3_f32 v200, v200, v150, v151
v_max3_f32 v204, v204, v152, v153
v_max3_f32 v204, v204, v154, v155
v_max3_f32 v204, v204, v156, v157
v_max3_f32 v204, v204, v158, v159
s_sub_u32 s48, s48, 12288
s_cbranch_scc0 L_att_redo_loop
s_barrier
ds_read_b128 a[240:243], v228 offset:12288
ds_read_b128 a[244:247], v229 offset:12288
ds_read_b128 a[248:251], v228 offset:18432
ds_read_b128 a[252:255], v229 offset:18432
s_waitcnt vmcnt(0) lgkmcnt(0)
s_nop 7
s_branch L_att_t1
L_code_end:
.section .rodata,"a"
.p2align 6
.amdhsa_kernel main_kernel
  .amdhsa_next_free_vgpr 512
  .amdhsa_next_free_sgpr 102
  .amdhsa_accum_offset 256
  .amdhsa_group_segment_fixed_size 0
  .amdhsa_kernarg_size 112
  .amdhsa_user_sgpr_count 2
  .amdhsa_user_sgpr_kernarg_segment_ptr 1
  .amdhsa_system_sgpr_workgroup_id_x 1
.end_amdhsa_kernel
```
